```python
import torch

def _softmax(x, axis=-1):
    return torch.softmax(x, dim=axis)

def _gelu(x):
    return torch.nn.functional.gelu(x, approximate='tanh')

def _silu(x):
    return torch.nn.functional.silu(x)

def _sigmoid(x):
    return torch.sigmoid(x)

def _layernorm(x, axis=-1, eps=1e-05):
    m = x.mean(dim=axis, keepdim=True)
    v = x.var(dim=axis, keepdim=True, unbiased=False)
    return (x - m) / torch.sqrt(v + eps)

def _scatter_add(tgt, idx, src, axis=0):
    return tgt.clone().index_add_(axis, idx, src)

def _segment_sum(src, seg, n):
    out = torch.zeros((n,) + src.shape[1:], dtype=src.dtype)
    return out.index_add_(0, seg, src)

def _pad(x, pw):
    flat = tuple((v for pair in reversed(pw) for v in pair))
    return torch.nn.functional.pad(x, flat)
kernel_name = 'concat_heads__softmax_full_mha__memory_aug_recurrent_mem_tr__prompt'

def setup_inputs():

    _w = lambda a: (lambda t: t.to(torch.bfloat16) if t.is_floating_point() else t)(torch.as_tensor(a))

    def _A_setup():
        B, S, D = (1, 2048, 640)
        return {'x': _w((lambda *s: torch.randn(*s, dtype=torch.bfloat16) * 0.2)(B, S, D)), 'wqkv': _w((lambda *s: torch.randn(*s, dtype=torch.bfloat16) * 0.2)(D, 3 * D)), 'wo': _w((lambda *s: torch.randn(*s, dtype=torch.bfloat16) * 0.05)(D, D))}
    _A_in = _A_setup()

    def _B_setup():
        B, S, Dm = (1, 2048, 640)
        H, Dh = (32, 128)
        M, seg = (8, 32)
        seg = min(seg, S)
        S = S // seg * seg
        return {'x': _w((lambda *s: torch.randn(*s, dtype=torch.bfloat16) * 0.05)(B, S, Dm)), 'mem0': _w((lambda *s: torch.randn(*s, dtype=torch.bfloat16) * 0.8)(B, M, Dm)), 'Wq': _w((lambda *s: torch.randn(*s, dtype=torch.bfloat16) * 1.6)(Dm, H, Dh) * Dm ** (-0.5)), 'Wk': _w((lambda *s: torch.randn(*s, dtype=torch.bfloat16) * 1.6)(Dm, H, Dh) * Dm ** (-0.5)), 'Wv': _w((lambda *s: torch.randn(*s, dtype=torch.bfloat16) * 0.8)(Dm, H, Dh) * Dm ** (-0.5)), 'Wo': _w((lambda *s: torch.randn(*s, dtype=torch.bfloat16) * 0.8)(H, Dh, Dm) * (H * Dh) ** (-0.5)), 'seg_len': seg}
    _B_in = _B_setup()
    return {'A_x': _A_in['x'], 'A_wqkv': _A_in['wqkv'], 'A_wo': _A_in['wo'], 'B_x': _B_in['x'], 'B_mem0': _B_in['mem0'], 'B_Wq': _B_in['Wq'], 'B_Wk': _B_in['Wk'], 'B_Wv': _B_in['Wv'], 'B_Wo': _B_in['Wo'], 'B_seg_len': _B_in['seg_len']}

def reference(A_x, A_wqkv, A_wo, B_x, B_mem0, B_Wq, B_Wk, B_Wv, B_Wo, B_seg_len):

    def _A_ref(x, wqkv, wo):
        B, S, D = x.shape
        H = 32
        Dh = D // H
        qkv = (lambda x, *d: x.permute(*d))((x @ wqkv).reshape(B, S, 3, H, Dh), 2, 0, 3, 1, 4)
        q, k, v = (qkv[0], qkv[1], qkv[2])
        scale = Dh ** (-0.5)
        scores = torch.einsum('bhqd,bhkd->bhqk', q, k) * scale
        p = _softmax(scores, axis=-1)
        o = torch.einsum('bhqk,bhkd->bhqd', p, v)
        return (lambda x, *d: x.permute(*d))(o, 0, 2, 1, 3).reshape(B, S, D) @ wo

    def _B_ref(x, mem0, Wq, Wk, Wv, Wo, seg_len):
        B, S, Dm = x.shape
        H, Dh = (Wq.shape[1], Wq.shape[2])
        M = mem0.shape[1]
        scale = Dh ** (-0.5)
        n_seg = S // seg_len
        L = M + seg_len
        idx = torch.arange(L)
        mask = (idx[:, None] < M) | (idx[:, None] >= idx[None, :])
        mem = mem0
        outs = []
        for s in range(n_seg):
            xs = x[:, s * seg_len:(s + 1) * seg_len, :].clone()
            h = torch.concatenate([mem, xs], axis=1)
            q = torch.einsum('btd,dhe->bhte', h, Wq)
            k = torch.einsum('btd,dhe->bhte', h, Wk)
            v = torch.einsum('btd,dhe->bhte', h, Wv)
            scores = torch.einsum('bhqe,bhke->bhqk', q, k) * scale
            scores = torch.where(mask[None, None], scores, -1000000000.0)
            p = _softmax(scores, axis=-1)
            o = torch.einsum('bhqk,bhke->bhqe', p, v)
            o = torch.einsum('bhte,hed->btd', o, Wo)
            mem = o[:, :M, :].clone()
            outs.append(o[:, M:, :])
        return torch.concatenate(outs, axis=1)
    a = _A_ref(A_x, A_wqkv, A_wo)
    b = _B_ref(B_x, B_mem0, B_Wq, B_Wk, B_Wv, B_Wo, B_seg_len)
    return torch.concatenate([a, b], axis=-1)
```

```asm
; @launch grid=(256,1,1) block=(256,1,1) lds=163840
.amdgcn_target "amdgcn-amd-amdhsa--gfx950"
.text
.globl concat_heads__softmax_full_mha__memory_aug_recurrent_mem_tr__prompt_kernel
.p2align 8
.type concat_heads__softmax_full_mha__memory_aug_recurrent_mem_tr__prompt_kernel,@function
concat_heads__softmax_full_mha__memory_aug_recurrent_mem_tr__prompt_kernel:
  s_cmp_ge_u32 s2, 256
  s_cbranch_scc1 L_exit
  s_mov_b32 s61, s2
  s_load_dwordx16 s[8:23], s[0:1], 0
  s_load_dwordx8 s[24:31], s[0:1], 64
  s_load_dwordx2 s[32:33], s[0:1], 96
  v_lshrrev_b32 v2, 6, v0
  v_and_b32 v1, 63, v0
  v_readfirstlane_b32 s57, v2
  s_mov_b32 s56, 200000
  s_waitcnt lgkmcnt(0)
  s_mov_b32 s36, s32
  s_mov_b32 s37, s33
  s_mov_b32 s38, 0x10000000
  s_mov_b32 s39, 0x20000
  s_mov_b32 s40, s28
  s_mov_b32 s41, s29
  s_mov_b32 s42, 0x500000
  s_mov_b32 s43, 0x20000
  s_mov_b32 s52, s30
  s_mov_b32 s53, s31
  s_mov_b32 s54, 0x100
  s_mov_b32 s55, 0x20000
  v_mov_b32 v4, -1
  v_mov_b32 v5, -1
  v_mov_b32 v6, -1
  v_mov_b32 v7, -1
  v_mov_b32 v8, 0
  v_mov_b32 v9, 0
  v_mov_b32 v10, 0
  v_mov_b32 v11, 0
  s_lshl_b32 s62, s57, 10
  v_lshlrev_b32 v2, 4, v1
  v_add_u32 v2, s62, v2
  s_mul_i32 s62, s61, 15360
  s_add_u32 s62, s62, 65536
  s_add_u32 s63, s62, 4096
  buffer_store_dwordx4 v[4:7], v2, s[36:39], s62 offen sc1
  buffer_store_dwordx4 v[4:7], v2, s[36:39], s63 offen sc1
  s_add_u32 s62, s62, 8192
  s_add_u32 s63, s63, 8192
  buffer_store_dwordx4 v[4:7], v2, s[36:39], s62 offen sc1
  v_cmp_gt_u32 vcc, 3072, v2
  s_and_saveexec_b64 s[64:65], vcc
  buffer_store_dwordx4 v[4:7], v2, s[36:39], s63 offen sc1
  s_mov_b64 exec, s[64:65]
  v_cmp_gt_u32 vcc, 128, v2
  s_and_saveexec_b64 s[64:65], vcc
  s_lshl_b32 s62, s61, 7
  buffer_store_dwordx4 v[8:11], v2, s[36:39], s62 offen sc1
  s_mov_b64 exec, s[64:65]
  s_and_b32 s64, s61, 7
  s_lshr_b32 s59, s61, 3
  s_sub_u32 s58, s64, 2
  s_cmp_ge_u32 s64, 2
  s_cbranch_scc1 L_bulk
  s_lshl_b32 s64, s64, 5
  s_add_u32 s64, s64, s59
  s_branch L_chain
L_bulk:
  s_mov_b32 s60, -1
L_next:
  s_add_u32 s60, s60, 1
  s_lshr_b32 s84, s59, 4
  s_and_b32 s85, s59, 15
  s_mov_b32 s88, 0
  s_mov_b32 s89, 1
  s_lshl_b32 s82, s58, 4
  s_add_u32 s82, s82, s60
  s_cmp_eq_u32 s82, 0
  s_cbranch_scc1 L_s0_0
  s_cmp_eq_u32 s82, 1
  s_cbranch_scc1 L_s0_1
  s_cmp_eq_u32 s82, 2
  s_cbranch_scc1 L_s0_2
  s_cmp_eq_u32 s82, 3
  s_cbranch_scc1 L_s0_3
  s_cmp_eq_u32 s82, 4
  s_cbranch_scc1 L_s0_4
  s_cmp_eq_u32 s82, 5
  s_cbranch_scc1 L_s0_5
  s_cmp_eq_u32 s82, 6
  s_cbranch_scc1 L_s0_6
  s_cmp_eq_u32 s82, 7
  s_cbranch_scc1 L_s0_7
  s_cmp_eq_u32 s82, 8
  s_cbranch_scc1 L_s0_8
  s_cmp_eq_u32 s82, 9
  s_cbranch_scc1 L_s0_9
  s_cmp_eq_u32 s82, 16
  s_cbranch_scc1 L_s1_0
  s_cmp_eq_u32 s82, 17
  s_cbranch_scc1 L_s1_1
  s_cmp_eq_u32 s82, 18
  s_cbranch_scc1 L_s1_2
  s_cmp_eq_u32 s82, 19
  s_cbranch_scc1 L_s1_3
  s_cmp_eq_u32 s82, 20
  s_cbranch_scc1 L_s1_4
  s_cmp_eq_u32 s82, 21
  s_cbranch_scc1 L_s1_5
  s_cmp_eq_u32 s82, 22
  s_cbranch_scc1 L_s1_6
  s_cmp_eq_u32 s82, 23
  s_cbranch_scc1 L_s1_7
  s_cmp_eq_u32 s82, 24
  s_cbranch_scc1 L_s1_8
  s_cmp_eq_u32 s82, 32
  s_cbranch_scc1 L_s2_0
  s_cmp_eq_u32 s82, 33
  s_cbranch_scc1 L_s2_1
  s_cmp_eq_u32 s82, 34
  s_cbranch_scc1 L_s2_2
  s_cmp_eq_u32 s82, 35
  s_cbranch_scc1 L_s2_3
  s_cmp_eq_u32 s82, 36
  s_cbranch_scc1 L_s2_4
  s_cmp_eq_u32 s82, 37
  s_cbranch_scc1 L_s2_5
  s_cmp_eq_u32 s82, 38
  s_cbranch_scc1 L_s2_6
  s_cmp_eq_u32 s82, 39
  s_cbranch_scc1 L_s2_7
  s_cmp_eq_u32 s82, 40
  s_cbranch_scc1 L_s2_8
  s_cmp_eq_u32 s82, 48
  s_cbranch_scc1 L_s3_0
  s_cmp_eq_u32 s82, 49
  s_cbranch_scc1 L_s3_1
  s_cmp_eq_u32 s82, 50
  s_cbranch_scc1 L_s3_2
  s_cmp_eq_u32 s82, 51
  s_cbranch_scc1 L_s3_3
  s_cmp_eq_u32 s82, 52
  s_cbranch_scc1 L_s3_4
  s_cmp_eq_u32 s82, 53
  s_cbranch_scc1 L_s3_5
  s_cmp_eq_u32 s82, 54
  s_cbranch_scc1 L_s3_6
  s_cmp_eq_u32 s82, 55
  s_cbranch_scc1 L_s3_7
  s_cmp_eq_u32 s82, 56
  s_cbranch_scc1 L_s3_8
  s_cmp_eq_u32 s82, 64
  s_cbranch_scc1 L_s4_0
  s_cmp_eq_u32 s82, 65
  s_cbranch_scc1 L_s4_1
  s_cmp_eq_u32 s82, 66
  s_cbranch_scc1 L_s4_2
  s_cmp_eq_u32 s82, 67
  s_cbranch_scc1 L_s4_3
  s_cmp_eq_u32 s82, 68
  s_cbranch_scc1 L_s4_4
  s_cmp_eq_u32 s82, 69
  s_cbranch_scc1 L_s4_5
  s_cmp_eq_u32 s82, 70
  s_cbranch_scc1 L_s4_6
  s_cmp_eq_u32 s82, 71
  s_cbranch_scc1 L_s4_7
  s_cmp_eq_u32 s82, 72
  s_cbranch_scc1 L_s4_8
  s_cmp_eq_u32 s82, 80
  s_cbranch_scc1 L_s5_0
  s_cmp_eq_u32 s82, 81
  s_cbranch_scc1 L_s5_1
  s_cmp_eq_u32 s82, 82
  s_cbranch_scc1 L_s5_2
  s_cmp_eq_u32 s82, 83
  s_cbranch_scc1 L_s5_3
  s_cmp_eq_u32 s82, 84
  s_cbranch_scc1 L_s5_4
  s_cmp_eq_u32 s82, 85
  s_cbranch_scc1 L_s5_5
  s_cmp_eq_u32 s82, 86
  s_cbranch_scc1 L_s5_6
  s_cmp_eq_u32 s82, 87
  s_cbranch_scc1 L_s5_7
  s_cmp_eq_u32 s82, 88
  s_cbranch_scc1 L_s5_8
  s_branch L_exit
L_s0_0:
  s_mov_b32 s80, 0
  s_add_u32 s81, s85, 0
  s_add_u32 s88, s84, 1
  s_branch L_j1
L_s0_1:
  s_add_u32 s80, s84, 3
  s_add_u32 s81, s85, 0
  s_branch L_j1
L_s0_2:
  s_add_u32 s80, s84, 5
  s_add_u32 s81, s85, 0
  s_branch L_j1
L_s0_3:
  s_add_u32 s80, s84, 6
  s_mov_b32 s81, s85
  s_branch L_j2
L_s0_4:
  s_mov_b32 s80, 24
  s_branch L_j4
L_s0_5:
  s_branch L_j5
L_s0_6:
  s_branch L_j6
L_s0_7:
  s_branch L_j7
L_s0_8:
  s_branch L_fast
L_s0_9:
  s_branch L_fast2
L_s1_0:
  s_mov_b32 s80, 0
  s_add_u32 s81, s85, 16
  s_add_u32 s88, s84, 1
  s_branch L_j1
L_s1_1:
  s_add_u32 s80, s84, 3
  s_add_u32 s81, s85, 16
  s_branch L_j1
L_s1_2:
  s_add_u32 s80, s84, 5
  s_add_u32 s81, s85, 16
  s_branch L_j1
L_s1_3:
  s_mov_b32 s80, 28
  s_branch L_j4
L_s1_4:
  s_branch L_j5
L_s1_5:
  s_branch L_j6
L_s1_6:
  s_branch L_j7
L_s1_7:
  s_branch L_fast
L_s1_8:
  s_branch L_fast2
L_s2_0:
  s_add_u32 s80, s84, 1
  s_add_u32 s81, s85, 0
  s_branch L_j1
L_s2_1:
  s_lshr_b32 s80, s59, 2
  s_and_b32 s81, s59, 3
  s_add_u32 s81, s81, 8
  s_branch L_j3
L_s2_2:
  s_mov_b32 s80, 0
  s_branch L_j4
L_s2_3:
  s_mov_b32 s80, 12
  s_branch L_j4
L_s2_4:
  s_branch L_j5
L_s2_5:
  s_branch L_j6
L_s2_6:
  s_branch L_j7
L_s2_7:
  s_branch L_fast
L_s2_8:
  s_branch L_fast2
L_s3_0:
  s_add_u32 s80, s84, 1
  s_add_u32 s81, s85, 16
  s_branch L_j1
L_s3_1:
  s_mov_b32 s80, 7
  s_mov_b32 s81, s59
  s_branch L_j1
L_s3_2:
  s_mov_b32 s80, 4
  s_branch L_j4
L_s3_3:
  s_mov_b32 s80, 16
  s_branch L_j4
L_s3_4:
  s_branch L_j5
L_s3_5:
  s_branch L_j6
L_s3_6:
  s_branch L_j7
L_s3_7:
  s_branch L_fast
L_s3_8:
  s_branch L_fast2
L_s4_0:
  s_lshr_b32 s80, s59, 2
  s_and_b32 s81, s59, 3
  s_add_u32 s81, s81, 0
  s_branch L_j3
L_s4_1:
  s_add_u32 s80, s84, 0
  s_mov_b32 s81, s85
  s_branch L_j2
L_s4_2:
  s_mov_b32 s80, 8
  s_branch L_j4
L_s4_3:
  s_mov_b32 s80, 20
  s_branch L_j4
L_s4_4:
  s_branch L_j5
L_s4_5:
  s_branch L_j6
L_s4_6:
  s_branch L_j7
L_s4_7:
  s_branch L_fast
L_s4_8:
  s_branch L_fast2
L_s5_0:
  s_lshr_b32 s80, s59, 2
  s_and_b32 s81, s59, 3
  s_add_u32 s81, s81, 4
  s_branch L_j3
L_s5_1:
  s_add_u32 s80, s84, 2
  s_mov_b32 s81, s85
  s_branch L_j2
L_s5_2:
  s_add_u32 s80, s84, 4
  s_mov_b32 s81, s85
  s_branch L_j2
L_s5_3:
  s_branch L_prep
L_s5_4:
  s_branch L_j5
L_s5_5:
  s_branch L_j6
L_s5_6:
  s_branch L_j7
L_s5_7:
  s_branch L_fast
L_s5_8:
  s_branch L_fast2
L_j1:
  s_cmp_eq_u32 s88, 0
  s_cselect_b32 s89, 2, 1
  s_lshl_b32 s73, s81, 2
  s_lshl_b32 s82, s80, 7
  s_add_u32 s73, s73, s82
  s_add_u32 s73, s73, 0
  s_mov_b32 s69, 4194304
  s_cmp_ge_u32 s81, 16
  s_cselect_b32 s76, 1, 0
  s_cselect_b32 s48, s22, s20
  s_cselect_b32 s49, s23, s21
  s_cselect_b32 s69, 20971520, s69
  s_and_b32 s81, s81, 15
  s_branch L_jB
L_j2:
  s_lshl_b32 s73, s81, 2
  s_lshl_b32 s82, s80, 6
  s_add_u32 s73, s73, s82
  s_add_u32 s73, s73, 1024
  s_mov_b32 s76, 0
  s_mov_b32 s48, s18
  s_mov_b32 s49, s19
  s_mov_b32 s69, 37748736
L_jB:
  s_mov_b32 s50, 5242880
  s_mov_b32 s51, 0x20000
  s_mov_b32 s44, s14
  s_mov_b32 s45, s15
  s_mov_b32 s46, 0x280000
  s_mov_b32 s47, 0x20000
  s_mov_b32 s75, 8192
  s_mov_b32 s74, 64
  s_lshl_b32 s65, s81, 9
  s_mov_b32 s72, 0
  s_mov_b32 s70, 262144
  s_mov_b32 s71, 2048
  s_and_b32 s82, s57, 1
  s_lshl_b32 s82, s82, 2
  s_lshl_b32 s83, s80, 3
  s_add_u32 s82, s82, s83
  s_lshl_b32 s82, s82, 5
  s_lshr_b32 s83, s57, 1
  s_add_u32 s82, s82, s83
  s_lshl_b32 s83, s81, 1
  s_add_u32 s82, s82, s83
  s_lshl_b32 s82, s82, 13
  s_add_u32 s69, s69, s82
  s_branch L_gemm
L_j3:
  s_lshl_b32 s73, s81, 7
  s_add_u32 s73, s73, 2048
  s_mov_b32 s48, s10
  s_mov_b32 s49, s11
  s_mov_b32 s50, 0x258000
  s_mov_b32 s51, 0x20000
  s_mov_b32 s44, s8
  s_mov_b32 s45, s9
  s_mov_b32 s46, 0x280000
  s_mov_b32 s47, 0x20000
  s_mov_b32 s75, 3840
  s_mov_b32 s74, 40
  s_mul_i32 s65, s81, 320
  s_lshr_b32 s82, s81, 2
  s_add_u32 s72, s82, 1
  s_mov_b32 s70, 1536
  s_mov_b32 s69, 82837504
  s_cmp_eq_u32 s82, 2
  s_cselect_b32 s76, 1, 0
  s_cselect_b32 s70, 2048, s70
  s_cselect_b32 s69, 85983232, s69
  s_cmp_eq_u32 s82, 0
  s_cselect_b32 s69, 79691776, s69
  s_lshl_b32 s71, s70, 6
  s_and_b32 s81, s81, 3
  s_lshl_b32 s81, s81, 3
  s_lshr_b32 s83, s57, 1
  s_lshl_b32 s83, s83, 2
  s_add_u32 s81, s81, s83
  s_lshl_b32 s81, s81, 6
  s_and_b32 s82, s57, 1
  s_lshl_b32 s82, s82, 2
  s_lshl_b32 s83, s80, 3
  s_add_u32 s82, s82, s83
  s_add_u32 s81, s81, s82
  s_mul_i32 s81, s81, s70
  s_add_u32 s69, s69, s81
L_gemm:
  s_mul_i32 s64, s80, 327680
  s_and_b32 s77, s57, 1
  s_lshr_b32 s78, s57, 1
  v_and_b32 v96, 31, v1
  v_lshrrev_b32 v97, 5, v1
  v_lshrrev_b32 v98, 1, v96
  v_and_b32 v98, 7, v98
  s_lshl_b32 s79, s77, 14
  v_lshlrev_b32 v96, 7, v96
  v_add_u32 v96, s79, v96
  v_add_u32 v99, 0, v97
  v_xor_b32 v99, v99, v98
  v_lshlrev_b32 v99, 4, v99
  v_add_u32 v4, v96, v99
  v_add_u32 v99, 2, v97
  v_xor_b32 v99, v99, v98
  v_lshlrev_b32 v99, 4, v99
  v_add_u32 v5, v96, v99
  v_add_u32 v99, 4, v97
  v_xor_b32 v99, v99, v98
  v_lshlrev_b32 v99, 4, v99
  v_add_u32 v6, v96, v99
  v_add_u32 v99, 6, v97
  v_xor_b32 v99, v99, v98
  v_lshlrev_b32 v99, 4, v99
  v_add_u32 v7, v96, v99
  v_bfe_u32 v96, v1, 2, 2
  v_lshlrev_b32 v97, 3, v97
  v_add_u32 v97, v97, v96
  v_lshlrev_b32 v97, 9, v97
  v_add_u32 v97, 0x8000, v97
  v_bfe_u32 v98, v1, 4, 1
  v_lshlrev_b32 v98, 5, v98
  v_and_b32 v99, 3, v1
  v_lshlrev_b32 v99, 3, v99
  v_add_u32 v98, v98, v99
  s_lshl_b32 s79, s78, 2
  s_add_u32 s80, s79, 0
  s_mul_i32 s80, s80, s74
  v_add_u32 v99, s80, v98
  v_lshrrev_b32 v100, 6, v99
  v_xor_b32 v100, v100, v96
  v_lshlrev_b32 v100, 6, v100
  v_and_b32 v99, 63, v99
  v_add3_u32 v8, v97, v100, v99
  s_add_u32 s80, s79, 1
  s_mul_i32 s80, s80, s74
  v_add_u32 v99, s80, v98
  v_lshrrev_b32 v100, 6, v99
  v_xor_b32 v100, v100, v96
  v_lshlrev_b32 v100, 6, v100
  v_and_b32 v99, 63, v99
  v_add3_u32 v9, v97, v100, v99
  s_add_u32 s80, s79, 2
  s_mul_i32 s80, s80, s74
  v_add_u32 v99, s80, v98
  v_lshrrev_b32 v100, 6, v99
  v_xor_b32 v100, v100, v96
  v_lshlrev_b32 v100, 6, v100
  v_and_b32 v99, 63, v99
  v_add3_u32 v10, v97, v100, v99
  s_add_u32 s80, s79, 3
  s_mul_i32 s80, s80, s74
  v_add_u32 v99, s80, v98
  v_lshrrev_b32 v100, 6, v99
  v_xor_b32 v100, v100, v96
  v_lshlrev_b32 v100, 6, v100
  v_and_b32 v99, 63, v99
  v_add3_u32 v11, v97, v100, v99
  v_lshrrev_b32 v96, 3, v1
  s_lshl_b32 s79, s57, 6
  v_add_u32 v96, s79, v96
  s_movk_i32 s80, 1280
  v_mul_lo_u32 v96, v96, s80
  v_lshrrev_b32 v97, 4, v1
  v_and_b32 v98, 7, v1
  v_add_u32 v99, 0, v97
  v_xor_b32 v99, v99, v98
  v_lshlrev_b32 v99, 4, v99
  v_add_u32 v99, 0, v99
  v_add_u32 v12, v96, v99
  v_add_u32 v99, 4, v97
  v_xor_b32 v99, v99, v98
  v_lshlrev_b32 v99, 4, v99
  v_add_u32 v99, 9216, v99
  v_add_u32 v13, v96, v99
  v_add_u32 v99, 0, v97
  v_xor_b32 v99, v99, v98
  v_lshlrev_b32 v99, 4, v99
  v_add_u32 v99, 18432, v99
  v_add_u32 v14, v96, v99
  v_add_u32 v99, 4, v97
  v_xor_b32 v99, v99, v98
  v_lshlrev_b32 v99, 4, v99
  v_add_u32 v99, 27648, v99
  v_add_u32 v15, v96, v99
  v_add_u32 v99, 0, v97
  v_xor_b32 v99, v99, v98
  v_lshlrev_b32 v99, 4, v99
  v_add_u32 v99, 40960, v99
  v_add_u32 v16, v96, v99
  v_add_u32 v99, 4, v97
  v_xor_b32 v99, v99, v98
  v_lshlrev_b32 v99, 4, v99
  v_add_u32 v99, 50176, v99
  v_add_u32 v17, v96, v99
  v_add_u32 v99, 0, v97
  v_xor_b32 v99, v99, v98
  v_lshlrev_b32 v99, 4, v99
  v_add_u32 v99, 59392, v99
  v_add_u32 v18, v96, v99
  v_add_u32 v99, 4, v97
  v_xor_b32 v99, v99, v98
  v_lshlrev_b32 v99, 4, v99
  v_add_u32 v99, 68608, v99
  v_add_u32 v19, v96, v99
  v_lshrrev_b32 v96, 5, v1
  s_lshl_b32 s79, s57, 4
  v_add_u32 v97, s79, v96
  v_mul_lo_u32 v97, v97, s75
  v_and_b32 v98, 3, v1
  v_lshlrev_b32 v98, 4, v98
  v_add_u32 v97, v97, v98
  v_bfe_u32 v98, v1, 2, 3
  v_add_u32 v99, 0, v96
  v_xor_b32 v99, v99, v98
  v_lshlrev_b32 v99, 6, v99
  s_mul_i32 s80, s75, 0
  s_sub_u32 s80, s80, 0
  v_add3_u32 v20, v97, v99, s80
  v_add_u32 v99, 2, v96
  v_xor_b32 v99, v99, v98
  v_lshlrev_b32 v99, 6, v99
  s_mul_i32 s80, s75, 2
  s_sub_u32 s80, s80, 1024
  v_add3_u32 v21, v97, v99, s80
  v_add_u32 v99, 0, v96
  v_xor_b32 v99, v99, v98
  v_lshlrev_b32 v99, 6, v99
  s_mul_i32 s80, s75, 4
  s_sub_u32 s80, s80, 2048
  v_add3_u32 v22, v97, v99, s80
  v_add_u32 v99, 2, v96
  v_xor_b32 v99, v99, v98
  v_lshlrev_b32 v99, 6, v99
  s_mul_i32 s80, s75, 6
  s_sub_u32 s80, s80, 3072
  v_add3_u32 v23, v97, v99, s80
  v_add_u32 v99, 0, v96
  v_xor_b32 v99, v99, v98
  v_lshlrev_b32 v99, 6, v99
  s_mul_i32 s80, s75, 8
  s_sub_u32 s80, s80, 0
  v_add3_u32 v24, v97, v99, s80
  v_add_u32 v99, 2, v96
  v_xor_b32 v99, v99, v98
  v_lshlrev_b32 v99, 6, v99
  s_mul_i32 s80, s75, 10
  s_sub_u32 s80, s80, 1024
  v_add3_u32 v25, v97, v99, s80
  v_add_u32 v99, 0, v96
  v_xor_b32 v99, v99, v98
  v_lshlrev_b32 v99, 6, v99
  s_mul_i32 s80, s75, 12
  s_sub_u32 s80, s80, 2048
  v_add3_u32 v26, v97, v99, s80
  v_add_u32 v99, 2, v96
  v_xor_b32 v99, v99, v98
  v_lshlrev_b32 v99, 6, v99
  s_mul_i32 s80, s75, 14
  s_sub_u32 s80, s80, 3072
  v_add3_u32 v27, v97, v99, s80
  s_lshl_b32 s66, s75, 6
  s_lshl_b32 s67, s57, 13
  s_cmp_lg_u32 s88, 0
  s_cbranch_scc1 L_gemm_h
  s_cmp_lg_u32 s76, 0
  s_cbranch_scc1 L_gemm_o1
  s_add_u32 m0, s67, 0
  s_nop 0
  buffer_load_dwordx4 v12, s[44:47], s64 offen offset:0 lds
  buffer_load_dwordx4 v13, s[44:47], s64 offen offset:1024 lds
  buffer_load_dwordx4 v14, s[44:47], s64 offen offset:2048 lds
  buffer_load_dwordx4 v15, s[44:47], s64 offen offset:3072 lds
  s_add_u32 m0, s67, 4096
  s_nop 0
  buffer_load_dwordx4 v16, s[44:47], s64 offen offset:0 lds
  buffer_load_dwordx4 v17, s[44:47], s64 offen offset:1024 lds
  buffer_load_dwordx4 v18, s[44:47], s64 offen offset:2048 lds
  buffer_load_dwordx4 v19, s[44:47], s64 offen offset:3072 lds
  s_add_u32 m0, s67, 32768
  s_nop 0
  buffer_load_dwordx4 v20, s[48:51], s65 offen offset:0 lds
  buffer_load_dwordx4 v21, s[48:51], s65 offen offset:1024 lds
  buffer_load_dwordx4 v22, s[48:51], s65 offen offset:2048 lds
  buffer_load_dwordx4 v23, s[48:51], s65 offen offset:3072 lds
  s_add_u32 m0, s67, 36864
  s_nop 0
  buffer_load_dwordx4 v24, s[48:51], s65 offen offset:0 lds
  buffer_load_dwordx4 v25, s[48:51], s65 offen offset:1024 lds
  buffer_load_dwordx4 v26, s[48:51], s65 offen offset:2048 lds
  buffer_load_dwordx4 v27, s[48:51], s65 offen offset:3072 lds
  s_add_u32 s64, s64, 128
  s_add_u32 s65, s65, s66
  s_xor_b32 s67, s67, 0x10000
  s_add_u32 m0, s67, 0
  s_nop 0
  buffer_load_dwordx4 v12, s[44:47], s64 offen offset:0 lds
  buffer_load_dwordx4 v13, s[44:47], s64 offen offset:1024 lds
  buffer_load_dwordx4 v14, s[44:47], s64 offen offset:2048 lds
  buffer_load_dwordx4 v15, s[44:47], s64 offen offset:3072 lds
  s_add_u32 m0, s67, 4096
  s_nop 0
  buffer_load_dwordx4 v16, s[44:47], s64 offen offset:0 lds
  buffer_load_dwordx4 v17, s[44:47], s64 offen offset:1024 lds
  buffer_load_dwordx4 v18, s[44:47], s64 offen offset:2048 lds
  buffer_load_dwordx4 v19, s[44:47], s64 offen offset:3072 lds
  s_add_u32 s64, s64, 128
  v_accvgpr_write_b32 a0, 0
  v_accvgpr_write_b32 a1, 0
  v_accvgpr_write_b32 a2, 0
  v_accvgpr_write_b32 a3, 0
  v_accvgpr_write_b32 a4, 0
  v_accvgpr_write_b32 a5, 0
  v_accvgpr_write_b32 a6, 0
  v_accvgpr_write_b32 a7, 0
  v_accvgpr_write_b32 a8, 0
  v_accvgpr_write_b32 a9, 0
  v_accvgpr_write_b32 a10, 0
  v_accvgpr_write_b32 a11, 0
  v_accvgpr_write_b32 a12, 0
  v_accvgpr_write_b32 a13, 0
  v_accvgpr_write_b32 a14, 0
  v_accvgpr_write_b32 a15, 0
  v_accvgpr_write_b32 a16, 0
  v_accvgpr_write_b32 a17, 0
  v_accvgpr_write_b32 a18, 0
  v_accvgpr_write_b32 a19, 0
  v_accvgpr_write_b32 a20, 0
  v_accvgpr_write_b32 a21, 0
  v_accvgpr_write_b32 a22, 0
  v_accvgpr_write_b32 a23, 0
  v_accvgpr_write_b32 a24, 0
  v_accvgpr_write_b32 a25, 0
  v_accvgpr_write_b32 a26, 0
  v_accvgpr_write_b32 a27, 0
  v_accvgpr_write_b32 a28, 0
  v_accvgpr_write_b32 a29, 0
  v_accvgpr_write_b32 a30, 0
  v_accvgpr_write_b32 a31, 0
  v_accvgpr_write_b32 a32, 0
  v_accvgpr_write_b32 a33, 0
  v_accvgpr_write_b32 a34, 0
  v_accvgpr_write_b32 a35, 0
  v_accvgpr_write_b32 a36, 0
  v_accvgpr_write_b32 a37, 0
  v_accvgpr_write_b32 a38, 0
  v_accvgpr_write_b32 a39, 0
  v_accvgpr_write_b32 a40, 0
  v_accvgpr_write_b32 a41, 0
  v_accvgpr_write_b32 a42, 0
  v_accvgpr_write_b32 a43, 0
  v_accvgpr_write_b32 a44, 0
  v_accvgpr_write_b32 a45, 0
  v_accvgpr_write_b32 a46, 0
  v_accvgpr_write_b32 a47, 0
  v_accvgpr_write_b32 a48, 0
  v_accvgpr_write_b32 a49, 0
  v_accvgpr_write_b32 a50, 0
  v_accvgpr_write_b32 a51, 0
  v_accvgpr_write_b32 a52, 0
  v_accvgpr_write_b32 a53, 0
  v_accvgpr_write_b32 a54, 0
  v_accvgpr_write_b32 a55, 0
  v_accvgpr_write_b32 a56, 0
  v_accvgpr_write_b32 a57, 0
  v_accvgpr_write_b32 a58, 0
  v_accvgpr_write_b32 a59, 0
  v_accvgpr_write_b32 a60, 0
  v_accvgpr_write_b32 a61, 0
  v_accvgpr_write_b32 a62, 0
  v_accvgpr_write_b32 a63, 0
  v_accvgpr_write_b32 a64, 0
  v_accvgpr_write_b32 a65, 0
  v_accvgpr_write_b32 a66, 0
  v_accvgpr_write_b32 a67, 0
  v_accvgpr_write_b32 a68, 0
  v_accvgpr_write_b32 a69, 0
  v_accvgpr_write_b32 a70, 0
  v_accvgpr_write_b32 a71, 0
  v_accvgpr_write_b32 a72, 0
  v_accvgpr_write_b32 a73, 0
  v_accvgpr_write_b32 a74, 0
  v_accvgpr_write_b32 a75, 0
  v_accvgpr_write_b32 a76, 0
  v_accvgpr_write_b32 a77, 0
  v_accvgpr_write_b32 a78, 0
  v_accvgpr_write_b32 a79, 0
  v_accvgpr_write_b32 a80, 0
  v_accvgpr_write_b32 a81, 0
  v_accvgpr_write_b32 a82, 0
  v_accvgpr_write_b32 a83, 0
  v_accvgpr_write_b32 a84, 0
  v_accvgpr_write_b32 a85, 0
  v_accvgpr_write_b32 a86, 0
  v_accvgpr_write_b32 a87, 0
  v_accvgpr_write_b32 a88, 0
  v_accvgpr_write_b32 a89, 0
  v_accvgpr_write_b32 a90, 0
  v_accvgpr_write_b32 a91, 0
  v_accvgpr_write_b32 a92, 0
  v_accvgpr_write_b32 a93, 0
  v_accvgpr_write_b32 a94, 0
  v_accvgpr_write_b32 a95, 0
  v_accvgpr_write_b32 a96, 0
  v_accvgpr_write_b32 a97, 0
  v_accvgpr_write_b32 a98, 0
  v_accvgpr_write_b32 a99, 0
  v_accvgpr_write_b32 a100, 0
  v_accvgpr_write_b32 a101, 0
  v_accvgpr_write_b32 a102, 0
  v_accvgpr_write_b32 a103, 0
  v_accvgpr_write_b32 a104, 0
  v_accvgpr_write_b32 a105, 0
  v_accvgpr_write_b32 a106, 0
  v_accvgpr_write_b32 a107, 0
  v_accvgpr_write_b32 a108, 0
  v_accvgpr_write_b32 a109, 0
  v_accvgpr_write_b32 a110, 0
  v_accvgpr_write_b32 a111, 0
  v_accvgpr_write_b32 a112, 0
  v_accvgpr_write_b32 a113, 0
  v_accvgpr_write_b32 a114, 0
  v_accvgpr_write_b32 a115, 0
  v_accvgpr_write_b32 a116, 0
  v_accvgpr_write_b32 a117, 0
  v_accvgpr_write_b32 a118, 0
  v_accvgpr_write_b32 a119, 0
  v_accvgpr_write_b32 a120, 0
  v_accvgpr_write_b32 a121, 0
  v_accvgpr_write_b32 a122, 0
  v_accvgpr_write_b32 a123, 0
  v_accvgpr_write_b32 a124, 0
  v_accvgpr_write_b32 a125, 0
  v_accvgpr_write_b32 a126, 0
  v_accvgpr_write_b32 a127, 0
  v_accvgpr_write_b32 a128, 0
  v_accvgpr_write_b32 a129, 0
  v_accvgpr_write_b32 a130, 0
  v_accvgpr_write_b32 a131, 0
  v_accvgpr_write_b32 a132, 0
  v_accvgpr_write_b32 a133, 0
  v_accvgpr_write_b32 a134, 0
  v_accvgpr_write_b32 a135, 0
  v_accvgpr_write_b32 a136, 0
  v_accvgpr_write_b32 a137, 0
  v_accvgpr_write_b32 a138, 0
  v_accvgpr_write_b32 a139, 0
  v_accvgpr_write_b32 a140, 0
  v_accvgpr_write_b32 a141, 0
  v_accvgpr_write_b32 a142, 0
  v_accvgpr_write_b32 a143, 0
  v_accvgpr_write_b32 a144, 0
  v_accvgpr_write_b32 a145, 0
  v_accvgpr_write_b32 a146, 0
  v_accvgpr_write_b32 a147, 0
  v_accvgpr_write_b32 a148, 0
  v_accvgpr_write_b32 a149, 0
  v_accvgpr_write_b32 a150, 0
  v_accvgpr_write_b32 a151, 0
  v_accvgpr_write_b32 a152, 0
  v_accvgpr_write_b32 a153, 0
  v_accvgpr_write_b32 a154, 0
  v_accvgpr_write_b32 a155, 0
  v_accvgpr_write_b32 a156, 0
  v_accvgpr_write_b32 a157, 0
  v_accvgpr_write_b32 a158, 0
  v_accvgpr_write_b32 a159, 0
  v_accvgpr_write_b32 a160, 0
  v_accvgpr_write_b32 a161, 0
  v_accvgpr_write_b32 a162, 0
  v_accvgpr_write_b32 a163, 0
  v_accvgpr_write_b32 a164, 0
  v_accvgpr_write_b32 a165, 0
  v_accvgpr_write_b32 a166, 0
  v_accvgpr_write_b32 a167, 0
  v_accvgpr_write_b32 a168, 0
  v_accvgpr_write_b32 a169, 0
  v_accvgpr_write_b32 a170, 0
  v_accvgpr_write_b32 a171, 0
  v_accvgpr_write_b32 a172, 0
  v_accvgpr_write_b32 a173, 0
  v_accvgpr_write_b32 a174, 0
  v_accvgpr_write_b32 a175, 0
  v_accvgpr_write_b32 a176, 0
  v_accvgpr_write_b32 a177, 0
  v_accvgpr_write_b32 a178, 0
  v_accvgpr_write_b32 a179, 0
  v_accvgpr_write_b32 a180, 0
  v_accvgpr_write_b32 a181, 0
  v_accvgpr_write_b32 a182, 0
  v_accvgpr_write_b32 a183, 0
  v_accvgpr_write_b32 a184, 0
  v_accvgpr_write_b32 a185, 0
  v_accvgpr_write_b32 a186, 0
  v_accvgpr_write_b32 a187, 0
  v_accvgpr_write_b32 a188, 0
  v_accvgpr_write_b32 a189, 0
  v_accvgpr_write_b32 a190, 0
  v_accvgpr_write_b32 a191, 0
  v_accvgpr_write_b32 a192, 0
  v_accvgpr_write_b32 a193, 0
  v_accvgpr_write_b32 a194, 0
  v_accvgpr_write_b32 a195, 0
  v_accvgpr_write_b32 a196, 0
  v_accvgpr_write_b32 a197, 0
  v_accvgpr_write_b32 a198, 0
  v_accvgpr_write_b32 a199, 0
  v_accvgpr_write_b32 a200, 0
  v_accvgpr_write_b32 a201, 0
  v_accvgpr_write_b32 a202, 0
  v_accvgpr_write_b32 a203, 0
  v_accvgpr_write_b32 a204, 0
  v_accvgpr_write_b32 a205, 0
  v_accvgpr_write_b32 a206, 0
  v_accvgpr_write_b32 a207, 0
  v_accvgpr_write_b32 a208, 0
  v_accvgpr_write_b32 a209, 0
  v_accvgpr_write_b32 a210, 0
  v_accvgpr_write_b32 a211, 0
  v_accvgpr_write_b32 a212, 0
  v_accvgpr_write_b32 a213, 0
  v_accvgpr_write_b32 a214, 0
  v_accvgpr_write_b32 a215, 0
  v_accvgpr_write_b32 a216, 0
  v_accvgpr_write_b32 a217, 0
  v_accvgpr_write_b32 a218, 0
  v_accvgpr_write_b32 a219, 0
  v_accvgpr_write_b32 a220, 0
  v_accvgpr_write_b32 a221, 0
  v_accvgpr_write_b32 a222, 0
  v_accvgpr_write_b32 a223, 0
  v_accvgpr_write_b32 a224, 0
  v_accvgpr_write_b32 a225, 0
  v_accvgpr_write_b32 a226, 0
  v_accvgpr_write_b32 a227, 0
  v_accvgpr_write_b32 a228, 0
  v_accvgpr_write_b32 a229, 0
  v_accvgpr_write_b32 a230, 0
  v_accvgpr_write_b32 a231, 0
  v_accvgpr_write_b32 a232, 0
  v_accvgpr_write_b32 a233, 0
  v_accvgpr_write_b32 a234, 0
  v_accvgpr_write_b32 a235, 0
  v_accvgpr_write_b32 a236, 0
  v_accvgpr_write_b32 a237, 0
  v_accvgpr_write_b32 a238, 0
  v_accvgpr_write_b32 a239, 0
  v_accvgpr_write_b32 a240, 0
  v_accvgpr_write_b32 a241, 0
  v_accvgpr_write_b32 a242, 0
  v_accvgpr_write_b32 a243, 0
  v_accvgpr_write_b32 a244, 0
  v_accvgpr_write_b32 a245, 0
  v_accvgpr_write_b32 a246, 0
  v_accvgpr_write_b32 a247, 0
  v_accvgpr_write_b32 a248, 0
  v_accvgpr_write_b32 a249, 0
  v_accvgpr_write_b32 a250, 0
  v_accvgpr_write_b32 a251, 0
  v_accvgpr_write_b32 a252, 0
  v_accvgpr_write_b32 a253, 0
  v_accvgpr_write_b32 a254, 0
  v_accvgpr_write_b32 a255, 0
  s_waitcnt vmcnt(8)
  s_barrier
  s_cmp_lg_u32 s60, 0
  s_cbranch_scc1 gr_1
  s_cmp_lg_u32 s57, 0
  s_cbranch_scc1 rg_2
  s_getreg_b32 s62, hwreg(HW_REG_XCC_ID)
  s_and_b32 s62, s62, 15
  s_lshl_b32 s62, s62, 2
  s_and_b32 s81, s61, 7
  s_mov_b32 s63, 1
  s_cmp_eq_u32 s81, 0
  s_cselect_b32 s63, 0x401, s63
  s_cmp_eq_u32 s81, 1
  s_cselect_b32 s63, 0x100001, s63
  s_mov_b64 exec, 1
  v_mov_b32 v2, s63
  v_mov_b32 v3, 0
  buffer_atomic_add v2, v3, s[52:55], s62 offen sc1
  s_mov_b64 exec, -1
rg_2:
gr_1:
  ds_read_b128 v[32:35], v4 offset:0
  ds_read_b64_tr_b16 v[64:65], v8 offset:0
  ds_read_b64_tr_b16 v[66:67], v8 offset:2048
  ds_read_b128 v[36:39], v4 offset:4096
  ds_read_b64_tr_b16 v[68:69], v9 offset:0
  ds_read_b64_tr_b16 v[70:71], v9 offset:2048
  ds_read_b128 v[40:43], v4 offset:8192
  ds_read_b64_tr_b16 v[72:73], v10 offset:0
  ds_read_b64_tr_b16 v[74:75], v10 offset:2048
  ds_read_b128 v[44:47], v4 offset:12288
  ds_read_b64_tr_b16 v[76:77], v11 offset:0
  ds_read_b64_tr_b16 v[78:79], v11 offset:2048
  s_mov_b32 s68, 8
gl_3:
  s_waitcnt lgkmcnt(0)
  s_add_u32 m0, s67, 32768
  v_mfma_f32_32x32x16_bf16 a[0:15], v[64:67], v[32:35], a[0:15]
  buffer_load_dwordx4 v20, s[48:51], s65 offen offset:0 lds
  ds_read_b128 v[48:51], v5 offset:0
  ds_read_b64_tr_b16 v[80:81], v8 offset:8192
  v_mfma_f32_32x32x16_bf16 a[16:31], v[68:71], v[32:35], a[16:31]
  ds_read_b64_tr_b16 v[82:83], v8 offset:10240
  ds_read_b128 v[52:55], v5 offset:4096
  v_mfma_f32_32x32x16_bf16 a[32:47], v[72:75], v[32:35], a[32:47]
  buffer_load_dwordx4 v21, s[48:51], s65 offen offset:1024 lds
  ds_read_b64_tr_b16 v[84:85], v9 offset:8192
  ds_read_b64_tr_b16 v[86:87], v9 offset:10240
  v_mfma_f32_32x32x16_bf16 a[48:63], v[76:79], v[32:35], a[48:63]
  ds_read_b128 v[56:59], v5 offset:8192
  ds_read_b64_tr_b16 v[88:89], v10 offset:8192
  v_mfma_f32_32x32x16_bf16 a[64:79], v[64:67], v[36:39], a[64:79]
  buffer_load_dwordx4 v22, s[48:51], s65 offen offset:2048 lds
  ds_read_b64_tr_b16 v[90:91], v10 offset:10240
  v_mfma_f32_32x32x16_bf16 a[80:95], v[68:71], v[36:39], a[80:95]
  ds_read_b128 v[60:63], v5 offset:12288
  v_mfma_f32_32x32x16_bf16 a[96:111], v[72:75], v[36:39], a[96:111]
  buffer_load_dwordx4 v23, s[48:51], s65 offen offset:3072 lds
  ds_read_b64_tr_b16 v[92:93], v11 offset:8192
  v_mfma_f32_32x32x16_bf16 a[112:127], v[76:79], v[36:39], a[112:127]
  ds_read_b64_tr_b16 v[94:95], v11 offset:10240
  s_add_u32 m0, s67, 36864
  v_mfma_f32_32x32x16_bf16 a[128:143], v[64:67], v[40:43], a[128:143]
  buffer_load_dwordx4 v24, s[48:51], s65 offen offset:0 lds
  v_mfma_f32_32x32x16_bf16 a[144:159], v[68:71], v[40:43], a[144:159]
  v_mfma_f32_32x32x16_bf16 a[160:175], v[72:75], v[40:43], a[160:175]
  buffer_load_dwordx4 v25, s[48:51], s65 offen offset:1024 lds
  v_mfma_f32_32x32x16_bf16 a[176:191], v[76:79], v[40:43], a[176:191]
  v_mfma_f32_32x32x16_bf16 a[192:207], v[64:67], v[44:47], a[192:207]
  buffer_load_dwordx4 v26, s[48:51], s65 offen offset:2048 lds
  v_mfma_f32_32x32x16_bf16 a[208:223], v[68:71], v[44:47], a[208:223]
  v_mfma_f32_32x32x16_bf16 a[224:239], v[72:75], v[44:47], a[224:239]
  buffer_load_dwordx4 v27, s[48:51], s65 offen offset:3072 lds
  v_mfma_f32_32x32x16_bf16 a[240:255], v[76:79], v[44:47], a[240:255]
  s_add_u32 s65, s65, s66
  s_xor_b32 s67, s67, 0x10000
  s_waitcnt lgkmcnt(0)
  v_mfma_f32_32x32x16_bf16 a[0:15], v[80:83], v[48:51], a[0:15]
  ds_read_b128 v[32:35], v6 offset:0
  ds_read_b64_tr_b16 v[64:65], v8 offset:16384
  v_mfma_f32_32x32x16_bf16 a[16:31], v[84:87], v[48:51], a[16:31]
  ds_read_b64_tr_b16 v[66:67], v8 offset:18432
  ds_read_b128 v[36:39], v6 offset:4096
  v_mfma_f32_32x32x16_bf16 a[32:47], v[88:91], v[48:51], a[32:47]
  ds_read_b64_tr_b16 v[68:69], v9 offset:16384
  ds_read_b64_tr_b16 v[70:71], v9 offset:18432
  v_mfma_f32_32x32x16_bf16 a[48:63], v[92:95], v[48:51], a[48:63]
  ds_read_b128 v[40:43], v6 offset:8192
  ds_read_b64_tr_b16 v[72:73], v10 offset:16384
  v_mfma_f32_32x32x16_bf16 a[64:79], v[80:83], v[52:55], a[64:79]
  ds_read_b64_tr_b16 v[74:75], v10 offset:18432
  v_mfma_f32_32x32x16_bf16 a[80:95], v[84:87], v[52:55], a[80:95]
  ds_read_b128 v[44:47], v6 offset:12288
  v_mfma_f32_32x32x16_bf16 a[96:111], v[88:91], v[52:55], a[96:111]
  ds_read_b64_tr_b16 v[76:77], v11 offset:16384
  v_mfma_f32_32x32x16_bf16 a[112:127], v[92:95], v[52:55], a[112:127]
  ds_read_b64_tr_b16 v[78:79], v11 offset:18432
  v_mfma_f32_32x32x16_bf16 a[128:143], v[80:83], v[56:59], a[128:143]
  v_mfma_f32_32x32x16_bf16 a[144:159], v[84:87], v[56:59], a[144:159]
  v_mfma_f32_32x32x16_bf16 a[160:175], v[88:91], v[56:59], a[160:175]
  v_mfma_f32_32x32x16_bf16 a[176:191], v[92:95], v[56:59], a[176:191]
  v_mfma_f32_32x32x16_bf16 a[192:207], v[80:83], v[60:63], a[192:207]
  v_mfma_f32_32x32x16_bf16 a[208:223], v[84:87], v[60:63], a[208:223]
  v_mfma_f32_32x32x16_bf16 a[224:239], v[88:91], v[60:63], a[224:239]
  v_mfma_f32_32x32x16_bf16 a[240:255], v[92:95], v[60:63], a[240:255]
  s_waitcnt lgkmcnt(0)
  v_mfma_f32_32x32x16_bf16 a[0:15], v[64:67], v[32:35], a[0:15]
  ds_read_b128 v[48:51], v7 offset:0
  ds_read_b64_tr_b16 v[80:81], v8 offset:24576
  v_mfma_f32_32x32x16_bf16 a[16:31], v[68:71], v[32:35], a[16:31]
  ds_read_b64_tr_b16 v[82:83], v8 offset:26624
  ds_read_b128 v[52:55], v7 offset:4096
  v_mfma_f32_32x32x16_bf16 a[32:47], v[72:75], v[32:35], a[32:47]
  ds_read_b64_tr_b16 v[84:85], v9 offset:24576
  ds_read_b64_tr_b16 v[86:87], v9 offset:26624
  v_mfma_f32_32x32x16_bf16 a[48:63], v[76:79], v[32:35], a[48:63]
  ds_read_b128 v[56:59], v7 offset:8192
  ds_read_b64_tr_b16 v[88:89], v10 offset:24576
  v_mfma_f32_32x32x16_bf16 a[64:79], v[64:67], v[36:39], a[64:79]
  ds_read_b64_tr_b16 v[90:91], v10 offset:26624
  v_mfma_f32_32x32x16_bf16 a[80:95], v[68:71], v[36:39], a[80:95]
  ds_read_b128 v[60:63], v7 offset:12288
  v_mfma_f32_32x32x16_bf16 a[96:111], v[72:75], v[36:39], a[96:111]
  ds_read_b64_tr_b16 v[92:93], v11 offset:24576
  v_mfma_f32_32x32x16_bf16 a[112:127], v[76:79], v[36:39], a[112:127]
  ds_read_b64_tr_b16 v[94:95], v11 offset:26624
  v_mfma_f32_32x32x16_bf16 a[128:143], v[64:67], v[40:43], a[128:143]
  v_mfma_f32_32x32x16_bf16 a[144:159], v[68:71], v[40:43], a[144:159]
  v_mfma_f32_32x32x16_bf16 a[160:175], v[72:75], v[40:43], a[160:175]
  v_mfma_f32_32x32x16_bf16 a[176:191], v[76:79], v[40:43], a[176:191]
  v_mfma_f32_32x32x16_bf16 a[192:207], v[64:67], v[44:47], a[192:207]
  v_mfma_f32_32x32x16_bf16 a[208:223], v[68:71], v[44:47], a[208:223]
  v_mfma_f32_32x32x16_bf16 a[224:239], v[72:75], v[44:47], a[224:239]
  v_mfma_f32_32x32x16_bf16 a[240:255], v[76:79], v[44:47], a[240:255]
  s_waitcnt vmcnt(0) lgkmcnt(0)
  s_barrier
  v_xor_b32 v4, 0x10000, v4
  v_xor_b32 v5, 0x10000, v5
  v_xor_b32 v6, 0x10000, v6
  v_xor_b32 v7, 0x10000, v7
  v_xor_b32 v8, 0x10000, v8
  v_xor_b32 v9, 0x10000, v9
  v_xor_b32 v10, 0x10000, v10
  v_xor_b32 v11, 0x10000, v11
  s_add_u32 m0, s67, 0
  v_mfma_f32_32x32x16_bf16 a[0:15], v[80:83], v[48:51], a[0:15]
  buffer_load_dwordx4 v12, s[44:47], s64 offen offset:0 lds
  ds_read_b128 v[32:35], v4 offset:0
  ds_read_b64_tr_b16 v[64:65], v8 offset:0
  v_mfma_f32_32x32x16_bf16 a[16:31], v[84:87], v[48:51], a[16:31]
  ds_read_b64_tr_b16 v[66:67], v8 offset:2048
  ds_read_b128 v[36:39], v4 offset:4096
  v_mfma_f32_32x32x16_bf16 a[32:47], v[88:91], v[48:51], a[32:47]
  buffer_load_dwordx4 v13, s[44:47], s64 offen offset:1024 lds
  ds_read_b64_tr_b16 v[68:69], v9 offset:0
  ds_read_b64_tr_b16 v[70:71], v9 offset:2048
  v_mfma_f32_32x32x16_bf16 a[48:63], v[92:95], v[48:51], a[48:63]
  ds_read_b128 v[40:43], v4 offset:8192
  ds_read_b64_tr_b16 v[72:73], v10 offset:0
  v_mfma_f32_32x32x16_bf16 a[64:79], v[80:83], v[52:55], a[64:79]
  buffer_load_dwordx4 v14, s[44:47], s64 offen offset:2048 lds
  ds_read_b64_tr_b16 v[74:75], v10 offset:2048
  v_mfma_f32_32x32x16_bf16 a[80:95], v[84:87], v[52:55], a[80:95]
  ds_read_b128 v[44:47], v4 offset:12288
  v_mfma_f32_32x32x16_bf16 a[96:111], v[88:91], v[52:55], a[96:111]
  buffer_load_dwordx4 v15, s[44:47], s64 offen offset:3072 lds
  ds_read_b64_tr_b16 v[76:77], v11 offset:0
  v_mfma_f32_32x32x16_bf16 a[112:127], v[92:95], v[52:55], a[112:127]
  ds_read_b64_tr_b16 v[78:79], v11 offset:2048
  s_add_u32 m0, s67, 4096
  v_mfma_f32_32x32x16_bf16 a[128:143], v[80:83], v[56:59], a[128:143]
  buffer_load_dwordx4 v16, s[44:47], s64 offen offset:0 lds
  v_mfma_f32_32x32x16_bf16 a[144:159], v[84:87], v[56:59], a[144:159]
  v_mfma_f32_32x32x16_bf16 a[160:175], v[88:91], v[56:59], a[160:175]
  buffer_load_dwordx4 v17, s[44:47], s64 offen offset:1024 lds
  v_mfma_f32_32x32x16_bf16 a[176:191], v[92:95], v[56:59], a[176:191]
  v_mfma_f32_32x32x16_bf16 a[192:207], v[80:83], v[60:63], a[192:207]
  buffer_load_dwordx4 v18, s[44:47], s64 offen offset:2048 lds
  v_mfma_f32_32x32x16_bf16 a[208:223], v[84:87], v[60:63], a[208:223]
  v_mfma_f32_32x32x16_bf16 a[224:239], v[88:91], v[60:63], a[224:239]
  buffer_load_dwordx4 v19, s[44:47], s64 offen offset:3072 lds
  v_mfma_f32_32x32x16_bf16 a[240:255], v[92:95], v[60:63], a[240:255]
  s_add_u32 s64, s64, 128
  s_sub_u32 s68, s68, 1
  s_cmp_lg_u32 s68, 0
  s_cbranch_scc1 gl_3
  v_lshlrev_b32 v131, 2, v1
  buffer_load_dword v130, v131, s[52:55], 0 offen sc1
  s_waitcnt lgkmcnt(0)
  s_add_u32 m0, s67, 32768
  v_mfma_f32_32x32x16_bf16 a[0:15], v[64:67], v[32:35], a[0:15]
  buffer_load_dwordx4 v20, s[48:51], s65 offen offset:0 lds
  ds_read_b128 v[48:51], v5 offset:0
  ds_read_b64_tr_b16 v[80:81], v8 offset:8192
  v_mfma_f32_32x32x16_bf16 a[16:31], v[68:71], v[32:35], a[16:31]
  ds_read_b64_tr_b16 v[82:83], v8 offset:10240
  ds_read_b128 v[52:55], v5 offset:4096
  v_mfma_f32_32x32x16_bf16 a[32:47], v[72:75], v[32:35], a[32:47]
  buffer_load_dwordx4 v21, s[48:51], s65 offen offset:1024 lds
  ds_read_b64_tr_b16 v[84:85], v9 offset:8192
  ds_read_b64_tr_b16 v[86:87], v9 offset:10240
  v_mfma_f32_32x32x16_bf16 a[48:63], v[76:79], v[32:35], a[48:63]
  ds_read_b128 v[56:59], v5 offset:8192
  ds_read_b64_tr_b16 v[88:89], v10 offset:8192
  v_mfma_f32_32x32x16_bf16 a[64:79], v[64:67], v[36:39], a[64:79]
  buffer_load_dwordx4 v22, s[48:51], s65 offen offset:2048 lds
  ds_read_b64_tr_b16 v[90:91], v10 offset:10240
  v_mfma_f32_32x32x16_bf16 a[80:95], v[68:71], v[36:39], a[80:95]
  ds_read_b128 v[60:63], v5 offset:12288
  v_mfma_f32_32x32x16_bf16 a[96:111], v[72:75], v[36:39], a[96:111]
  buffer_load_dwordx4 v23, s[48:51], s65 offen offset:3072 lds
  ds_read_b64_tr_b16 v[92:93], v11 offset:8192
  v_mfma_f32_32x32x16_bf16 a[112:127], v[76:79], v[36:39], a[112:127]
  ds_read_b64_tr_b16 v[94:95], v11 offset:10240
  s_add_u32 m0, s67, 36864
  v_mfma_f32_32x32x16_bf16 a[128:143], v[64:67], v[40:43], a[128:143]
  buffer_load_dwordx4 v24, s[48:51], s65 offen offset:0 lds
  v_mfma_f32_32x32x16_bf16 a[144:159], v[68:71], v[40:43], a[144:159]
  v_mfma_f32_32x32x16_bf16 a[160:175], v[72:75], v[40:43], a[160:175]
  buffer_load_dwordx4 v25, s[48:51], s65 offen offset:1024 lds
  v_mfma_f32_32x32x16_bf16 a[176:191], v[76:79], v[40:43], a[176:191]
  v_mfma_f32_32x32x16_bf16 a[192:207], v[64:67], v[44:47], a[192:207]
  buffer_load_dwordx4 v26, s[48:51], s65 offen offset:2048 lds
  v_mfma_f32_32x32x16_bf16 a[208:223], v[68:71], v[44:47], a[208:223]
  v_mfma_f32_32x32x16_bf16 a[224:239], v[72:75], v[44:47], a[224:239]
  buffer_load_dwordx4 v27, s[48:51], s65 offen offset:3072 lds
  v_mfma_f32_32x32x16_bf16 a[240:255], v[76:79], v[44:47], a[240:255]
  s_add_u32 s65, s65, s66
  s_xor_b32 s67, s67, 0x10000
  s_waitcnt lgkmcnt(0)
  v_mfma_f32_32x32x16_bf16 a[0:15], v[80:83], v[48:51], a[0:15]
  ds_read_b128 v[32:35], v6 offset:0
  ds_read_b64_tr_b16 v[64:65], v8 offset:16384
  v_mfma_f32_32x32x16_bf16 a[16:31], v[84:87], v[48:51], a[16:31]
  ds_read_b64_tr_b16 v[66:67], v8 offset:18432
  ds_read_b128 v[36:39], v6 offset:4096
  v_mfma_f32_32x32x16_bf16 a[32:47], v[88:91], v[48:51], a[32:47]
  ds_read_b64_tr_b16 v[68:69], v9 offset:16384
  ds_read_b64_tr_b16 v[70:71], v9 offset:18432
  v_mfma_f32_32x32x16_bf16 a[48:63], v[92:95], v[48:51], a[48:63]
  ds_read_b128 v[40:43], v6 offset:8192
  ds_read_b64_tr_b16 v[72:73], v10 offset:16384
  v_mfma_f32_32x32x16_bf16 a[64:79], v[80:83], v[52:55], a[64:79]
  ds_read_b64_tr_b16 v[74:75], v10 offset:18432
  v_mfma_f32_32x32x16_bf16 a[80:95], v[84:87], v[52:55], a[80:95]
  ds_read_b128 v[44:47], v6 offset:12288
  v_mfma_f32_32x32x16_bf16 a[96:111], v[88:91], v[52:55], a[96:111]
  ds_read_b64_tr_b16 v[76:77], v11 offset:16384
  v_mfma_f32_32x32x16_bf16 a[112:127], v[92:95], v[52:55], a[112:127]
  ds_read_b64_tr_b16 v[78:79], v11 offset:18432
  v_mfma_f32_32x32x16_bf16 a[128:143], v[80:83], v[56:59], a[128:143]
  v_mfma_f32_32x32x16_bf16 a[144:159], v[84:87], v[56:59], a[144:159]
  v_mfma_f32_32x32x16_bf16 a[160:175], v[88:91], v[56:59], a[160:175]
  v_mfma_f32_32x32x16_bf16 a[176:191], v[92:95], v[56:59], a[176:191]
  v_mfma_f32_32x32x16_bf16 a[192:207], v[80:83], v[60:63], a[192:207]
  v_mfma_f32_32x32x16_bf16 a[208:223], v[84:87], v[60:63], a[208:223]
  v_mfma_f32_32x32x16_bf16 a[224:239], v[88:91], v[60:63], a[224:239]
  v_mfma_f32_32x32x16_bf16 a[240:255], v[92:95], v[60:63], a[240:255]
  s_waitcnt lgkmcnt(0)
  v_mfma_f32_32x32x16_bf16 a[0:15], v[64:67], v[32:35], a[0:15]
  ds_read_b128 v[48:51], v7 offset:0
  ds_read_b64_tr_b16 v[80:81], v8 offset:24576
  v_mfma_f32_32x32x16_bf16 a[16:31], v[68:71], v[32:35], a[16:31]
  ds_read_b64_tr_b16 v[82:83], v8 offset:26624
  ds_read_b128 v[52:55], v7 offset:4096
  v_mfma_f32_32x32x16_bf16 a[32:47], v[72:75], v[32:35], a[32:47]
  ds_read_b64_tr_b16 v[84:85], v9 offset:24576
  ds_read_b64_tr_b16 v[86:87], v9 offset:26624
  v_mfma_f32_32x32x16_bf16 a[48:63], v[76:79], v[32:35], a[48:63]
  ds_read_b128 v[56:59], v7 offset:8192
  ds_read_b64_tr_b16 v[88:89], v10 offset:24576
  v_mfma_f32_32x32x16_bf16 a[64:79], v[64:67], v[36:39], a[64:79]
  ds_read_b64_tr_b16 v[90:91], v10 offset:26624
  v_mfma_f32_32x32x16_bf16 a[80:95], v[68:71], v[36:39], a[80:95]
  ds_read_b128 v[60:63], v7 offset:12288
  v_mfma_f32_32x32x16_bf16 a[96:111], v[72:75], v[36:39], a[96:111]
  ds_read_b64_tr_b16 v[92:93], v11 offset:24576
  v_mfma_f32_32x32x16_bf16 a[112:127], v[76:79], v[36:39], a[112:127]
  ds_read_b64_tr_b16 v[94:95], v11 offset:26624
  v_mfma_f32_32x32x16_bf16 a[128:143], v[64:67], v[40:43], a[128:143]
  v_mfma_f32_32x32x16_bf16 a[144:159], v[68:71], v[40:43], a[144:159]
  v_mfma_f32_32x32x16_bf16 a[160:175], v[72:75], v[40:43], a[160:175]
  v_mfma_f32_32x32x16_bf16 a[176:191], v[76:79], v[40:43], a[176:191]
  v_mfma_f32_32x32x16_bf16 a[192:207], v[64:67], v[44:47], a[192:207]
  v_mfma_f32_32x32x16_bf16 a[208:223], v[68:71], v[44:47], a[208:223]
  v_mfma_f32_32x32x16_bf16 a[224:239], v[72:75], v[44:47], a[224:239]
  v_mfma_f32_32x32x16_bf16 a[240:255], v[76:79], v[44:47], a[240:255]
  s_waitcnt vmcnt(0) lgkmcnt(0)
  s_barrier
  v_xor_b32 v4, 0x10000, v4
  v_xor_b32 v5, 0x10000, v5
  v_xor_b32 v6, 0x10000, v6
  v_xor_b32 v7, 0x10000, v7
  v_xor_b32 v8, 0x10000, v8
  v_xor_b32 v9, 0x10000, v9
  v_xor_b32 v10, 0x10000, v10
  v_xor_b32 v11, 0x10000, v11
  v_mfma_f32_32x32x16_bf16 a[0:15], v[80:83], v[48:51], a[0:15]
  ds_read_b128 v[32:35], v4 offset:0
  ds_read_b64_tr_b16 v[64:65], v8 offset:0
  v_mfma_f32_32x32x16_bf16 a[16:31], v[84:87], v[48:51], a[16:31]
  ds_read_b64_tr_b16 v[66:67], v8 offset:2048
  ds_read_b128 v[36:39], v4 offset:4096
  v_mfma_f32_32x32x16_bf16 a[32:47], v[88:91], v[48:51], a[32:47]
  ds_read_b64_tr_b16 v[68:69], v9 offset:0
  ds_read_b64_tr_b16 v[70:71], v9 offset:2048
  v_mfma_f32_32x32x16_bf16 a[48:63], v[92:95], v[48:51], a[48:63]
  ds_read_b128 v[40:43], v4 offset:8192
  ds_read_b64_tr_b16 v[72:73], v10 offset:0
  v_mfma_f32_32x32x16_bf16 a[64:79], v[80:83], v[52:55], a[64:79]
  ds_read_b64_tr_b16 v[74:75], v10 offset:2048
  v_mfma_f32_32x32x16_bf16 a[80:95], v[84:87], v[52:55], a[80:95]
  ds_read_b128 v[44:47], v4 offset:12288
  v_mfma_f32_32x32x16_bf16 a[96:111], v[88:91], v[52:55], a[96:111]
  ds_read_b64_tr_b16 v[76:77], v11 offset:0
  v_mfma_f32_32x32x16_bf16 a[112:127], v[92:95], v[52:55], a[112:127]
  ds_read_b64_tr_b16 v[78:79], v11 offset:2048
  v_mfma_f32_32x32x16_bf16 a[128:143], v[80:83], v[56:59], a[128:143]
  v_mfma_f32_32x32x16_bf16 a[144:159], v[84:87], v[56:59], a[144:159]
  v_mfma_f32_32x32x16_bf16 a[160:175], v[88:91], v[56:59], a[160:175]
  v_mfma_f32_32x32x16_bf16 a[176:191], v[92:95], v[56:59], a[176:191]
  v_mfma_f32_32x32x16_bf16 a[192:207], v[80:83], v[60:63], a[192:207]
  v_mfma_f32_32x32x16_bf16 a[208:223], v[84:87], v[60:63], a[208:223]
  v_mfma_f32_32x32x16_bf16 a[224:239], v[88:91], v[60:63], a[224:239]
  v_mfma_f32_32x32x16_bf16 a[240:255], v[92:95], v[60:63], a[240:255]
  s_waitcnt lgkmcnt(0)
  v_mfma_f32_32x32x16_bf16 a[0:15], v[64:67], v[32:35], a[0:15]
  ds_read_b128 v[48:51], v5 offset:0
  ds_read_b64_tr_b16 v[80:81], v8 offset:8192
  v_mfma_f32_32x32x16_bf16 a[16:31], v[68:71], v[32:35], a[16:31]
  ds_read_b64_tr_b16 v[82:83], v8 offset:10240
  ds_read_b128 v[52:55], v5 offset:4096
  v_mfma_f32_32x32x16_bf16 a[32:47], v[72:75], v[32:35], a[32:47]
  ds_read_b64_tr_b16 v[84:85], v9 offset:8192
  ds_read_b64_tr_b16 v[86:87], v9 offset:10240
  v_mfma_f32_32x32x16_bf16 a[48:63], v[76:79], v[32:35], a[48:63]
  ds_read_b128 v[56:59], v5 offset:8192
  ds_read_b64_tr_b16 v[88:89], v10 offset:8192
  v_mfma_f32_32x32x16_bf16 a[64:79], v[64:67], v[36:39], a[64:79]
  ds_read_b64_tr_b16 v[90:91], v10 offset:10240
  v_mfma_f32_32x32x16_bf16 a[80:95], v[68:71], v[36:39], a[80:95]
  ds_read_b128 v[60:63], v5 offset:12288
  v_mfma_f32_32x32x16_bf16 a[96:111], v[72:75], v[36:39], a[96:111]
  ds_read_b64_tr_b16 v[92:93], v11 offset:8192
  v_mfma_f32_32x32x16_bf16 a[112:127], v[76:79], v[36:39], a[112:127]
  ds_read_b64_tr_b16 v[94:95], v11 offset:10240
  v_mfma_f32_32x32x16_bf16 a[128:143], v[64:67], v[40:43], a[128:143]
  v_mfma_f32_32x32x16_bf16 a[144:159], v[68:71], v[40:43], a[144:159]
  v_mfma_f32_32x32x16_bf16 a[160:175], v[72:75], v[40:43], a[160:175]
  v_mfma_f32_32x32x16_bf16 a[176:191], v[76:79], v[40:43], a[176:191]
  v_mfma_f32_32x32x16_bf16 a[192:207], v[64:67], v[44:47], a[192:207]
  v_mfma_f32_32x32x16_bf16 a[208:223], v[68:71], v[44:47], a[208:223]
  v_mfma_f32_32x32x16_bf16 a[224:239], v[72:75], v[44:47], a[224:239]
  v_mfma_f32_32x32x16_bf16 a[240:255], v[76:79], v[44:47], a[240:255]
  s_waitcnt lgkmcnt(0)
  v_mfma_f32_32x32x16_bf16 a[0:15], v[80:83], v[48:51], a[0:15]
  ds_read_b128 v[32:35], v6 offset:0
  ds_read_b64_tr_b16 v[64:65], v8 offset:16384
  v_mfma_f32_32x32x16_bf16 a[16:31], v[84:87], v[48:51], a[16:31]
  ds_read_b64_tr_b16 v[66:67], v8 offset:18432
  ds_read_b128 v[36:39], v6 offset:4096
  v_mfma_f32_32x32x16_bf16 a[32:47], v[88:91], v[48:51], a[32:47]
  ds_read_b64_tr_b16 v[68:69], v9 offset:16384
  ds_read_b64_tr_b16 v[70:71], v9 offset:18432
  v_mfma_f32_32x32x16_bf16 a[48:63], v[92:95], v[48:51], a[48:63]
  ds_read_b128 v[40:43], v6 offset:8192
  ds_read_b64_tr_b16 v[72:73], v10 offset:16384
  v_mfma_f32_32x32x16_bf16 a[64:79], v[80:83], v[52:55], a[64:79]
  ds_read_b64_tr_b16 v[74:75], v10 offset:18432
  v_mfma_f32_32x32x16_bf16 a[80:95], v[84:87], v[52:55], a[80:95]
  ds_read_b128 v[44:47], v6 offset:12288
  v_mfma_f32_32x32x16_bf16 a[96:111], v[88:91], v[52:55], a[96:111]
  ds_read_b64_tr_b16 v[76:77], v11 offset:16384
  v_mfma_f32_32x32x16_bf16 a[112:127], v[92:95], v[52:55], a[112:127]
  ds_read_b64_tr_b16 v[78:79], v11 offset:18432
  v_mfma_f32_32x32x16_bf16 a[128:143], v[80:83], v[56:59], a[128:143]
  v_mfma_f32_32x32x16_bf16 a[144:159], v[84:87], v[56:59], a[144:159]
  v_mfma_f32_32x32x16_bf16 a[160:175], v[88:91], v[56:59], a[160:175]
  v_mfma_f32_32x32x16_bf16 a[176:191], v[92:95], v[56:59], a[176:191]
  v_mfma_f32_32x32x16_bf16 a[192:207], v[80:83], v[60:63], a[192:207]
  v_mfma_f32_32x32x16_bf16 a[208:223], v[84:87], v[60:63], a[208:223]
  v_mfma_f32_32x32x16_bf16 a[224:239], v[88:91], v[60:63], a[224:239]
  v_mfma_f32_32x32x16_bf16 a[240:255], v[92:95], v[60:63], a[240:255]
  s_waitcnt lgkmcnt(0)
  v_mfma_f32_32x32x16_bf16 a[0:15], v[64:67], v[32:35], a[0:15]
  ds_read_b128 v[48:51], v7 offset:0
  ds_read_b64_tr_b16 v[80:81], v8 offset:24576
  v_mfma_f32_32x32x16_bf16 a[16:31], v[68:71], v[32:35], a[16:31]
  ds_read_b64_tr_b16 v[82:83], v8 offset:26624
  ds_read_b128 v[52:55], v7 offset:4096
  v_mfma_f32_32x32x16_bf16 a[32:47], v[72:75], v[32:35], a[32:47]
  ds_read_b64_tr_b16 v[84:85], v9 offset:24576
  ds_read_b64_tr_b16 v[86:87], v9 offset:26624
  v_mfma_f32_32x32x16_bf16 a[48:63], v[76:79], v[32:35], a[48:63]
  ds_read_b128 v[56:59], v7 offset:8192
  ds_read_b64_tr_b16 v[88:89], v10 offset:24576
  v_mfma_f32_32x32x16_bf16 a[64:79], v[64:67], v[36:39], a[64:79]
  ds_read_b64_tr_b16 v[90:91], v10 offset:26624
  v_mfma_f32_32x32x16_bf16 a[80:95], v[68:71], v[36:39], a[80:95]
  ds_read_b128 v[60:63], v7 offset:12288
  v_mfma_f32_32x32x16_bf16 a[96:111], v[72:75], v[36:39], a[96:111]
  ds_read_b64_tr_b16 v[92:93], v11 offset:24576
  v_mfma_f32_32x32x16_bf16 a[112:127], v[76:79], v[36:39], a[112:127]
  ds_read_b64_tr_b16 v[94:95], v11 offset:26624
  v_mfma_f32_32x32x16_bf16 a[128:143], v[64:67], v[40:43], a[128:143]
  v_mfma_f32_32x32x16_bf16 a[144:159], v[68:71], v[40:43], a[144:159]
  v_mfma_f32_32x32x16_bf16 a[160:175], v[72:75], v[40:43], a[160:175]
  v_mfma_f32_32x32x16_bf16 a[176:191], v[76:79], v[40:43], a[176:191]
  v_mfma_f32_32x32x16_bf16 a[192:207], v[64:67], v[44:47], a[192:207]
  v_mfma_f32_32x32x16_bf16 a[208:223], v[68:71], v[44:47], a[208:223]
  v_mfma_f32_32x32x16_bf16 a[224:239], v[72:75], v[44:47], a[224:239]
  v_mfma_f32_32x32x16_bf16 a[240:255], v[76:79], v[44:47], a[240:255]
  s_waitcnt lgkmcnt(0)
  v_mfma_f32_32x32x16_bf16 a[0:15], v[80:83], v[48:51], a[0:15]
  v_mfma_f32_32x32x16_bf16 a[16:31], v[84:87], v[48:51], a[16:31]
  v_mfma_f32_32x32x16_bf16 a[32:47], v[88:91], v[48:51], a[32:47]
  v_mfma_f32_32x32x16_bf16 a[48:63], v[92:95], v[48:51], a[48:63]
  v_mfma_f32_32x32x16_bf16 a[64:79], v[80:83], v[52:55], a[64:79]
  v_mfma_f32_32x32x16_bf16 a[80:95], v[84:87], v[52:55], a[80:95]
  v_mfma_f32_32x32x16_bf16 a[96:111], v[88:91], v[52:55], a[96:111]
  v_mfma_f32_32x32x16_bf16 a[112:127], v[92:95], v[52:55], a[112:127]
  v_mfma_f32_32x32x16_bf16 a[128:143], v[80:83], v[56:59], a[128:143]
  v_mfma_f32_32x32x16_bf16 a[144:159], v[84:87], v[56:59], a[144:159]
  v_mfma_f32_32x32x16_bf16 a[160:175], v[88:91], v[56:59], a[160:175]
  v_mfma_f32_32x32x16_bf16 a[176:191], v[92:95], v[56:59], a[176:191]
  v_mfma_f32_32x32x16_bf16 a[192:207], v[80:83], v[60:63], a[192:207]
  v_mfma_f32_32x32x16_bf16 a[208:223], v[84:87], v[60:63], a[208:223]
  v_mfma_f32_32x32x16_bf16 a[224:239], v[88:91], v[60:63], a[224:239]
  v_mfma_f32_32x32x16_bf16 a[240:255], v[92:95], v[60:63], a[240:255]
  s_cmp_eq_u32 s72, 1
  s_cbranch_scc1 L_epi_aq
  s_cmp_eq_u32 s72, 2
  s_cbranch_scc1 L_epi_ak
  s_branch L_epi_b
L_gemm_o1:
  s_add_u32 m0, s67, 0
  s_nop 0
  buffer_load_dwordx4 v12, s[44:47], s64 offen offset:0 lds
  buffer_load_dwordx4 v13, s[44:47], s64 offen offset:1024 lds
  buffer_load_dwordx4 v14, s[44:47], s64 offen offset:2048 lds
  buffer_load_dwordx4 v15, s[44:47], s64 offen offset:3072 lds
  s_add_u32 m0, s67, 4096
  s_nop 0
  buffer_load_dwordx4 v16, s[44:47], s64 offen offset:0 lds
  buffer_load_dwordx4 v17, s[44:47], s64 offen offset:1024 lds
  buffer_load_dwordx4 v18, s[44:47], s64 offen offset:2048 lds
  buffer_load_dwordx4 v19, s[44:47], s64 offen offset:3072 lds
  s_add_u32 m0, s67, 32768
  s_nop 0
  buffer_load_dwordx4 v20, s[48:51], s65 offen offset:0 lds
  buffer_load_dwordx4 v21, s[48:51], s65 offen offset:1024 lds
  buffer_load_dwordx4 v22, s[48:51], s65 offen offset:2048 lds
  buffer_load_dwordx4 v23, s[48:51], s65 offen offset:3072 lds
  s_add_u32 m0, s67, 36864
  s_nop 0
  buffer_load_dwordx4 v24, s[48:51], s65 offen offset:0 lds
  buffer_load_dwordx4 v25, s[48:51], s65 offen offset:1024 lds
  buffer_load_dwordx4 v26, s[48:51], s65 offen offset:2048 lds
  buffer_load_dwordx4 v27, s[48:51], s65 offen offset:3072 lds
  s_add_u32 s64, s64, 128
  s_add_u32 s65, s65, s66
  s_xor_b32 s67, s67, 0x10000
  s_add_u32 m0, s67, 0
  s_nop 0
  buffer_load_dwordx4 v12, s[44:47], s64 offen offset:0 lds
  buffer_load_dwordx4 v13, s[44:47], s64 offen offset:1024 lds
  buffer_load_dwordx4 v14, s[44:47], s64 offen offset:2048 lds
  buffer_load_dwordx4 v15, s[44:47], s64 offen offset:3072 lds
  s_add_u32 m0, s67, 4096
  s_nop 0
  buffer_load_dwordx4 v16, s[44:47], s64 offen offset:0 lds
  buffer_load_dwordx4 v17, s[44:47], s64 offen offset:1024 lds
  buffer_load_dwordx4 v18, s[44:47], s64 offen offset:2048 lds
  buffer_load_dwordx4 v19, s[44:47], s64 offen offset:3072 lds
  s_add_u32 s64, s64, 128
  v_accvgpr_write_b32 a0, 0
  v_accvgpr_write_b32 a1, 0
  v_accvgpr_write_b32 a2, 0
  v_accvgpr_write_b32 a3, 0
  v_accvgpr_write_b32 a4, 0
  v_accvgpr_write_b32 a5, 0
  v_accvgpr_write_b32 a6, 0
  v_accvgpr_write_b32 a7, 0
  v_accvgpr_write_b32 a8, 0
  v_accvgpr_write_b32 a9, 0
  v_accvgpr_write_b32 a10, 0
  v_accvgpr_write_b32 a11, 0
  v_accvgpr_write_b32 a12, 0
  v_accvgpr_write_b32 a13, 0
  v_accvgpr_write_b32 a14, 0
  v_accvgpr_write_b32 a15, 0
  v_accvgpr_write_b32 a16, 0
  v_accvgpr_write_b32 a17, 0
  v_accvgpr_write_b32 a18, 0
  v_accvgpr_write_b32 a19, 0
  v_accvgpr_write_b32 a20, 0
  v_accvgpr_write_b32 a21, 0
  v_accvgpr_write_b32 a22, 0
  v_accvgpr_write_b32 a23, 0
  v_accvgpr_write_b32 a24, 0
  v_accvgpr_write_b32 a25, 0
  v_accvgpr_write_b32 a26, 0
  v_accvgpr_write_b32 a27, 0
  v_accvgpr_write_b32 a28, 0
  v_accvgpr_write_b32 a29, 0
  v_accvgpr_write_b32 a30, 0
  v_accvgpr_write_b32 a31, 0
  v_accvgpr_write_b32 a32, 0
  v_accvgpr_write_b32 a33, 0
  v_accvgpr_write_b32 a34, 0
  v_accvgpr_write_b32 a35, 0
  v_accvgpr_write_b32 a36, 0
  v_accvgpr_write_b32 a37, 0
  v_accvgpr_write_b32 a38, 0
  v_accvgpr_write_b32 a39, 0
  v_accvgpr_write_b32 a40, 0
  v_accvgpr_write_b32 a41, 0
  v_accvgpr_write_b32 a42, 0
  v_accvgpr_write_b32 a43, 0
  v_accvgpr_write_b32 a44, 0
  v_accvgpr_write_b32 a45, 0
  v_accvgpr_write_b32 a46, 0
  v_accvgpr_write_b32 a47, 0
  v_accvgpr_write_b32 a48, 0
  v_accvgpr_write_b32 a49, 0
  v_accvgpr_write_b32 a50, 0
  v_accvgpr_write_b32 a51, 0
  v_accvgpr_write_b32 a52, 0
  v_accvgpr_write_b32 a53, 0
  v_accvgpr_write_b32 a54, 0
  v_accvgpr_write_b32 a55, 0
  v_accvgpr_write_b32 a56, 0
  v_accvgpr_write_b32 a57, 0
  v_accvgpr_write_b32 a58, 0
  v_accvgpr_write_b32 a59, 0
  v_accvgpr_write_b32 a60, 0
  v_accvgpr_write_b32 a61, 0
  v_accvgpr_write_b32 a62, 0
  v_accvgpr_write_b32 a63, 0
  v_accvgpr_write_b32 a64, 0
  v_accvgpr_write_b32 a65, 0
  v_accvgpr_write_b32 a66, 0
  v_accvgpr_write_b32 a67, 0
  v_accvgpr_write_b32 a68, 0
  v_accvgpr_write_b32 a69, 0
  v_accvgpr_write_b32 a70, 0
  v_accvgpr_write_b32 a71, 0
  v_accvgpr_write_b32 a72, 0
  v_accvgpr_write_b32 a73, 0
  v_accvgpr_write_b32 a74, 0
  v_accvgpr_write_b32 a75, 0
  v_accvgpr_write_b32 a76, 0
  v_accvgpr_write_b32 a77, 0
  v_accvgpr_write_b32 a78, 0
  v_accvgpr_write_b32 a79, 0
  v_accvgpr_write_b32 a80, 0
  v_accvgpr_write_b32 a81, 0
  v_accvgpr_write_b32 a82, 0
  v_accvgpr_write_b32 a83, 0
  v_accvgpr_write_b32 a84, 0
  v_accvgpr_write_b32 a85, 0
  v_accvgpr_write_b32 a86, 0
  v_accvgpr_write_b32 a87, 0
  v_accvgpr_write_b32 a88, 0
  v_accvgpr_write_b32 a89, 0
  v_accvgpr_write_b32 a90, 0
  v_accvgpr_write_b32 a91, 0
  v_accvgpr_write_b32 a92, 0
  v_accvgpr_write_b32 a93, 0
  v_accvgpr_write_b32 a94, 0
  v_accvgpr_write_b32 a95, 0
  v_accvgpr_write_b32 a96, 0
  v_accvgpr_write_b32 a97, 0
  v_accvgpr_write_b32 a98, 0
  v_accvgpr_write_b32 a99, 0
  v_accvgpr_write_b32 a100, 0
  v_accvgpr_write_b32 a101, 0
  v_accvgpr_write_b32 a102, 0
  v_accvgpr_write_b32 a103, 0
  v_accvgpr_write_b32 a104, 0
  v_accvgpr_write_b32 a105, 0
  v_accvgpr_write_b32 a106, 0
  v_accvgpr_write_b32 a107, 0
  v_accvgpr_write_b32 a108, 0
  v_accvgpr_write_b32 a109, 0
  v_accvgpr_write_b32 a110, 0
  v_accvgpr_write_b32 a111, 0
  v_accvgpr_write_b32 a112, 0
  v_accvgpr_write_b32 a113, 0
  v_accvgpr_write_b32 a114, 0
  v_accvgpr_write_b32 a115, 0
  v_accvgpr_write_b32 a116, 0
  v_accvgpr_write_b32 a117, 0
  v_accvgpr_write_b32 a118, 0
  v_accvgpr_write_b32 a119, 0
  v_accvgpr_write_b32 a120, 0
  v_accvgpr_write_b32 a121, 0
  v_accvgpr_write_b32 a122, 0
  v_accvgpr_write_b32 a123, 0
  v_accvgpr_write_b32 a124, 0
  v_accvgpr_write_b32 a125, 0
  v_accvgpr_write_b32 a126, 0
  v_accvgpr_write_b32 a127, 0
  v_accvgpr_write_b32 a128, 0
  v_accvgpr_write_b32 a129, 0
  v_accvgpr_write_b32 a130, 0
  v_accvgpr_write_b32 a131, 0
  v_accvgpr_write_b32 a132, 0
  v_accvgpr_write_b32 a133, 0
  v_accvgpr_write_b32 a134, 0
  v_accvgpr_write_b32 a135, 0
  v_accvgpr_write_b32 a136, 0
  v_accvgpr_write_b32 a137, 0
  v_accvgpr_write_b32 a138, 0
  v_accvgpr_write_b32 a139, 0
  v_accvgpr_write_b32 a140, 0
  v_accvgpr_write_b32 a141, 0
  v_accvgpr_write_b32 a142, 0
  v_accvgpr_write_b32 a143, 0
  v_accvgpr_write_b32 a144, 0
  v_accvgpr_write_b32 a145, 0
  v_accvgpr_write_b32 a146, 0
  v_accvgpr_write_b32 a147, 0
  v_accvgpr_write_b32 a148, 0
  v_accvgpr_write_b32 a149, 0
  v_accvgpr_write_b32 a150, 0
  v_accvgpr_write_b32 a151, 0
  v_accvgpr_write_b32 a152, 0
  v_accvgpr_write_b32 a153, 0
  v_accvgpr_write_b32 a154, 0
  v_accvgpr_write_b32 a155, 0
  v_accvgpr_write_b32 a156, 0
  v_accvgpr_write_b32 a157, 0
  v_accvgpr_write_b32 a158, 0
  v_accvgpr_write_b32 a159, 0
  v_accvgpr_write_b32 a160, 0
  v_accvgpr_write_b32 a161, 0
  v_accvgpr_write_b32 a162, 0
  v_accvgpr_write_b32 a163, 0
  v_accvgpr_write_b32 a164, 0
  v_accvgpr_write_b32 a165, 0
  v_accvgpr_write_b32 a166, 0
  v_accvgpr_write_b32 a167, 0
  v_accvgpr_write_b32 a168, 0
  v_accvgpr_write_b32 a169, 0
  v_accvgpr_write_b32 a170, 0
  v_accvgpr_write_b32 a171, 0
  v_accvgpr_write_b32 a172, 0
  v_accvgpr_write_b32 a173, 0
  v_accvgpr_write_b32 a174, 0
  v_accvgpr_write_b32 a175, 0
  v_accvgpr_write_b32 a176, 0
  v_accvgpr_write_b32 a177, 0
  v_accvgpr_write_b32 a178, 0
  v_accvgpr_write_b32 a179, 0
  v_accvgpr_write_b32 a180, 0
  v_accvgpr_write_b32 a181, 0
  v_accvgpr_write_b32 a182, 0
  v_accvgpr_write_b32 a183, 0
  v_accvgpr_write_b32 a184, 0
  v_accvgpr_write_b32 a185, 0
  v_accvgpr_write_b32 a186, 0
  v_accvgpr_write_b32 a187, 0
  v_accvgpr_write_b32 a188, 0
  v_accvgpr_write_b32 a189, 0
  v_accvgpr_write_b32 a190, 0
  v_accvgpr_write_b32 a191, 0
  v_accvgpr_write_b32 a192, 0
  v_accvgpr_write_b32 a193, 0
  v_accvgpr_write_b32 a194, 0
  v_accvgpr_write_b32 a195, 0
  v_accvgpr_write_b32 a196, 0
  v_accvgpr_write_b32 a197, 0
  v_accvgpr_write_b32 a198, 0
  v_accvgpr_write_b32 a199, 0
  v_accvgpr_write_b32 a200, 0
  v_accvgpr_write_b32 a201, 0
  v_accvgpr_write_b32 a202, 0
  v_accvgpr_write_b32 a203, 0
  v_accvgpr_write_b32 a204, 0
  v_accvgpr_write_b32 a205, 0
  v_accvgpr_write_b32 a206, 0
  v_accvgpr_write_b32 a207, 0
  v_accvgpr_write_b32 a208, 0
  v_accvgpr_write_b32 a209, 0
  v_accvgpr_write_b32 a210, 0
  v_accvgpr_write_b32 a211, 0
  v_accvgpr_write_b32 a212, 0
  v_accvgpr_write_b32 a213, 0
  v_accvgpr_write_b32 a214, 0
  v_accvgpr_write_b32 a215, 0
  v_accvgpr_write_b32 a216, 0
  v_accvgpr_write_b32 a217, 0
  v_accvgpr_write_b32 a218, 0
  v_accvgpr_write_b32 a219, 0
  v_accvgpr_write_b32 a220, 0
  v_accvgpr_write_b32 a221, 0
  v_accvgpr_write_b32 a222, 0
  v_accvgpr_write_b32 a223, 0
  v_accvgpr_write_b32 a224, 0
  v_accvgpr_write_b32 a225, 0
  v_accvgpr_write_b32 a226, 0
  v_accvgpr_write_b32 a227, 0
  v_accvgpr_write_b32 a228, 0
  v_accvgpr_write_b32 a229, 0
  v_accvgpr_write_b32 a230, 0
  v_accvgpr_write_b32 a231, 0
  v_accvgpr_write_b32 a232, 0
  v_accvgpr_write_b32 a233, 0
  v_accvgpr_write_b32 a234, 0
  v_accvgpr_write_b32 a235, 0
  v_accvgpr_write_b32 a236, 0
  v_accvgpr_write_b32 a237, 0
  v_accvgpr_write_b32 a238, 0
  v_accvgpr_write_b32 a239, 0
  v_accvgpr_write_b32 a240, 0
  v_accvgpr_write_b32 a241, 0
  v_accvgpr_write_b32 a242, 0
  v_accvgpr_write_b32 a243, 0
  v_accvgpr_write_b32 a244, 0
  v_accvgpr_write_b32 a245, 0
  v_accvgpr_write_b32 a246, 0
  v_accvgpr_write_b32 a247, 0
  v_accvgpr_write_b32 a248, 0
  v_accvgpr_write_b32 a249, 0
  v_accvgpr_write_b32 a250, 0
  v_accvgpr_write_b32 a251, 0
  v_accvgpr_write_b32 a252, 0
  v_accvgpr_write_b32 a253, 0
  v_accvgpr_write_b32 a254, 0
  v_accvgpr_write_b32 a255, 0
  s_waitcnt vmcnt(8)
  s_barrier
  s_cmp_lg_u32 s60, 0
  s_cbranch_scc1 gr_4
  s_cmp_lg_u32 s57, 0
  s_cbranch_scc1 rg_5
  s_getreg_b32 s62, hwreg(HW_REG_XCC_ID)
  s_and_b32 s62, s62, 15
  s_lshl_b32 s62, s62, 2
  s_and_b32 s81, s61, 7
  s_mov_b32 s63, 1
  s_cmp_eq_u32 s81, 0
  s_cselect_b32 s63, 0x401, s63
  s_cmp_eq_u32 s81, 1
  s_cselect_b32 s63, 0x100001, s63
  s_mov_b64 exec, 1
  v_mov_b32 v2, s63
  v_mov_b32 v3, 0
  buffer_atomic_add v2, v3, s[52:55], s62 offen sc1
  s_mov_b64 exec, -1
rg_5:
gr_4:
  ds_read_b128 v[32:35], v4 offset:0
  ds_read_b64_tr_b16 v[64:65], v8 offset:0
  ds_read_b64_tr_b16 v[66:67], v8 offset:2048
  ds_read_b128 v[36:39], v4 offset:4096
  ds_read_b64_tr_b16 v[68:69], v9 offset:0
  ds_read_b64_tr_b16 v[70:71], v9 offset:2048
  ds_read_b128 v[40:43], v4 offset:8192
  ds_read_b64_tr_b16 v[72:73], v10 offset:0
  ds_read_b64_tr_b16 v[74:75], v10 offset:2048
  ds_read_b128 v[44:47], v4 offset:12288
  ds_read_b64_tr_b16 v[76:77], v11 offset:0
  ds_read_b64_tr_b16 v[78:79], v11 offset:2048
  s_mov_b32 s68, 8
gl_6:
  s_waitcnt lgkmcnt(0)
  s_add_u32 m0, s67, 32768
  v_mfma_f32_32x32x16_bf16 a[0:15], v[32:35], v[64:67], a[0:15]
  buffer_load_dwordx4 v20, s[48:51], s65 offen offset:0 lds
  ds_read_b128 v[48:51], v5 offset:0
  ds_read_b64_tr_b16 v[80:81], v8 offset:8192
  v_mfma_f32_32x32x16_bf16 a[16:31], v[32:35], v[68:71], a[16:31]
  ds_read_b64_tr_b16 v[82:83], v8 offset:10240
  ds_read_b128 v[52:55], v5 offset:4096
  v_mfma_f32_32x32x16_bf16 a[32:47], v[32:35], v[72:75], a[32:47]
  buffer_load_dwordx4 v21, s[48:51], s65 offen offset:1024 lds
  ds_read_b64_tr_b16 v[84:85], v9 offset:8192
  ds_read_b64_tr_b16 v[86:87], v9 offset:10240
  v_mfma_f32_32x32x16_bf16 a[48:63], v[32:35], v[76:79], a[48:63]
  ds_read_b128 v[56:59], v5 offset:8192
  ds_read_b64_tr_b16 v[88:89], v10 offset:8192
  v_mfma_f32_32x32x16_bf16 a[64:79], v[36:39], v[64:67], a[64:79]
  buffer_load_dwordx4 v22, s[48:51], s65 offen offset:2048 lds
  ds_read_b64_tr_b16 v[90:91], v10 offset:10240
  v_mfma_f32_32x32x16_bf16 a[80:95], v[36:39], v[68:71], a[80:95]
  ds_read_b128 v[60:63], v5 offset:12288
  v_mfma_f32_32x32x16_bf16 a[96:111], v[36:39], v[72:75], a[96:111]
  buffer_load_dwordx4 v23, s[48:51], s65 offen offset:3072 lds
  ds_read_b64_tr_b16 v[92:93], v11 offset:8192
  v_mfma_f32_32x32x16_bf16 a[112:127], v[36:39], v[76:79], a[112:127]
  ds_read_b64_tr_b16 v[94:95], v11 offset:10240
  s_add_u32 m0, s67, 36864
  v_mfma_f32_32x32x16_bf16 a[128:143], v[40:43], v[64:67], a[128:143]
  buffer_load_dwordx4 v24, s[48:51], s65 offen offset:0 lds
  v_mfma_f32_32x32x16_bf16 a[144:159], v[40:43], v[68:71], a[144:159]
  v_mfma_f32_32x32x16_bf16 a[160:175], v[40:43], v[72:75], a[160:175]
  buffer_load_dwordx4 v25, s[48:51], s65 offen offset:1024 lds
  v_mfma_f32_32x32x16_bf16 a[176:191], v[40:43], v[76:79], a[176:191]
  v_mfma_f32_32x32x16_bf16 a[192:207], v[44:47], v[64:67], a[192:207]
  buffer_load_dwordx4 v26, s[48:51], s65 offen offset:2048 lds
  v_mfma_f32_32x32x16_bf16 a[208:223], v[44:47], v[68:71], a[208:223]
  v_mfma_f32_32x32x16_bf16 a[224:239], v[44:47], v[72:75], a[224:239]
  buffer_load_dwordx4 v27, s[48:51], s65 offen offset:3072 lds
  v_mfma_f32_32x32x16_bf16 a[240:255], v[44:47], v[76:79], a[240:255]
  s_add_u32 s65, s65, s66
  s_xor_b32 s67, s67, 0x10000
  s_waitcnt lgkmcnt(0)
  v_mfma_f32_32x32x16_bf16 a[0:15], v[48:51], v[80:83], a[0:15]
  ds_read_b128 v[32:35], v6 offset:0
  ds_read_b64_tr_b16 v[64:65], v8 offset:16384
  v_mfma_f32_32x32x16_bf16 a[16:31], v[48:51], v[84:87], a[16:31]
  ds_read_b64_tr_b16 v[66:67], v8 offset:18432
  ds_read_b128 v[36:39], v6 offset:4096
  v_mfma_f32_32x32x16_bf16 a[32:47], v[48:51], v[88:91], a[32:47]
  ds_read_b64_tr_b16 v[68:69], v9 offset:16384
  ds_read_b64_tr_b16 v[70:71], v9 offset:18432
  v_mfma_f32_32x32x16_bf16 a[48:63], v[48:51], v[92:95], a[48:63]
  ds_read_b128 v[40:43], v6 offset:8192
  ds_read_b64_tr_b16 v[72:73], v10 offset:16384
  v_mfma_f32_32x32x16_bf16 a[64:79], v[52:55], v[80:83], a[64:79]
  ds_read_b64_tr_b16 v[74:75], v10 offset:18432
  v_mfma_f32_32x32x16_bf16 a[80:95], v[52:55], v[84:87], a[80:95]
  ds_read_b128 v[44:47], v6 offset:12288
  v_mfma_f32_32x32x16_bf16 a[96:111], v[52:55], v[88:91], a[96:111]
  ds_read_b64_tr_b16 v[76:77], v11 offset:16384
  v_mfma_f32_32x32x16_bf16 a[112:127], v[52:55], v[92:95], a[112:127]
  ds_read_b64_tr_b16 v[78:79], v11 offset:18432
  v_mfma_f32_32x32x16_bf16 a[128:143], v[56:59], v[80:83], a[128:143]
  v_mfma_f32_32x32x16_bf16 a[144:159], v[56:59], v[84:87], a[144:159]
  v_mfma_f32_32x32x16_bf16 a[160:175], v[56:59], v[88:91], a[160:175]
  v_mfma_f32_32x32x16_bf16 a[176:191], v[56:59], v[92:95], a[176:191]
  v_mfma_f32_32x32x16_bf16 a[192:207], v[60:63], v[80:83], a[192:207]
  v_mfma_f32_32x32x16_bf16 a[208:223], v[60:63], v[84:87], a[208:223]
  v_mfma_f32_32x32x16_bf16 a[224:239], v[60:63], v[88:91], a[224:239]
  v_mfma_f32_32x32x16_bf16 a[240:255], v[60:63], v[92:95], a[240:255]
  s_waitcnt lgkmcnt(0)
  v_mfma_f32_32x32x16_bf16 a[0:15], v[32:35], v[64:67], a[0:15]
  ds_read_b128 v[48:51], v7 offset:0
  ds_read_b64_tr_b16 v[80:81], v8 offset:24576
  v_mfma_f32_32x32x16_bf16 a[16:31], v[32:35], v[68:71], a[16:31]
  ds_read_b64_tr_b16 v[82:83], v8 offset:26624
  ds_read_b128 v[52:55], v7 offset:4096
  v_mfma_f32_32x32x16_bf16 a[32:47], v[32:35], v[72:75], a[32:47]
  ds_read_b64_tr_b16 v[84:85], v9 offset:24576
  ds_read_b64_tr_b16 v[86:87], v9 offset:26624
  v_mfma_f32_32x32x16_bf16 a[48:63], v[32:35], v[76:79], a[48:63]
  ds_read_b128 v[56:59], v7 offset:8192
  ds_read_b64_tr_b16 v[88:89], v10 offset:24576
  v_mfma_f32_32x32x16_bf16 a[64:79], v[36:39], v[64:67], a[64:79]
  ds_read_b64_tr_b16 v[90:91], v10 offset:26624
  v_mfma_f32_32x32x16_bf16 a[80:95], v[36:39], v[68:71], a[80:95]
  ds_read_b128 v[60:63], v7 offset:12288
  v_mfma_f32_32x32x16_bf16 a[96:111], v[36:39], v[72:75], a[96:111]
  ds_read_b64_tr_b16 v[92:93], v11 offset:24576
  v_mfma_f32_32x32x16_bf16 a[112:127], v[36:39], v[76:79], a[112:127]
  ds_read_b64_tr_b16 v[94:95], v11 offset:26624
  v_mfma_f32_32x32x16_bf16 a[128:143], v[40:43], v[64:67], a[128:143]
  v_mfma_f32_32x32x16_bf16 a[144:159], v[40:43], v[68:71], a[144:159]
  v_mfma_f32_32x32x16_bf16 a[160:175], v[40:43], v[72:75], a[160:175]
  v_mfma_f32_32x32x16_bf16 a[176:191], v[40:43], v[76:79], a[176:191]
  v_mfma_f32_32x32x16_bf16 a[192:207], v[44:47], v[64:67], a[192:207]
  v_mfma_f32_32x32x16_bf16 a[208:223], v[44:47], v[68:71], a[208:223]
  v_mfma_f32_32x32x16_bf16 a[224:239], v[44:47], v[72:75], a[224:239]
  v_mfma_f32_32x32x16_bf16 a[240:255], v[44:47], v[76:79], a[240:255]
  s_waitcnt vmcnt(0) lgkmcnt(0)
  s_barrier
  v_xor_b32 v4, 0x10000, v4
  v_xor_b32 v5, 0x10000, v5
  v_xor_b32 v6, 0x10000, v6
  v_xor_b32 v7, 0x10000, v7
  v_xor_b32 v8, 0x10000, v8
  v_xor_b32 v9, 0x10000, v9
  v_xor_b32 v10, 0x10000, v10
  v_xor_b32 v11, 0x10000, v11
  s_add_u32 m0, s67, 0
  v_mfma_f32_32x32x16_bf16 a[0:15], v[48:51], v[80:83], a[0:15]
  buffer_load_dwordx4 v12, s[44:47], s64 offen offset:0 lds
  ds_read_b128 v[32:35], v4 offset:0
  ds_read_b64_tr_b16 v[64:65], v8 offset:0
  v_mfma_f32_32x32x16_bf16 a[16:31], v[48:51], v[84:87], a[16:31]
  ds_read_b64_tr_b16 v[66:67], v8 offset:2048
  ds_read_b128 v[36:39], v4 offset:4096
  v_mfma_f32_32x32x16_bf16 a[32:47], v[48:51], v[88:91], a[32:47]
  buffer_load_dwordx4 v13, s[44:47], s64 offen offset:1024 lds
  ds_read_b64_tr_b16 v[68:69], v9 offset:0
  ds_read_b64_tr_b16 v[70:71], v9 offset:2048
  v_mfma_f32_32x32x16_bf16 a[48:63], v[48:51], v[92:95], a[48:63]
  ds_read_b128 v[40:43], v4 offset:8192
  ds_read_b64_tr_b16 v[72:73], v10 offset:0
  v_mfma_f32_32x32x16_bf16 a[64:79], v[52:55], v[80:83], a[64:79]
  buffer_load_dwordx4 v14, s[44:47], s64 offen offset:2048 lds
  ds_read_b64_tr_b16 v[74:75], v10 offset:2048
  v_mfma_f32_32x32x16_bf16 a[80:95], v[52:55], v[84:87], a[80:95]
  ds_read_b128 v[44:47], v4 offset:12288
  v_mfma_f32_32x32x16_bf16 a[96:111], v[52:55], v[88:91], a[96:111]
  buffer_load_dwordx4 v15, s[44:47], s64 offen offset:3072 lds
  ds_read_b64_tr_b16 v[76:77], v11 offset:0
  v_mfma_f32_32x32x16_bf16 a[112:127], v[52:55], v[92:95], a[112:127]
  ds_read_b64_tr_b16 v[78:79], v11 offset:2048
  s_add_u32 m0, s67, 4096
  v_mfma_f32_32x32x16_bf16 a[128:143], v[56:59], v[80:83], a[128:143]
  buffer_load_dwordx4 v16, s[44:47], s64 offen offset:0 lds
  v_mfma_f32_32x32x16_bf16 a[144:159], v[56:59], v[84:87], a[144:159]
  v_mfma_f32_32x32x16_bf16 a[160:175], v[56:59], v[88:91], a[160:175]
  buffer_load_dwordx4 v17, s[44:47], s64 offen offset:1024 lds
  v_mfma_f32_32x32x16_bf16 a[176:191], v[56:59], v[92:95], a[176:191]
  v_mfma_f32_32x32x16_bf16 a[192:207], v[60:63], v[80:83], a[192:207]
  buffer_load_dwordx4 v18, s[44:47], s64 offen offset:2048 lds
  v_mfma_f32_32x32x16_bf16 a[208:223], v[60:63], v[84:87], a[208:223]
  v_mfma_f32_32x32x16_bf16 a[224:239], v[60:63], v[88:91], a[224:239]
  buffer_load_dwordx4 v19, s[44:47], s64 offen offset:3072 lds
  v_mfma_f32_32x32x16_bf16 a[240:255], v[60:63], v[92:95], a[240:255]
  s_add_u32 s64, s64, 128
  s_sub_u32 s68, s68, 1
  s_cmp_lg_u32 s68, 0
  s_cbranch_scc1 gl_6
  v_lshlrev_b32 v131, 2, v1
  buffer_load_dword v130, v131, s[52:55], 0 offen sc1
  s_waitcnt lgkmcnt(0)
  s_add_u32 m0, s67, 32768
  v_mfma_f32_32x32x16_bf16 a[0:15], v[32:35], v[64:67], a[0:15]
  buffer_load_dwordx4 v20, s[48:51], s65 offen offset:0 lds
  ds_read_b128 v[48:51], v5 offset:0
  ds_read_b64_tr_b16 v[80:81], v8 offset:8192
  v_mfma_f32_32x32x16_bf16 a[16:31], v[32:35], v[68:71], a[16:31]
  ds_read_b64_tr_b16 v[82:83], v8 offset:10240
  ds_read_b128 v[52:55], v5 offset:4096
  v_mfma_f32_32x32x16_bf16 a[32:47], v[32:35], v[72:75], a[32:47]
  buffer_load_dwordx4 v21, s[48:51], s65 offen offset:1024 lds
  ds_read_b64_tr_b16 v[84:85], v9 offset:8192
  ds_read_b64_tr_b16 v[86:87], v9 offset:10240
  v_mfma_f32_32x32x16_bf16 a[48:63], v[32:35], v[76:79], a[48:63]
  ds_read_b128 v[56:59], v5 offset:8192
  ds_read_b64_tr_b16 v[88:89], v10 offset:8192
  v_mfma_f32_32x32x16_bf16 a[64:79], v[36:39], v[64:67], a[64:79]
  buffer_load_dwordx4 v22, s[48:51], s65 offen offset:2048 lds
  ds_read_b64_tr_b16 v[90:91], v10 offset:10240
  v_mfma_f32_32x32x16_bf16 a[80:95], v[36:39], v[68:71], a[80:95]
  ds_read_b128 v[60:63], v5 offset:12288
  v_mfma_f32_32x32x16_bf16 a[96:111], v[36:39], v[72:75], a[96:111]
  buffer_load_dwordx4 v23, s[48:51], s65 offen offset:3072 lds
  ds_read_b64_tr_b16 v[92:93], v11 offset:8192
  v_mfma_f32_32x32x16_bf16 a[112:127], v[36:39], v[76:79], a[112:127]
  ds_read_b64_tr_b16 v[94:95], v11 offset:10240
  s_add_u32 m0, s67, 36864
  v_mfma_f32_32x32x16_bf16 a[128:143], v[40:43], v[64:67], a[128:143]
  buffer_load_dwordx4 v24, s[48:51], s65 offen offset:0 lds
  v_mfma_f32_32x32x16_bf16 a[144:159], v[40:43], v[68:71], a[144:159]
  v_mfma_f32_32x32x16_bf16 a[160:175], v[40:43], v[72:75], a[160:175]
  buffer_load_dwordx4 v25, s[48:51], s65 offen offset:1024 lds
  v_mfma_f32_32x32x16_bf16 a[176:191], v[40:43], v[76:79], a[176:191]
  v_mfma_f32_32x32x16_bf16 a[192:207], v[44:47], v[64:67], a[192:207]
  buffer_load_dwordx4 v26, s[48:51], s65 offen offset:2048 lds
  v_mfma_f32_32x32x16_bf16 a[208:223], v[44:47], v[68:71], a[208:223]
  v_mfma_f32_32x32x16_bf16 a[224:239], v[44:47], v[72:75], a[224:239]
  buffer_load_dwordx4 v27, s[48:51], s65 offen offset:3072 lds
  v_mfma_f32_32x32x16_bf16 a[240:255], v[44:47], v[76:79], a[240:255]
  s_add_u32 s65, s65, s66
  s_xor_b32 s67, s67, 0x10000
  s_waitcnt lgkmcnt(0)
  v_mfma_f32_32x32x16_bf16 a[0:15], v[48:51], v[80:83], a[0:15]
  ds_read_b128 v[32:35], v6 offset:0
  ds_read_b64_tr_b16 v[64:65], v8 offset:16384
  v_mfma_f32_32x32x16_bf16 a[16:31], v[48:51], v[84:87], a[16:31]
  ds_read_b64_tr_b16 v[66:67], v8 offset:18432
  ds_read_b128 v[36:39], v6 offset:4096
  v_mfma_f32_32x32x16_bf16 a[32:47], v[48:51], v[88:91], a[32:47]
  ds_read_b64_tr_b16 v[68:69], v9 offset:16384
  ds_read_b64_tr_b16 v[70:71], v9 offset:18432
  v_mfma_f32_32x32x16_bf16 a[48:63], v[48:51], v[92:95], a[48:63]
  ds_read_b128 v[40:43], v6 offset:8192
  ds_read_b64_tr_b16 v[72:73], v10 offset:16384
  v_mfma_f32_32x32x16_bf16 a[64:79], v[52:55], v[80:83], a[64:79]
  ds_read_b64_tr_b16 v[74:75], v10 offset:18432
  v_mfma_f32_32x32x16_bf16 a[80:95], v[52:55], v[84:87], a[80:95]
  ds_read_b128 v[44:47], v6 offset:12288
  v_mfma_f32_32x32x16_bf16 a[96:111], v[52:55], v[88:91], a[96:111]
  ds_read_b64_tr_b16 v[76:77], v11 offset:16384
  v_mfma_f32_32x32x16_bf16 a[112:127], v[52:55], v[92:95], a[112:127]
  ds_read_b64_tr_b16 v[78:79], v11 offset:18432
  v_mfma_f32_32x32x16_bf16 a[128:143], v[56:59], v[80:83], a[128:143]
  v_mfma_f32_32x32x16_bf16 a[144:159], v[56:59], v[84:87], a[144:159]
  v_mfma_f32_32x32x16_bf16 a[160:175], v[56:59], v[88:91], a[160:175]
  v_mfma_f32_32x32x16_bf16 a[176:191], v[56:59], v[92:95], a[176:191]
  v_mfma_f32_32x32x16_bf16 a[192:207], v[60:63], v[80:83], a[192:207]
  v_mfma_f32_32x32x16_bf16 a[208:223], v[60:63], v[84:87], a[208:223]
  v_mfma_f32_32x32x16_bf16 a[224:239], v[60:63], v[88:91], a[224:239]
  v_mfma_f32_32x32x16_bf16 a[240:255], v[60:63], v[92:95], a[240:255]
  s_waitcnt lgkmcnt(0)
  v_mfma_f32_32x32x16_bf16 a[0:15], v[32:35], v[64:67], a[0:15]
  ds_read_b128 v[48:51], v7 offset:0
  ds_read_b64_tr_b16 v[80:81], v8 offset:24576
  v_mfma_f32_32x32x16_bf16 a[16:31], v[32:35], v[68:71], a[16:31]
  ds_read_b64_tr_b16 v[82:83], v8 offset:26624
  ds_read_b128 v[52:55], v7 offset:4096
  v_mfma_f32_32x32x16_bf16 a[32:47], v[32:35], v[72:75], a[32:47]
  ds_read_b64_tr_b16 v[84:85], v9 offset:24576
  ds_read_b64_tr_b16 v[86:87], v9 offset:26624
  v_mfma_f32_32x32x16_bf16 a[48:63], v[32:35], v[76:79], a[48:63]
  ds_read_b128 v[56:59], v7 offset:8192
  ds_read_b64_tr_b16 v[88:89], v10 offset:24576
  v_mfma_f32_32x32x16_bf16 a[64:79], v[36:39], v[64:67], a[64:79]
  ds_read_b64_tr_b16 v[90:91], v10 offset:26624
  v_mfma_f32_32x32x16_bf16 a[80:95], v[36:39], v[68:71], a[80:95]
  ds_read_b128 v[60:63], v7 offset:12288
  v_mfma_f32_32x32x16_bf16 a[96:111], v[36:39], v[72:75], a[96:111]
  ds_read_b64_tr_b16 v[92:93], v11 offset:24576
  v_mfma_f32_32x32x16_bf16 a[112:127], v[36:39], v[76:79], a[112:127]
  ds_read_b64_tr_b16 v[94:95], v11 offset:26624
  v_mfma_f32_32x32x16_bf16 a[128:143], v[40:43], v[64:67], a[128:143]
  v_mfma_f32_32x32x16_bf16 a[144:159], v[40:43], v[68:71], a[144:159]
  v_mfma_f32_32x32x16_bf16 a[160:175], v[40:43], v[72:75], a[160:175]
  v_mfma_f32_32x32x16_bf16 a[176:191], v[40:43], v[76:79], a[176:191]
  v_mfma_f32_32x32x16_bf16 a[192:207], v[44:47], v[64:67], a[192:207]
  v_mfma_f32_32x32x16_bf16 a[208:223], v[44:47], v[68:71], a[208:223]
  v_mfma_f32_32x32x16_bf16 a[224:239], v[44:47], v[72:75], a[224:239]
  v_mfma_f32_32x32x16_bf16 a[240:255], v[44:47], v[76:79], a[240:255]
  s_waitcnt vmcnt(0) lgkmcnt(0)
  s_barrier
  v_xor_b32 v4, 0x10000, v4
  v_xor_b32 v5, 0x10000, v5
  v_xor_b32 v6, 0x10000, v6
  v_xor_b32 v7, 0x10000, v7
  v_xor_b32 v8, 0x10000, v8
  v_xor_b32 v9, 0x10000, v9
  v_xor_b32 v10, 0x10000, v10
  v_xor_b32 v11, 0x10000, v11
  v_mfma_f32_32x32x16_bf16 a[0:15], v[48:51], v[80:83], a[0:15]
  ds_read_b128 v[32:35], v4 offset:0
  ds_read_b64_tr_b16 v[64:65], v8 offset:0
  v_mfma_f32_32x32x16_bf16 a[16:31], v[48:51], v[84:87], a[16:31]
  ds_read_b64_tr_b16 v[66:67], v8 offset:2048
  ds_read_b128 v[36:39], v4 offset:4096
  v_mfma_f32_32x32x16_bf16 a[32:47], v[48:51], v[88:91], a[32:47]
  ds_read_b64_tr_b16 v[68:69], v9 offset:0
  ds_read_b64_tr_b16 v[70:71], v9 offset:2048
  v_mfma_f32_32x32x16_bf16 a[48:63], v[48:51], v[92:95], a[48:63]
  ds_read_b128 v[40:43], v4 offset:8192
  ds_read_b64_tr_b16 v[72:73], v10 offset:0
  v_mfma_f32_32x32x16_bf16 a[64:79], v[52:55], v[80:83], a[64:79]
  ds_read_b64_tr_b16 v[74:75], v10 offset:2048
  v_mfma_f32_32x32x16_bf16 a[80:95], v[52:55], v[84:87], a[80:95]
  ds_read_b128 v[44:47], v4 offset:12288
  v_mfma_f32_32x32x16_bf16 a[96:111], v[52:55], v[88:91], a[96:111]
  ds_read_b64_tr_b16 v[76:77], v11 offset:0
  v_mfma_f32_32x32x16_bf16 a[112:127], v[52:55], v[92:95], a[112:127]
  ds_read_b64_tr_b16 v[78:79], v11 offset:2048
  v_mfma_f32_32x32x16_bf16 a[128:143], v[56:59], v[80:83], a[128:143]
  v_mfma_f32_32x32x16_bf16 a[144:159], v[56:59], v[84:87], a[144:159]
  v_mfma_f32_32x32x16_bf16 a[160:175], v[56:59], v[88:91], a[160:175]
  v_mfma_f32_32x32x16_bf16 a[176:191], v[56:59], v[92:95], a[176:191]
  v_mfma_f32_32x32x16_bf16 a[192:207], v[60:63], v[80:83], a[192:207]
  v_mfma_f32_32x32x16_bf16 a[208:223], v[60:63], v[84:87], a[208:223]
  v_mfma_f32_32x32x16_bf16 a[224:239], v[60:63], v[88:91], a[224:239]
  v_mfma_f32_32x32x16_bf16 a[240:255], v[60:63], v[92:95], a[240:255]
  s_waitcnt lgkmcnt(0)
  v_mfma_f32_32x32x16_bf16 a[0:15], v[32:35], v[64:67], a[0:15]
  ds_read_b128 v[48:51], v5 offset:0
  ds_read_b64_tr_b16 v[80:81], v8 offset:8192
  v_mfma_f32_32x32x16_bf16 a[16:31], v[32:35], v[68:71], a[16:31]
  ds_read_b64_tr_b16 v[82:83], v8 offset:10240
  ds_read_b128 v[52:55], v5 offset:4096
  v_mfma_f32_32x32x16_bf16 a[32:47], v[32:35], v[72:75], a[32:47]
  ds_read_b64_tr_b16 v[84:85], v9 offset:8192
  ds_read_b64_tr_b16 v[86:87], v9 offset:10240
  v_mfma_f32_32x32x16_bf16 a[48:63], v[32:35], v[76:79], a[48:63]
  ds_read_b128 v[56:59], v5 offset:8192
  ds_read_b64_tr_b16 v[88:89], v10 offset:8192
  v_mfma_f32_32x32x16_bf16 a[64:79], v[36:39], v[64:67], a[64:79]
  ds_read_b64_tr_b16 v[90:91], v10 offset:10240
  v_mfma_f32_32x32x16_bf16 a[80:95], v[36:39], v[68:71], a[80:95]
  ds_read_b128 v[60:63], v5 offset:12288
  v_mfma_f32_32x32x16_bf16 a[96:111], v[36:39], v[72:75], a[96:111]
  ds_read_b64_tr_b16 v[92:93], v11 offset:8192
  v_mfma_f32_32x32x16_bf16 a[112:127], v[36:39], v[76:79], a[112:127]
  ds_read_b64_tr_b16 v[94:95], v11 offset:10240
  v_mfma_f32_32x32x16_bf16 a[128:143], v[40:43], v[64:67], a[128:143]
  v_mfma_f32_32x32x16_bf16 a[144:159], v[40:43], v[68:71], a[144:159]
  v_mfma_f32_32x32x16_bf16 a[160:175], v[40:43], v[72:75], a[160:175]
  v_mfma_f32_32x32x16_bf16 a[176:191], v[40:43], v[76:79], a[176:191]
  v_mfma_f32_32x32x16_bf16 a[192:207], v[44:47], v[64:67], a[192:207]
  v_mfma_f32_32x32x16_bf16 a[208:223], v[44:47], v[68:71], a[208:223]
  v_mfma_f32_32x32x16_bf16 a[224:239], v[44:47], v[72:75], a[224:239]
  v_mfma_f32_32x32x16_bf16 a[240:255], v[44:47], v[76:79], a[240:255]
  s_waitcnt lgkmcnt(0)
  v_mfma_f32_32x32x16_bf16 a[0:15], v[48:51], v[80:83], a[0:15]
  ds_read_b128 v[32:35], v6 offset:0
  ds_read_b64_tr_b16 v[64:65], v8 offset:16384
  v_mfma_f32_32x32x16_bf16 a[16:31], v[48:51], v[84:87], a[16:31]
  ds_read_b64_tr_b16 v[66:67], v8 offset:18432
  ds_read_b128 v[36:39], v6 offset:4096
  v_mfma_f32_32x32x16_bf16 a[32:47], v[48:51], v[88:91], a[32:47]
  ds_read_b64_tr_b16 v[68:69], v9 offset:16384
  ds_read_b64_tr_b16 v[70:71], v9 offset:18432
  v_mfma_f32_32x32x16_bf16 a[48:63], v[48:51], v[92:95], a[48:63]
  ds_read_b128 v[40:43], v6 offset:8192
  ds_read_b64_tr_b16 v[72:73], v10 offset:16384
  v_mfma_f32_32x32x16_bf16 a[64:79], v[52:55], v[80:83], a[64:79]
  ds_read_b64_tr_b16 v[74:75], v10 offset:18432
  v_mfma_f32_32x32x16_bf16 a[80:95], v[52:55], v[84:87], a[80:95]
  ds_read_b128 v[44:47], v6 offset:12288
  v_mfma_f32_32x32x16_bf16 a[96:111], v[52:55], v[88:91], a[96:111]
  ds_read_b64_tr_b16 v[76:77], v11 offset:16384
  v_mfma_f32_32x32x16_bf16 a[112:127], v[52:55], v[92:95], a[112:127]
  ds_read_b64_tr_b16 v[78:79], v11 offset:18432
  v_mfma_f32_32x32x16_bf16 a[128:143], v[56:59], v[80:83], a[128:143]
  v_mfma_f32_32x32x16_bf16 a[144:159], v[56:59], v[84:87], a[144:159]
  v_mfma_f32_32x32x16_bf16 a[160:175], v[56:59], v[88:91], a[160:175]
  v_mfma_f32_32x32x16_bf16 a[176:191], v[56:59], v[92:95], a[176:191]
  v_mfma_f32_32x32x16_bf16 a[192:207], v[60:63], v[80:83], a[192:207]
  v_mfma_f32_32x32x16_bf16 a[208:223], v[60:63], v[84:87], a[208:223]
  v_mfma_f32_32x32x16_bf16 a[224:239], v[60:63], v[88:91], a[224:239]
  v_mfma_f32_32x32x16_bf16 a[240:255], v[60:63], v[92:95], a[240:255]
  s_waitcnt lgkmcnt(0)
  v_mfma_f32_32x32x16_bf16 a[0:15], v[32:35], v[64:67], a[0:15]
  ds_read_b128 v[48:51], v7 offset:0
  ds_read_b64_tr_b16 v[80:81], v8 offset:24576
  v_mfma_f32_32x32x16_bf16 a[16:31], v[32:35], v[68:71], a[16:31]
  ds_read_b64_tr_b16 v[82:83], v8 offset:26624
  ds_read_b128 v[52:55], v7 offset:4096
  v_mfma_f32_32x32x16_bf16 a[32:47], v[32:35], v[72:75], a[32:47]
  ds_read_b64_tr_b16 v[84:85], v9 offset:24576
  ds_read_b64_tr_b16 v[86:87], v9 offset:26624
  v_mfma_f32_32x32x16_bf16 a[48:63], v[32:35], v[76:79], a[48:63]
  ds_read_b128 v[56:59], v7 offset:8192
  ds_read_b64_tr_b16 v[88:89], v10 offset:24576
  v_mfma_f32_32x32x16_bf16 a[64:79], v[36:39], v[64:67], a[64:79]
  ds_read_b64_tr_b16 v[90:91], v10 offset:26624
  v_mfma_f32_32x32x16_bf16 a[80:95], v[36:39], v[68:71], a[80:95]
  ds_read_b128 v[60:63], v7 offset:12288
  v_mfma_f32_32x32x16_bf16 a[96:111], v[36:39], v[72:75], a[96:111]
  ds_read_b64_tr_b16 v[92:93], v11 offset:24576
  v_mfma_f32_32x32x16_bf16 a[112:127], v[36:39], v[76:79], a[112:127]
  ds_read_b64_tr_b16 v[94:95], v11 offset:26624
  v_mfma_f32_32x32x16_bf16 a[128:143], v[40:43], v[64:67], a[128:143]
  v_mfma_f32_32x32x16_bf16 a[144:159], v[40:43], v[68:71], a[144:159]
  v_mfma_f32_32x32x16_bf16 a[160:175], v[40:43], v[72:75], a[160:175]
  v_mfma_f32_32x32x16_bf16 a[176:191], v[40:43], v[76:79], a[176:191]
  v_mfma_f32_32x32x16_bf16 a[192:207], v[44:47], v[64:67], a[192:207]
  v_mfma_f32_32x32x16_bf16 a[208:223], v[44:47], v[68:71], a[208:223]
  v_mfma_f32_32x32x16_bf16 a[224:239], v[44:47], v[72:75], a[224:239]
  v_mfma_f32_32x32x16_bf16 a[240:255], v[44:47], v[76:79], a[240:255]
  s_waitcnt lgkmcnt(0)
  v_mfma_f32_32x32x16_bf16 a[0:15], v[48:51], v[80:83], a[0:15]
  v_mfma_f32_32x32x16_bf16 a[16:31], v[48:51], v[84:87], a[16:31]
  v_mfma_f32_32x32x16_bf16 a[32:47], v[48:51], v[88:91], a[32:47]
  v_mfma_f32_32x32x16_bf16 a[48:63], v[48:51], v[92:95], a[48:63]
  v_mfma_f32_32x32x16_bf16 a[64:79], v[52:55], v[80:83], a[64:79]
  v_mfma_f32_32x32x16_bf16 a[80:95], v[52:55], v[84:87], a[80:95]
  v_mfma_f32_32x32x16_bf16 a[96:111], v[52:55], v[88:91], a[96:111]
  v_mfma_f32_32x32x16_bf16 a[112:127], v[52:55], v[92:95], a[112:127]
  v_mfma_f32_32x32x16_bf16 a[128:143], v[56:59], v[80:83], a[128:143]
  v_mfma_f32_32x32x16_bf16 a[144:159], v[56:59], v[84:87], a[144:159]
  v_mfma_f32_32x32x16_bf16 a[160:175], v[56:59], v[88:91], a[160:175]
  v_mfma_f32_32x32x16_bf16 a[176:191], v[56:59], v[92:95], a[176:191]
  v_mfma_f32_32x32x16_bf16 a[192:207], v[60:63], v[80:83], a[192:207]
  v_mfma_f32_32x32x16_bf16 a[208:223], v[60:63], v[84:87], a[208:223]
  v_mfma_f32_32x32x16_bf16 a[224:239], v[60:63], v[88:91], a[224:239]
  v_mfma_f32_32x32x16_bf16 a[240:255], v[60:63], v[92:95], a[240:255]
  s_cmp_eq_u32 s72, 3
  s_cbranch_scc1 L_epi_av
L_epi_b:
  v_lshlrev_b32 v96, 4, v1
  v_lshlrev_b32 v97, 3, v1
  s_mul_i32 s77, s70, 0
  s_add_u32 s77, s77, s69
  v_accvgpr_read_b32 v32, a0
  v_accvgpr_read_b32 v33, a1
  v_accvgpr_read_b32 v34, a2
  v_accvgpr_read_b32 v35, a3
  v_accvgpr_read_b32 v36, a4
  v_accvgpr_read_b32 v37, a5
  v_accvgpr_read_b32 v38, a6
  v_accvgpr_read_b32 v39, a7
  v_accvgpr_read_b32 v40, a8
  v_accvgpr_read_b32 v41, a9
  v_accvgpr_read_b32 v42, a10
  v_accvgpr_read_b32 v43, a11
  v_accvgpr_read_b32 v44, a12
  v_accvgpr_read_b32 v45, a13
  v_accvgpr_read_b32 v46, a14
  v_accvgpr_read_b32 v47, a15
  v_cvt_pk_bf16_f32 v48, v32, v33
  v_cvt_pk_bf16_f32 v49, v34, v35
  v_cvt_pk_bf16_f32 v50, v36, v37
  v_cvt_pk_bf16_f32 v51, v38, v39
  v_cvt_pk_bf16_f32 v52, v40, v41
  v_cvt_pk_bf16_f32 v53, v42, v43
  v_cvt_pk_bf16_f32 v54, v44, v45
  v_cvt_pk_bf16_f32 v55, v46, v47
  buffer_store_dwordx4 v[48:51], v96, s[36:39], s77 offen sc1
  buffer_store_dwordx4 v[52:55], v96, s[36:39], s77 offen offset:1024 sc1
  s_add_u32 s77, s77, s71
  v_accvgpr_read_b32 v56, a16
  v_accvgpr_read_b32 v57, a17
  v_accvgpr_read_b32 v58, a18
  v_accvgpr_read_b32 v59, a19
  v_accvgpr_read_b32 v60, a20
  v_accvgpr_read_b32 v61, a21
  v_accvgpr_read_b32 v62, a22
  v_accvgpr_read_b32 v63, a23
  v_accvgpr_read_b32 v64, a24
  v_accvgpr_read_b32 v65, a25
  v_accvgpr_read_b32 v66, a26
  v_accvgpr_read_b32 v67, a27
  v_accvgpr_read_b32 v68, a28
  v_accvgpr_read_b32 v69, a29
  v_accvgpr_read_b32 v70, a30
  v_accvgpr_read_b32 v71, a31
  v_cvt_pk_bf16_f32 v72, v56, v57
  v_cvt_pk_bf16_f32 v73, v58, v59
  v_cvt_pk_bf16_f32 v74, v60, v61
  v_cvt_pk_bf16_f32 v75, v62, v63
  v_cvt_pk_bf16_f32 v76, v64, v65
  v_cvt_pk_bf16_f32 v77, v66, v67
  v_cvt_pk_bf16_f32 v78, v68, v69
  v_cvt_pk_bf16_f32 v79, v70, v71
  buffer_store_dwordx4 v[72:75], v96, s[36:39], s77 offen sc1
  buffer_store_dwordx4 v[76:79], v96, s[36:39], s77 offen offset:1024 sc1
  s_add_u32 s77, s77, s71
  v_accvgpr_read_b32 v32, a32
  v_accvgpr_read_b32 v33, a33
  v_accvgpr_read_b32 v34, a34
  v_accvgpr_read_b32 v35, a35
  v_accvgpr_read_b32 v36, a36
  v_accvgpr_read_b32 v37, a37
  v_accvgpr_read_b32 v38, a38
  v_accvgpr_read_b32 v39, a39
  v_accvgpr_read_b32 v40, a40
  v_accvgpr_read_b32 v41, a41
  v_accvgpr_read_b32 v42, a42
  v_accvgpr_read_b32 v43, a43
  v_accvgpr_read_b32 v44, a44
  v_accvgpr_read_b32 v45, a45
  v_accvgpr_read_b32 v46, a46
  v_accvgpr_read_b32 v47, a47
  v_cvt_pk_bf16_f32 v48, v32, v33
  v_cvt_pk_bf16_f32 v49, v34, v35
  v_cvt_pk_bf16_f32 v50, v36, v37
  v_cvt_pk_bf16_f32 v51, v38, v39
  v_cvt_pk_bf16_f32 v52, v40, v41
  v_cvt_pk_bf16_f32 v53, v42, v43
  v_cvt_pk_bf16_f32 v54, v44, v45
  v_cvt_pk_bf16_f32 v55, v46, v47
  buffer_store_dwordx4 v[48:51], v96, s[36:39], s77 offen sc1
  buffer_store_dwordx4 v[52:55], v96, s[36:39], s77 offen offset:1024 sc1
  s_add_u32 s77, s77, s71
  v_accvgpr_read_b32 v56, a48
  v_accvgpr_read_b32 v57, a49
  v_accvgpr_read_b32 v58, a50
  v_accvgpr_read_b32 v59, a51
  v_accvgpr_read_b32 v60, a52
  v_accvgpr_read_b32 v61, a53
  v_accvgpr_read_b32 v62, a54
  v_accvgpr_read_b32 v63, a55
  v_accvgpr_read_b32 v64, a56
  v_accvgpr_read_b32 v65, a57
  v_accvgpr_read_b32 v66, a58
  v_accvgpr_read_b32 v67, a59
  v_accvgpr_read_b32 v68, a60
  v_accvgpr_read_b32 v69, a61
  v_accvgpr_read_b32 v70, a62
  v_accvgpr_read_b32 v71, a63
  v_cvt_pk_bf16_f32 v72, v56, v57
  v_cvt_pk_bf16_f32 v73, v58, v59
  v_cvt_pk_bf16_f32 v74, v60, v61
  v_cvt_pk_bf16_f32 v75, v62, v63
  v_cvt_pk_bf16_f32 v76, v64, v65
  v_cvt_pk_bf16_f32 v77, v66, v67
  v_cvt_pk_bf16_f32 v78, v68, v69
  v_cvt_pk_bf16_f32 v79, v70, v71
  buffer_store_dwordx4 v[72:75], v96, s[36:39], s77 offen sc1
  buffer_store_dwordx4 v[76:79], v96, s[36:39], s77 offen offset:1024 sc1
  s_mul_i32 s77, s70, 1
  s_add_u32 s77, s77, s69
  v_accvgpr_read_b32 v32, a64
  v_accvgpr_read_b32 v33, a65
  v_accvgpr_read_b32 v34, a66
  v_accvgpr_read_b32 v35, a67
  v_accvgpr_read_b32 v36, a68
  v_accvgpr_read_b32 v37, a69
  v_accvgpr_read_b32 v38, a70
  v_accvgpr_read_b32 v39, a71
  v_accvgpr_read_b32 v40, a72
  v_accvgpr_read_b32 v41, a73
  v_accvgpr_read_b32 v42, a74
  v_accvgpr_read_b32 v43, a75
  v_accvgpr_read_b32 v44, a76
  v_accvgpr_read_b32 v45, a77
  v_accvgpr_read_b32 v46, a78
  v_accvgpr_read_b32 v47, a79
  v_cvt_pk_bf16_f32 v48, v32, v33
  v_cvt_pk_bf16_f32 v49, v34, v35
  v_cvt_pk_bf16_f32 v50, v36, v37
  v_cvt_pk_bf16_f32 v51, v38, v39
  v_cvt_pk_bf16_f32 v52, v40, v41
  v_cvt_pk_bf16_f32 v53, v42, v43
  v_cvt_pk_bf16_f32 v54, v44, v45
  v_cvt_pk_bf16_f32 v55, v46, v47
  buffer_store_dwordx4 v[48:51], v96, s[36:39], s77 offen sc1
  buffer_store_dwordx4 v[52:55], v96, s[36:39], s77 offen offset:1024 sc1
  s_add_u32 s77, s77, s71
  v_accvgpr_read_b32 v56, a80
  v_accvgpr_read_b32 v57, a81
  v_accvgpr_read_b32 v58, a82
  v_accvgpr_read_b32 v59, a83
  v_accvgpr_read_b32 v60, a84
  v_accvgpr_read_b32 v61, a85
  v_accvgpr_read_b32 v62, a86
  v_accvgpr_read_b32 v63, a87
  v_accvgpr_read_b32 v64, a88
  v_accvgpr_read_b32 v65, a89
  v_accvgpr_read_b32 v66, a90
  v_accvgpr_read_b32 v67, a91
  v_accvgpr_read_b32 v68, a92
  v_accvgpr_read_b32 v69, a93
  v_accvgpr_read_b32 v70, a94
  v_accvgpr_read_b32 v71, a95
  v_cvt_pk_bf16_f32 v72, v56, v57
  v_cvt_pk_bf16_f32 v73, v58, v59
  v_cvt_pk_bf16_f32 v74, v60, v61
  v_cvt_pk_bf16_f32 v75, v62, v63
  v_cvt_pk_bf16_f32 v76, v64, v65
  v_cvt_pk_bf16_f32 v77, v66, v67
  v_cvt_pk_bf16_f32 v78, v68, v69
  v_cvt_pk_bf16_f32 v79, v70, v71
  buffer_store_dwordx4 v[72:75], v96, s[36:39], s77 offen sc1
  buffer_store_dwordx4 v[76:79], v96, s[36:39], s77 offen offset:1024 sc1
  s_add_u32 s77, s77, s71
  v_accvgpr_read_b32 v32, a96
  v_accvgpr_read_b32 v33, a97
  v_accvgpr_read_b32 v34, a98
  v_accvgpr_read_b32 v35, a99
  v_accvgpr_read_b32 v36, a100
  v_accvgpr_read_b32 v37, a101
  v_accvgpr_read_b32 v38, a102
  v_accvgpr_read_b32 v39, a103
  v_accvgpr_read_b32 v40, a104
  v_accvgpr_read_b32 v41, a105
  v_accvgpr_read_b32 v42, a106
  v_accvgpr_read_b32 v43, a107
  v_accvgpr_read_b32 v44, a108
  v_accvgpr_read_b32 v45, a109
  v_accvgpr_read_b32 v46, a110
  v_accvgpr_read_b32 v47, a111
  v_cvt_pk_bf16_f32 v48, v32, v33
  v_cvt_pk_bf16_f32 v49, v34, v35
  v_cvt_pk_bf16_f32 v50, v36, v37
  v_cvt_pk_bf16_f32 v51, v38, v39
  v_cvt_pk_bf16_f32 v52, v40, v41
  v_cvt_pk_bf16_f32 v53, v42, v43
  v_cvt_pk_bf16_f32 v54, v44, v45
  v_cvt_pk_bf16_f32 v55, v46, v47
  buffer_store_dwordx4 v[48:51], v96, s[36:39], s77 offen sc1
  buffer_store_dwordx4 v[52:55], v96, s[36:39], s77 offen offset:1024 sc1
  s_add_u32 s77, s77, s71
  v_accvgpr_read_b32 v56, a112
  v_accvgpr_read_b32 v57, a113
  v_accvgpr_read_b32 v58, a114
  v_accvgpr_read_b32 v59, a115
  v_accvgpr_read_b32 v60, a116
  v_accvgpr_read_b32 v61, a117
  v_accvgpr_read_b32 v62, a118
  v_accvgpr_read_b32 v63, a119
  v_accvgpr_read_b32 v64, a120
  v_accvgpr_read_b32 v65, a121
  v_accvgpr_read_b32 v66, a122
  v_accvgpr_read_b32 v67, a123
  v_accvgpr_read_b32 v68, a124
  v_accvgpr_read_b32 v69, a125
  v_accvgpr_read_b32 v70, a126
  v_accvgpr_read_b32 v71, a127
  v_cvt_pk_bf16_f32 v72, v56, v57
  v_cvt_pk_bf16_f32 v73, v58, v59
  v_cvt_pk_bf16_f32 v74, v60, v61
  v_cvt_pk_bf16_f32 v75, v62, v63
  v_cvt_pk_bf16_f32 v76, v64, v65
  v_cvt_pk_bf16_f32 v77, v66, v67
  v_cvt_pk_bf16_f32 v78, v68, v69
  v_cvt_pk_bf16_f32 v79, v70, v71
  buffer_store_dwordx4 v[72:75], v96, s[36:39], s77 offen sc1
  buffer_store_dwordx4 v[76:79], v96, s[36:39], s77 offen offset:1024 sc1
  s_mul_i32 s77, s70, 2
  s_add_u32 s77, s77, s69
  v_accvgpr_read_b32 v32, a128
  v_accvgpr_read_b32 v33, a129
  v_accvgpr_read_b32 v34, a130
  v_accvgpr_read_b32 v35, a131
  v_accvgpr_read_b32 v36, a132
  v_accvgpr_read_b32 v37, a133
  v_accvgpr_read_b32 v38, a134
  v_accvgpr_read_b32 v39, a135
  v_accvgpr_read_b32 v40, a136
  v_accvgpr_read_b32 v41, a137
  v_accvgpr_read_b32 v42, a138
  v_accvgpr_read_b32 v43, a139
  v_accvgpr_read_b32 v44, a140
  v_accvgpr_read_b32 v45, a141
  v_accvgpr_read_b32 v46, a142
  v_accvgpr_read_b32 v47, a143
  v_cvt_pk_bf16_f32 v48, v32, v33
  v_cvt_pk_bf16_f32 v49, v34, v35
  v_cvt_pk_bf16_f32 v50, v36, v37
  v_cvt_pk_bf16_f32 v51, v38, v39
  v_cvt_pk_bf16_f32 v52, v40, v41
  v_cvt_pk_bf16_f32 v53, v42, v43
  v_cvt_pk_bf16_f32 v54, v44, v45
  v_cvt_pk_bf16_f32 v55, v46, v47
  buffer_store_dwordx4 v[48:51], v96, s[36:39], s77 offen sc1
  buffer_store_dwordx4 v[52:55], v96, s[36:39], s77 offen offset:1024 sc1
  s_add_u32 s77, s77, s71
  v_accvgpr_read_b32 v56, a144
  v_accvgpr_read_b32 v57, a145
  v_accvgpr_read_b32 v58, a146
  v_accvgpr_read_b32 v59, a147
  v_accvgpr_read_b32 v60, a148
  v_accvgpr_read_b32 v61, a149
  v_accvgpr_read_b32 v62, a150
  v_accvgpr_read_b32 v63, a151
  v_accvgpr_read_b32 v64, a152
  v_accvgpr_read_b32 v65, a153
  v_accvgpr_read_b32 v66, a154
  v_accvgpr_read_b32 v67, a155
  v_accvgpr_read_b32 v68, a156
  v_accvgpr_read_b32 v69, a157
  v_accvgpr_read_b32 v70, a158
  v_accvgpr_read_b32 v71, a159
  v_cvt_pk_bf16_f32 v72, v56, v57
  v_cvt_pk_bf16_f32 v73, v58, v59
  v_cvt_pk_bf16_f32 v74, v60, v61
  v_cvt_pk_bf16_f32 v75, v62, v63
  v_cvt_pk_bf16_f32 v76, v64, v65
  v_cvt_pk_bf16_f32 v77, v66, v67
  v_cvt_pk_bf16_f32 v78, v68, v69
  v_cvt_pk_bf16_f32 v79, v70, v71
  buffer_store_dwordx4 v[72:75], v96, s[36:39], s77 offen sc1
  buffer_store_dwordx4 v[76:79], v96, s[36:39], s77 offen offset:1024 sc1
  s_add_u32 s77, s77, s71
  v_accvgpr_read_b32 v32, a160
  v_accvgpr_read_b32 v33, a161
  v_accvgpr_read_b32 v34, a162
  v_accvgpr_read_b32 v35, a163
  v_accvgpr_read_b32 v36, a164
  v_accvgpr_read_b32 v37, a165
  v_accvgpr_read_b32 v38, a166
  v_accvgpr_read_b32 v39, a167
  v_accvgpr_read_b32 v40, a168
  v_accvgpr_read_b32 v41, a169
  v_accvgpr_read_b32 v42, a170
  v_accvgpr_read_b32 v43, a171
  v_accvgpr_read_b32 v44, a172
  v_accvgpr_read_b32 v45, a173
  v_accvgpr_read_b32 v46, a174
  v_accvgpr_read_b32 v47, a175
  v_cvt_pk_bf16_f32 v48, v32, v33
  v_cvt_pk_bf16_f32 v49, v34, v35
  v_cvt_pk_bf16_f32 v50, v36, v37
  v_cvt_pk_bf16_f32 v51, v38, v39
  v_cvt_pk_bf16_f32 v52, v40, v41
  v_cvt_pk_bf16_f32 v53, v42, v43
  v_cvt_pk_bf16_f32 v54, v44, v45
  v_cvt_pk_bf16_f32 v55, v46, v47
  buffer_store_dwordx4 v[48:51], v96, s[36:39], s77 offen sc1
  buffer_store_dwordx4 v[52:55], v96, s[36:39], s77 offen offset:1024 sc1
  s_add_u32 s77, s77, s71
  v_accvgpr_read_b32 v56, a176
  v_accvgpr_read_b32 v57, a177
  v_accvgpr_read_b32 v58, a178
  v_accvgpr_read_b32 v59, a179
  v_accvgpr_read_b32 v60, a180
  v_accvgpr_read_b32 v61, a181
  v_accvgpr_read_b32 v62, a182
  v_accvgpr_read_b32 v63, a183
  v_accvgpr_read_b32 v64, a184
  v_accvgpr_read_b32 v65, a185
  v_accvgpr_read_b32 v66, a186
  v_accvgpr_read_b32 v67, a187
  v_accvgpr_read_b32 v68, a188
  v_accvgpr_read_b32 v69, a189
  v_accvgpr_read_b32 v70, a190
  v_accvgpr_read_b32 v71, a191
  v_cvt_pk_bf16_f32 v72, v56, v57
  v_cvt_pk_bf16_f32 v73, v58, v59
  v_cvt_pk_bf16_f32 v74, v60, v61
  v_cvt_pk_bf16_f32 v75, v62, v63
  v_cvt_pk_bf16_f32 v76, v64, v65
  v_cvt_pk_bf16_f32 v77, v66, v67
  v_cvt_pk_bf16_f32 v78, v68, v69
  v_cvt_pk_bf16_f32 v79, v70, v71
  buffer_store_dwordx4 v[72:75], v96, s[36:39], s77 offen sc1
  buffer_store_dwordx4 v[76:79], v96, s[36:39], s77 offen offset:1024 sc1
  s_mul_i32 s77, s70, 3
  s_add_u32 s77, s77, s69
  v_accvgpr_read_b32 v32, a192
  v_accvgpr_read_b32 v33, a193
  v_accvgpr_read_b32 v34, a194
  v_accvgpr_read_b32 v35, a195
  v_accvgpr_read_b32 v36, a196
  v_accvgpr_read_b32 v37, a197
  v_accvgpr_read_b32 v38, a198
  v_accvgpr_read_b32 v39, a199
  v_accvgpr_read_b32 v40, a200
  v_accvgpr_read_b32 v41, a201
  v_accvgpr_read_b32 v42, a202
  v_accvgpr_read_b32 v43, a203
  v_accvgpr_read_b32 v44, a204
  v_accvgpr_read_b32 v45, a205
  v_accvgpr_read_b32 v46, a206
  v_accvgpr_read_b32 v47, a207
  v_cvt_pk_bf16_f32 v48, v32, v33
  v_cvt_pk_bf16_f32 v49, v34, v35
  v_cvt_pk_bf16_f32 v50, v36, v37
  v_cvt_pk_bf16_f32 v51, v38, v39
  v_cvt_pk_bf16_f32 v52, v40, v41
  v_cvt_pk_bf16_f32 v53, v42, v43
  v_cvt_pk_bf16_f32 v54, v44, v45
  v_cvt_pk_bf16_f32 v55, v46, v47
  buffer_store_dwordx4 v[48:51], v96, s[36:39], s77 offen sc1
  buffer_store_dwordx4 v[52:55], v96, s[36:39], s77 offen offset:1024 sc1
  s_add_u32 s77, s77, s71
  v_accvgpr_read_b32 v56, a208
  v_accvgpr_read_b32 v57, a209
  v_accvgpr_read_b32 v58, a210
  v_accvgpr_read_b32 v59, a211
  v_accvgpr_read_b32 v60, a212
  v_accvgpr_read_b32 v61, a213
  v_accvgpr_read_b32 v62, a214
  v_accvgpr_read_b32 v63, a215
  v_accvgpr_read_b32 v64, a216
  v_accvgpr_read_b32 v65, a217
  v_accvgpr_read_b32 v66, a218
  v_accvgpr_read_b32 v67, a219
  v_accvgpr_read_b32 v68, a220
  v_accvgpr_read_b32 v69, a221
  v_accvgpr_read_b32 v70, a222
  v_accvgpr_read_b32 v71, a223
  v_cvt_pk_bf16_f32 v72, v56, v57
  v_cvt_pk_bf16_f32 v73, v58, v59
  v_cvt_pk_bf16_f32 v74, v60, v61
  v_cvt_pk_bf16_f32 v75, v62, v63
  v_cvt_pk_bf16_f32 v76, v64, v65
  v_cvt_pk_bf16_f32 v77, v66, v67
  v_cvt_pk_bf16_f32 v78, v68, v69
  v_cvt_pk_bf16_f32 v79, v70, v71
  buffer_store_dwordx4 v[72:75], v96, s[36:39], s77 offen sc1
  buffer_store_dwordx4 v[76:79], v96, s[36:39], s77 offen offset:1024 sc1
  s_add_u32 s77, s77, s71
  v_accvgpr_read_b32 v32, a224
  v_accvgpr_read_b32 v33, a225
  v_accvgpr_read_b32 v34, a226
  v_accvgpr_read_b32 v35, a227
  v_accvgpr_read_b32 v36, a228
  v_accvgpr_read_b32 v37, a229
  v_accvgpr_read_b32 v38, a230
  v_accvgpr_read_b32 v39, a231
  v_accvgpr_read_b32 v40, a232
  v_accvgpr_read_b32 v41, a233
  v_accvgpr_read_b32 v42, a234
  v_accvgpr_read_b32 v43, a235
  v_accvgpr_read_b32 v44, a236
  v_accvgpr_read_b32 v45, a237
  v_accvgpr_read_b32 v46, a238
  v_accvgpr_read_b32 v47, a239
  v_cvt_pk_bf16_f32 v48, v32, v33
  v_cvt_pk_bf16_f32 v49, v34, v35
  v_cvt_pk_bf16_f32 v50, v36, v37
  v_cvt_pk_bf16_f32 v51, v38, v39
  v_cvt_pk_bf16_f32 v52, v40, v41
  v_cvt_pk_bf16_f32 v53, v42, v43
  v_cvt_pk_bf16_f32 v54, v44, v45
  v_cvt_pk_bf16_f32 v55, v46, v47
  buffer_store_dwordx4 v[48:51], v96, s[36:39], s77 offen sc1
  buffer_store_dwordx4 v[52:55], v96, s[36:39], s77 offen offset:1024 sc1
  s_add_u32 s77, s77, s71
  v_accvgpr_read_b32 v56, a240
  v_accvgpr_read_b32 v57, a241
  v_accvgpr_read_b32 v58, a242
  v_accvgpr_read_b32 v59, a243
  v_accvgpr_read_b32 v60, a244
  v_accvgpr_read_b32 v61, a245
  v_accvgpr_read_b32 v62, a246
  v_accvgpr_read_b32 v63, a247
  v_accvgpr_read_b32 v64, a248
  v_accvgpr_read_b32 v65, a249
  v_accvgpr_read_b32 v66, a250
  v_accvgpr_read_b32 v67, a251
  v_accvgpr_read_b32 v68, a252
  v_accvgpr_read_b32 v69, a253
  v_accvgpr_read_b32 v70, a254
  v_accvgpr_read_b32 v71, a255
  v_cvt_pk_bf16_f32 v72, v56, v57
  v_cvt_pk_bf16_f32 v73, v58, v59
  v_cvt_pk_bf16_f32 v74, v60, v61
  v_cvt_pk_bf16_f32 v75, v62, v63
  v_cvt_pk_bf16_f32 v76, v64, v65
  v_cvt_pk_bf16_f32 v77, v66, v67
  v_cvt_pk_bf16_f32 v78, v68, v69
  v_cvt_pk_bf16_f32 v79, v70, v71
  buffer_store_dwordx4 v[72:75], v96, s[36:39], s77 offen sc1
  buffer_store_dwordx4 v[76:79], v96, s[36:39], s77 offen offset:1024 sc1
  s_branch L_gemm_end
L_epi_aq:
  v_lshlrev_b32 v96, 4, v1
  v_lshlrev_b32 v97, 3, v1
  v_cmp_lt_u32 vcc, 31, v1
  v_mov_b32 v98, 0
  v_mov_b32 v99, 0
  s_mov_b32 s80, 0x3ea52b5c
  s_mul_i32 s77, s70, 0
  s_add_u32 s77, s77, s69
  v_accvgpr_read_b32 v32, a0
  v_accvgpr_read_b32 v33, a1
  v_accvgpr_read_b32 v34, a2
  v_accvgpr_read_b32 v35, a3
  v_accvgpr_read_b32 v36, a4
  v_accvgpr_read_b32 v37, a5
  v_accvgpr_read_b32 v38, a6
  v_accvgpr_read_b32 v39, a7
  v_accvgpr_read_b32 v40, a8
  v_accvgpr_read_b32 v41, a9
  v_accvgpr_read_b32 v42, a10
  v_accvgpr_read_b32 v43, a11
  v_mul_f32 v32, s80, v32
  v_mul_f32 v33, s80, v33
  v_mul_f32 v34, s80, v34
  v_mul_f32 v35, s80, v35
  v_mul_f32 v36, s80, v36
  v_mul_f32 v37, s80, v37
  v_mul_f32 v38, s80, v38
  v_mul_f32 v39, s80, v39
  v_mul_f32 v40, s80, v40
  v_mul_f32 v41, s80, v41
  v_mul_f32 v42, s80, v42
  v_mul_f32 v43, s80, v43
  v_cvt_pk_bf16_f32 v48, v32, v33
  v_cvt_pk_bf16_f32 v49, v34, v35
  v_cvt_pk_bf16_f32 v50, v36, v37
  v_cvt_pk_bf16_f32 v51, v38, v39
  v_cvt_pk_bf16_f32 v52, v40, v41
  v_cvt_pk_bf16_f32 v53, v42, v43
  v_cndmask_b32 v52, v52, v98, vcc
  v_cndmask_b32 v53, v53, v99, vcc
  buffer_store_dwordx4 v[48:51], v96, s[36:39], s77 offen sc1
  buffer_store_dwordx2 v[52:53], v97, s[36:39], s77 offen offset:1024 sc1
  s_add_u32 s77, s77, s71
  v_accvgpr_read_b32 v56, a16
  v_accvgpr_read_b32 v57, a17
  v_accvgpr_read_b32 v58, a18
  v_accvgpr_read_b32 v59, a19
  v_accvgpr_read_b32 v60, a20
  v_accvgpr_read_b32 v61, a21
  v_accvgpr_read_b32 v62, a22
  v_accvgpr_read_b32 v63, a23
  v_accvgpr_read_b32 v64, a24
  v_accvgpr_read_b32 v65, a25
  v_accvgpr_read_b32 v66, a26
  v_accvgpr_read_b32 v67, a27
  v_mul_f32 v56, s80, v56
  v_mul_f32 v57, s80, v57
  v_mul_f32 v58, s80, v58
  v_mul_f32 v59, s80, v59
  v_mul_f32 v60, s80, v60
  v_mul_f32 v61, s80, v61
  v_mul_f32 v62, s80, v62
  v_mul_f32 v63, s80, v63
  v_mul_f32 v64, s80, v64
  v_mul_f32 v65, s80, v65
  v_mul_f32 v66, s80, v66
  v_mul_f32 v67, s80, v67
  v_cvt_pk_bf16_f32 v72, v56, v57
  v_cvt_pk_bf16_f32 v73, v58, v59
  v_cvt_pk_bf16_f32 v74, v60, v61
  v_cvt_pk_bf16_f32 v75, v62, v63
  v_cvt_pk_bf16_f32 v76, v64, v65
  v_cvt_pk_bf16_f32 v77, v66, v67
  v_cndmask_b32 v76, v76, v98, vcc
  v_cndmask_b32 v77, v77, v99, vcc
  buffer_store_dwordx4 v[72:75], v96, s[36:39], s77 offen sc1
  buffer_store_dwordx2 v[76:77], v97, s[36:39], s77 offen offset:1024 sc1
  s_add_u32 s77, s77, s71
  v_accvgpr_read_b32 v32, a32
  v_accvgpr_read_b32 v33, a33
  v_accvgpr_read_b32 v34, a34
  v_accvgpr_read_b32 v35, a35
  v_accvgpr_read_b32 v36, a36
  v_accvgpr_read_b32 v37, a37
  v_accvgpr_read_b32 v38, a38
  v_accvgpr_read_b32 v39, a39
  v_accvgpr_read_b32 v40, a40
  v_accvgpr_read_b32 v41, a41
  v_accvgpr_read_b32 v42, a42
  v_accvgpr_read_b32 v43, a43
  v_mul_f32 v32, s80, v32
  v_mul_f32 v33, s80, v33
  v_mul_f32 v34, s80, v34
  v_mul_f32 v35, s80, v35
  v_mul_f32 v36, s80, v36
  v_mul_f32 v37, s80, v37
  v_mul_f32 v38, s80, v38
  v_mul_f32 v39, s80, v39
  v_mul_f32 v40, s80, v40
  v_mul_f32 v41, s80, v41
  v_mul_f32 v42, s80, v42
  v_mul_f32 v43, s80, v43
  v_cvt_pk_bf16_f32 v48, v32, v33
  v_cvt_pk_bf16_f32 v49, v34, v35
  v_cvt_pk_bf16_f32 v50, v36, v37
  v_cvt_pk_bf16_f32 v51, v38, v39
  v_cvt_pk_bf16_f32 v52, v40, v41
  v_cvt_pk_bf16_f32 v53, v42, v43
  v_cndmask_b32 v52, v52, v98, vcc
  v_cndmask_b32 v53, v53, v99, vcc
  buffer_store_dwordx4 v[48:51], v96, s[36:39], s77 offen sc1
  buffer_store_dwordx2 v[52:53], v97, s[36:39], s77 offen offset:1024 sc1
  s_add_u32 s77, s77, s71
  v_accvgpr_read_b32 v56, a48
  v_accvgpr_read_b32 v57, a49
  v_accvgpr_read_b32 v58, a50
  v_accvgpr_read_b32 v59, a51
  v_accvgpr_read_b32 v60, a52
  v_accvgpr_read_b32 v61, a53
  v_accvgpr_read_b32 v62, a54
  v_accvgpr_read_b32 v63, a55
  v_accvgpr_read_b32 v64, a56
  v_accvgpr_read_b32 v65, a57
  v_accvgpr_read_b32 v66, a58
  v_accvgpr_read_b32 v67, a59
  v_mul_f32 v56, s80, v56
  v_mul_f32 v57, s80, v57
  v_mul_f32 v58, s80, v58
  v_mul_f32 v59, s80, v59
  v_mul_f32 v60, s80, v60
  v_mul_f32 v61, s80, v61
  v_mul_f32 v62, s80, v62
  v_mul_f32 v63, s80, v63
  v_mul_f32 v64, s80, v64
  v_mul_f32 v65, s80, v65
  v_mul_f32 v66, s80, v66
  v_mul_f32 v67, s80, v67
  v_cvt_pk_bf16_f32 v72, v56, v57
  v_cvt_pk_bf16_f32 v73, v58, v59
  v_cvt_pk_bf16_f32 v74, v60, v61
  v_cvt_pk_bf16_f32 v75, v62, v63
  v_cvt_pk_bf16_f32 v76, v64, v65
  v_cvt_pk_bf16_f32 v77, v66, v67
  v_cndmask_b32 v76, v76, v98, vcc
  v_cndmask_b32 v77, v77, v99, vcc
  buffer_store_dwordx4 v[72:75], v96, s[36:39], s77 offen sc1
  buffer_store_dwordx2 v[76:77], v97, s[36:39], s77 offen offset:1024 sc1
  s_mul_i32 s77, s70, 1
  s_add_u32 s77, s77, s69
  v_accvgpr_read_b32 v32, a64
  v_accvgpr_read_b32 v33, a65
  v_accvgpr_read_b32 v34, a66
  v_accvgpr_read_b32 v35, a67
  v_accvgpr_read_b32 v36, a68
  v_accvgpr_read_b32 v37, a69
  v_accvgpr_read_b32 v38, a70
  v_accvgpr_read_b32 v39, a71
  v_accvgpr_read_b32 v40, a72
  v_accvgpr_read_b32 v41, a73
  v_accvgpr_read_b32 v42, a74
  v_accvgpr_read_b32 v43, a75
  v_mul_f32 v32, s80, v32
  v_mul_f32 v33, s80, v33
  v_mul_f32 v34, s80, v34
  v_mul_f32 v35, s80, v35
  v_mul_f32 v36, s80, v36
  v_mul_f32 v37, s80, v37
  v_mul_f32 v38, s80, v38
  v_mul_f32 v39, s80, v39
  v_mul_f32 v40, s80, v40
  v_mul_f32 v41, s80, v41
  v_mul_f32 v42, s80, v42
  v_mul_f32 v43, s80, v43
  v_cvt_pk_bf16_f32 v48, v32, v33
  v_cvt_pk_bf16_f32 v49, v34, v35
  v_cvt_pk_bf16_f32 v50, v36, v37
  v_cvt_pk_bf16_f32 v51, v38, v39
  v_cvt_pk_bf16_f32 v52, v40, v41
  v_cvt_pk_bf16_f32 v53, v42, v43
  v_cndmask_b32 v52, v52, v98, vcc
  v_cndmask_b32 v53, v53, v99, vcc
  buffer_store_dwordx4 v[48:51], v96, s[36:39], s77 offen sc1
  buffer_store_dwordx2 v[52:53], v97, s[36:39], s77 offen offset:1024 sc1
  s_add_u32 s77, s77, s71
  v_accvgpr_read_b32 v56, a80
  v_accvgpr_read_b32 v57, a81
  v_accvgpr_read_b32 v58, a82
  v_accvgpr_read_b32 v59, a83
  v_accvgpr_read_b32 v60, a84
  v_accvgpr_read_b32 v61, a85
  v_accvgpr_read_b32 v62, a86
  v_accvgpr_read_b32 v63, a87
  v_accvgpr_read_b32 v64, a88
  v_accvgpr_read_b32 v65, a89
  v_accvgpr_read_b32 v66, a90
  v_accvgpr_read_b32 v67, a91
  v_mul_f32 v56, s80, v56
  v_mul_f32 v57, s80, v57
  v_mul_f32 v58, s80, v58
  v_mul_f32 v59, s80, v59
  v_mul_f32 v60, s80, v60
  v_mul_f32 v61, s80, v61
  v_mul_f32 v62, s80, v62
  v_mul_f32 v63, s80, v63
  v_mul_f32 v64, s80, v64
  v_mul_f32 v65, s80, v65
  v_mul_f32 v66, s80, v66
  v_mul_f32 v67, s80, v67
  v_cvt_pk_bf16_f32 v72, v56, v57
  v_cvt_pk_bf16_f32 v73, v58, v59
  v_cvt_pk_bf16_f32 v74, v60, v61
  v_cvt_pk_bf16_f32 v75, v62, v63
  v_cvt_pk_bf16_f32 v76, v64, v65
  v_cvt_pk_bf16_f32 v77, v66, v67
  v_cndmask_b32 v76, v76, v98, vcc
  v_cndmask_b32 v77, v77, v99, vcc
  buffer_store_dwordx4 v[72:75], v96, s[36:39], s77 offen sc1
  buffer_store_dwordx2 v[76:77], v97, s[36:39], s77 offen offset:1024 sc1
  s_add_u32 s77, s77, s71
  v_accvgpr_read_b32 v32, a96
  v_accvgpr_read_b32 v33, a97
  v_accvgpr_read_b32 v34, a98
  v_accvgpr_read_b32 v35, a99
  v_accvgpr_read_b32 v36, a100
  v_accvgpr_read_b32 v37, a101
  v_accvgpr_read_b32 v38, a102
  v_accvgpr_read_b32 v39, a103
  v_accvgpr_read_b32 v40, a104
  v_accvgpr_read_b32 v41, a105
  v_accvgpr_read_b32 v42, a106
  v_accvgpr_read_b32 v43, a107
  v_mul_f32 v32, s80, v32
  v_mul_f32 v33, s80, v33
  v_mul_f32 v34, s80, v34
  v_mul_f32 v35, s80, v35
  v_mul_f32 v36, s80, v36
  v_mul_f32 v37, s80, v37
  v_mul_f32 v38, s80, v38
  v_mul_f32 v39, s80, v39
  v_mul_f32 v40, s80, v40
  v_mul_f32 v41, s80, v41
  v_mul_f32 v42, s80, v42
  v_mul_f32 v43, s80, v43
  v_cvt_pk_bf16_f32 v48, v32, v33
  v_cvt_pk_bf16_f32 v49, v34, v35
  v_cvt_pk_bf16_f32 v50, v36, v37
  v_cvt_pk_bf16_f32 v51, v38, v39
  v_cvt_pk_bf16_f32 v52, v40, v41
  v_cvt_pk_bf16_f32 v53, v42, v43
  v_cndmask_b32 v52, v52, v98, vcc
  v_cndmask_b32 v53, v53, v99, vcc
  buffer_store_dwordx4 v[48:51], v96, s[36:39], s77 offen sc1
  buffer_store_dwordx2 v[52:53], v97, s[36:39], s77 offen offset:1024 sc1
  s_add_u32 s77, s77, s71
  v_accvgpr_read_b32 v56, a112
  v_accvgpr_read_b32 v57, a113
  v_accvgpr_read_b32 v58, a114
  v_accvgpr_read_b32 v59, a115
  v_accvgpr_read_b32 v60, a116
  v_accvgpr_read_b32 v61, a117
  v_accvgpr_read_b32 v62, a118
  v_accvgpr_read_b32 v63, a119
  v_accvgpr_read_b32 v64, a120
  v_accvgpr_read_b32 v65, a121
  v_accvgpr_read_b32 v66, a122
  v_accvgpr_read_b32 v67, a123
  v_mul_f32 v56, s80, v56
  v_mul_f32 v57, s80, v57
  v_mul_f32 v58, s80, v58
  v_mul_f32 v59, s80, v59
  v_mul_f32 v60, s80, v60
  v_mul_f32 v61, s80, v61
  v_mul_f32 v62, s80, v62
  v_mul_f32 v63, s80, v63
  v_mul_f32 v64, s80, v64
  v_mul_f32 v65, s80, v65
  v_mul_f32 v66, s80, v66
  v_mul_f32 v67, s80, v67
  v_cvt_pk_bf16_f32 v72, v56, v57
  v_cvt_pk_bf16_f32 v73, v58, v59
  v_cvt_pk_bf16_f32 v74, v60, v61
  v_cvt_pk_bf16_f32 v75, v62, v63
  v_cvt_pk_bf16_f32 v76, v64, v65
  v_cvt_pk_bf16_f32 v77, v66, v67
  v_cndmask_b32 v76, v76, v98, vcc
  v_cndmask_b32 v77, v77, v99, vcc
  buffer_store_dwordx4 v[72:75], v96, s[36:39], s77 offen sc1
  buffer_store_dwordx2 v[76:77], v97, s[36:39], s77 offen offset:1024 sc1
  s_mul_i32 s77, s70, 2
  s_add_u32 s77, s77, s69
  v_accvgpr_read_b32 v32, a128
  v_accvgpr_read_b32 v33, a129
  v_accvgpr_read_b32 v34, a130
  v_accvgpr_read_b32 v35, a131
  v_accvgpr_read_b32 v36, a132
  v_accvgpr_read_b32 v37, a133
  v_accvgpr_read_b32 v38, a134
  v_accvgpr_read_b32 v39, a135
  v_accvgpr_read_b32 v40, a136
  v_accvgpr_read_b32 v41, a137
  v_accvgpr_read_b32 v42, a138
  v_accvgpr_read_b32 v43, a139
  v_mul_f32 v32, s80, v32
  v_mul_f32 v33, s80, v33
  v_mul_f32 v34, s80, v34
  v_mul_f32 v35, s80, v35
  v_mul_f32 v36, s80, v36
  v_mul_f32 v37, s80, v37
  v_mul_f32 v38, s80, v38
  v_mul_f32 v39, s80, v39
  v_mul_f32 v40, s80, v40
  v_mul_f32 v41, s80, v41
  v_mul_f32 v42, s80, v42
  v_mul_f32 v43, s80, v43
  v_cvt_pk_bf16_f32 v48, v32, v33
  v_cvt_pk_bf16_f32 v49, v34, v35
  v_cvt_pk_bf16_f32 v50, v36, v37
  v_cvt_pk_bf16_f32 v51, v38, v39
  v_cvt_pk_bf16_f32 v52, v40, v41
  v_cvt_pk_bf16_f32 v53, v42, v43
  v_cndmask_b32 v52, v52, v98, vcc
  v_cndmask_b32 v53, v53, v99, vcc
  buffer_store_dwordx4 v[48:51], v96, s[36:39], s77 offen sc1
  buffer_store_dwordx2 v[52:53], v97, s[36:39], s77 offen offset:1024 sc1
  s_add_u32 s77, s77, s71
  v_accvgpr_read_b32 v56, a144
  v_accvgpr_read_b32 v57, a145
  v_accvgpr_read_b32 v58, a146
  v_accvgpr_read_b32 v59, a147
  v_accvgpr_read_b32 v60, a148
  v_accvgpr_read_b32 v61, a149
  v_accvgpr_read_b32 v62, a150
  v_accvgpr_read_b32 v63, a151
  v_accvgpr_read_b32 v64, a152
  v_accvgpr_read_b32 v65, a153
  v_accvgpr_read_b32 v66, a154
  v_accvgpr_read_b32 v67, a155
  v_mul_f32 v56, s80, v56
  v_mul_f32 v57, s80, v57
  v_mul_f32 v58, s80, v58
  v_mul_f32 v59, s80, v59
  v_mul_f32 v60, s80, v60
  v_mul_f32 v61, s80, v61
  v_mul_f32 v62, s80, v62
  v_mul_f32 v63, s80, v63
  v_mul_f32 v64, s80, v64
  v_mul_f32 v65, s80, v65
  v_mul_f32 v66, s80, v66
  v_mul_f32 v67, s80, v67
  v_cvt_pk_bf16_f32 v72, v56, v57
  v_cvt_pk_bf16_f32 v73, v58, v59
  v_cvt_pk_bf16_f32 v74, v60, v61
  v_cvt_pk_bf16_f32 v75, v62, v63
  v_cvt_pk_bf16_f32 v76, v64, v65
  v_cvt_pk_bf16_f32 v77, v66, v67
  v_cndmask_b32 v76, v76, v98, vcc
  v_cndmask_b32 v77, v77, v99, vcc
  buffer_store_dwordx4 v[72:75], v96, s[36:39], s77 offen sc1
  buffer_store_dwordx2 v[76:77], v97, s[36:39], s77 offen offset:1024 sc1
  s_add_u32 s77, s77, s71
  v_accvgpr_read_b32 v32, a160
  v_accvgpr_read_b32 v33, a161
  v_accvgpr_read_b32 v34, a162
  v_accvgpr_read_b32 v35, a163
  v_accvgpr_read_b32 v36, a164
  v_accvgpr_read_b32 v37, a165
  v_accvgpr_read_b32 v38, a166
  v_accvgpr_read_b32 v39, a167
  v_accvgpr_read_b32 v40, a168
  v_accvgpr_read_b32 v41, a169
  v_accvgpr_read_b32 v42, a170
  v_accvgpr_read_b32 v43, a171
  v_mul_f32 v32, s80, v32
  v_mul_f32 v33, s80, v33
  v_mul_f32 v34, s80, v34
  v_mul_f32 v35, s80, v35
  v_mul_f32 v36, s80, v36
  v_mul_f32 v37, s80, v37
  v_mul_f32 v38, s80, v38
  v_mul_f32 v39, s80, v39
  v_mul_f32 v40, s80, v40
  v_mul_f32 v41, s80, v41
  v_mul_f32 v42, s80, v42
  v_mul_f32 v43, s80, v43
  v_cvt_pk_bf16_f32 v48, v32, v33
  v_cvt_pk_bf16_f32 v49, v34, v35
  v_cvt_pk_bf16_f32 v50, v36, v37
  v_cvt_pk_bf16_f32 v51, v38, v39
  v_cvt_pk_bf16_f32 v52, v40, v41
  v_cvt_pk_bf16_f32 v53, v42, v43
  v_cndmask_b32 v52, v52, v98, vcc
  v_cndmask_b32 v53, v53, v99, vcc
  buffer_store_dwordx4 v[48:51], v96, s[36:39], s77 offen sc1
  buffer_store_dwordx2 v[52:53], v97, s[36:39], s77 offen offset:1024 sc1
  s_add_u32 s77, s77, s71
  v_accvgpr_read_b32 v56, a176
  v_accvgpr_read_b32 v57, a177
  v_accvgpr_read_b32 v58, a178
  v_accvgpr_read_b32 v59, a179
  v_accvgpr_read_b32 v60, a180
  v_accvgpr_read_b32 v61, a181
  v_accvgpr_read_b32 v62, a182
  v_accvgpr_read_b32 v63, a183
  v_accvgpr_read_b32 v64, a184
  v_accvgpr_read_b32 v65, a185
  v_accvgpr_read_b32 v66, a186
  v_accvgpr_read_b32 v67, a187
  v_mul_f32 v56, s80, v56
  v_mul_f32 v57, s80, v57
  v_mul_f32 v58, s80, v58
  v_mul_f32 v59, s80, v59
  v_mul_f32 v60, s80, v60
  v_mul_f32 v61, s80, v61
  v_mul_f32 v62, s80, v62
  v_mul_f32 v63, s80, v63
  v_mul_f32 v64, s80, v64
  v_mul_f32 v65, s80, v65
  v_mul_f32 v66, s80, v66
  v_mul_f32 v67, s80, v67
  v_cvt_pk_bf16_f32 v72, v56, v57
  v_cvt_pk_bf16_f32 v73, v58, v59
  v_cvt_pk_bf16_f32 v74, v60, v61
  v_cvt_pk_bf16_f32 v75, v62, v63
  v_cvt_pk_bf16_f32 v76, v64, v65
  v_cvt_pk_bf16_f32 v77, v66, v67
  v_cndmask_b32 v76, v76, v98, vcc
  v_cndmask_b32 v77, v77, v99, vcc
  buffer_store_dwordx4 v[72:75], v96, s[36:39], s77 offen sc1
  buffer_store_dwordx2 v[76:77], v97, s[36:39], s77 offen offset:1024 sc1
  s_mul_i32 s77, s70, 3
  s_add_u32 s77, s77, s69
  v_accvgpr_read_b32 v32, a192
  v_accvgpr_read_b32 v33, a193
  v_accvgpr_read_b32 v34, a194
  v_accvgpr_read_b32 v35, a195
  v_accvgpr_read_b32 v36, a196
  v_accvgpr_read_b32 v37, a197
  v_accvgpr_read_b32 v38, a198
  v_accvgpr_read_b32 v39, a199
  v_accvgpr_read_b32 v40, a200
  v_accvgpr_read_b32 v41, a201
  v_accvgpr_read_b32 v42, a202
  v_accvgpr_read_b32 v43, a203
  v_mul_f32 v32, s80, v32
  v_mul_f32 v33, s80, v33
  v_mul_f32 v34, s80, v34
  v_mul_f32 v35, s80, v35
  v_mul_f32 v36, s80, v36
  v_mul_f32 v37, s80, v37
  v_mul_f32 v38, s80, v38
  v_mul_f32 v39, s80, v39
  v_mul_f32 v40, s80, v40
  v_mul_f32 v41, s80, v41
  v_mul_f32 v42, s80, v42
  v_mul_f32 v43, s80, v43
  v_cvt_pk_bf16_f32 v48, v32, v33
  v_cvt_pk_bf16_f32 v49, v34, v35
  v_cvt_pk_bf16_f32 v50, v36, v37
  v_cvt_pk_bf16_f32 v51, v38, v39
  v_cvt_pk_bf16_f32 v52, v40, v41
  v_cvt_pk_bf16_f32 v53, v42, v43
  v_cndmask_b32 v52, v52, v98, vcc
  v_cndmask_b32 v53, v53, v99, vcc
  buffer_store_dwordx4 v[48:51], v96, s[36:39], s77 offen sc1
  buffer_store_dwordx2 v[52:53], v97, s[36:39], s77 offen offset:1024 sc1
  s_add_u32 s77, s77, s71
  v_accvgpr_read_b32 v56, a208
  v_accvgpr_read_b32 v57, a209
  v_accvgpr_read_b32 v58, a210
  v_accvgpr_read_b32 v59, a211
  v_accvgpr_read_b32 v60, a212
  v_accvgpr_read_b32 v61, a213
  v_accvgpr_read_b32 v62, a214
  v_accvgpr_read_b32 v63, a215
  v_accvgpr_read_b32 v64, a216
  v_accvgpr_read_b32 v65, a217
  v_accvgpr_read_b32 v66, a218
  v_accvgpr_read_b32 v67, a219
  v_mul_f32 v56, s80, v56
  v_mul_f32 v57, s80, v57
  v_mul_f32 v58, s80, v58
  v_mul_f32 v59, s80, v59
  v_mul_f32 v60, s80, v60
  v_mul_f32 v61, s80, v61
  v_mul_f32 v62, s80, v62
  v_mul_f32 v63, s80, v63
  v_mul_f32 v64, s80, v64
  v_mul_f32 v65, s80, v65
  v_mul_f32 v66, s80, v66
  v_mul_f32 v67, s80, v67
  v_cvt_pk_bf16_f32 v72, v56, v57
  v_cvt_pk_bf16_f32 v73, v58, v59
  v_cvt_pk_bf16_f32 v74, v60, v61
  v_cvt_pk_bf16_f32 v75, v62, v63
  v_cvt_pk_bf16_f32 v76, v64, v65
  v_cvt_pk_bf16_f32 v77, v66, v67
  v_cndmask_b32 v76, v76, v98, vcc
  v_cndmask_b32 v77, v77, v99, vcc
  buffer_store_dwordx4 v[72:75], v96, s[36:39], s77 offen sc1
  buffer_store_dwordx2 v[76:77], v97, s[36:39], s77 offen offset:1024 sc1
  s_add_u32 s77, s77, s71
  v_accvgpr_read_b32 v32, a224
  v_accvgpr_read_b32 v33, a225
  v_accvgpr_read_b32 v34, a226
  v_accvgpr_read_b32 v35, a227
  v_accvgpr_read_b32 v36, a228
  v_accvgpr_read_b32 v37, a229
  v_accvgpr_read_b32 v38, a230
  v_accvgpr_read_b32 v39, a231
  v_accvgpr_read_b32 v40, a232
  v_accvgpr_read_b32 v41, a233
  v_accvgpr_read_b32 v42, a234
  v_accvgpr_read_b32 v43, a235
  v_mul_f32 v32, s80, v32
  v_mul_f32 v33, s80, v33
  v_mul_f32 v34, s80, v34
  v_mul_f32 v35, s80, v35
  v_mul_f32 v36, s80, v36
  v_mul_f32 v37, s80, v37
  v_mul_f32 v38, s80, v38
  v_mul_f32 v39, s80, v39
  v_mul_f32 v40, s80, v40
  v_mul_f32 v41, s80, v41
  v_mul_f32 v42, s80, v42
  v_mul_f32 v43, s80, v43
  v_cvt_pk_bf16_f32 v48, v32, v33
  v_cvt_pk_bf16_f32 v49, v34, v35
  v_cvt_pk_bf16_f32 v50, v36, v37
  v_cvt_pk_bf16_f32 v51, v38, v39
  v_cvt_pk_bf16_f32 v52, v40, v41
  v_cvt_pk_bf16_f32 v53, v42, v43
  v_cndmask_b32 v52, v52, v98, vcc
  v_cndmask_b32 v53, v53, v99, vcc
  buffer_store_dwordx4 v[48:51], v96, s[36:39], s77 offen sc1
  buffer_store_dwordx2 v[52:53], v97, s[36:39], s77 offen offset:1024 sc1
  s_add_u32 s77, s77, s71
  v_accvgpr_read_b32 v56, a240
  v_accvgpr_read_b32 v57, a241
  v_accvgpr_read_b32 v58, a242
  v_accvgpr_read_b32 v59, a243
  v_accvgpr_read_b32 v60, a244
  v_accvgpr_read_b32 v61, a245
  v_accvgpr_read_b32 v62, a246
  v_accvgpr_read_b32 v63, a247
  v_accvgpr_read_b32 v64, a248
  v_accvgpr_read_b32 v65, a249
  v_accvgpr_read_b32 v66, a250
  v_accvgpr_read_b32 v67, a251
  v_mul_f32 v56, s80, v56
  v_mul_f32 v57, s80, v57
  v_mul_f32 v58, s80, v58
  v_mul_f32 v59, s80, v59
  v_mul_f32 v60, s80, v60
  v_mul_f32 v61, s80, v61
  v_mul_f32 v62, s80, v62
  v_mul_f32 v63, s80, v63
  v_mul_f32 v64, s80, v64
  v_mul_f32 v65, s80, v65
  v_mul_f32 v66, s80, v66
  v_mul_f32 v67, s80, v67
  v_cvt_pk_bf16_f32 v72, v56, v57
  v_cvt_pk_bf16_f32 v73, v58, v59
  v_cvt_pk_bf16_f32 v74, v60, v61
  v_cvt_pk_bf16_f32 v75, v62, v63
  v_cvt_pk_bf16_f32 v76, v64, v65
  v_cvt_pk_bf16_f32 v77, v66, v67
  v_cndmask_b32 v76, v76, v98, vcc
  v_cndmask_b32 v77, v77, v99, vcc
  buffer_store_dwordx4 v[72:75], v96, s[36:39], s77 offen sc1
  buffer_store_dwordx2 v[76:77], v97, s[36:39], s77 offen offset:1024 sc1
  s_branch L_gemm_end
L_epi_ak:
  v_lshlrev_b32 v96, 4, v1
  v_lshlrev_b32 v97, 3, v1
  v_cmp_lt_u32 vcc, 31, v1
  v_mov_b32 v98, 0x3f803f80
  v_mov_b32 v99, 0
  s_mul_i32 s77, s70, 0
  s_add_u32 s77, s77, s69
  v_accvgpr_read_b32 v32, a0
  v_accvgpr_read_b32 v33, a1
  v_accvgpr_read_b32 v34, a2
  v_accvgpr_read_b32 v35, a3
  v_accvgpr_read_b32 v36, a4
  v_accvgpr_read_b32 v37, a5
  v_accvgpr_read_b32 v38, a6
  v_accvgpr_read_b32 v39, a7
  v_accvgpr_read_b32 v40, a8
  v_accvgpr_read_b32 v41, a9
  v_accvgpr_read_b32 v42, a10
  v_accvgpr_read_b32 v43, a11
  v_cvt_pk_bf16_f32 v48, v32, v33
  v_cvt_pk_bf16_f32 v49, v34, v35
  v_cvt_pk_bf16_f32 v50, v36, v37
  v_cvt_pk_bf16_f32 v51, v38, v39
  v_cvt_pk_bf16_f32 v52, v40, v41
  v_cvt_pk_bf16_f32 v53, v42, v43
  v_cndmask_b32 v52, v52, v98, vcc
  v_cndmask_b32 v53, v53, v99, vcc
  buffer_store_dwordx4 v[48:51], v96, s[36:39], s77 offen sc1
  buffer_store_dwordx2 v[52:53], v97, s[36:39], s77 offen offset:1024 sc1
  s_add_u32 s77, s77, s71
  v_accvgpr_read_b32 v56, a16
  v_accvgpr_read_b32 v57, a17
  v_accvgpr_read_b32 v58, a18
  v_accvgpr_read_b32 v59, a19
  v_accvgpr_read_b32 v60, a20
  v_accvgpr_read_b32 v61, a21
  v_accvgpr_read_b32 v62, a22
  v_accvgpr_read_b32 v63, a23
  v_accvgpr_read_b32 v64, a24
  v_accvgpr_read_b32 v65, a25
  v_accvgpr_read_b32 v66, a26
  v_accvgpr_read_b32 v67, a27
  v_cvt_pk_bf16_f32 v72, v56, v57
  v_cvt_pk_bf16_f32 v73, v58, v59
  v_cvt_pk_bf16_f32 v74, v60, v61
  v_cvt_pk_bf16_f32 v75, v62, v63
  v_cvt_pk_bf16_f32 v76, v64, v65
  v_cvt_pk_bf16_f32 v77, v66, v67
  v_cndmask_b32 v76, v76, v98, vcc
  v_cndmask_b32 v77, v77, v99, vcc
  buffer_store_dwordx4 v[72:75], v96, s[36:39], s77 offen sc1
  buffer_store_dwordx2 v[76:77], v97, s[36:39], s77 offen offset:1024 sc1
  s_add_u32 s77, s77, s71
  v_accvgpr_read_b32 v32, a32
  v_accvgpr_read_b32 v33, a33
  v_accvgpr_read_b32 v34, a34
  v_accvgpr_read_b32 v35, a35
  v_accvgpr_read_b32 v36, a36
  v_accvgpr_read_b32 v37, a37
  v_accvgpr_read_b32 v38, a38
  v_accvgpr_read_b32 v39, a39
  v_accvgpr_read_b32 v40, a40
  v_accvgpr_read_b32 v41, a41
  v_accvgpr_read_b32 v42, a42
  v_accvgpr_read_b32 v43, a43
  v_cvt_pk_bf16_f32 v48, v32, v33
  v_cvt_pk_bf16_f32 v49, v34, v35
  v_cvt_pk_bf16_f32 v50, v36, v37
  v_cvt_pk_bf16_f32 v51, v38, v39
  v_cvt_pk_bf16_f32 v52, v40, v41
  v_cvt_pk_bf16_f32 v53, v42, v43
  v_cndmask_b32 v52, v52, v98, vcc
  v_cndmask_b32 v53, v53, v99, vcc
  buffer_store_dwordx4 v[48:51], v96, s[36:39], s77 offen sc1
  buffer_store_dwordx2 v[52:53], v97, s[36:39], s77 offen offset:1024 sc1
  s_add_u32 s77, s77, s71
  v_accvgpr_read_b32 v56, a48
  v_accvgpr_read_b32 v57, a49
  v_accvgpr_read_b32 v58, a50
  v_accvgpr_read_b32 v59, a51
  v_accvgpr_read_b32 v60, a52
  v_accvgpr_read_b32 v61, a53
  v_accvgpr_read_b32 v62, a54
  v_accvgpr_read_b32 v63, a55
  v_accvgpr_read_b32 v64, a56
  v_accvgpr_read_b32 v65, a57
  v_accvgpr_read_b32 v66, a58
  v_accvgpr_read_b32 v67, a59
  v_cvt_pk_bf16_f32 v72, v56, v57
  v_cvt_pk_bf16_f32 v73, v58, v59
  v_cvt_pk_bf16_f32 v74, v60, v61
  v_cvt_pk_bf16_f32 v75, v62, v63
  v_cvt_pk_bf16_f32 v76, v64, v65
  v_cvt_pk_bf16_f32 v77, v66, v67
  v_cndmask_b32 v76, v76, v98, vcc
  v_cndmask_b32 v77, v77, v99, vcc
  buffer_store_dwordx4 v[72:75], v96, s[36:39], s77 offen sc1
  buffer_store_dwordx2 v[76:77], v97, s[36:39], s77 offen offset:1024 sc1
  s_mul_i32 s77, s70, 1
  s_add_u32 s77, s77, s69
  v_accvgpr_read_b32 v32, a64
  v_accvgpr_read_b32 v33, a65
  v_accvgpr_read_b32 v34, a66
  v_accvgpr_read_b32 v35, a67
  v_accvgpr_read_b32 v36, a68
  v_accvgpr_read_b32 v37, a69
  v_accvgpr_read_b32 v38, a70
  v_accvgpr_read_b32 v39, a71
  v_accvgpr_read_b32 v40, a72
  v_accvgpr_read_b32 v41, a73
  v_accvgpr_read_b32 v42, a74
  v_accvgpr_read_b32 v43, a75
  v_cvt_pk_bf16_f32 v48, v32, v33
  v_cvt_pk_bf16_f32 v49, v34, v35
  v_cvt_pk_bf16_f32 v50, v36, v37
  v_cvt_pk_bf16_f32 v51, v38, v39
  v_cvt_pk_bf16_f32 v52, v40, v41
  v_cvt_pk_bf16_f32 v53, v42, v43
  v_cndmask_b32 v52, v52, v98, vcc
  v_cndmask_b32 v53, v53, v99, vcc
  buffer_store_dwordx4 v[48:51], v96, s[36:39], s77 offen sc1
  buffer_store_dwordx2 v[52:53], v97, s[36:39], s77 offen offset:1024 sc1
  s_add_u32 s77, s77, s71
  v_accvgpr_read_b32 v56, a80
  v_accvgpr_read_b32 v57, a81
  v_accvgpr_read_b32 v58, a82
  v_accvgpr_read_b32 v59, a83
  v_accvgpr_read_b32 v60, a84
  v_accvgpr_read_b32 v61, a85
  v_accvgpr_read_b32 v62, a86
  v_accvgpr_read_b32 v63, a87
  v_accvgpr_read_b32 v64, a88
  v_accvgpr_read_b32 v65, a89
  v_accvgpr_read_b32 v66, a90
  v_accvgpr_read_b32 v67, a91
  v_cvt_pk_bf16_f32 v72, v56, v57
  v_cvt_pk_bf16_f32 v73, v58, v59
  v_cvt_pk_bf16_f32 v74, v60, v61
  v_cvt_pk_bf16_f32 v75, v62, v63
  v_cvt_pk_bf16_f32 v76, v64, v65
  v_cvt_pk_bf16_f32 v77, v66, v67
  v_cndmask_b32 v76, v76, v98, vcc
  v_cndmask_b32 v77, v77, v99, vcc
  buffer_store_dwordx4 v[72:75], v96, s[36:39], s77 offen sc1
  buffer_store_dwordx2 v[76:77], v97, s[36:39], s77 offen offset:1024 sc1
  s_add_u32 s77, s77, s71
  v_accvgpr_read_b32 v32, a96
  v_accvgpr_read_b32 v33, a97
  v_accvgpr_read_b32 v34, a98
  v_accvgpr_read_b32 v35, a99
  v_accvgpr_read_b32 v36, a100
  v_accvgpr_read_b32 v37, a101
  v_accvgpr_read_b32 v38, a102
  v_accvgpr_read_b32 v39, a103
  v_accvgpr_read_b32 v40, a104
  v_accvgpr_read_b32 v41, a105
  v_accvgpr_read_b32 v42, a106
  v_accvgpr_read_b32 v43, a107
  v_cvt_pk_bf16_f32 v48, v32, v33
  v_cvt_pk_bf16_f32 v49, v34, v35
  v_cvt_pk_bf16_f32 v50, v36, v37
  v_cvt_pk_bf16_f32 v51, v38, v39
  v_cvt_pk_bf16_f32 v52, v40, v41
  v_cvt_pk_bf16_f32 v53, v42, v43
  v_cndmask_b32 v52, v52, v98, vcc
  v_cndmask_b32 v53, v53, v99, vcc
  buffer_store_dwordx4 v[48:51], v96, s[36:39], s77 offen sc1
  buffer_store_dwordx2 v[52:53], v97, s[36:39], s77 offen offset:1024 sc1
  s_add_u32 s77, s77, s71
  v_accvgpr_read_b32 v56, a112
  v_accvgpr_read_b32 v57, a113
  v_accvgpr_read_b32 v58, a114
  v_accvgpr_read_b32 v59, a115
  v_accvgpr_read_b32 v60, a116
  v_accvgpr_read_b32 v61, a117
  v_accvgpr_read_b32 v62, a118
  v_accvgpr_read_b32 v63, a119
  v_accvgpr_read_b32 v64, a120
  v_accvgpr_read_b32 v65, a121
  v_accvgpr_read_b32 v66, a122
  v_accvgpr_read_b32 v67, a123
  v_cvt_pk_bf16_f32 v72, v56, v57
  v_cvt_pk_bf16_f32 v73, v58, v59
  v_cvt_pk_bf16_f32 v74, v60, v61
  v_cvt_pk_bf16_f32 v75, v62, v63
  v_cvt_pk_bf16_f32 v76, v64, v65
  v_cvt_pk_bf16_f32 v77, v66, v67
  v_cndmask_b32 v76, v76, v98, vcc
  v_cndmask_b32 v77, v77, v99, vcc
  buffer_store_dwordx4 v[72:75], v96, s[36:39], s77 offen sc1
  buffer_store_dwordx2 v[76:77], v97, s[36:39], s77 offen offset:1024 sc1
  s_mul_i32 s77, s70, 2
  s_add_u32 s77, s77, s69
  v_accvgpr_read_b32 v32, a128
  v_accvgpr_read_b32 v33, a129
  v_accvgpr_read_b32 v34, a130
  v_accvgpr_read_b32 v35, a131
  v_accvgpr_read_b32 v36, a132
  v_accvgpr_read_b32 v37, a133
  v_accvgpr_read_b32 v38, a134
  v_accvgpr_read_b32 v39, a135
  v_accvgpr_read_b32 v40, a136
  v_accvgpr_read_b32 v41, a137
  v_accvgpr_read_b32 v42, a138
  v_accvgpr_read_b32 v43, a139
  v_cvt_pk_bf16_f32 v48, v32, v33
  v_cvt_pk_bf16_f32 v49, v34, v35
  v_cvt_pk_bf16_f32 v50, v36, v37
  v_cvt_pk_bf16_f32 v51, v38, v39
  v_cvt_pk_bf16_f32 v52, v40, v41
  v_cvt_pk_bf16_f32 v53, v42, v43
  v_cndmask_b32 v52, v52, v98, vcc
  v_cndmask_b32 v53, v53, v99, vcc
  buffer_store_dwordx4 v[48:51], v96, s[36:39], s77 offen sc1
  buffer_store_dwordx2 v[52:53], v97, s[36:39], s77 offen offset:1024 sc1
  s_add_u32 s77, s77, s71
  v_accvgpr_read_b32 v56, a144
  v_accvgpr_read_b32 v57, a145
  v_accvgpr_read_b32 v58, a146
  v_accvgpr_read_b32 v59, a147
  v_accvgpr_read_b32 v60, a148
  v_accvgpr_read_b32 v61, a149
  v_accvgpr_read_b32 v62, a150
  v_accvgpr_read_b32 v63, a151
  v_accvgpr_read_b32 v64, a152
  v_accvgpr_read_b32 v65, a153
  v_accvgpr_read_b32 v66, a154
  v_accvgpr_read_b32 v67, a155
  v_cvt_pk_bf16_f32 v72, v56, v57
  v_cvt_pk_bf16_f32 v73, v58, v59
  v_cvt_pk_bf16_f32 v74, v60, v61
  v_cvt_pk_bf16_f32 v75, v62, v63
  v_cvt_pk_bf16_f32 v76, v64, v65
  v_cvt_pk_bf16_f32 v77, v66, v67
  v_cndmask_b32 v76, v76, v98, vcc
  v_cndmask_b32 v77, v77, v99, vcc
  buffer_store_dwordx4 v[72:75], v96, s[36:39], s77 offen sc1
  buffer_store_dwordx2 v[76:77], v97, s[36:39], s77 offen offset:1024 sc1
  s_add_u32 s77, s77, s71
  v_accvgpr_read_b32 v32, a160
  v_accvgpr_read_b32 v33, a161
  v_accvgpr_read_b32 v34, a162
  v_accvgpr_read_b32 v35, a163
  v_accvgpr_read_b32 v36, a164
  v_accvgpr_read_b32 v37, a165
  v_accvgpr_read_b32 v38, a166
  v_accvgpr_read_b32 v39, a167
  v_accvgpr_read_b32 v40, a168
  v_accvgpr_read_b32 v41, a169
  v_accvgpr_read_b32 v42, a170
  v_accvgpr_read_b32 v43, a171
  v_cvt_pk_bf16_f32 v48, v32, v33
  v_cvt_pk_bf16_f32 v49, v34, v35
  v_cvt_pk_bf16_f32 v50, v36, v37
  v_cvt_pk_bf16_f32 v51, v38, v39
  v_cvt_pk_bf16_f32 v52, v40, v41
  v_cvt_pk_bf16_f32 v53, v42, v43
  v_cndmask_b32 v52, v52, v98, vcc
  v_cndmask_b32 v53, v53, v99, vcc
  buffer_store_dwordx4 v[48:51], v96, s[36:39], s77 offen sc1
  buffer_store_dwordx2 v[52:53], v97, s[36:39], s77 offen offset:1024 sc1
  s_add_u32 s77, s77, s71
  v_accvgpr_read_b32 v56, a176
  v_accvgpr_read_b32 v57, a177
  v_accvgpr_read_b32 v58, a178
  v_accvgpr_read_b32 v59, a179
  v_accvgpr_read_b32 v60, a180
  v_accvgpr_read_b32 v61, a181
  v_accvgpr_read_b32 v62, a182
  v_accvgpr_read_b32 v63, a183
  v_accvgpr_read_b32 v64, a184
  v_accvgpr_read_b32 v65, a185
  v_accvgpr_read_b32 v66, a186
  v_accvgpr_read_b32 v67, a187
  v_cvt_pk_bf16_f32 v72, v56, v57
  v_cvt_pk_bf16_f32 v73, v58, v59
  v_cvt_pk_bf16_f32 v74, v60, v61
  v_cvt_pk_bf16_f32 v75, v62, v63
  v_cvt_pk_bf16_f32 v76, v64, v65
  v_cvt_pk_bf16_f32 v77, v66, v67
  v_cndmask_b32 v76, v76, v98, vcc
  v_cndmask_b32 v77, v77, v99, vcc
  buffer_store_dwordx4 v[72:75], v96, s[36:39], s77 offen sc1
  buffer_store_dwordx2 v[76:77], v97, s[36:39], s77 offen offset:1024 sc1
  s_mul_i32 s77, s70, 3
  s_add_u32 s77, s77, s69
  v_accvgpr_read_b32 v32, a192
  v_accvgpr_read_b32 v33, a193
  v_accvgpr_read_b32 v34, a194
  v_accvgpr_read_b32 v35, a195
  v_accvgpr_read_b32 v36, a196
  v_accvgpr_read_b32 v37, a197
  v_accvgpr_read_b32 v38, a198
  v_accvgpr_read_b32 v39, a199
  v_accvgpr_read_b32 v40, a200
  v_accvgpr_read_b32 v41, a201
  v_accvgpr_read_b32 v42, a202
  v_accvgpr_read_b32 v43, a203
  v_cvt_pk_bf16_f32 v48, v32, v33
  v_cvt_pk_bf16_f32 v49, v34, v35
  v_cvt_pk_bf16_f32 v50, v36, v37
  v_cvt_pk_bf16_f32 v51, v38, v39
  v_cvt_pk_bf16_f32 v52, v40, v41
  v_cvt_pk_bf16_f32 v53, v42, v43
  v_cndmask_b32 v52, v52, v98, vcc
  v_cndmask_b32 v53, v53, v99, vcc
  buffer_store_dwordx4 v[48:51], v96, s[36:39], s77 offen sc1
  buffer_store_dwordx2 v[52:53], v97, s[36:39], s77 offen offset:1024 sc1
  s_add_u32 s77, s77, s71
  v_accvgpr_read_b32 v56, a208
  v_accvgpr_read_b32 v57, a209
  v_accvgpr_read_b32 v58, a210
  v_accvgpr_read_b32 v59, a211
  v_accvgpr_read_b32 v60, a212
  v_accvgpr_read_b32 v61, a213
  v_accvgpr_read_b32 v62, a214
  v_accvgpr_read_b32 v63, a215
  v_accvgpr_read_b32 v64, a216
  v_accvgpr_read_b32 v65, a217
  v_accvgpr_read_b32 v66, a218
  v_accvgpr_read_b32 v67, a219
  v_cvt_pk_bf16_f32 v72, v56, v57
  v_cvt_pk_bf16_f32 v73, v58, v59
  v_cvt_pk_bf16_f32 v74, v60, v61
  v_cvt_pk_bf16_f32 v75, v62, v63
  v_cvt_pk_bf16_f32 v76, v64, v65
  v_cvt_pk_bf16_f32 v77, v66, v67
  v_cndmask_b32 v76, v76, v98, vcc
  v_cndmask_b32 v77, v77, v99, vcc
  buffer_store_dwordx4 v[72:75], v96, s[36:39], s77 offen sc1
  buffer_store_dwordx2 v[76:77], v97, s[36:39], s77 offen offset:1024 sc1
  s_add_u32 s77, s77, s71
  v_accvgpr_read_b32 v32, a224
  v_accvgpr_read_b32 v33, a225
  v_accvgpr_read_b32 v34, a226
  v_accvgpr_read_b32 v35, a227
  v_accvgpr_read_b32 v36, a228
  v_accvgpr_read_b32 v37, a229
  v_accvgpr_read_b32 v38, a230
  v_accvgpr_read_b32 v39, a231
  v_accvgpr_read_b32 v40, a232
  v_accvgpr_read_b32 v41, a233
  v_accvgpr_read_b32 v42, a234
  v_accvgpr_read_b32 v43, a235
  v_cvt_pk_bf16_f32 v48, v32, v33
  v_cvt_pk_bf16_f32 v49, v34, v35
  v_cvt_pk_bf16_f32 v50, v36, v37
  v_cvt_pk_bf16_f32 v51, v38, v39
  v_cvt_pk_bf16_f32 v52, v40, v41
  v_cvt_pk_bf16_f32 v53, v42, v43
  v_cndmask_b32 v52, v52, v98, vcc
  v_cndmask_b32 v53, v53, v99, vcc
  buffer_store_dwordx4 v[48:51], v96, s[36:39], s77 offen sc1
  buffer_store_dwordx2 v[52:53], v97, s[36:39], s77 offen offset:1024 sc1
  s_add_u32 s77, s77, s71
  v_accvgpr_read_b32 v56, a240
  v_accvgpr_read_b32 v57, a241
  v_accvgpr_read_b32 v58, a242
  v_accvgpr_read_b32 v59, a243
  v_accvgpr_read_b32 v60, a244
  v_accvgpr_read_b32 v61, a245
  v_accvgpr_read_b32 v62, a246
  v_accvgpr_read_b32 v63, a247
  v_accvgpr_read_b32 v64, a248
  v_accvgpr_read_b32 v65, a249
  v_accvgpr_read_b32 v66, a250
  v_accvgpr_read_b32 v67, a251
  v_cvt_pk_bf16_f32 v72, v56, v57
  v_cvt_pk_bf16_f32 v73, v58, v59
  v_cvt_pk_bf16_f32 v74, v60, v61
  v_cvt_pk_bf16_f32 v75, v62, v63
  v_cvt_pk_bf16_f32 v76, v64, v65
  v_cvt_pk_bf16_f32 v77, v66, v67
  v_cndmask_b32 v76, v76, v98, vcc
  v_cndmask_b32 v77, v77, v99, vcc
  buffer_store_dwordx4 v[72:75], v96, s[36:39], s77 offen sc1
  buffer_store_dwordx2 v[76:77], v97, s[36:39], s77 offen offset:1024 sc1
  s_branch L_gemm_end
L_epi_av:
  v_lshlrev_b32 v96, 4, v1
  v_lshlrev_b32 v97, 3, v1
  v_and_b32 v98, 31, v1
  v_cmp_eq_u32 vcc, 20, v98
  v_mov_b32 v98, 0x3f803f80
  s_mul_i32 s77, s70, 0
  s_add_u32 s77, s77, s69
  v_accvgpr_read_b32 v32, a0
  v_accvgpr_read_b32 v33, a1
  v_accvgpr_read_b32 v34, a2
  v_accvgpr_read_b32 v35, a3
  v_accvgpr_read_b32 v36, a4
  v_accvgpr_read_b32 v37, a5
  v_accvgpr_read_b32 v38, a6
  v_accvgpr_read_b32 v39, a7
  v_accvgpr_read_b32 v40, a8
  v_accvgpr_read_b32 v41, a9
  v_accvgpr_read_b32 v42, a10
  v_accvgpr_read_b32 v43, a11
  v_accvgpr_read_b32 v44, a12
  v_accvgpr_read_b32 v45, a13
  v_accvgpr_read_b32 v46, a14
  v_accvgpr_read_b32 v47, a15
  v_cvt_pk_bf16_f32 v48, v32, v33
  v_cvt_pk_bf16_f32 v49, v34, v35
  v_cvt_pk_bf16_f32 v50, v36, v37
  v_cvt_pk_bf16_f32 v51, v38, v39
  v_cvt_pk_bf16_f32 v52, v40, v41
  v_cvt_pk_bf16_f32 v53, v42, v43
  v_cvt_pk_bf16_f32 v54, v44, v45
  v_cvt_pk_bf16_f32 v55, v46, v47
  v_cndmask_b32 v48, v48, v98, vcc
  v_cndmask_b32 v49, v49, v98, vcc
  v_cndmask_b32 v50, v50, v98, vcc
  v_cndmask_b32 v51, v51, v98, vcc
  v_cndmask_b32 v52, v52, v98, vcc
  v_cndmask_b32 v53, v53, v98, vcc
  v_cndmask_b32 v54, v54, v98, vcc
  v_cndmask_b32 v55, v55, v98, vcc
  buffer_store_dwordx4 v[48:51], v96, s[36:39], s77 offen sc1
  buffer_store_dwordx4 v[52:55], v96, s[36:39], s77 offen offset:1024 sc1
  s_add_u32 s77, s77, s71
  v_accvgpr_read_b32 v56, a16
  v_accvgpr_read_b32 v57, a17
  v_accvgpr_read_b32 v58, a18
  v_accvgpr_read_b32 v59, a19
  v_accvgpr_read_b32 v60, a20
  v_accvgpr_read_b32 v61, a21
  v_accvgpr_read_b32 v62, a22
  v_accvgpr_read_b32 v63, a23
  v_accvgpr_read_b32 v64, a24
  v_accvgpr_read_b32 v65, a25
  v_accvgpr_read_b32 v66, a26
  v_accvgpr_read_b32 v67, a27
  v_accvgpr_read_b32 v68, a28
  v_accvgpr_read_b32 v69, a29
  v_accvgpr_read_b32 v70, a30
  v_accvgpr_read_b32 v71, a31
  v_cvt_pk_bf16_f32 v72, v56, v57
  v_cvt_pk_bf16_f32 v73, v58, v59
  v_cvt_pk_bf16_f32 v74, v60, v61
  v_cvt_pk_bf16_f32 v75, v62, v63
  v_cvt_pk_bf16_f32 v76, v64, v65
  v_cvt_pk_bf16_f32 v77, v66, v67
  v_cvt_pk_bf16_f32 v78, v68, v69
  v_cvt_pk_bf16_f32 v79, v70, v71
  v_cndmask_b32 v72, v72, v98, vcc
  v_cndmask_b32 v73, v73, v98, vcc
  v_cndmask_b32 v74, v74, v98, vcc
  v_cndmask_b32 v75, v75, v98, vcc
  v_cndmask_b32 v76, v76, v98, vcc
  v_cndmask_b32 v77, v77, v98, vcc
  v_cndmask_b32 v78, v78, v98, vcc
  v_cndmask_b32 v79, v79, v98, vcc
  buffer_store_dwordx4 v[72:75], v96, s[36:39], s77 offen sc1
  buffer_store_dwordx4 v[76:79], v96, s[36:39], s77 offen offset:1024 sc1
  s_add_u32 s77, s77, s71
  v_accvgpr_read_b32 v32, a32
  v_accvgpr_read_b32 v33, a33
  v_accvgpr_read_b32 v34, a34
  v_accvgpr_read_b32 v35, a35
  v_accvgpr_read_b32 v36, a36
  v_accvgpr_read_b32 v37, a37
  v_accvgpr_read_b32 v38, a38
  v_accvgpr_read_b32 v39, a39
  v_accvgpr_read_b32 v40, a40
  v_accvgpr_read_b32 v41, a41
  v_accvgpr_read_b32 v42, a42
  v_accvgpr_read_b32 v43, a43
  v_accvgpr_read_b32 v44, a44
  v_accvgpr_read_b32 v45, a45
  v_accvgpr_read_b32 v46, a46
  v_accvgpr_read_b32 v47, a47
  v_cvt_pk_bf16_f32 v48, v32, v33
  v_cvt_pk_bf16_f32 v49, v34, v35
  v_cvt_pk_bf16_f32 v50, v36, v37
  v_cvt_pk_bf16_f32 v51, v38, v39
  v_cvt_pk_bf16_f32 v52, v40, v41
  v_cvt_pk_bf16_f32 v53, v42, v43
  v_cvt_pk_bf16_f32 v54, v44, v45
  v_cvt_pk_bf16_f32 v55, v46, v47
  v_cndmask_b32 v48, v48, v98, vcc
  v_cndmask_b32 v49, v49, v98, vcc
  v_cndmask_b32 v50, v50, v98, vcc
  v_cndmask_b32 v51, v51, v98, vcc
  v_cndmask_b32 v52, v52, v98, vcc
  v_cndmask_b32 v53, v53, v98, vcc
  v_cndmask_b32 v54, v54, v98, vcc
  v_cndmask_b32 v55, v55, v98, vcc
  buffer_store_dwordx4 v[48:51], v96, s[36:39], s77 offen sc1
  buffer_store_dwordx4 v[52:55], v96, s[36:39], s77 offen offset:1024 sc1
  s_add_u32 s77, s77, s71
  v_accvgpr_read_b32 v56, a48
  v_accvgpr_read_b32 v57, a49
  v_accvgpr_read_b32 v58, a50
  v_accvgpr_read_b32 v59, a51
  v_accvgpr_read_b32 v60, a52
  v_accvgpr_read_b32 v61, a53
  v_accvgpr_read_b32 v62, a54
  v_accvgpr_read_b32 v63, a55
  v_accvgpr_read_b32 v64, a56
  v_accvgpr_read_b32 v65, a57
  v_accvgpr_read_b32 v66, a58
  v_accvgpr_read_b32 v67, a59
  v_accvgpr_read_b32 v68, a60
  v_accvgpr_read_b32 v69, a61
  v_accvgpr_read_b32 v70, a62
  v_accvgpr_read_b32 v71, a63
  v_cvt_pk_bf16_f32 v72, v56, v57
  v_cvt_pk_bf16_f32 v73, v58, v59
  v_cvt_pk_bf16_f32 v74, v60, v61
  v_cvt_pk_bf16_f32 v75, v62, v63
  v_cvt_pk_bf16_f32 v76, v64, v65
  v_cvt_pk_bf16_f32 v77, v66, v67
  v_cvt_pk_bf16_f32 v78, v68, v69
  v_cvt_pk_bf16_f32 v79, v70, v71
  v_cndmask_b32 v72, v72, v98, vcc
  v_cndmask_b32 v73, v73, v98, vcc
  v_cndmask_b32 v74, v74, v98, vcc
  v_cndmask_b32 v75, v75, v98, vcc
  v_cndmask_b32 v76, v76, v98, vcc
  v_cndmask_b32 v77, v77, v98, vcc
  v_cndmask_b32 v78, v78, v98, vcc
  v_cndmask_b32 v79, v79, v98, vcc
  buffer_store_dwordx4 v[72:75], v96, s[36:39], s77 offen sc1
  buffer_store_dwordx4 v[76:79], v96, s[36:39], s77 offen offset:1024 sc1
  s_mul_i32 s77, s70, 1
  s_add_u32 s77, s77, s69
  v_accvgpr_read_b32 v32, a64
  v_accvgpr_read_b32 v33, a65
  v_accvgpr_read_b32 v34, a66
  v_accvgpr_read_b32 v35, a67
  v_accvgpr_read_b32 v36, a68
  v_accvgpr_read_b32 v37, a69
  v_accvgpr_read_b32 v38, a70
  v_accvgpr_read_b32 v39, a71
  v_accvgpr_read_b32 v40, a72
  v_accvgpr_read_b32 v41, a73
  v_accvgpr_read_b32 v42, a74
  v_accvgpr_read_b32 v43, a75
  v_accvgpr_read_b32 v44, a76
  v_accvgpr_read_b32 v45, a77
  v_accvgpr_read_b32 v46, a78
  v_accvgpr_read_b32 v47, a79
  v_cvt_pk_bf16_f32 v48, v32, v33
  v_cvt_pk_bf16_f32 v49, v34, v35
  v_cvt_pk_bf16_f32 v50, v36, v37
  v_cvt_pk_bf16_f32 v51, v38, v39
  v_cvt_pk_bf16_f32 v52, v40, v41
  v_cvt_pk_bf16_f32 v53, v42, v43
  v_cvt_pk_bf16_f32 v54, v44, v45
  v_cvt_pk_bf16_f32 v55, v46, v47
  v_cndmask_b32 v48, v48, v98, vcc
  v_cndmask_b32 v49, v49, v98, vcc
  v_cndmask_b32 v50, v50, v98, vcc
  v_cndmask_b32 v51, v51, v98, vcc
  v_cndmask_b32 v52, v52, v98, vcc
  v_cndmask_b32 v53, v53, v98, vcc
  v_cndmask_b32 v54, v54, v98, vcc
  v_cndmask_b32 v55, v55, v98, vcc
  buffer_store_dwordx4 v[48:51], v96, s[36:39], s77 offen sc1
  buffer_store_dwordx4 v[52:55], v96, s[36:39], s77 offen offset:1024 sc1
  s_add_u32 s77, s77, s71
  v_accvgpr_read_b32 v56, a80
  v_accvgpr_read_b32 v57, a81
  v_accvgpr_read_b32 v58, a82
  v_accvgpr_read_b32 v59, a83
  v_accvgpr_read_b32 v60, a84
  v_accvgpr_read_b32 v61, a85
  v_accvgpr_read_b32 v62, a86
  v_accvgpr_read_b32 v63, a87
  v_accvgpr_read_b32 v64, a88
  v_accvgpr_read_b32 v65, a89
  v_accvgpr_read_b32 v66, a90
  v_accvgpr_read_b32 v67, a91
  v_accvgpr_read_b32 v68, a92
  v_accvgpr_read_b32 v69, a93
  v_accvgpr_read_b32 v70, a94
  v_accvgpr_read_b32 v71, a95
  v_cvt_pk_bf16_f32 v72, v56, v57
  v_cvt_pk_bf16_f32 v73, v58, v59
  v_cvt_pk_bf16_f32 v74, v60, v61
  v_cvt_pk_bf16_f32 v75, v62, v63
  v_cvt_pk_bf16_f32 v76, v64, v65
  v_cvt_pk_bf16_f32 v77, v66, v67
  v_cvt_pk_bf16_f32 v78, v68, v69
  v_cvt_pk_bf16_f32 v79, v70, v71
  v_cndmask_b32 v72, v72, v98, vcc
  v_cndmask_b32 v73, v73, v98, vcc
  v_cndmask_b32 v74, v74, v98, vcc
  v_cndmask_b32 v75, v75, v98, vcc
  v_cndmask_b32 v76, v76, v98, vcc
  v_cndmask_b32 v77, v77, v98, vcc
  v_cndmask_b32 v78, v78, v98, vcc
  v_cndmask_b32 v79, v79, v98, vcc
  buffer_store_dwordx4 v[72:75], v96, s[36:39], s77 offen sc1
  buffer_store_dwordx4 v[76:79], v96, s[36:39], s77 offen offset:1024 sc1
  s_add_u32 s77, s77, s71
  v_accvgpr_read_b32 v32, a96
  v_accvgpr_read_b32 v33, a97
  v_accvgpr_read_b32 v34, a98
  v_accvgpr_read_b32 v35, a99
  v_accvgpr_read_b32 v36, a100
  v_accvgpr_read_b32 v37, a101
  v_accvgpr_read_b32 v38, a102
  v_accvgpr_read_b32 v39, a103
  v_accvgpr_read_b32 v40, a104
  v_accvgpr_read_b32 v41, a105
  v_accvgpr_read_b32 v42, a106
  v_accvgpr_read_b32 v43, a107
  v_accvgpr_read_b32 v44, a108
  v_accvgpr_read_b32 v45, a109
  v_accvgpr_read_b32 v46, a110
  v_accvgpr_read_b32 v47, a111
  v_cvt_pk_bf16_f32 v48, v32, v33
  v_cvt_pk_bf16_f32 v49, v34, v35
  v_cvt_pk_bf16_f32 v50, v36, v37
  v_cvt_pk_bf16_f32 v51, v38, v39
  v_cvt_pk_bf16_f32 v52, v40, v41
  v_cvt_pk_bf16_f32 v53, v42, v43
  v_cvt_pk_bf16_f32 v54, v44, v45
  v_cvt_pk_bf16_f32 v55, v46, v47
  v_cndmask_b32 v48, v48, v98, vcc
  v_cndmask_b32 v49, v49, v98, vcc
  v_cndmask_b32 v50, v50, v98, vcc
  v_cndmask_b32 v51, v51, v98, vcc
  v_cndmask_b32 v52, v52, v98, vcc
  v_cndmask_b32 v53, v53, v98, vcc
  v_cndmask_b32 v54, v54, v98, vcc
  v_cndmask_b32 v55, v55, v98, vcc
  buffer_store_dwordx4 v[48:51], v96, s[36:39], s77 offen sc1
  buffer_store_dwordx4 v[52:55], v96, s[36:39], s77 offen offset:1024 sc1
  s_add_u32 s77, s77, s71
  v_accvgpr_read_b32 v56, a112
  v_accvgpr_read_b32 v57, a113
  v_accvgpr_read_b32 v58, a114
  v_accvgpr_read_b32 v59, a115
  v_accvgpr_read_b32 v60, a116
  v_accvgpr_read_b32 v61, a117
  v_accvgpr_read_b32 v62, a118
  v_accvgpr_read_b32 v63, a119
  v_accvgpr_read_b32 v64, a120
  v_accvgpr_read_b32 v65, a121
  v_accvgpr_read_b32 v66, a122
  v_accvgpr_read_b32 v67, a123
  v_accvgpr_read_b32 v68, a124
  v_accvgpr_read_b32 v69, a125
  v_accvgpr_read_b32 v70, a126
  v_accvgpr_read_b32 v71, a127
  v_cvt_pk_bf16_f32 v72, v56, v57
  v_cvt_pk_bf16_f32 v73, v58, v59
  v_cvt_pk_bf16_f32 v74, v60, v61
  v_cvt_pk_bf16_f32 v75, v62, v63
  v_cvt_pk_bf16_f32 v76, v64, v65
  v_cvt_pk_bf16_f32 v77, v66, v67
  v_cvt_pk_bf16_f32 v78, v68, v69
  v_cvt_pk_bf16_f32 v79, v70, v71
  v_cndmask_b32 v72, v72, v98, vcc
  v_cndmask_b32 v73, v73, v98, vcc
  v_cndmask_b32 v74, v74, v98, vcc
  v_cndmask_b32 v75, v75, v98, vcc
  v_cndmask_b32 v76, v76, v98, vcc
  v_cndmask_b32 v77, v77, v98, vcc
  v_cndmask_b32 v78, v78, v98, vcc
  v_cndmask_b32 v79, v79, v98, vcc
  buffer_store_dwordx4 v[72:75], v96, s[36:39], s77 offen sc1
  buffer_store_dwordx4 v[76:79], v96, s[36:39], s77 offen offset:1024 sc1
  s_mul_i32 s77, s70, 2
  s_add_u32 s77, s77, s69
  v_accvgpr_read_b32 v32, a128
  v_accvgpr_read_b32 v33, a129
  v_accvgpr_read_b32 v34, a130
  v_accvgpr_read_b32 v35, a131
  v_accvgpr_read_b32 v36, a132
  v_accvgpr_read_b32 v37, a133
  v_accvgpr_read_b32 v38, a134
  v_accvgpr_read_b32 v39, a135
  v_accvgpr_read_b32 v40, a136
  v_accvgpr_read_b32 v41, a137
  v_accvgpr_read_b32 v42, a138
  v_accvgpr_read_b32 v43, a139
  v_accvgpr_read_b32 v44, a140
  v_accvgpr_read_b32 v45, a141
  v_accvgpr_read_b32 v46, a142
  v_accvgpr_read_b32 v47, a143
  v_cvt_pk_bf16_f32 v48, v32, v33
  v_cvt_pk_bf16_f32 v49, v34, v35
  v_cvt_pk_bf16_f32 v50, v36, v37
  v_cvt_pk_bf16_f32 v51, v38, v39
  v_cvt_pk_bf16_f32 v52, v40, v41
  v_cvt_pk_bf16_f32 v53, v42, v43
  v_cvt_pk_bf16_f32 v54, v44, v45
  v_cvt_pk_bf16_f32 v55, v46, v47
  v_cndmask_b32 v48, v48, v98, vcc
  v_cndmask_b32 v49, v49, v98, vcc
  v_cndmask_b32 v50, v50, v98, vcc
  v_cndmask_b32 v51, v51, v98, vcc
  v_cndmask_b32 v52, v52, v98, vcc
  v_cndmask_b32 v53, v53, v98, vcc
  v_cndmask_b32 v54, v54, v98, vcc
  v_cndmask_b32 v55, v55, v98, vcc
  buffer_store_dwordx4 v[48:51], v96, s[36:39], s77 offen sc1
  buffer_store_dwordx4 v[52:55], v96, s[36:39], s77 offen offset:1024 sc1
  s_add_u32 s77, s77, s71
  v_accvgpr_read_b32 v56, a144
  v_accvgpr_read_b32 v57, a145
  v_accvgpr_read_b32 v58, a146
  v_accvgpr_read_b32 v59, a147
  v_accvgpr_read_b32 v60, a148
  v_accvgpr_read_b32 v61, a149
  v_accvgpr_read_b32 v62, a150
  v_accvgpr_read_b32 v63, a151
  v_accvgpr_read_b32 v64, a152
  v_accvgpr_read_b32 v65, a153
  v_accvgpr_read_b32 v66, a154
  v_accvgpr_read_b32 v67, a155
  v_accvgpr_read_b32 v68, a156
  v_accvgpr_read_b32 v69, a157
  v_accvgpr_read_b32 v70, a158
  v_accvgpr_read_b32 v71, a159
  v_cvt_pk_bf16_f32 v72, v56, v57
  v_cvt_pk_bf16_f32 v73, v58, v59
  v_cvt_pk_bf16_f32 v74, v60, v61
  v_cvt_pk_bf16_f32 v75, v62, v63
  v_cvt_pk_bf16_f32 v76, v64, v65
  v_cvt_pk_bf16_f32 v77, v66, v67
  v_cvt_pk_bf16_f32 v78, v68, v69
  v_cvt_pk_bf16_f32 v79, v70, v71
  v_cndmask_b32 v72, v72, v98, vcc
  v_cndmask_b32 v73, v73, v98, vcc
  v_cndmask_b32 v74, v74, v98, vcc
  v_cndmask_b32 v75, v75, v98, vcc
  v_cndmask_b32 v76, v76, v98, vcc
  v_cndmask_b32 v77, v77, v98, vcc
  v_cndmask_b32 v78, v78, v98, vcc
  v_cndmask_b32 v79, v79, v98, vcc
  buffer_store_dwordx4 v[72:75], v96, s[36:39], s77 offen sc1
  buffer_store_dwordx4 v[76:79], v96, s[36:39], s77 offen offset:1024 sc1
  s_add_u32 s77, s77, s71
  v_accvgpr_read_b32 v32, a160
  v_accvgpr_read_b32 v33, a161
  v_accvgpr_read_b32 v34, a162
  v_accvgpr_read_b32 v35, a163
  v_accvgpr_read_b32 v36, a164
  v_accvgpr_read_b32 v37, a165
  v_accvgpr_read_b32 v38, a166
  v_accvgpr_read_b32 v39, a167
  v_accvgpr_read_b32 v40, a168
  v_accvgpr_read_b32 v41, a169
  v_accvgpr_read_b32 v42, a170
  v_accvgpr_read_b32 v43, a171
  v_accvgpr_read_b32 v44, a172
  v_accvgpr_read_b32 v45, a173
  v_accvgpr_read_b32 v46, a174
  v_accvgpr_read_b32 v47, a175
  v_cvt_pk_bf16_f32 v48, v32, v33
  v_cvt_pk_bf16_f32 v49, v34, v35
  v_cvt_pk_bf16_f32 v50, v36, v37
  v_cvt_pk_bf16_f32 v51, v38, v39
  v_cvt_pk_bf16_f32 v52, v40, v41
  v_cvt_pk_bf16_f32 v53, v42, v43
  v_cvt_pk_bf16_f32 v54, v44, v45
  v_cvt_pk_bf16_f32 v55, v46, v47
  v_cndmask_b32 v48, v48, v98, vcc
  v_cndmask_b32 v49, v49, v98, vcc
  v_cndmask_b32 v50, v50, v98, vcc
  v_cndmask_b32 v51, v51, v98, vcc
  v_cndmask_b32 v52, v52, v98, vcc
  v_cndmask_b32 v53, v53, v98, vcc
  v_cndmask_b32 v54, v54, v98, vcc
  v_cndmask_b32 v55, v55, v98, vcc
  buffer_store_dwordx4 v[48:51], v96, s[36:39], s77 offen sc1
  buffer_store_dwordx4 v[52:55], v96, s[36:39], s77 offen offset:1024 sc1
  s_add_u32 s77, s77, s71
  v_accvgpr_read_b32 v56, a176
  v_accvgpr_read_b32 v57, a177
  v_accvgpr_read_b32 v58, a178
  v_accvgpr_read_b32 v59, a179
  v_accvgpr_read_b32 v60, a180
  v_accvgpr_read_b32 v61, a181
  v_accvgpr_read_b32 v62, a182
  v_accvgpr_read_b32 v63, a183
  v_accvgpr_read_b32 v64, a184
  v_accvgpr_read_b32 v65, a185
  v_accvgpr_read_b32 v66, a186
  v_accvgpr_read_b32 v67, a187
  v_accvgpr_read_b32 v68, a188
  v_accvgpr_read_b32 v69, a189
  v_accvgpr_read_b32 v70, a190
  v_accvgpr_read_b32 v71, a191
  v_cvt_pk_bf16_f32 v72, v56, v57
  v_cvt_pk_bf16_f32 v73, v58, v59
  v_cvt_pk_bf16_f32 v74, v60, v61
  v_cvt_pk_bf16_f32 v75, v62, v63
  v_cvt_pk_bf16_f32 v76, v64, v65
  v_cvt_pk_bf16_f32 v77, v66, v67
  v_cvt_pk_bf16_f32 v78, v68, v69
  v_cvt_pk_bf16_f32 v79, v70, v71
  v_cndmask_b32 v72, v72, v98, vcc
  v_cndmask_b32 v73, v73, v98, vcc
  v_cndmask_b32 v74, v74, v98, vcc
  v_cndmask_b32 v75, v75, v98, vcc
  v_cndmask_b32 v76, v76, v98, vcc
  v_cndmask_b32 v77, v77, v98, vcc
  v_cndmask_b32 v78, v78, v98, vcc
  v_cndmask_b32 v79, v79, v98, vcc
  buffer_store_dwordx4 v[72:75], v96, s[36:39], s77 offen sc1
  buffer_store_dwordx4 v[76:79], v96, s[36:39], s77 offen offset:1024 sc1
  s_mul_i32 s77, s70, 3
  s_add_u32 s77, s77, s69
  v_accvgpr_read_b32 v32, a192
  v_accvgpr_read_b32 v33, a193
  v_accvgpr_read_b32 v34, a194
  v_accvgpr_read_b32 v35, a195
  v_accvgpr_read_b32 v36, a196
  v_accvgpr_read_b32 v37, a197
  v_accvgpr_read_b32 v38, a198
  v_accvgpr_read_b32 v39, a199
  v_accvgpr_read_b32 v40, a200
  v_accvgpr_read_b32 v41, a201
  v_accvgpr_read_b32 v42, a202
  v_accvgpr_read_b32 v43, a203
  v_accvgpr_read_b32 v44, a204
  v_accvgpr_read_b32 v45, a205
  v_accvgpr_read_b32 v46, a206
  v_accvgpr_read_b32 v47, a207
  v_cvt_pk_bf16_f32 v48, v32, v33
  v_cvt_pk_bf16_f32 v49, v34, v35
  v_cvt_pk_bf16_f32 v50, v36, v37
  v_cvt_pk_bf16_f32 v51, v38, v39
  v_cvt_pk_bf16_f32 v52, v40, v41
  v_cvt_pk_bf16_f32 v53, v42, v43
  v_cvt_pk_bf16_f32 v54, v44, v45
  v_cvt_pk_bf16_f32 v55, v46, v47
  v_cndmask_b32 v48, v48, v98, vcc
  v_cndmask_b32 v49, v49, v98, vcc
  v_cndmask_b32 v50, v50, v98, vcc
  v_cndmask_b32 v51, v51, v98, vcc
  v_cndmask_b32 v52, v52, v98, vcc
  v_cndmask_b32 v53, v53, v98, vcc
  v_cndmask_b32 v54, v54, v98, vcc
  v_cndmask_b32 v55, v55, v98, vcc
  buffer_store_dwordx4 v[48:51], v96, s[36:39], s77 offen sc1
  buffer_store_dwordx4 v[52:55], v96, s[36:39], s77 offen offset:1024 sc1
  s_add_u32 s77, s77, s71
  v_accvgpr_read_b32 v56, a208
  v_accvgpr_read_b32 v57, a209
  v_accvgpr_read_b32 v58, a210
  v_accvgpr_read_b32 v59, a211
  v_accvgpr_read_b32 v60, a212
  v_accvgpr_read_b32 v61, a213
  v_accvgpr_read_b32 v62, a214
  v_accvgpr_read_b32 v63, a215
  v_accvgpr_read_b32 v64, a216
  v_accvgpr_read_b32 v65, a217
  v_accvgpr_read_b32 v66, a218
  v_accvgpr_read_b32 v67, a219
  v_accvgpr_read_b32 v68, a220
  v_accvgpr_read_b32 v69, a221
  v_accvgpr_read_b32 v70, a222
  v_accvgpr_read_b32 v71, a223
  v_cvt_pk_bf16_f32 v72, v56, v57
  v_cvt_pk_bf16_f32 v73, v58, v59
  v_cvt_pk_bf16_f32 v74, v60, v61
  v_cvt_pk_bf16_f32 v75, v62, v63
  v_cvt_pk_bf16_f32 v76, v64, v65
  v_cvt_pk_bf16_f32 v77, v66, v67
  v_cvt_pk_bf16_f32 v78, v68, v69
  v_cvt_pk_bf16_f32 v79, v70, v71
  v_cndmask_b32 v72, v72, v98, vcc
  v_cndmask_b32 v73, v73, v98, vcc
  v_cndmask_b32 v74, v74, v98, vcc
  v_cndmask_b32 v75, v75, v98, vcc
  v_cndmask_b32 v76, v76, v98, vcc
  v_cndmask_b32 v77, v77, v98, vcc
  v_cndmask_b32 v78, v78, v98, vcc
  v_cndmask_b32 v79, v79, v98, vcc
  buffer_store_dwordx4 v[72:75], v96, s[36:39], s77 offen sc1
  buffer_store_dwordx4 v[76:79], v96, s[36:39], s77 offen offset:1024 sc1
  s_add_u32 s77, s77, s71
  v_accvgpr_read_b32 v32, a224
  v_accvgpr_read_b32 v33, a225
  v_accvgpr_read_b32 v34, a226
  v_accvgpr_read_b32 v35, a227
  v_accvgpr_read_b32 v36, a228
  v_accvgpr_read_b32 v37, a229
  v_accvgpr_read_b32 v38, a230
  v_accvgpr_read_b32 v39, a231
  v_accvgpr_read_b32 v40, a232
  v_accvgpr_read_b32 v41, a233
  v_accvgpr_read_b32 v42, a234
  v_accvgpr_read_b32 v43, a235
  v_accvgpr_read_b32 v44, a236
  v_accvgpr_read_b32 v45, a237
  v_accvgpr_read_b32 v46, a238
  v_accvgpr_read_b32 v47, a239
  v_cvt_pk_bf16_f32 v48, v32, v33
  v_cvt_pk_bf16_f32 v49, v34, v35
  v_cvt_pk_bf16_f32 v50, v36, v37
  v_cvt_pk_bf16_f32 v51, v38, v39
  v_cvt_pk_bf16_f32 v52, v40, v41
  v_cvt_pk_bf16_f32 v53, v42, v43
  v_cvt_pk_bf16_f32 v54, v44, v45
  v_cvt_pk_bf16_f32 v55, v46, v47
  v_cndmask_b32 v48, v48, v98, vcc
  v_cndmask_b32 v49, v49, v98, vcc
  v_cndmask_b32 v50, v50, v98, vcc
  v_cndmask_b32 v51, v51, v98, vcc
  v_cndmask_b32 v52, v52, v98, vcc
  v_cndmask_b32 v53, v53, v98, vcc
  v_cndmask_b32 v54, v54, v98, vcc
  v_cndmask_b32 v55, v55, v98, vcc
  buffer_store_dwordx4 v[48:51], v96, s[36:39], s77 offen sc1
  buffer_store_dwordx4 v[52:55], v96, s[36:39], s77 offen offset:1024 sc1
  s_add_u32 s77, s77, s71
  v_accvgpr_read_b32 v56, a240
  v_accvgpr_read_b32 v57, a241
  v_accvgpr_read_b32 v58, a242
  v_accvgpr_read_b32 v59, a243
  v_accvgpr_read_b32 v60, a244
  v_accvgpr_read_b32 v61, a245
  v_accvgpr_read_b32 v62, a246
  v_accvgpr_read_b32 v63, a247
  v_accvgpr_read_b32 v64, a248
  v_accvgpr_read_b32 v65, a249
  v_accvgpr_read_b32 v66, a250
  v_accvgpr_read_b32 v67, a251
  v_accvgpr_read_b32 v68, a252
  v_accvgpr_read_b32 v69, a253
  v_accvgpr_read_b32 v70, a254
  v_accvgpr_read_b32 v71, a255
  v_cvt_pk_bf16_f32 v72, v56, v57
  v_cvt_pk_bf16_f32 v73, v58, v59
  v_cvt_pk_bf16_f32 v74, v60, v61
  v_cvt_pk_bf16_f32 v75, v62, v63
  v_cvt_pk_bf16_f32 v76, v64, v65
  v_cvt_pk_bf16_f32 v77, v66, v67
  v_cvt_pk_bf16_f32 v78, v68, v69
  v_cvt_pk_bf16_f32 v79, v70, v71
  v_cndmask_b32 v72, v72, v98, vcc
  v_cndmask_b32 v73, v73, v98, vcc
  v_cndmask_b32 v74, v74, v98, vcc
  v_cndmask_b32 v75, v75, v98, vcc
  v_cndmask_b32 v76, v76, v98, vcc
  v_cndmask_b32 v77, v77, v98, vcc
  v_cndmask_b32 v78, v78, v98, vcc
  v_cndmask_b32 v79, v79, v98, vcc
  buffer_store_dwordx4 v[72:75], v96, s[36:39], s77 offen sc1
  buffer_store_dwordx4 v[76:79], v96, s[36:39], s77 offen offset:1024 sc1
  s_branch L_gemm_end
L_gemm_h:
  s_sub_u32 s82, s88, 1
  s_and_b32 s83, s57, 1
  s_cmp_eq_u32 s82, s83
  s_cselect_b64 s[86:87], -1, 0
  s_lshl_b32 s83, s82, 13
  s_mul_i32 s82, s82, s70
  s_lshl_b32 s82, s82, 1
  s_add_u32 s69, s69, s82
  v_add_u32 v4, s83, v4
  v_add_u32 v5, s83, v5
  v_add_u32 v6, s83, v6
  v_add_u32 v7, s83, v7
  s_cmp_lg_u32 s76, 0
  s_cbranch_scc1 L_gemm_h1
  s_cmp_eq_u64 s[86:87], 0
  s_cbranch_scc0 hx_7
  s_add_u32 m0, s67, 32768
  s_nop 0
  buffer_load_dwordx4 v20, s[48:51], s65 offen offset:0 lds
  buffer_load_dwordx4 v21, s[48:51], s65 offen offset:1024 lds
  buffer_load_dwordx4 v22, s[48:51], s65 offen offset:2048 lds
  buffer_load_dwordx4 v23, s[48:51], s65 offen offset:3072 lds
  s_add_u32 m0, s67, 36864
  s_nop 0
  buffer_load_dwordx4 v24, s[48:51], s65 offen offset:0 lds
  buffer_load_dwordx4 v25, s[48:51], s65 offen offset:1024 lds
  buffer_load_dwordx4 v26, s[48:51], s65 offen offset:2048 lds
  buffer_load_dwordx4 v27, s[48:51], s65 offen offset:3072 lds
  s_add_u32 s64, s64, 128
  s_add_u32 s65, s65, s66
  s_xor_b32 s67, s67, 0x10000
  s_add_u32 s64, s64, 128
  v_lshrrev_b32 v132, 2, v1
  s_lshl_b32 s81, s57, 4
  v_add_u32 v132, s81, v132
  v_mul_lo_u32 v132, v132, s75
  v_and_b32 v133, 3, v1
  v_lshl_add_u32 v132, v133, 7, v132
  s_mov_b32 s81, s65
  v_accvgpr_write_b32 a0, 0
  v_accvgpr_write_b32 a1, 0
  v_accvgpr_write_b32 a2, 0
  v_accvgpr_write_b32 a3, 0
  v_accvgpr_write_b32 a4, 0
  v_accvgpr_write_b32 a5, 0
  v_accvgpr_write_b32 a6, 0
  v_accvgpr_write_b32 a7, 0
  v_accvgpr_write_b32 a8, 0
  v_accvgpr_write_b32 a9, 0
  v_accvgpr_write_b32 a10, 0
  v_accvgpr_write_b32 a11, 0
  v_accvgpr_write_b32 a12, 0
  v_accvgpr_write_b32 a13, 0
  v_accvgpr_write_b32 a14, 0
  v_accvgpr_write_b32 a15, 0
  v_accvgpr_write_b32 a16, 0
  v_accvgpr_write_b32 a17, 0
  v_accvgpr_write_b32 a18, 0
  v_accvgpr_write_b32 a19, 0
  v_accvgpr_write_b32 a20, 0
  v_accvgpr_write_b32 a21, 0
  v_accvgpr_write_b32 a22, 0
  v_accvgpr_write_b32 a23, 0
  v_accvgpr_write_b32 a24, 0
  v_accvgpr_write_b32 a25, 0
  v_accvgpr_write_b32 a26, 0
  v_accvgpr_write_b32 a27, 0
  v_accvgpr_write_b32 a28, 0
  v_accvgpr_write_b32 a29, 0
  v_accvgpr_write_b32 a30, 0
  v_accvgpr_write_b32 a31, 0
  v_accvgpr_write_b32 a32, 0
  v_accvgpr_write_b32 a33, 0
  v_accvgpr_write_b32 a34, 0
  v_accvgpr_write_b32 a35, 0
  v_accvgpr_write_b32 a36, 0
  v_accvgpr_write_b32 a37, 0
  v_accvgpr_write_b32 a38, 0
  v_accvgpr_write_b32 a39, 0
  v_accvgpr_write_b32 a40, 0
  v_accvgpr_write_b32 a41, 0
  v_accvgpr_write_b32 a42, 0
  v_accvgpr_write_b32 a43, 0
  v_accvgpr_write_b32 a44, 0
  v_accvgpr_write_b32 a45, 0
  v_accvgpr_write_b32 a46, 0
  v_accvgpr_write_b32 a47, 0
  v_accvgpr_write_b32 a48, 0
  v_accvgpr_write_b32 a49, 0
  v_accvgpr_write_b32 a50, 0
  v_accvgpr_write_b32 a51, 0
  v_accvgpr_write_b32 a52, 0
  v_accvgpr_write_b32 a53, 0
  v_accvgpr_write_b32 a54, 0
  v_accvgpr_write_b32 a55, 0
  v_accvgpr_write_b32 a56, 0
  v_accvgpr_write_b32 a57, 0
  v_accvgpr_write_b32 a58, 0
  v_accvgpr_write_b32 a59, 0
  v_accvgpr_write_b32 a60, 0
  v_accvgpr_write_b32 a61, 0
  v_accvgpr_write_b32 a62, 0
  v_accvgpr_write_b32 a63, 0
  v_accvgpr_write_b32 a64, 0
  v_accvgpr_write_b32 a65, 0
  v_accvgpr_write_b32 a66, 0
  v_accvgpr_write_b32 a67, 0
  v_accvgpr_write_b32 a68, 0
  v_accvgpr_write_b32 a69, 0
  v_accvgpr_write_b32 a70, 0
  v_accvgpr_write_b32 a71, 0
  v_accvgpr_write_b32 a72, 0
  v_accvgpr_write_b32 a73, 0
  v_accvgpr_write_b32 a74, 0
  v_accvgpr_write_b32 a75, 0
  v_accvgpr_write_b32 a76, 0
  v_accvgpr_write_b32 a77, 0
  v_accvgpr_write_b32 a78, 0
  v_accvgpr_write_b32 a79, 0
  v_accvgpr_write_b32 a80, 0
  v_accvgpr_write_b32 a81, 0
  v_accvgpr_write_b32 a82, 0
  v_accvgpr_write_b32 a83, 0
  v_accvgpr_write_b32 a84, 0
  v_accvgpr_write_b32 a85, 0
  v_accvgpr_write_b32 a86, 0
  v_accvgpr_write_b32 a87, 0
  v_accvgpr_write_b32 a88, 0
  v_accvgpr_write_b32 a89, 0
  v_accvgpr_write_b32 a90, 0
  v_accvgpr_write_b32 a91, 0
  v_accvgpr_write_b32 a92, 0
  v_accvgpr_write_b32 a93, 0
  v_accvgpr_write_b32 a94, 0
  v_accvgpr_write_b32 a95, 0
  v_accvgpr_write_b32 a96, 0
  v_accvgpr_write_b32 a97, 0
  v_accvgpr_write_b32 a98, 0
  v_accvgpr_write_b32 a99, 0
  v_accvgpr_write_b32 a100, 0
  v_accvgpr_write_b32 a101, 0
  v_accvgpr_write_b32 a102, 0
  v_accvgpr_write_b32 a103, 0
  v_accvgpr_write_b32 a104, 0
  v_accvgpr_write_b32 a105, 0
  v_accvgpr_write_b32 a106, 0
  v_accvgpr_write_b32 a107, 0
  v_accvgpr_write_b32 a108, 0
  v_accvgpr_write_b32 a109, 0
  v_accvgpr_write_b32 a110, 0
  v_accvgpr_write_b32 a111, 0
  v_accvgpr_write_b32 a112, 0
  v_accvgpr_write_b32 a113, 0
  v_accvgpr_write_b32 a114, 0
  v_accvgpr_write_b32 a115, 0
  v_accvgpr_write_b32 a116, 0
  v_accvgpr_write_b32 a117, 0
  v_accvgpr_write_b32 a118, 0
  v_accvgpr_write_b32 a119, 0
  v_accvgpr_write_b32 a120, 0
  v_accvgpr_write_b32 a121, 0
  v_accvgpr_write_b32 a122, 0
  v_accvgpr_write_b32 a123, 0
  v_accvgpr_write_b32 a124, 0
  v_accvgpr_write_b32 a125, 0
  v_accvgpr_write_b32 a126, 0
  v_accvgpr_write_b32 a127, 0
  s_waitcnt vmcnt(0)
  s_branch hx_7_e
hx_7:
  s_add_u32 m0, s67, 0
  s_nop 0
  buffer_load_dwordx4 v12, s[44:47], s64 offen offset:0 lds
  buffer_load_dwordx4 v13, s[44:47], s64 offen offset:1024 lds
  buffer_load_dwordx4 v14, s[44:47], s64 offen offset:2048 lds
  buffer_load_dwordx4 v15, s[44:47], s64 offen offset:3072 lds
  s_add_u32 m0, s67, 4096
  s_nop 0
  buffer_load_dwordx4 v16, s[44:47], s64 offen offset:0 lds
  buffer_load_dwordx4 v17, s[44:47], s64 offen offset:1024 lds
  buffer_load_dwordx4 v18, s[44:47], s64 offen offset:2048 lds
  buffer_load_dwordx4 v19, s[44:47], s64 offen offset:3072 lds
  s_add_u32 m0, s67, 32768
  s_nop 0
  buffer_load_dwordx4 v20, s[48:51], s65 offen offset:0 lds
  buffer_load_dwordx4 v21, s[48:51], s65 offen offset:1024 lds
  buffer_load_dwordx4 v22, s[48:51], s65 offen offset:2048 lds
  buffer_load_dwordx4 v23, s[48:51], s65 offen offset:3072 lds
  s_add_u32 m0, s67, 36864
  s_nop 0
  buffer_load_dwordx4 v24, s[48:51], s65 offen offset:0 lds
  buffer_load_dwordx4 v25, s[48:51], s65 offen offset:1024 lds
  buffer_load_dwordx4 v26, s[48:51], s65 offen offset:2048 lds
  buffer_load_dwordx4 v27, s[48:51], s65 offen offset:3072 lds
  s_add_u32 s64, s64, 128
  s_add_u32 s65, s65, s66
  s_xor_b32 s67, s67, 0x10000
  s_add_u32 m0, s67, 0
  s_nop 0
  buffer_load_dwordx4 v12, s[44:47], s64 offen offset:0 lds
  buffer_load_dwordx4 v13, s[44:47], s64 offen offset:1024 lds
  buffer_load_dwordx4 v14, s[44:47], s64 offen offset:2048 lds
  buffer_load_dwordx4 v15, s[44:47], s64 offen offset:3072 lds
  s_add_u32 m0, s67, 4096
  s_nop 0
  buffer_load_dwordx4 v16, s[44:47], s64 offen offset:0 lds
  buffer_load_dwordx4 v17, s[44:47], s64 offen offset:1024 lds
  buffer_load_dwordx4 v18, s[44:47], s64 offen offset:2048 lds
  buffer_load_dwordx4 v19, s[44:47], s64 offen offset:3072 lds
  s_add_u32 s64, s64, 128
  v_lshrrev_b32 v132, 2, v1
  s_lshl_b32 s81, s57, 4
  v_add_u32 v132, s81, v132
  v_mul_lo_u32 v132, v132, s75
  v_and_b32 v133, 3, v1
  v_lshl_add_u32 v132, v133, 7, v132
  s_mov_b32 s81, s65
  s_lshl_b32 s81, s57, 6
  v_add_u32 v133, s81, v1
  v_mul_u32_u24 v133, 1280, v133
  v_accvgpr_write_b32 a0, 0
  v_accvgpr_write_b32 a1, 0
  v_accvgpr_write_b32 a2, 0
  v_accvgpr_write_b32 a3, 0
  v_accvgpr_write_b32 a4, 0
  v_accvgpr_write_b32 a5, 0
  v_accvgpr_write_b32 a6, 0
  v_accvgpr_write_b32 a7, 0
  v_accvgpr_write_b32 a8, 0
  v_accvgpr_write_b32 a9, 0
  v_accvgpr_write_b32 a10, 0
  v_accvgpr_write_b32 a11, 0
  v_accvgpr_write_b32 a12, 0
  v_accvgpr_write_b32 a13, 0
  v_accvgpr_write_b32 a14, 0
  v_accvgpr_write_b32 a15, 0
  v_accvgpr_write_b32 a16, 0
  v_accvgpr_write_b32 a17, 0
  v_accvgpr_write_b32 a18, 0
  v_accvgpr_write_b32 a19, 0
  v_accvgpr_write_b32 a20, 0
  v_accvgpr_write_b32 a21, 0
  v_accvgpr_write_b32 a22, 0
  v_accvgpr_write_b32 a23, 0
  v_accvgpr_write_b32 a24, 0
  v_accvgpr_write_b32 a25, 0
  v_accvgpr_write_b32 a26, 0
  v_accvgpr_write_b32 a27, 0
  v_accvgpr_write_b32 a28, 0
  v_accvgpr_write_b32 a29, 0
  v_accvgpr_write_b32 a30, 0
  v_accvgpr_write_b32 a31, 0
  v_accvgpr_write_b32 a32, 0
  v_accvgpr_write_b32 a33, 0
  v_accvgpr_write_b32 a34, 0
  v_accvgpr_write_b32 a35, 0
  v_accvgpr_write_b32 a36, 0
  v_accvgpr_write_b32 a37, 0
  v_accvgpr_write_b32 a38, 0
  v_accvgpr_write_b32 a39, 0
  v_accvgpr_write_b32 a40, 0
  v_accvgpr_write_b32 a41, 0
  v_accvgpr_write_b32 a42, 0
  v_accvgpr_write_b32 a43, 0
  v_accvgpr_write_b32 a44, 0
  v_accvgpr_write_b32 a45, 0
  v_accvgpr_write_b32 a46, 0
  v_accvgpr_write_b32 a47, 0
  v_accvgpr_write_b32 a48, 0
  v_accvgpr_write_b32 a49, 0
  v_accvgpr_write_b32 a50, 0
  v_accvgpr_write_b32 a51, 0
  v_accvgpr_write_b32 a52, 0
  v_accvgpr_write_b32 a53, 0
  v_accvgpr_write_b32 a54, 0
  v_accvgpr_write_b32 a55, 0
  v_accvgpr_write_b32 a56, 0
  v_accvgpr_write_b32 a57, 0
  v_accvgpr_write_b32 a58, 0
  v_accvgpr_write_b32 a59, 0
  v_accvgpr_write_b32 a60, 0
  v_accvgpr_write_b32 a61, 0
  v_accvgpr_write_b32 a62, 0
  v_accvgpr_write_b32 a63, 0
  v_accvgpr_write_b32 a64, 0
  v_accvgpr_write_b32 a65, 0
  v_accvgpr_write_b32 a66, 0
  v_accvgpr_write_b32 a67, 0
  v_accvgpr_write_b32 a68, 0
  v_accvgpr_write_b32 a69, 0
  v_accvgpr_write_b32 a70, 0
  v_accvgpr_write_b32 a71, 0
  v_accvgpr_write_b32 a72, 0
  v_accvgpr_write_b32 a73, 0
  v_accvgpr_write_b32 a74, 0
  v_accvgpr_write_b32 a75, 0
  v_accvgpr_write_b32 a76, 0
  v_accvgpr_write_b32 a77, 0
  v_accvgpr_write_b32 a78, 0
  v_accvgpr_write_b32 a79, 0
  v_accvgpr_write_b32 a80, 0
  v_accvgpr_write_b32 a81, 0
  v_accvgpr_write_b32 a82, 0
  v_accvgpr_write_b32 a83, 0
  v_accvgpr_write_b32 a84, 0
  v_accvgpr_write_b32 a85, 0
  v_accvgpr_write_b32 a86, 0
  v_accvgpr_write_b32 a87, 0
  v_accvgpr_write_b32 a88, 0
  v_accvgpr_write_b32 a89, 0
  v_accvgpr_write_b32 a90, 0
  v_accvgpr_write_b32 a91, 0
  v_accvgpr_write_b32 a92, 0
  v_accvgpr_write_b32 a93, 0
  v_accvgpr_write_b32 a94, 0
  v_accvgpr_write_b32 a95, 0
  v_accvgpr_write_b32 a96, 0
  v_accvgpr_write_b32 a97, 0
  v_accvgpr_write_b32 a98, 0
  v_accvgpr_write_b32 a99, 0
  v_accvgpr_write_b32 a100, 0
  v_accvgpr_write_b32 a101, 0
  v_accvgpr_write_b32 a102, 0
  v_accvgpr_write_b32 a103, 0
  v_accvgpr_write_b32 a104, 0
  v_accvgpr_write_b32 a105, 0
  v_accvgpr_write_b32 a106, 0
  v_accvgpr_write_b32 a107, 0
  v_accvgpr_write_b32 a108, 0
  v_accvgpr_write_b32 a109, 0
  v_accvgpr_write_b32 a110, 0
  v_accvgpr_write_b32 a111, 0
  v_accvgpr_write_b32 a112, 0
  v_accvgpr_write_b32 a113, 0
  v_accvgpr_write_b32 a114, 0
  v_accvgpr_write_b32 a115, 0
  v_accvgpr_write_b32 a116, 0
  v_accvgpr_write_b32 a117, 0
  v_accvgpr_write_b32 a118, 0
  v_accvgpr_write_b32 a119, 0
  v_accvgpr_write_b32 a120, 0
  v_accvgpr_write_b32 a121, 0
  v_accvgpr_write_b32 a122, 0
  v_accvgpr_write_b32 a123, 0
  v_accvgpr_write_b32 a124, 0
  v_accvgpr_write_b32 a125, 0
  v_accvgpr_write_b32 a126, 0
  v_accvgpr_write_b32 a127, 0
  s_waitcnt vmcnt(8)
hx_7_e:
  s_barrier
  s_cmp_lg_u32 s60, 0
  s_cbranch_scc1 gr_8
  s_cmp_lg_u32 s57, 0
  s_cbranch_scc1 rg_9
  s_getreg_b32 s62, hwreg(HW_REG_XCC_ID)
  s_and_b32 s62, s62, 15
  s_lshl_b32 s62, s62, 2
  s_and_b32 s81, s61, 7
  s_mov_b32 s63, 1
  s_cmp_eq_u32 s81, 0
  s_cselect_b32 s63, 0x401, s63
  s_cmp_eq_u32 s81, 1
  s_cselect_b32 s63, 0x100001, s63
  s_mov_b64 exec, 1
  v_mov_b32 v2, s63
  v_mov_b32 v3, 0
  buffer_atomic_add v2, v3, s[52:55], s62 offen sc1
  s_mov_b64 exec, -1
rg_9:
gr_8:
  ds_read_b128 v[32:35], v4 offset:0
  ds_read_b64_tr_b16 v[64:65], v8 offset:0
  ds_read_b64_tr_b16 v[66:67], v8 offset:2048
  ds_read_b128 v[36:39], v4 offset:4096
  ds_read_b64_tr_b16 v[68:69], v9 offset:0
  ds_read_b64_tr_b16 v[70:71], v9 offset:2048
  ds_read_b64_tr_b16 v[72:73], v10 offset:0
  ds_read_b64_tr_b16 v[74:75], v10 offset:2048
  ds_read_b64_tr_b16 v[76:77], v11 offset:0
  ds_read_b64_tr_b16 v[78:79], v11 offset:2048
  s_mov_b32 s68, 8
gl_10:
  s_waitcnt lgkmcnt(0)
  s_add_u32 m0, s67, 32768
  v_mfma_f32_32x32x16_bf16 a[0:15], v[64:67], v[32:35], a[0:15]
  buffer_load_dwordx4 v20, s[48:51], s65 offen offset:0 lds
  ds_read_b128 v[48:51], v5 offset:0
  ds_read_b64_tr_b16 v[80:81], v8 offset:8192
  v_mfma_f32_32x32x16_bf16 a[16:31], v[68:71], v[32:35], a[16:31]
  buffer_load_dwordx4 v21, s[48:51], s65 offen offset:1024 lds
  ds_read_b64_tr_b16 v[82:83], v8 offset:10240
  ds_read_b128 v[52:55], v5 offset:4096
  v_mfma_f32_32x32x16_bf16 a[32:47], v[72:75], v[32:35], a[32:47]
  buffer_load_dwordx4 v22, s[48:51], s65 offen offset:2048 lds
  ds_read_b64_tr_b16 v[84:85], v9 offset:8192
  ds_read_b64_tr_b16 v[86:87], v9 offset:10240
  v_mfma_f32_32x32x16_bf16 a[48:63], v[76:79], v[32:35], a[48:63]
  buffer_load_dwordx4 v23, s[48:51], s65 offen offset:3072 lds
  ds_read_b64_tr_b16 v[88:89], v10 offset:8192
  ds_read_b64_tr_b16 v[90:91], v10 offset:10240
  s_add_u32 m0, s67, 36864
  v_mfma_f32_32x32x16_bf16 a[64:79], v[64:67], v[36:39], a[64:79]
  buffer_load_dwordx4 v24, s[48:51], s65 offen offset:0 lds
  ds_read_b64_tr_b16 v[92:93], v11 offset:8192
  v_mfma_f32_32x32x16_bf16 a[80:95], v[68:71], v[36:39], a[80:95]
  buffer_load_dwordx4 v25, s[48:51], s65 offen offset:1024 lds
  ds_read_b64_tr_b16 v[94:95], v11 offset:10240
  v_mfma_f32_32x32x16_bf16 a[96:111], v[72:75], v[36:39], a[96:111]
  buffer_load_dwordx4 v26, s[48:51], s65 offen offset:2048 lds
  v_mfma_f32_32x32x16_bf16 a[112:127], v[76:79], v[36:39], a[112:127]
  buffer_load_dwordx4 v27, s[48:51], s65 offen offset:3072 lds
  s_add_u32 s65, s65, s66
  s_xor_b32 s67, s67, 0x10000
  s_waitcnt lgkmcnt(0)
  v_mfma_f32_32x32x16_bf16 a[0:15], v[80:83], v[48:51], a[0:15]
  ds_read_b128 v[32:35], v6 offset:0
  ds_read_b64_tr_b16 v[64:65], v8 offset:16384
  v_mfma_f32_32x32x16_bf16 a[16:31], v[84:87], v[48:51], a[16:31]
  ds_read_b64_tr_b16 v[66:67], v8 offset:18432
  ds_read_b128 v[36:39], v6 offset:4096
  v_mfma_f32_32x32x16_bf16 a[32:47], v[88:91], v[48:51], a[32:47]
  ds_read_b64_tr_b16 v[68:69], v9 offset:16384
  ds_read_b64_tr_b16 v[70:71], v9 offset:18432
  v_mfma_f32_32x32x16_bf16 a[48:63], v[92:95], v[48:51], a[48:63]
  ds_read_b64_tr_b16 v[72:73], v10 offset:16384
  ds_read_b64_tr_b16 v[74:75], v10 offset:18432
  v_mfma_f32_32x32x16_bf16 a[64:79], v[80:83], v[52:55], a[64:79]
  ds_read_b64_tr_b16 v[76:77], v11 offset:16384
  v_mfma_f32_32x32x16_bf16 a[80:95], v[84:87], v[52:55], a[80:95]
  ds_read_b64_tr_b16 v[78:79], v11 offset:18432
  v_mfma_f32_32x32x16_bf16 a[96:111], v[88:91], v[52:55], a[96:111]
  v_mfma_f32_32x32x16_bf16 a[112:127], v[92:95], v[52:55], a[112:127]
  s_waitcnt lgkmcnt(0)
  v_mfma_f32_32x32x16_bf16 a[0:15], v[64:67], v[32:35], a[0:15]
  ds_read_b128 v[48:51], v7 offset:0
  ds_read_b64_tr_b16 v[80:81], v8 offset:24576
  v_mfma_f32_32x32x16_bf16 a[16:31], v[68:71], v[32:35], a[16:31]
  ds_read_b64_tr_b16 v[82:83], v8 offset:26624
  ds_read_b128 v[52:55], v7 offset:4096
  v_mfma_f32_32x32x16_bf16 a[32:47], v[72:75], v[32:35], a[32:47]
  ds_read_b64_tr_b16 v[84:85], v9 offset:24576
  ds_read_b64_tr_b16 v[86:87], v9 offset:26624
  v_mfma_f32_32x32x16_bf16 a[48:63], v[76:79], v[32:35], a[48:63]
  ds_read_b64_tr_b16 v[88:89], v10 offset:24576
  ds_read_b64_tr_b16 v[90:91], v10 offset:26624
  v_mfma_f32_32x32x16_bf16 a[64:79], v[64:67], v[36:39], a[64:79]
  ds_read_b64_tr_b16 v[92:93], v11 offset:24576
  v_mfma_f32_32x32x16_bf16 a[80:95], v[68:71], v[36:39], a[80:95]
  ds_read_b64_tr_b16 v[94:95], v11 offset:26624
  v_mfma_f32_32x32x16_bf16 a[96:111], v[72:75], v[36:39], a[96:111]
  v_mfma_f32_32x32x16_bf16 a[112:127], v[76:79], v[36:39], a[112:127]
  s_waitcnt vmcnt(0) lgkmcnt(0)
  s_barrier
  v_xor_b32 v4, 0x10000, v4
  v_xor_b32 v5, 0x10000, v5
  v_xor_b32 v6, 0x10000, v6
  v_xor_b32 v7, 0x10000, v7
  v_xor_b32 v8, 0x10000, v8
  v_xor_b32 v9, 0x10000, v9
  v_xor_b32 v10, 0x10000, v10
  v_xor_b32 v11, 0x10000, v11
  s_add_u32 m0, s67, 0
  v_mfma_f32_32x32x16_bf16 a[0:15], v[80:83], v[48:51], a[0:15]
  s_mov_b64 exec, s[86:87]
  buffer_load_dwordx4 v12, s[44:47], s64 offen offset:0 lds
  s_mov_b64 exec, -1
  ds_read_b128 v[32:35], v4 offset:0
  ds_read_b64_tr_b16 v[64:65], v8 offset:0
  v_mfma_f32_32x32x16_bf16 a[16:31], v[84:87], v[48:51], a[16:31]
  s_mov_b64 exec, s[86:87]
  buffer_load_dwordx4 v13, s[44:47], s64 offen offset:1024 lds
  s_mov_b64 exec, -1
  ds_read_b64_tr_b16 v[66:67], v8 offset:2048
  ds_read_b128 v[36:39], v4 offset:4096
  v_mfma_f32_32x32x16_bf16 a[32:47], v[88:91], v[48:51], a[32:47]
  s_mov_b64 exec, s[86:87]
  buffer_load_dwordx4 v14, s[44:47], s64 offen offset:2048 lds
  s_mov_b64 exec, -1
  ds_read_b64_tr_b16 v[68:69], v9 offset:0
  ds_read_b64_tr_b16 v[70:71], v9 offset:2048
  v_mfma_f32_32x32x16_bf16 a[48:63], v[92:95], v[48:51], a[48:63]
  s_mov_b64 exec, s[86:87]
  buffer_load_dwordx4 v15, s[44:47], s64 offen offset:3072 lds
  s_mov_b64 exec, -1
  ds_read_b64_tr_b16 v[72:73], v10 offset:0
  ds_read_b64_tr_b16 v[74:75], v10 offset:2048
  s_add_u32 m0, s67, 4096
  v_mfma_f32_32x32x16_bf16 a[64:79], v[80:83], v[52:55], a[64:79]
  s_mov_b64 exec, s[86:87]
  buffer_load_dwordx4 v16, s[44:47], s64 offen offset:0 lds
  s_mov_b64 exec, -1
  ds_read_b64_tr_b16 v[76:77], v11 offset:0
  v_mfma_f32_32x32x16_bf16 a[80:95], v[84:87], v[52:55], a[80:95]
  s_mov_b64 exec, s[86:87]
  buffer_load_dwordx4 v17, s[44:47], s64 offen offset:1024 lds
  s_mov_b64 exec, -1
  ds_read_b64_tr_b16 v[78:79], v11 offset:2048
  v_mfma_f32_32x32x16_bf16 a[96:111], v[88:91], v[52:55], a[96:111]
  s_mov_b64 exec, s[86:87]
  buffer_load_dwordx4 v18, s[44:47], s64 offen offset:2048 lds
  s_mov_b64 exec, -1
  v_mfma_f32_32x32x16_bf16 a[112:127], v[92:95], v[52:55], a[112:127]
  s_mov_b64 exec, s[86:87]
  buffer_load_dwordx4 v19, s[44:47], s64 offen offset:3072 lds
  s_mov_b64 exec, -1
  s_add_u32 s64, s64, 128
  s_sub_u32 s68, s68, 1
  s_cmp_lg_u32 s68, 0
  s_cbranch_scc1 gl_10
  v_lshlrev_b32 v131, 2, v1
  buffer_load_dword v130, v131, s[52:55], 0 offen sc1
  s_waitcnt lgkmcnt(0)
  s_add_u32 m0, s67, 32768
  v_mfma_f32_32x32x16_bf16 a[0:15], v[64:67], v[32:35], a[0:15]
  buffer_load_dwordx4 v20, s[48:51], s65 offen offset:0 lds
  ds_read_b128 v[48:51], v5 offset:0
  ds_read_b64_tr_b16 v[80:81], v8 offset:8192
  v_mfma_f32_32x32x16_bf16 a[16:31], v[68:71], v[32:35], a[16:31]
  buffer_load_dwordx4 v21, s[48:51], s65 offen offset:1024 lds
  ds_read_b64_tr_b16 v[82:83], v8 offset:10240
  ds_read_b128 v[52:55], v5 offset:4096
  v_mfma_f32_32x32x16_bf16 a[32:47], v[72:75], v[32:35], a[32:47]
  buffer_load_dwordx4 v22, s[48:51], s65 offen offset:2048 lds
  ds_read_b64_tr_b16 v[84:85], v9 offset:8192
  ds_read_b64_tr_b16 v[86:87], v9 offset:10240
  v_mfma_f32_32x32x16_bf16 a[48:63], v[76:79], v[32:35], a[48:63]
  buffer_load_dwordx4 v23, s[48:51], s65 offen offset:3072 lds
  ds_read_b64_tr_b16 v[88:89], v10 offset:8192
  ds_read_b64_tr_b16 v[90:91], v10 offset:10240
  s_add_u32 m0, s67, 36864
  v_mfma_f32_32x32x16_bf16 a[64:79], v[64:67], v[36:39], a[64:79]
  buffer_load_dwordx4 v24, s[48:51], s65 offen offset:0 lds
  ds_read_b64_tr_b16 v[92:93], v11 offset:8192
  v_mfma_f32_32x32x16_bf16 a[80:95], v[68:71], v[36:39], a[80:95]
  buffer_load_dwordx4 v25, s[48:51], s65 offen offset:1024 lds
  ds_read_b64_tr_b16 v[94:95], v11 offset:10240
  v_mfma_f32_32x32x16_bf16 a[96:111], v[72:75], v[36:39], a[96:111]
  buffer_load_dwordx4 v26, s[48:51], s65 offen offset:2048 lds
  v_mfma_f32_32x32x16_bf16 a[112:127], v[76:79], v[36:39], a[112:127]
  buffer_load_dwordx4 v27, s[48:51], s65 offen offset:3072 lds
  s_add_u32 s65, s65, s66
  s_xor_b32 s67, s67, 0x10000
  s_waitcnt lgkmcnt(0)
  v_mfma_f32_32x32x16_bf16 a[0:15], v[80:83], v[48:51], a[0:15]
  ds_read_b128 v[32:35], v6 offset:0
  ds_read_b64_tr_b16 v[64:65], v8 offset:16384
  v_mfma_f32_32x32x16_bf16 a[16:31], v[84:87], v[48:51], a[16:31]
  ds_read_b64_tr_b16 v[66:67], v8 offset:18432
  ds_read_b128 v[36:39], v6 offset:4096
  v_mfma_f32_32x32x16_bf16 a[32:47], v[88:91], v[48:51], a[32:47]
  ds_read_b64_tr_b16 v[68:69], v9 offset:16384
  ds_read_b64_tr_b16 v[70:71], v9 offset:18432
  v_mfma_f32_32x32x16_bf16 a[48:63], v[92:95], v[48:51], a[48:63]
  ds_read_b64_tr_b16 v[72:73], v10 offset:16384
  ds_read_b64_tr_b16 v[74:75], v10 offset:18432
  v_mfma_f32_32x32x16_bf16 a[64:79], v[80:83], v[52:55], a[64:79]
  ds_read_b64_tr_b16 v[76:77], v11 offset:16384
  v_mfma_f32_32x32x16_bf16 a[80:95], v[84:87], v[52:55], a[80:95]
  ds_read_b64_tr_b16 v[78:79], v11 offset:18432
  v_mfma_f32_32x32x16_bf16 a[96:111], v[88:91], v[52:55], a[96:111]
  v_mfma_f32_32x32x16_bf16 a[112:127], v[92:95], v[52:55], a[112:127]
  s_waitcnt lgkmcnt(0)
  v_mfma_f32_32x32x16_bf16 a[0:15], v[64:67], v[32:35], a[0:15]
  ds_read_b128 v[48:51], v7 offset:0
  ds_read_b64_tr_b16 v[80:81], v8 offset:24576
  v_mfma_f32_32x32x16_bf16 a[16:31], v[68:71], v[32:35], a[16:31]
  ds_read_b64_tr_b16 v[82:83], v8 offset:26624
  ds_read_b128 v[52:55], v7 offset:4096
  v_mfma_f32_32x32x16_bf16 a[32:47], v[72:75], v[32:35], a[32:47]
  ds_read_b64_tr_b16 v[84:85], v9 offset:24576
  ds_read_b64_tr_b16 v[86:87], v9 offset:26624
  v_mfma_f32_32x32x16_bf16 a[48:63], v[76:79], v[32:35], a[48:63]
  ds_read_b64_tr_b16 v[88:89], v10 offset:24576
  ds_read_b64_tr_b16 v[90:91], v10 offset:26624
  v_mfma_f32_32x32x16_bf16 a[64:79], v[64:67], v[36:39], a[64:79]
  ds_read_b64_tr_b16 v[92:93], v11 offset:24576
  v_mfma_f32_32x32x16_bf16 a[80:95], v[68:71], v[36:39], a[80:95]
  ds_read_b64_tr_b16 v[94:95], v11 offset:26624
  v_mfma_f32_32x32x16_bf16 a[96:111], v[72:75], v[36:39], a[96:111]
  v_mfma_f32_32x32x16_bf16 a[112:127], v[76:79], v[36:39], a[112:127]
  s_waitcnt vmcnt(0) lgkmcnt(0)
  s_barrier
  v_xor_b32 v4, 0x10000, v4
  v_xor_b32 v5, 0x10000, v5
  v_xor_b32 v6, 0x10000, v6
  v_xor_b32 v7, 0x10000, v7
  v_xor_b32 v8, 0x10000, v8
  v_xor_b32 v9, 0x10000, v9
  v_xor_b32 v10, 0x10000, v10
  v_xor_b32 v11, 0x10000, v11
  v_mfma_f32_32x32x16_bf16 a[0:15], v[80:83], v[48:51], a[0:15]
  ds_read_b128 v[32:35], v4 offset:0
  ds_read_b64_tr_b16 v[64:65], v8 offset:0
  v_mfma_f32_32x32x16_bf16 a[16:31], v[84:87], v[48:51], a[16:31]
  ds_read_b64_tr_b16 v[66:67], v8 offset:2048
  ds_read_b128 v[36:39], v4 offset:4096
  v_mfma_f32_32x32x16_bf16 a[32:47], v[88:91], v[48:51], a[32:47]
  ds_read_b64_tr_b16 v[68:69], v9 offset:0
  ds_read_b64_tr_b16 v[70:71], v9 offset:2048
  v_mfma_f32_32x32x16_bf16 a[48:63], v[92:95], v[48:51], a[48:63]
  ds_read_b64_tr_b16 v[72:73], v10 offset:0
  ds_read_b64_tr_b16 v[74:75], v10 offset:2048
  v_mfma_f32_32x32x16_bf16 a[64:79], v[80:83], v[52:55], a[64:79]
  ds_read_b64_tr_b16 v[76:77], v11 offset:0
  v_mfma_f32_32x32x16_bf16 a[80:95], v[84:87], v[52:55], a[80:95]
  ds_read_b64_tr_b16 v[78:79], v11 offset:2048
  v_mfma_f32_32x32x16_bf16 a[96:111], v[88:91], v[52:55], a[96:111]
  v_mfma_f32_32x32x16_bf16 a[112:127], v[92:95], v[52:55], a[112:127]
  s_waitcnt lgkmcnt(0)
  v_mfma_f32_32x32x16_bf16 a[0:15], v[64:67], v[32:35], a[0:15]
  ds_read_b128 v[48:51], v5 offset:0
  ds_read_b64_tr_b16 v[80:81], v8 offset:8192
  v_mfma_f32_32x32x16_bf16 a[16:31], v[68:71], v[32:35], a[16:31]
  ds_read_b64_tr_b16 v[82:83], v8 offset:10240
  ds_read_b128 v[52:55], v5 offset:4096
  v_mfma_f32_32x32x16_bf16 a[32:47], v[72:75], v[32:35], a[32:47]
  ds_read_b64_tr_b16 v[84:85], v9 offset:8192
  ds_read_b64_tr_b16 v[86:87], v9 offset:10240
  v_mfma_f32_32x32x16_bf16 a[48:63], v[76:79], v[32:35], a[48:63]
  ds_read_b64_tr_b16 v[88:89], v10 offset:8192
  ds_read_b64_tr_b16 v[90:91], v10 offset:10240
  v_mfma_f32_32x32x16_bf16 a[64:79], v[64:67], v[36:39], a[64:79]
  ds_read_b64_tr_b16 v[92:93], v11 offset:8192
  v_mfma_f32_32x32x16_bf16 a[80:95], v[68:71], v[36:39], a[80:95]
  ds_read_b64_tr_b16 v[94:95], v11 offset:10240
  v_mfma_f32_32x32x16_bf16 a[96:111], v[72:75], v[36:39], a[96:111]
  v_mfma_f32_32x32x16_bf16 a[112:127], v[76:79], v[36:39], a[112:127]
  s_waitcnt lgkmcnt(0)
  v_mfma_f32_32x32x16_bf16 a[0:15], v[80:83], v[48:51], a[0:15]
  ds_read_b128 v[32:35], v6 offset:0
  ds_read_b64_tr_b16 v[64:65], v8 offset:16384
  v_mfma_f32_32x32x16_bf16 a[16:31], v[84:87], v[48:51], a[16:31]
  ds_read_b64_tr_b16 v[66:67], v8 offset:18432
  ds_read_b128 v[36:39], v6 offset:4096
  v_mfma_f32_32x32x16_bf16 a[32:47], v[88:91], v[48:51], a[32:47]
  ds_read_b64_tr_b16 v[68:69], v9 offset:16384
  ds_read_b64_tr_b16 v[70:71], v9 offset:18432
  v_mfma_f32_32x32x16_bf16 a[48:63], v[92:95], v[48:51], a[48:63]
  ds_read_b64_tr_b16 v[72:73], v10 offset:16384
  ds_read_b64_tr_b16 v[74:75], v10 offset:18432
  v_mfma_f32_32x32x16_bf16 a[64:79], v[80:83], v[52:55], a[64:79]
  ds_read_b64_tr_b16 v[76:77], v11 offset:16384
  v_mfma_f32_32x32x16_bf16 a[80:95], v[84:87], v[52:55], a[80:95]
  ds_read_b64_tr_b16 v[78:79], v11 offset:18432
  v_mfma_f32_32x32x16_bf16 a[96:111], v[88:91], v[52:55], a[96:111]
  v_mfma_f32_32x32x16_bf16 a[112:127], v[92:95], v[52:55], a[112:127]
  s_waitcnt lgkmcnt(0)
  v_mfma_f32_32x32x16_bf16 a[0:15], v[64:67], v[32:35], a[0:15]
  ds_read_b128 v[48:51], v7 offset:0
  ds_read_b64_tr_b16 v[80:81], v8 offset:24576
  v_mfma_f32_32x32x16_bf16 a[16:31], v[68:71], v[32:35], a[16:31]
  ds_read_b64_tr_b16 v[82:83], v8 offset:26624
  ds_read_b128 v[52:55], v7 offset:4096
  v_mfma_f32_32x32x16_bf16 a[32:47], v[72:75], v[32:35], a[32:47]
  ds_read_b64_tr_b16 v[84:85], v9 offset:24576
  ds_read_b64_tr_b16 v[86:87], v9 offset:26624
  v_mfma_f32_32x32x16_bf16 a[48:63], v[76:79], v[32:35], a[48:63]
  ds_read_b64_tr_b16 v[88:89], v10 offset:24576
  ds_read_b64_tr_b16 v[90:91], v10 offset:26624
  v_mfma_f32_32x32x16_bf16 a[64:79], v[64:67], v[36:39], a[64:79]
  ds_read_b64_tr_b16 v[92:93], v11 offset:24576
  v_mfma_f32_32x32x16_bf16 a[80:95], v[68:71], v[36:39], a[80:95]
  ds_read_b64_tr_b16 v[94:95], v11 offset:26624
  v_mfma_f32_32x32x16_bf16 a[96:111], v[72:75], v[36:39], a[96:111]
  v_mfma_f32_32x32x16_bf16 a[112:127], v[76:79], v[36:39], a[112:127]
  s_waitcnt lgkmcnt(0)
  v_mfma_f32_32x32x16_bf16 a[0:15], v[80:83], v[48:51], a[0:15]
  v_mfma_f32_32x32x16_bf16 a[16:31], v[84:87], v[48:51], a[16:31]
  v_mfma_f32_32x32x16_bf16 a[32:47], v[88:91], v[48:51], a[32:47]
  v_mfma_f32_32x32x16_bf16 a[48:63], v[92:95], v[48:51], a[48:63]
  v_mfma_f32_32x32x16_bf16 a[64:79], v[80:83], v[52:55], a[64:79]
  v_mfma_f32_32x32x16_bf16 a[80:95], v[84:87], v[52:55], a[80:95]
  v_mfma_f32_32x32x16_bf16 a[96:111], v[88:91], v[52:55], a[96:111]
  v_mfma_f32_32x32x16_bf16 a[112:127], v[92:95], v[52:55], a[112:127]
  s_branch L_epi_h
L_gemm_h1:
  s_cmp_eq_u64 s[86:87], 0
  s_cbranch_scc0 hx_11
  s_add_u32 m0, s67, 32768
  s_nop 0
  buffer_load_dwordx4 v20, s[48:51], s65 offen offset:0 lds
  buffer_load_dwordx4 v21, s[48:51], s65 offen offset:1024 lds
  buffer_load_dwordx4 v22, s[48:51], s65 offen offset:2048 lds
  buffer_load_dwordx4 v23, s[48:51], s65 offen offset:3072 lds
  s_add_u32 m0, s67, 36864
  s_nop 0
  buffer_load_dwordx4 v24, s[48:51], s65 offen offset:0 lds
  buffer_load_dwordx4 v25, s[48:51], s65 offen offset:1024 lds
  buffer_load_dwordx4 v26, s[48:51], s65 offen offset:2048 lds
  buffer_load_dwordx4 v27, s[48:51], s65 offen offset:3072 lds
  s_add_u32 s64, s64, 128
  s_add_u32 s65, s65, s66
  s_xor_b32 s67, s67, 0x10000
  s_add_u32 s64, s64, 128
  v_lshrrev_b32 v132, 2, v1
  s_lshl_b32 s81, s57, 4
  v_add_u32 v132, s81, v132
  v_mul_lo_u32 v132, v132, s75
  v_and_b32 v133, 3, v1
  v_lshl_add_u32 v132, v133, 7, v132
  s_mov_b32 s81, s65
  v_accvgpr_write_b32 a0, 0
  v_accvgpr_write_b32 a1, 0
  v_accvgpr_write_b32 a2, 0
  v_accvgpr_write_b32 a3, 0
  v_accvgpr_write_b32 a4, 0
  v_accvgpr_write_b32 a5, 0
  v_accvgpr_write_b32 a6, 0
  v_accvgpr_write_b32 a7, 0
  v_accvgpr_write_b32 a8, 0
  v_accvgpr_write_b32 a9, 0
  v_accvgpr_write_b32 a10, 0
  v_accvgpr_write_b32 a11, 0
  v_accvgpr_write_b32 a12, 0
  v_accvgpr_write_b32 a13, 0
  v_accvgpr_write_b32 a14, 0
  v_accvgpr_write_b32 a15, 0
  v_accvgpr_write_b32 a16, 0
  v_accvgpr_write_b32 a17, 0
  v_accvgpr_write_b32 a18, 0
  v_accvgpr_write_b32 a19, 0
  v_accvgpr_write_b32 a20, 0
  v_accvgpr_write_b32 a21, 0
  v_accvgpr_write_b32 a22, 0
  v_accvgpr_write_b32 a23, 0
  v_accvgpr_write_b32 a24, 0
  v_accvgpr_write_b32 a25, 0
  v_accvgpr_write_b32 a26, 0
  v_accvgpr_write_b32 a27, 0
  v_accvgpr_write_b32 a28, 0
  v_accvgpr_write_b32 a29, 0
  v_accvgpr_write_b32 a30, 0
  v_accvgpr_write_b32 a31, 0
  v_accvgpr_write_b32 a32, 0
  v_accvgpr_write_b32 a33, 0
  v_accvgpr_write_b32 a34, 0
  v_accvgpr_write_b32 a35, 0
  v_accvgpr_write_b32 a36, 0
  v_accvgpr_write_b32 a37, 0
  v_accvgpr_write_b32 a38, 0
  v_accvgpr_write_b32 a39, 0
  v_accvgpr_write_b32 a40, 0
  v_accvgpr_write_b32 a41, 0
  v_accvgpr_write_b32 a42, 0
  v_accvgpr_write_b32 a43, 0
  v_accvgpr_write_b32 a44, 0
  v_accvgpr_write_b32 a45, 0
  v_accvgpr_write_b32 a46, 0
  v_accvgpr_write_b32 a47, 0
  v_accvgpr_write_b32 a48, 0
  v_accvgpr_write_b32 a49, 0
  v_accvgpr_write_b32 a50, 0
  v_accvgpr_write_b32 a51, 0
  v_accvgpr_write_b32 a52, 0
  v_accvgpr_write_b32 a53, 0
  v_accvgpr_write_b32 a54, 0
  v_accvgpr_write_b32 a55, 0
  v_accvgpr_write_b32 a56, 0
  v_accvgpr_write_b32 a57, 0
  v_accvgpr_write_b32 a58, 0
  v_accvgpr_write_b32 a59, 0
  v_accvgpr_write_b32 a60, 0
  v_accvgpr_write_b32 a61, 0
  v_accvgpr_write_b32 a62, 0
  v_accvgpr_write_b32 a63, 0
  v_accvgpr_write_b32 a64, 0
  v_accvgpr_write_b32 a65, 0
  v_accvgpr_write_b32 a66, 0
  v_accvgpr_write_b32 a67, 0
  v_accvgpr_write_b32 a68, 0
  v_accvgpr_write_b32 a69, 0
  v_accvgpr_write_b32 a70, 0
  v_accvgpr_write_b32 a71, 0
  v_accvgpr_write_b32 a72, 0
  v_accvgpr_write_b32 a73, 0
  v_accvgpr_write_b32 a74, 0
  v_accvgpr_write_b32 a75, 0
  v_accvgpr_write_b32 a76, 0
  v_accvgpr_write_b32 a77, 0
  v_accvgpr_write_b32 a78, 0
  v_accvgpr_write_b32 a79, 0
  v_accvgpr_write_b32 a80, 0
  v_accvgpr_write_b32 a81, 0
  v_accvgpr_write_b32 a82, 0
  v_accvgpr_write_b32 a83, 0
  v_accvgpr_write_b32 a84, 0
  v_accvgpr_write_b32 a85, 0
  v_accvgpr_write_b32 a86, 0
  v_accvgpr_write_b32 a87, 0
  v_accvgpr_write_b32 a88, 0
  v_accvgpr_write_b32 a89, 0
  v_accvgpr_write_b32 a90, 0
  v_accvgpr_write_b32 a91, 0
  v_accvgpr_write_b32 a92, 0
  v_accvgpr_write_b32 a93, 0
  v_accvgpr_write_b32 a94, 0
  v_accvgpr_write_b32 a95, 0
  v_accvgpr_write_b32 a96, 0
  v_accvgpr_write_b32 a97, 0
  v_accvgpr_write_b32 a98, 0
  v_accvgpr_write_b32 a99, 0
  v_accvgpr_write_b32 a100, 0
  v_accvgpr_write_b32 a101, 0
  v_accvgpr_write_b32 a102, 0
  v_accvgpr_write_b32 a103, 0
  v_accvgpr_write_b32 a104, 0
  v_accvgpr_write_b32 a105, 0
  v_accvgpr_write_b32 a106, 0
  v_accvgpr_write_b32 a107, 0
  v_accvgpr_write_b32 a108, 0
  v_accvgpr_write_b32 a109, 0
  v_accvgpr_write_b32 a110, 0
  v_accvgpr_write_b32 a111, 0
  v_accvgpr_write_b32 a112, 0
  v_accvgpr_write_b32 a113, 0
  v_accvgpr_write_b32 a114, 0
  v_accvgpr_write_b32 a115, 0
  v_accvgpr_write_b32 a116, 0
  v_accvgpr_write_b32 a117, 0
  v_accvgpr_write_b32 a118, 0
  v_accvgpr_write_b32 a119, 0
  v_accvgpr_write_b32 a120, 0
  v_accvgpr_write_b32 a121, 0
  v_accvgpr_write_b32 a122, 0
  v_accvgpr_write_b32 a123, 0
  v_accvgpr_write_b32 a124, 0
  v_accvgpr_write_b32 a125, 0
  v_accvgpr_write_b32 a126, 0
  v_accvgpr_write_b32 a127, 0
  s_waitcnt vmcnt(0)
  s_branch hx_11_e
hx_11:
  s_add_u32 m0, s67, 0
  s_nop 0
  buffer_load_dwordx4 v12, s[44:47], s64 offen offset:0 lds
  buffer_load_dwordx4 v13, s[44:47], s64 offen offset:1024 lds
  buffer_load_dwordx4 v14, s[44:47], s64 offen offset:2048 lds
  buffer_load_dwordx4 v15, s[44:47], s64 offen offset:3072 lds
  s_add_u32 m0, s67, 4096
  s_nop 0
  buffer_load_dwordx4 v16, s[44:47], s64 offen offset:0 lds
  buffer_load_dwordx4 v17, s[44:47], s64 offen offset:1024 lds
  buffer_load_dwordx4 v18, s[44:47], s64 offen offset:2048 lds
  buffer_load_dwordx4 v19, s[44:47], s64 offen offset:3072 lds
  s_add_u32 m0, s67, 32768
  s_nop 0
  buffer_load_dwordx4 v20, s[48:51], s65 offen offset:0 lds
  buffer_load_dwordx4 v21, s[48:51], s65 offen offset:1024 lds
  buffer_load_dwordx4 v22, s[48:51], s65 offen offset:2048 lds
  buffer_load_dwordx4 v23, s[48:51], s65 offen offset:3072 lds
  s_add_u32 m0, s67, 36864
  s_nop 0
  buffer_load_dwordx4 v24, s[48:51], s65 offen offset:0 lds
  buffer_load_dwordx4 v25, s[48:51], s65 offen offset:1024 lds
  buffer_load_dwordx4 v26, s[48:51], s65 offen offset:2048 lds
  buffer_load_dwordx4 v27, s[48:51], s65 offen offset:3072 lds
  s_add_u32 s64, s64, 128
  s_add_u32 s65, s65, s66
  s_xor_b32 s67, s67, 0x10000
  s_add_u32 m0, s67, 0
  s_nop 0
  buffer_load_dwordx4 v12, s[44:47], s64 offen offset:0 lds
  buffer_load_dwordx4 v13, s[44:47], s64 offen offset:1024 lds
  buffer_load_dwordx4 v14, s[44:47], s64 offen offset:2048 lds
  buffer_load_dwordx4 v15, s[44:47], s64 offen offset:3072 lds
  s_add_u32 m0, s67, 4096
  s_nop 0
  buffer_load_dwordx4 v16, s[44:47], s64 offen offset:0 lds
  buffer_load_dwordx4 v17, s[44:47], s64 offen offset:1024 lds
  buffer_load_dwordx4 v18, s[44:47], s64 offen offset:2048 lds
  buffer_load_dwordx4 v19, s[44:47], s64 offen offset:3072 lds
  s_add_u32 s64, s64, 128
  v_lshrrev_b32 v132, 2, v1
  s_lshl_b32 s81, s57, 4
  v_add_u32 v132, s81, v132
  v_mul_lo_u32 v132, v132, s75
  v_and_b32 v133, 3, v1
  v_lshl_add_u32 v132, v133, 7, v132
  s_mov_b32 s81, s65
  s_lshl_b32 s81, s57, 6
  v_add_u32 v133, s81, v1
  v_mul_u32_u24 v133, 1280, v133
  v_accvgpr_write_b32 a0, 0
  v_accvgpr_write_b32 a1, 0
  v_accvgpr_write_b32 a2, 0
  v_accvgpr_write_b32 a3, 0
  v_accvgpr_write_b32 a4, 0
  v_accvgpr_write_b32 a5, 0
  v_accvgpr_write_b32 a6, 0
  v_accvgpr_write_b32 a7, 0
  v_accvgpr_write_b32 a8, 0
  v_accvgpr_write_b32 a9, 0
  v_accvgpr_write_b32 a10, 0
  v_accvgpr_write_b32 a11, 0
  v_accvgpr_write_b32 a12, 0
  v_accvgpr_write_b32 a13, 0
  v_accvgpr_write_b32 a14, 0
  v_accvgpr_write_b32 a15, 0
  v_accvgpr_write_b32 a16, 0
  v_accvgpr_write_b32 a17, 0
  v_accvgpr_write_b32 a18, 0
  v_accvgpr_write_b32 a19, 0
  v_accvgpr_write_b32 a20, 0
  v_accvgpr_write_b32 a21, 0
  v_accvgpr_write_b32 a22, 0
  v_accvgpr_write_b32 a23, 0
  v_accvgpr_write_b32 a24, 0
  v_accvgpr_write_b32 a25, 0
  v_accvgpr_write_b32 a26, 0
  v_accvgpr_write_b32 a27, 0
  v_accvgpr_write_b32 a28, 0
  v_accvgpr_write_b32 a29, 0
  v_accvgpr_write_b32 a30, 0
  v_accvgpr_write_b32 a31, 0
  v_accvgpr_write_b32 a32, 0
  v_accvgpr_write_b32 a33, 0
  v_accvgpr_write_b32 a34, 0
  v_accvgpr_write_b32 a35, 0
  v_accvgpr_write_b32 a36, 0
  v_accvgpr_write_b32 a37, 0
  v_accvgpr_write_b32 a38, 0
  v_accvgpr_write_b32 a39, 0
  v_accvgpr_write_b32 a40, 0
  v_accvgpr_write_b32 a41, 0
  v_accvgpr_write_b32 a42, 0
  v_accvgpr_write_b32 a43, 0
  v_accvgpr_write_b32 a44, 0
  v_accvgpr_write_b32 a45, 0
  v_accvgpr_write_b32 a46, 0
  v_accvgpr_write_b32 a47, 0
  v_accvgpr_write_b32 a48, 0
  v_accvgpr_write_b32 a49, 0
  v_accvgpr_write_b32 a50, 0
  v_accvgpr_write_b32 a51, 0
  v_accvgpr_write_b32 a52, 0
  v_accvgpr_write_b32 a53, 0
  v_accvgpr_write_b32 a54, 0
  v_accvgpr_write_b32 a55, 0
  v_accvgpr_write_b32 a56, 0
  v_accvgpr_write_b32 a57, 0
  v_accvgpr_write_b32 a58, 0
  v_accvgpr_write_b32 a59, 0
  v_accvgpr_write_b32 a60, 0
  v_accvgpr_write_b32 a61, 0
  v_accvgpr_write_b32 a62, 0
  v_accvgpr_write_b32 a63, 0
  v_accvgpr_write_b32 a64, 0
  v_accvgpr_write_b32 a65, 0
  v_accvgpr_write_b32 a66, 0
  v_accvgpr_write_b32 a67, 0
  v_accvgpr_write_b32 a68, 0
  v_accvgpr_write_b32 a69, 0
  v_accvgpr_write_b32 a70, 0
  v_accvgpr_write_b32 a71, 0
  v_accvgpr_write_b32 a72, 0
  v_accvgpr_write_b32 a73, 0
  v_accvgpr_write_b32 a74, 0
  v_accvgpr_write_b32 a75, 0
  v_accvgpr_write_b32 a76, 0
  v_accvgpr_write_b32 a77, 0
  v_accvgpr_write_b32 a78, 0
  v_accvgpr_write_b32 a79, 0
  v_accvgpr_write_b32 a80, 0
  v_accvgpr_write_b32 a81, 0
  v_accvgpr_write_b32 a82, 0
  v_accvgpr_write_b32 a83, 0
  v_accvgpr_write_b32 a84, 0
  v_accvgpr_write_b32 a85, 0
  v_accvgpr_write_b32 a86, 0
  v_accvgpr_write_b32 a87, 0
  v_accvgpr_write_b32 a88, 0
  v_accvgpr_write_b32 a89, 0
  v_accvgpr_write_b32 a90, 0
  v_accvgpr_write_b32 a91, 0
  v_accvgpr_write_b32 a92, 0
  v_accvgpr_write_b32 a93, 0
  v_accvgpr_write_b32 a94, 0
  v_accvgpr_write_b32 a95, 0
  v_accvgpr_write_b32 a96, 0
  v_accvgpr_write_b32 a97, 0
  v_accvgpr_write_b32 a98, 0
  v_accvgpr_write_b32 a99, 0
  v_accvgpr_write_b32 a100, 0
  v_accvgpr_write_b32 a101, 0
  v_accvgpr_write_b32 a102, 0
  v_accvgpr_write_b32 a103, 0
  v_accvgpr_write_b32 a104, 0
  v_accvgpr_write_b32 a105, 0
  v_accvgpr_write_b32 a106, 0
  v_accvgpr_write_b32 a107, 0
  v_accvgpr_write_b32 a108, 0
  v_accvgpr_write_b32 a109, 0
  v_accvgpr_write_b32 a110, 0
  v_accvgpr_write_b32 a111, 0
  v_accvgpr_write_b32 a112, 0
  v_accvgpr_write_b32 a113, 0
  v_accvgpr_write_b32 a114, 0
  v_accvgpr_write_b32 a115, 0
  v_accvgpr_write_b32 a116, 0
  v_accvgpr_write_b32 a117, 0
  v_accvgpr_write_b32 a118, 0
  v_accvgpr_write_b32 a119, 0
  v_accvgpr_write_b32 a120, 0
  v_accvgpr_write_b32 a121, 0
  v_accvgpr_write_b32 a122, 0
  v_accvgpr_write_b32 a123, 0
  v_accvgpr_write_b32 a124, 0
  v_accvgpr_write_b32 a125, 0
  v_accvgpr_write_b32 a126, 0
  v_accvgpr_write_b32 a127, 0
  s_waitcnt vmcnt(8)
hx_11_e:
  s_barrier
  s_cmp_lg_u32 s60, 0
  s_cbranch_scc1 gr_12
  s_cmp_lg_u32 s57, 0
  s_cbranch_scc1 rg_13
  s_getreg_b32 s62, hwreg(HW_REG_XCC_ID)
  s_and_b32 s62, s62, 15
  s_lshl_b32 s62, s62, 2
  s_and_b32 s81, s61, 7
  s_mov_b32 s63, 1
  s_cmp_eq_u32 s81, 0
  s_cselect_b32 s63, 0x401, s63
  s_cmp_eq_u32 s81, 1
  s_cselect_b32 s63, 0x100001, s63
  s_mov_b64 exec, 1
  v_mov_b32 v2, s63
  v_mov_b32 v3, 0
  buffer_atomic_add v2, v3, s[52:55], s62 offen sc1
  s_mov_b64 exec, -1
rg_13:
gr_12:
  ds_read_b128 v[32:35], v4 offset:0
  ds_read_b64_tr_b16 v[64:65], v8 offset:0
  ds_read_b64_tr_b16 v[66:67], v8 offset:2048
  ds_read_b128 v[36:39], v4 offset:4096
  ds_read_b64_tr_b16 v[68:69], v9 offset:0
  ds_read_b64_tr_b16 v[70:71], v9 offset:2048
  ds_read_b64_tr_b16 v[72:73], v10 offset:0
  ds_read_b64_tr_b16 v[74:75], v10 offset:2048
  ds_read_b64_tr_b16 v[76:77], v11 offset:0
  ds_read_b64_tr_b16 v[78:79], v11 offset:2048
  s_mov_b32 s68, 8
gl_14:
  s_waitcnt lgkmcnt(0)
  s_add_u32 m0, s67, 32768
  v_mfma_f32_32x32x16_bf16 a[0:15], v[32:35], v[64:67], a[0:15]
  buffer_load_dwordx4 v20, s[48:51], s65 offen offset:0 lds
  ds_read_b128 v[48:51], v5 offset:0
  ds_read_b64_tr_b16 v[80:81], v8 offset:8192
  v_mfma_f32_32x32x16_bf16 a[16:31], v[32:35], v[68:71], a[16:31]
  buffer_load_dwordx4 v21, s[48:51], s65 offen offset:1024 lds
  ds_read_b64_tr_b16 v[82:83], v8 offset:10240
  ds_read_b128 v[52:55], v5 offset:4096
  v_mfma_f32_32x32x16_bf16 a[32:47], v[32:35], v[72:75], a[32:47]
  buffer_load_dwordx4 v22, s[48:51], s65 offen offset:2048 lds
  ds_read_b64_tr_b16 v[84:85], v9 offset:8192
  ds_read_b64_tr_b16 v[86:87], v9 offset:10240
  v_mfma_f32_32x32x16_bf16 a[48:63], v[32:35], v[76:79], a[48:63]
  buffer_load_dwordx4 v23, s[48:51], s65 offen offset:3072 lds
  ds_read_b64_tr_b16 v[88:89], v10 offset:8192
  ds_read_b64_tr_b16 v[90:91], v10 offset:10240
  s_add_u32 m0, s67, 36864
  v_mfma_f32_32x32x16_bf16 a[64:79], v[36:39], v[64:67], a[64:79]
  buffer_load_dwordx4 v24, s[48:51], s65 offen offset:0 lds
  ds_read_b64_tr_b16 v[92:93], v11 offset:8192
  v_mfma_f32_32x32x16_bf16 a[80:95], v[36:39], v[68:71], a[80:95]
  buffer_load_dwordx4 v25, s[48:51], s65 offen offset:1024 lds
  ds_read_b64_tr_b16 v[94:95], v11 offset:10240
  v_mfma_f32_32x32x16_bf16 a[96:111], v[36:39], v[72:75], a[96:111]
  buffer_load_dwordx4 v26, s[48:51], s65 offen offset:2048 lds
  v_mfma_f32_32x32x16_bf16 a[112:127], v[36:39], v[76:79], a[112:127]
  buffer_load_dwordx4 v27, s[48:51], s65 offen offset:3072 lds
  s_add_u32 s65, s65, s66
  s_xor_b32 s67, s67, 0x10000
  s_waitcnt lgkmcnt(0)
  v_mfma_f32_32x32x16_bf16 a[0:15], v[48:51], v[80:83], a[0:15]
  ds_read_b128 v[32:35], v6 offset:0
  ds_read_b64_tr_b16 v[64:65], v8 offset:16384
  v_mfma_f32_32x32x16_bf16 a[16:31], v[48:51], v[84:87], a[16:31]
  ds_read_b64_tr_b16 v[66:67], v8 offset:18432
  ds_read_b128 v[36:39], v6 offset:4096
  v_mfma_f32_32x32x16_bf16 a[32:47], v[48:51], v[88:91], a[32:47]
  ds_read_b64_tr_b16 v[68:69], v9 offset:16384
  ds_read_b64_tr_b16 v[70:71], v9 offset:18432
  v_mfma_f32_32x32x16_bf16 a[48:63], v[48:51], v[92:95], a[48:63]
  ds_read_b64_tr_b16 v[72:73], v10 offset:16384
  ds_read_b64_tr_b16 v[74:75], v10 offset:18432
  v_mfma_f32_32x32x16_bf16 a[64:79], v[52:55], v[80:83], a[64:79]
  ds_read_b64_tr_b16 v[76:77], v11 offset:16384
  v_mfma_f32_32x32x16_bf16 a[80:95], v[52:55], v[84:87], a[80:95]
  ds_read_b64_tr_b16 v[78:79], v11 offset:18432
  v_mfma_f32_32x32x16_bf16 a[96:111], v[52:55], v[88:91], a[96:111]
  v_mfma_f32_32x32x16_bf16 a[112:127], v[52:55], v[92:95], a[112:127]
  s_waitcnt lgkmcnt(0)
  v_mfma_f32_32x32x16_bf16 a[0:15], v[32:35], v[64:67], a[0:15]
  ds_read_b128 v[48:51], v7 offset:0
  ds_read_b64_tr_b16 v[80:81], v8 offset:24576
  v_mfma_f32_32x32x16_bf16 a[16:31], v[32:35], v[68:71], a[16:31]
  ds_read_b64_tr_b16 v[82:83], v8 offset:26624
  ds_read_b128 v[52:55], v7 offset:4096
  v_mfma_f32_32x32x16_bf16 a[32:47], v[32:35], v[72:75], a[32:47]
  ds_read_b64_tr_b16 v[84:85], v9 offset:24576
  ds_read_b64_tr_b16 v[86:87], v9 offset:26624
  v_mfma_f32_32x32x16_bf16 a[48:63], v[32:35], v[76:79], a[48:63]
  ds_read_b64_tr_b16 v[88:89], v10 offset:24576
  ds_read_b64_tr_b16 v[90:91], v10 offset:26624
  v_mfma_f32_32x32x16_bf16 a[64:79], v[36:39], v[64:67], a[64:79]
  ds_read_b64_tr_b16 v[92:93], v11 offset:24576
  v_mfma_f32_32x32x16_bf16 a[80:95], v[36:39], v[68:71], a[80:95]
  ds_read_b64_tr_b16 v[94:95], v11 offset:26624
  v_mfma_f32_32x32x16_bf16 a[96:111], v[36:39], v[72:75], a[96:111]
  v_mfma_f32_32x32x16_bf16 a[112:127], v[36:39], v[76:79], a[112:127]
  s_waitcnt vmcnt(0) lgkmcnt(0)
  s_barrier
  v_xor_b32 v4, 0x10000, v4
  v_xor_b32 v5, 0x10000, v5
  v_xor_b32 v6, 0x10000, v6
  v_xor_b32 v7, 0x10000, v7
  v_xor_b32 v8, 0x10000, v8
  v_xor_b32 v9, 0x10000, v9
  v_xor_b32 v10, 0x10000, v10
  v_xor_b32 v11, 0x10000, v11
  s_add_u32 m0, s67, 0
  v_mfma_f32_32x32x16_bf16 a[0:15], v[48:51], v[80:83], a[0:15]
  s_mov_b64 exec, s[86:87]
  buffer_load_dwordx4 v12, s[44:47], s64 offen offset:0 lds
  s_mov_b64 exec, -1
  ds_read_b128 v[32:35], v4 offset:0
  ds_read_b64_tr_b16 v[64:65], v8 offset:0
  v_mfma_f32_32x32x16_bf16 a[16:31], v[48:51], v[84:87], a[16:31]
  s_mov_b64 exec, s[86:87]
  buffer_load_dwordx4 v13, s[44:47], s64 offen offset:1024 lds
  s_mov_b64 exec, -1
  ds_read_b64_tr_b16 v[66:67], v8 offset:2048
  ds_read_b128 v[36:39], v4 offset:4096
  v_mfma_f32_32x32x16_bf16 a[32:47], v[48:51], v[88:91], a[32:47]
  s_mov_b64 exec, s[86:87]
  buffer_load_dwordx4 v14, s[44:47], s64 offen offset:2048 lds
  s_mov_b64 exec, -1
  ds_read_b64_tr_b16 v[68:69], v9 offset:0
  ds_read_b64_tr_b16 v[70:71], v9 offset:2048
  v_mfma_f32_32x32x16_bf16 a[48:63], v[48:51], v[92:95], a[48:63]
  s_mov_b64 exec, s[86:87]
  buffer_load_dwordx4 v15, s[44:47], s64 offen offset:3072 lds
  s_mov_b64 exec, -1
  ds_read_b64_tr_b16 v[72:73], v10 offset:0
  ds_read_b64_tr_b16 v[74:75], v10 offset:2048
  s_add_u32 m0, s67, 4096
  v_mfma_f32_32x32x16_bf16 a[64:79], v[52:55], v[80:83], a[64:79]
  s_mov_b64 exec, s[86:87]
  buffer_load_dwordx4 v16, s[44:47], s64 offen offset:0 lds
  s_mov_b64 exec, -1
  ds_read_b64_tr_b16 v[76:77], v11 offset:0
  v_mfma_f32_32x32x16_bf16 a[80:95], v[52:55], v[84:87], a[80:95]
  s_mov_b64 exec, s[86:87]
  buffer_load_dwordx4 v17, s[44:47], s64 offen offset:1024 lds
  s_mov_b64 exec, -1
  ds_read_b64_tr_b16 v[78:79], v11 offset:2048
  v_mfma_f32_32x32x16_bf16 a[96:111], v[52:55], v[88:91], a[96:111]
  s_mov_b64 exec, s[86:87]
  buffer_load_dwordx4 v18, s[44:47], s64 offen offset:2048 lds
  s_mov_b64 exec, -1
  v_mfma_f32_32x32x16_bf16 a[112:127], v[52:55], v[92:95], a[112:127]
  s_mov_b64 exec, s[86:87]
  buffer_load_dwordx4 v19, s[44:47], s64 offen offset:3072 lds
  s_mov_b64 exec, -1
  s_add_u32 s64, s64, 128
  s_sub_u32 s68, s68, 1
  s_cmp_lg_u32 s68, 0
  s_cbranch_scc1 gl_14
  v_lshlrev_b32 v131, 2, v1
  buffer_load_dword v130, v131, s[52:55], 0 offen sc1
  s_waitcnt lgkmcnt(0)
  s_add_u32 m0, s67, 32768
  v_mfma_f32_32x32x16_bf16 a[0:15], v[32:35], v[64:67], a[0:15]
  buffer_load_dwordx4 v20, s[48:51], s65 offen offset:0 lds
  ds_read_b128 v[48:51], v5 offset:0
  ds_read_b64_tr_b16 v[80:81], v8 offset:8192
  v_mfma_f32_32x32x16_bf16 a[16:31], v[32:35], v[68:71], a[16:31]
  buffer_load_dwordx4 v21, s[48:51], s65 offen offset:1024 lds
  ds_read_b64_tr_b16 v[82:83], v8 offset:10240
  ds_read_b128 v[52:55], v5 offset:4096
  v_mfma_f32_32x32x16_bf16 a[32:47], v[32:35], v[72:75], a[32:47]
  buffer_load_dwordx4 v22, s[48:51], s65 offen offset:2048 lds
  ds_read_b64_tr_b16 v[84:85], v9 offset:8192
  ds_read_b64_tr_b16 v[86:87], v9 offset:10240
  v_mfma_f32_32x32x16_bf16 a[48:63], v[32:35], v[76:79], a[48:63]
  buffer_load_dwordx4 v23, s[48:51], s65 offen offset:3072 lds
  ds_read_b64_tr_b16 v[88:89], v10 offset:8192
  ds_read_b64_tr_b16 v[90:91], v10 offset:10240
  s_add_u32 m0, s67, 36864
  v_mfma_f32_32x32x16_bf16 a[64:79], v[36:39], v[64:67], a[64:79]
  buffer_load_dwordx4 v24, s[48:51], s65 offen offset:0 lds
  ds_read_b64_tr_b16 v[92:93], v11 offset:8192
  v_mfma_f32_32x32x16_bf16 a[80:95], v[36:39], v[68:71], a[80:95]
  buffer_load_dwordx4 v25, s[48:51], s65 offen offset:1024 lds
  ds_read_b64_tr_b16 v[94:95], v11 offset:10240
  v_mfma_f32_32x32x16_bf16 a[96:111], v[36:39], v[72:75], a[96:111]
  buffer_load_dwordx4 v26, s[48:51], s65 offen offset:2048 lds
  v_mfma_f32_32x32x16_bf16 a[112:127], v[36:39], v[76:79], a[112:127]
  buffer_load_dwordx4 v27, s[48:51], s65 offen offset:3072 lds
  s_add_u32 s65, s65, s66
  s_xor_b32 s67, s67, 0x10000
  s_waitcnt lgkmcnt(0)
  v_mfma_f32_32x32x16_bf16 a[0:15], v[48:51], v[80:83], a[0:15]
  ds_read_b128 v[32:35], v6 offset:0
  ds_read_b64_tr_b16 v[64:65], v8 offset:16384
  v_mfma_f32_32x32x16_bf16 a[16:31], v[48:51], v[84:87], a[16:31]
  ds_read_b64_tr_b16 v[66:67], v8 offset:18432
  ds_read_b128 v[36:39], v6 offset:4096
  v_mfma_f32_32x32x16_bf16 a[32:47], v[48:51], v[88:91], a[32:47]
  ds_read_b64_tr_b16 v[68:69], v9 offset:16384
  ds_read_b64_tr_b16 v[70:71], v9 offset:18432
  v_mfma_f32_32x32x16_bf16 a[48:63], v[48:51], v[92:95], a[48:63]
  ds_read_b64_tr_b16 v[72:73], v10 offset:16384
  ds_read_b64_tr_b16 v[74:75], v10 offset:18432
  v_mfma_f32_32x32x16_bf16 a[64:79], v[52:55], v[80:83], a[64:79]
  ds_read_b64_tr_b16 v[76:77], v11 offset:16384
  v_mfma_f32_32x32x16_bf16 a[80:95], v[52:55], v[84:87], a[80:95]
  ds_read_b64_tr_b16 v[78:79], v11 offset:18432
  v_mfma_f32_32x32x16_bf16 a[96:111], v[52:55], v[88:91], a[96:111]
  v_mfma_f32_32x32x16_bf16 a[112:127], v[52:55], v[92:95], a[112:127]
  s_waitcnt lgkmcnt(0)
  v_mfma_f32_32x32x16_bf16 a[0:15], v[32:35], v[64:67], a[0:15]
  ds_read_b128 v[48:51], v7 offset:0
  ds_read_b64_tr_b16 v[80:81], v8 offset:24576
  v_mfma_f32_32x32x16_bf16 a[16:31], v[32:35], v[68:71], a[16:31]
  ds_read_b64_tr_b16 v[82:83], v8 offset:26624
  ds_read_b128 v[52:55], v7 offset:4096
  v_mfma_f32_32x32x16_bf16 a[32:47], v[32:35], v[72:75], a[32:47]
  ds_read_b64_tr_b16 v[84:85], v9 offset:24576
  ds_read_b64_tr_b16 v[86:87], v9 offset:26624
  v_mfma_f32_32x32x16_bf16 a[48:63], v[32:35], v[76:79], a[48:63]
  ds_read_b64_tr_b16 v[88:89], v10 offset:24576
  ds_read_b64_tr_b16 v[90:91], v10 offset:26624
  v_mfma_f32_32x32x16_bf16 a[64:79], v[36:39], v[64:67], a[64:79]
  ds_read_b64_tr_b16 v[92:93], v11 offset:24576
  v_mfma_f32_32x32x16_bf16 a[80:95], v[36:39], v[68:71], a[80:95]
  ds_read_b64_tr_b16 v[94:95], v11 offset:26624
  v_mfma_f32_32x32x16_bf16 a[96:111], v[36:39], v[72:75], a[96:111]
  v_mfma_f32_32x32x16_bf16 a[112:127], v[36:39], v[76:79], a[112:127]
  s_waitcnt vmcnt(0) lgkmcnt(0)
  s_barrier
  v_xor_b32 v4, 0x10000, v4
  v_xor_b32 v5, 0x10000, v5
  v_xor_b32 v6, 0x10000, v6
  v_xor_b32 v7, 0x10000, v7
  v_xor_b32 v8, 0x10000, v8
  v_xor_b32 v9, 0x10000, v9
  v_xor_b32 v10, 0x10000, v10
  v_xor_b32 v11, 0x10000, v11
  v_mfma_f32_32x32x16_bf16 a[0:15], v[48:51], v[80:83], a[0:15]
  ds_read_b128 v[32:35], v4 offset:0
  ds_read_b64_tr_b16 v[64:65], v8 offset:0
  v_mfma_f32_32x32x16_bf16 a[16:31], v[48:51], v[84:87], a[16:31]
  ds_read_b64_tr_b16 v[66:67], v8 offset:2048
  ds_read_b128 v[36:39], v4 offset:4096
  v_mfma_f32_32x32x16_bf16 a[32:47], v[48:51], v[88:91], a[32:47]
  ds_read_b64_tr_b16 v[68:69], v9 offset:0
  ds_read_b64_tr_b16 v[70:71], v9 offset:2048
  v_mfma_f32_32x32x16_bf16 a[48:63], v[48:51], v[92:95], a[48:63]
  ds_read_b64_tr_b16 v[72:73], v10 offset:0
  ds_read_b64_tr_b16 v[74:75], v10 offset:2048
  v_mfma_f32_32x32x16_bf16 a[64:79], v[52:55], v[80:83], a[64:79]
  ds_read_b64_tr_b16 v[76:77], v11 offset:0
  v_mfma_f32_32x32x16_bf16 a[80:95], v[52:55], v[84:87], a[80:95]
  ds_read_b64_tr_b16 v[78:79], v11 offset:2048
  v_mfma_f32_32x32x16_bf16 a[96:111], v[52:55], v[88:91], a[96:111]
  v_mfma_f32_32x32x16_bf16 a[112:127], v[52:55], v[92:95], a[112:127]
  s_waitcnt lgkmcnt(0)
  v_mfma_f32_32x32x16_bf16 a[0:15], v[32:35], v[64:67], a[0:15]
  ds_read_b128 v[48:51], v5 offset:0
  ds_read_b64_tr_b16 v[80:81], v8 offset:8192
  v_mfma_f32_32x32x16_bf16 a[16:31], v[32:35], v[68:71], a[16:31]
  ds_read_b64_tr_b16 v[82:83], v8 offset:10240
  ds_read_b128 v[52:55], v5 offset:4096
  v_mfma_f32_32x32x16_bf16 a[32:47], v[32:35], v[72:75], a[32:47]
  ds_read_b64_tr_b16 v[84:85], v9 offset:8192
  ds_read_b64_tr_b16 v[86:87], v9 offset:10240
  v_mfma_f32_32x32x16_bf16 a[48:63], v[32:35], v[76:79], a[48:63]
  ds_read_b64_tr_b16 v[88:89], v10 offset:8192
  ds_read_b64_tr_b16 v[90:91], v10 offset:10240
  v_mfma_f32_32x32x16_bf16 a[64:79], v[36:39], v[64:67], a[64:79]
  ds_read_b64_tr_b16 v[92:93], v11 offset:8192
  v_mfma_f32_32x32x16_bf16 a[80:95], v[36:39], v[68:71], a[80:95]
  ds_read_b64_tr_b16 v[94:95], v11 offset:10240
  v_mfma_f32_32x32x16_bf16 a[96:111], v[36:39], v[72:75], a[96:111]
  v_mfma_f32_32x32x16_bf16 a[112:127], v[36:39], v[76:79], a[112:127]
  s_waitcnt lgkmcnt(0)
  v_mfma_f32_32x32x16_bf16 a[0:15], v[48:51], v[80:83], a[0:15]
  ds_read_b128 v[32:35], v6 offset:0
  ds_read_b64_tr_b16 v[64:65], v8 offset:16384
  v_mfma_f32_32x32x16_bf16 a[16:31], v[48:51], v[84:87], a[16:31]
  ds_read_b64_tr_b16 v[66:67], v8 offset:18432
  ds_read_b128 v[36:39], v6 offset:4096
  v_mfma_f32_32x32x16_bf16 a[32:47], v[48:51], v[88:91], a[32:47]
  ds_read_b64_tr_b16 v[68:69], v9 offset:16384
  ds_read_b64_tr_b16 v[70:71], v9 offset:18432
  v_mfma_f32_32x32x16_bf16 a[48:63], v[48:51], v[92:95], a[48:63]
  ds_read_b64_tr_b16 v[72:73], v10 offset:16384
  ds_read_b64_tr_b16 v[74:75], v10 offset:18432
  v_mfma_f32_32x32x16_bf16 a[64:79], v[52:55], v[80:83], a[64:79]
  ds_read_b64_tr_b16 v[76:77], v11 offset:16384
  v_mfma_f32_32x32x16_bf16 a[80:95], v[52:55], v[84:87], a[80:95]
  ds_read_b64_tr_b16 v[78:79], v11 offset:18432
  v_mfma_f32_32x32x16_bf16 a[96:111], v[52:55], v[88:91], a[96:111]
  v_mfma_f32_32x32x16_bf16 a[112:127], v[52:55], v[92:95], a[112:127]
  s_waitcnt lgkmcnt(0)
  v_mfma_f32_32x32x16_bf16 a[0:15], v[32:35], v[64:67], a[0:15]
  ds_read_b128 v[48:51], v7 offset:0
  ds_read_b64_tr_b16 v[80:81], v8 offset:24576
  v_mfma_f32_32x32x16_bf16 a[16:31], v[32:35], v[68:71], a[16:31]
  ds_read_b64_tr_b16 v[82:83], v8 offset:26624
  ds_read_b128 v[52:55], v7 offset:4096
  v_mfma_f32_32x32x16_bf16 a[32:47], v[32:35], v[72:75], a[32:47]
  ds_read_b64_tr_b16 v[84:85], v9 offset:24576
  ds_read_b64_tr_b16 v[86:87], v9 offset:26624
  v_mfma_f32_32x32x16_bf16 a[48:63], v[32:35], v[76:79], a[48:63]
  ds_read_b64_tr_b16 v[88:89], v10 offset:24576
  ds_read_b64_tr_b16 v[90:91], v10 offset:26624
  v_mfma_f32_32x32x16_bf16 a[64:79], v[36:39], v[64:67], a[64:79]
  ds_read_b64_tr_b16 v[92:93], v11 offset:24576
  v_mfma_f32_32x32x16_bf16 a[80:95], v[36:39], v[68:71], a[80:95]
  ds_read_b64_tr_b16 v[94:95], v11 offset:26624
  v_mfma_f32_32x32x16_bf16 a[96:111], v[36:39], v[72:75], a[96:111]
  v_mfma_f32_32x32x16_bf16 a[112:127], v[36:39], v[76:79], a[112:127]
  s_waitcnt lgkmcnt(0)
  v_mfma_f32_32x32x16_bf16 a[0:15], v[48:51], v[80:83], a[0:15]
  v_mfma_f32_32x32x16_bf16 a[16:31], v[48:51], v[84:87], a[16:31]
  v_mfma_f32_32x32x16_bf16 a[32:47], v[48:51], v[88:91], a[32:47]
  v_mfma_f32_32x32x16_bf16 a[48:63], v[48:51], v[92:95], a[48:63]
  v_mfma_f32_32x32x16_bf16 a[64:79], v[52:55], v[80:83], a[64:79]
  v_mfma_f32_32x32x16_bf16 a[80:95], v[52:55], v[84:87], a[80:95]
  v_mfma_f32_32x32x16_bf16 a[96:111], v[52:55], v[88:91], a[96:111]
  v_mfma_f32_32x32x16_bf16 a[112:127], v[52:55], v[92:95], a[112:127]
L_epi_h:
  v_lshlrev_b32 v96, 4, v1
  v_lshlrev_b32 v97, 3, v1
  s_mul_i32 s77, s70, 0
  s_add_u32 s77, s77, s69
  v_accvgpr_read_b32 v32, a0
  v_accvgpr_read_b32 v33, a1
  v_accvgpr_read_b32 v34, a2
  v_accvgpr_read_b32 v35, a3
  v_accvgpr_read_b32 v36, a4
  v_accvgpr_read_b32 v37, a5
  v_accvgpr_read_b32 v38, a6
  v_accvgpr_read_b32 v39, a7
  v_accvgpr_read_b32 v40, a8
  v_accvgpr_read_b32 v41, a9
  v_accvgpr_read_b32 v42, a10
  v_accvgpr_read_b32 v43, a11
  v_accvgpr_read_b32 v44, a12
  v_accvgpr_read_b32 v45, a13
  v_accvgpr_read_b32 v46, a14
  v_accvgpr_read_b32 v47, a15
  v_cvt_pk_bf16_f32 v48, v32, v33
  v_cvt_pk_bf16_f32 v49, v34, v35
  v_cvt_pk_bf16_f32 v50, v36, v37
  v_cvt_pk_bf16_f32 v51, v38, v39
  v_cvt_pk_bf16_f32 v52, v40, v41
  v_cvt_pk_bf16_f32 v53, v42, v43
  v_cvt_pk_bf16_f32 v54, v44, v45
  v_cvt_pk_bf16_f32 v55, v46, v47
  buffer_store_dwordx4 v[48:51], v96, s[36:39], s77 offen sc1
  buffer_store_dwordx4 v[52:55], v96, s[36:39], s77 offen offset:1024 sc1
  s_add_u32 s77, s77, s71
  v_accvgpr_read_b32 v56, a16
  v_accvgpr_read_b32 v57, a17
  v_accvgpr_read_b32 v58, a18
  v_accvgpr_read_b32 v59, a19
  v_accvgpr_read_b32 v60, a20
  v_accvgpr_read_b32 v61, a21
  v_accvgpr_read_b32 v62, a22
  v_accvgpr_read_b32 v63, a23
  v_accvgpr_read_b32 v64, a24
  v_accvgpr_read_b32 v65, a25
  v_accvgpr_read_b32 v66, a26
  v_accvgpr_read_b32 v67, a27
  v_accvgpr_read_b32 v68, a28
  v_accvgpr_read_b32 v69, a29
  v_accvgpr_read_b32 v70, a30
  v_accvgpr_read_b32 v71, a31
  v_cvt_pk_bf16_f32 v72, v56, v57
  v_cvt_pk_bf16_f32 v73, v58, v59
  v_cvt_pk_bf16_f32 v74, v60, v61
  v_cvt_pk_bf16_f32 v75, v62, v63
  v_cvt_pk_bf16_f32 v76, v64, v65
  v_cvt_pk_bf16_f32 v77, v66, v67
  v_cvt_pk_bf16_f32 v78, v68, v69
  v_cvt_pk_bf16_f32 v79, v70, v71
  buffer_store_dwordx4 v[72:75], v96, s[36:39], s77 offen sc1
  buffer_store_dwordx4 v[76:79], v96, s[36:39], s77 offen offset:1024 sc1
  s_add_u32 s77, s77, s71
  v_accvgpr_read_b32 v32, a32
  v_accvgpr_read_b32 v33, a33
  v_accvgpr_read_b32 v34, a34
  v_accvgpr_read_b32 v35, a35
  v_accvgpr_read_b32 v36, a36
  v_accvgpr_read_b32 v37, a37
  v_accvgpr_read_b32 v38, a38
  v_accvgpr_read_b32 v39, a39
  v_accvgpr_read_b32 v40, a40
  v_accvgpr_read_b32 v41, a41
  v_accvgpr_read_b32 v42, a42
  v_accvgpr_read_b32 v43, a43
  v_accvgpr_read_b32 v44, a44
  v_accvgpr_read_b32 v45, a45
  v_accvgpr_read_b32 v46, a46
  v_accvgpr_read_b32 v47, a47
  v_cvt_pk_bf16_f32 v48, v32, v33
  v_cvt_pk_bf16_f32 v49, v34, v35
  v_cvt_pk_bf16_f32 v50, v36, v37
  v_cvt_pk_bf16_f32 v51, v38, v39
  v_cvt_pk_bf16_f32 v52, v40, v41
  v_cvt_pk_bf16_f32 v53, v42, v43
  v_cvt_pk_bf16_f32 v54, v44, v45
  v_cvt_pk_bf16_f32 v55, v46, v47
  buffer_store_dwordx4 v[48:51], v96, s[36:39], s77 offen sc1
  buffer_store_dwordx4 v[52:55], v96, s[36:39], s77 offen offset:1024 sc1
  s_add_u32 s77, s77, s71
  v_accvgpr_read_b32 v56, a48
  v_accvgpr_read_b32 v57, a49
  v_accvgpr_read_b32 v58, a50
  v_accvgpr_read_b32 v59, a51
  v_accvgpr_read_b32 v60, a52
  v_accvgpr_read_b32 v61, a53
  v_accvgpr_read_b32 v62, a54
  v_accvgpr_read_b32 v63, a55
  v_accvgpr_read_b32 v64, a56
  v_accvgpr_read_b32 v65, a57
  v_accvgpr_read_b32 v66, a58
  v_accvgpr_read_b32 v67, a59
  v_accvgpr_read_b32 v68, a60
  v_accvgpr_read_b32 v69, a61
  v_accvgpr_read_b32 v70, a62
  v_accvgpr_read_b32 v71, a63
  v_cvt_pk_bf16_f32 v72, v56, v57
  v_cvt_pk_bf16_f32 v73, v58, v59
  v_cvt_pk_bf16_f32 v74, v60, v61
  v_cvt_pk_bf16_f32 v75, v62, v63
  v_cvt_pk_bf16_f32 v76, v64, v65
  v_cvt_pk_bf16_f32 v77, v66, v67
  v_cvt_pk_bf16_f32 v78, v68, v69
  v_cvt_pk_bf16_f32 v79, v70, v71
  buffer_store_dwordx4 v[72:75], v96, s[36:39], s77 offen sc1
  buffer_store_dwordx4 v[76:79], v96, s[36:39], s77 offen offset:1024 sc1
  s_mul_i32 s77, s70, 1
  s_add_u32 s77, s77, s69
  v_accvgpr_read_b32 v32, a64
  v_accvgpr_read_b32 v33, a65
  v_accvgpr_read_b32 v34, a66
  v_accvgpr_read_b32 v35, a67
  v_accvgpr_read_b32 v36, a68
  v_accvgpr_read_b32 v37, a69
  v_accvgpr_read_b32 v38, a70
  v_accvgpr_read_b32 v39, a71
  v_accvgpr_read_b32 v40, a72
  v_accvgpr_read_b32 v41, a73
  v_accvgpr_read_b32 v42, a74
  v_accvgpr_read_b32 v43, a75
  v_accvgpr_read_b32 v44, a76
  v_accvgpr_read_b32 v45, a77
  v_accvgpr_read_b32 v46, a78
  v_accvgpr_read_b32 v47, a79
  v_cvt_pk_bf16_f32 v48, v32, v33
  v_cvt_pk_bf16_f32 v49, v34, v35
  v_cvt_pk_bf16_f32 v50, v36, v37
  v_cvt_pk_bf16_f32 v51, v38, v39
  v_cvt_pk_bf16_f32 v52, v40, v41
  v_cvt_pk_bf16_f32 v53, v42, v43
  v_cvt_pk_bf16_f32 v54, v44, v45
  v_cvt_pk_bf16_f32 v55, v46, v47
  buffer_store_dwordx4 v[48:51], v96, s[36:39], s77 offen sc1
  buffer_store_dwordx4 v[52:55], v96, s[36:39], s77 offen offset:1024 sc1
  s_add_u32 s77, s77, s71
  v_accvgpr_read_b32 v56, a80
  v_accvgpr_read_b32 v57, a81
  v_accvgpr_read_b32 v58, a82
  v_accvgpr_read_b32 v59, a83
  v_accvgpr_read_b32 v60, a84
  v_accvgpr_read_b32 v61, a85
  v_accvgpr_read_b32 v62, a86
  v_accvgpr_read_b32 v63, a87
  v_accvgpr_read_b32 v64, a88
  v_accvgpr_read_b32 v65, a89
  v_accvgpr_read_b32 v66, a90
  v_accvgpr_read_b32 v67, a91
  v_accvgpr_read_b32 v68, a92
  v_accvgpr_read_b32 v69, a93
  v_accvgpr_read_b32 v70, a94
  v_accvgpr_read_b32 v71, a95
  v_cvt_pk_bf16_f32 v72, v56, v57
  v_cvt_pk_bf16_f32 v73, v58, v59
  v_cvt_pk_bf16_f32 v74, v60, v61
  v_cvt_pk_bf16_f32 v75, v62, v63
  v_cvt_pk_bf16_f32 v76, v64, v65
  v_cvt_pk_bf16_f32 v77, v66, v67
  v_cvt_pk_bf16_f32 v78, v68, v69
  v_cvt_pk_bf16_f32 v79, v70, v71
  buffer_store_dwordx4 v[72:75], v96, s[36:39], s77 offen sc1
  buffer_store_dwordx4 v[76:79], v96, s[36:39], s77 offen offset:1024 sc1
  s_add_u32 s77, s77, s71
  v_accvgpr_read_b32 v32, a96
  v_accvgpr_read_b32 v33, a97
  v_accvgpr_read_b32 v34, a98
  v_accvgpr_read_b32 v35, a99
  v_accvgpr_read_b32 v36, a100
  v_accvgpr_read_b32 v37, a101
  v_accvgpr_read_b32 v38, a102
  v_accvgpr_read_b32 v39, a103
  v_accvgpr_read_b32 v40, a104
  v_accvgpr_read_b32 v41, a105
  v_accvgpr_read_b32 v42, a106
  v_accvgpr_read_b32 v43, a107
  v_accvgpr_read_b32 v44, a108
  v_accvgpr_read_b32 v45, a109
  v_accvgpr_read_b32 v46, a110
  v_accvgpr_read_b32 v47, a111
  v_cvt_pk_bf16_f32 v48, v32, v33
  v_cvt_pk_bf16_f32 v49, v34, v35
  v_cvt_pk_bf16_f32 v50, v36, v37
  v_cvt_pk_bf16_f32 v51, v38, v39
  v_cvt_pk_bf16_f32 v52, v40, v41
  v_cvt_pk_bf16_f32 v53, v42, v43
  v_cvt_pk_bf16_f32 v54, v44, v45
  v_cvt_pk_bf16_f32 v55, v46, v47
  buffer_store_dwordx4 v[48:51], v96, s[36:39], s77 offen sc1
  buffer_store_dwordx4 v[52:55], v96, s[36:39], s77 offen offset:1024 sc1
  s_add_u32 s77, s77, s71
  v_accvgpr_read_b32 v56, a112
  v_accvgpr_read_b32 v57, a113
  v_accvgpr_read_b32 v58, a114
  v_accvgpr_read_b32 v59, a115
  v_accvgpr_read_b32 v60, a116
  v_accvgpr_read_b32 v61, a117
  v_accvgpr_read_b32 v62, a118
  v_accvgpr_read_b32 v63, a119
  v_accvgpr_read_b32 v64, a120
  v_accvgpr_read_b32 v65, a121
  v_accvgpr_read_b32 v66, a122
  v_accvgpr_read_b32 v67, a123
  v_accvgpr_read_b32 v68, a124
  v_accvgpr_read_b32 v69, a125
  v_accvgpr_read_b32 v70, a126
  v_accvgpr_read_b32 v71, a127
  v_cvt_pk_bf16_f32 v72, v56, v57
  v_cvt_pk_bf16_f32 v73, v58, v59
  v_cvt_pk_bf16_f32 v74, v60, v61
  v_cvt_pk_bf16_f32 v75, v62, v63
  v_cvt_pk_bf16_f32 v76, v64, v65
  v_cvt_pk_bf16_f32 v77, v66, v67
  v_cvt_pk_bf16_f32 v78, v68, v69
  v_cvt_pk_bf16_f32 v79, v70, v71
  buffer_store_dwordx4 v[72:75], v96, s[36:39], s77 offen sc1
  buffer_store_dwordx4 v[76:79], v96, s[36:39], s77 offen offset:1024 sc1
L_gemm_end:
  s_or_b32 s82, s60, s57
  s_cmp_lg_u32 s82, 0
  s_cbranch_scc1 L_gemm_sig
  s_mov_b64 exec, 0xffff
  v_lshlrev_b32 v3, 2, v1
  v_mov_b32 v2, v130
  s_branch cnt_15_c
cnt_15:
  buffer_load_dword v2, v3, s[52:55], 0 offen sc1
  s_waitcnt vmcnt(0)
cnt_15_c:
  s_mov_b32 s68, 0
  s_mov_b32 s66, 1
  s_mov_b32 s67, 1
  v_readlane_b32 s65, v2, 0
  s_and_b32 s70, s65, 1023
  s_add_u32 s68, s68, s70
  s_bfe_u32 s70, s65, 0xa000a
  s_cmp_eq_u32 s70, 32
  s_cselect_b32 s66, 0, s66
  s_lshr_b32 s70, s65, 20
  s_cmp_eq_u32 s70, 32
  s_cselect_b32 s67, 0, s67
  v_readlane_b32 s65, v2, 1
  s_and_b32 s70, s65, 1023
  s_add_u32 s68, s68, s70
  s_bfe_u32 s70, s65, 0xa000a
  s_cmp_eq_u32 s70, 32
  s_cselect_b32 s66, 0, s66
  s_lshr_b32 s70, s65, 20
  s_cmp_eq_u32 s70, 32
  s_cselect_b32 s67, 0, s67
  v_readlane_b32 s65, v2, 2
  s_and_b32 s70, s65, 1023
  s_add_u32 s68, s68, s70
  s_bfe_u32 s70, s65, 0xa000a
  s_cmp_eq_u32 s70, 32
  s_cselect_b32 s66, 0, s66
  s_lshr_b32 s70, s65, 20
  s_cmp_eq_u32 s70, 32
  s_cselect_b32 s67, 0, s67
  v_readlane_b32 s65, v2, 3
  s_and_b32 s70, s65, 1023
  s_add_u32 s68, s68, s70
  s_bfe_u32 s70, s65, 0xa000a
  s_cmp_eq_u32 s70, 32
  s_cselect_b32 s66, 0, s66
  s_lshr_b32 s70, s65, 20
  s_cmp_eq_u32 s70, 32
  s_cselect_b32 s67, 0, s67
  v_readlane_b32 s65, v2, 4
  s_and_b32 s70, s65, 1023
  s_add_u32 s68, s68, s70
  s_bfe_u32 s70, s65, 0xa000a
  s_cmp_eq_u32 s70, 32
  s_cselect_b32 s66, 0, s66
  s_lshr_b32 s70, s65, 20
  s_cmp_eq_u32 s70, 32
  s_cselect_b32 s67, 0, s67
  v_readlane_b32 s65, v2, 5
  s_and_b32 s70, s65, 1023
  s_add_u32 s68, s68, s70
  s_bfe_u32 s70, s65, 0xa000a
  s_cmp_eq_u32 s70, 32
  s_cselect_b32 s66, 0, s66
  s_lshr_b32 s70, s65, 20
  s_cmp_eq_u32 s70, 32
  s_cselect_b32 s67, 0, s67
  v_readlane_b32 s65, v2, 6
  s_and_b32 s70, s65, 1023
  s_add_u32 s68, s68, s70
  s_bfe_u32 s70, s65, 0xa000a
  s_cmp_eq_u32 s70, 32
  s_cselect_b32 s66, 0, s66
  s_lshr_b32 s70, s65, 20
  s_cmp_eq_u32 s70, 32
  s_cselect_b32 s67, 0, s67
  v_readlane_b32 s65, v2, 7
  s_and_b32 s70, s65, 1023
  s_add_u32 s68, s68, s70
  s_bfe_u32 s70, s65, 0xa000a
  s_cmp_eq_u32 s70, 32
  s_cselect_b32 s66, 0, s66
  s_lshr_b32 s70, s65, 20
  s_cmp_eq_u32 s70, 32
  s_cselect_b32 s67, 0, s67
  v_readlane_b32 s65, v2, 8
  s_and_b32 s70, s65, 1023
  s_add_u32 s68, s68, s70
  s_bfe_u32 s70, s65, 0xa000a
  s_cmp_eq_u32 s70, 32
  s_cselect_b32 s66, 0, s66
  s_lshr_b32 s70, s65, 20
  s_cmp_eq_u32 s70, 32
  s_cselect_b32 s67, 0, s67
  v_readlane_b32 s65, v2, 9
  s_and_b32 s70, s65, 1023
  s_add_u32 s68, s68, s70
  s_bfe_u32 s70, s65, 0xa000a
  s_cmp_eq_u32 s70, 32
  s_cselect_b32 s66, 0, s66
  s_lshr_b32 s70, s65, 20
  s_cmp_eq_u32 s70, 32
  s_cselect_b32 s67, 0, s67
  v_readlane_b32 s65, v2, 10
  s_and_b32 s70, s65, 1023
  s_add_u32 s68, s68, s70
  s_bfe_u32 s70, s65, 0xa000a
  s_cmp_eq_u32 s70, 32
  s_cselect_b32 s66, 0, s66
  s_lshr_b32 s70, s65, 20
  s_cmp_eq_u32 s70, 32
  s_cselect_b32 s67, 0, s67
  v_readlane_b32 s65, v2, 11
  s_and_b32 s70, s65, 1023
  s_add_u32 s68, s68, s70
  s_bfe_u32 s70, s65, 0xa000a
  s_cmp_eq_u32 s70, 32
  s_cselect_b32 s66, 0, s66
  s_lshr_b32 s70, s65, 20
  s_cmp_eq_u32 s70, 32
  s_cselect_b32 s67, 0, s67
  v_readlane_b32 s65, v2, 12
  s_and_b32 s70, s65, 1023
  s_add_u32 s68, s68, s70
  s_bfe_u32 s70, s65, 0xa000a
  s_cmp_eq_u32 s70, 32
  s_cselect_b32 s66, 0, s66
  s_lshr_b32 s70, s65, 20
  s_cmp_eq_u32 s70, 32
  s_cselect_b32 s67, 0, s67
  v_readlane_b32 s65, v2, 13
  s_and_b32 s70, s65, 1023
  s_add_u32 s68, s68, s70
  s_bfe_u32 s70, s65, 0xa000a
  s_cmp_eq_u32 s70, 32
  s_cselect_b32 s66, 0, s66
  s_lshr_b32 s70, s65, 20
  s_cmp_eq_u32 s70, 32
  s_cselect_b32 s67, 0, s67
  v_readlane_b32 s65, v2, 14
  s_and_b32 s70, s65, 1023
  s_add_u32 s68, s68, s70
  s_bfe_u32 s70, s65, 0xa000a
  s_cmp_eq_u32 s70, 32
  s_cselect_b32 s66, 0, s66
  s_lshr_b32 s70, s65, 20
  s_cmp_eq_u32 s70, 32
  s_cselect_b32 s67, 0, s67
  v_readlane_b32 s65, v2, 15
  s_and_b32 s70, s65, 1023
  s_add_u32 s68, s68, s70
  s_bfe_u32 s70, s65, 0xa000a
  s_cmp_eq_u32 s70, 32
  s_cselect_b32 s66, 0, s66
  s_lshr_b32 s70, s65, 20
  s_cmp_eq_u32 s70, 32
  s_cselect_b32 s67, 0, s67
  s_cmp_ge_u32 s68, 256
  s_cbranch_scc1 cnt_15_d
  s_sleep 2
  s_sub_u32 s56, s56, 1
  s_cbranch_scc0 cnt_15
  s_mov_b32 s56, 0
cnt_15_d:
  s_mov_b64 exec, -1
L_gemm_sig:
  s_waitcnt vmcnt(0) lgkmcnt(0)
  s_barrier
  s_cmp_lg_u32 s57, 0
  s_cbranch_scc1 sg_16
  s_mov_b64 exec, 1
  v_mov_b32 v2, s89
  v_mov_b32 v3, 0
  buffer_atomic_add v2, v3, s[36:39], s73 offen sc1
  s_mov_b64 exec, -1
sg_16:
  s_branch L_next
L_j4:
  s_lshr_b32 s82, s59, 3
  s_add_u32 s80, s80, s82
  s_and_b32 s81, s59, 7
  s_lshr_b32 s82, s80, 3
  s_lshl_b32 s82, s82, 7
  s_add_u32 s82, s82, 2048
  s_cmp_lg_u32 s57, 0
  s_cbranch_scc1 wt_17
  s_mov_b64 exec, 0x7
  v_mul_u32_u24 v3, 512, v1
wl_18:
  buffer_load_dword v2, v3, s[36:39], s82 offen sc1
  s_waitcnt vmcnt(0)
  v_cmp_gt_u32 vcc, 8, v2
  s_nop 0
  s_cbranch_vccz wl_18_d
  s_sleep 4
  s_sub_u32 s56, s56, 1
  s_cbranch_scc0 wl_18
  s_mov_b32 s56, 0
wl_18_d:
  s_mov_b64 exec, -1
wt_17:
  s_barrier
  v_lshlrev_b32 v4, 4, v1
  v_lshlrev_b32 v5, 3, v1
  s_mul_i32 s82, s80, 98304
  s_lshl_b32 s83, s80, 17
  s_lshl_b32 s88, s81, 3
  s_lshl_b32 s89, s57, 1
  s_add_u32 s88, s88, s89
  s_mul_i32 s89, s88, 1536
  s_add_u32 s89, s89, s82
  s_add_u32 s89, s89, 79691776
  s_add_u32 s82, s82, 82837504
  s_add_u32 s83, s83, 85983232
  buffer_load_dwordx4 v[8:11], v4, s[36:39], s89 offen
  buffer_load_dwordx2 v[12:13], v5, s[36:39], s89 offen offset:1024
  buffer_load_dwordx4 v[16:19], v4, s[36:39], s89 offen offset:1536
  buffer_load_dwordx2 v[20:21], v5, s[36:39], s89 offen offset:2560
  v_mov_b32 v32, 0
  v_mov_b32 v33, 0
  v_mov_b32 v34, 0
  v_mov_b32 v35, 0
  v_mov_b32 v36, 0
  v_mov_b32 v37, 0
  v_mov_b32 v38, 0
  v_mov_b32 v39, 0
  v_mov_b32 v40, 0
  v_mov_b32 v41, 0
  v_mov_b32 v42, 0
  v_mov_b32 v43, 0
  v_mov_b32 v44, 0
  v_mov_b32 v45, 0
  v_mov_b32 v46, 0
  v_mov_b32 v47, 0
  v_mov_b32 v48, 0
  v_mov_b32 v49, 0
  v_mov_b32 v50, 0
  v_mov_b32 v51, 0
  v_mov_b32 v52, 0
  v_mov_b32 v53, 0
  v_mov_b32 v54, 0
  v_mov_b32 v55, 0
  v_mov_b32 v56, 0
  v_mov_b32 v57, 0
  v_mov_b32 v58, 0
  v_mov_b32 v59, 0
  v_mov_b32 v60, 0
  v_mov_b32 v61, 0
  v_mov_b32 v62, 0
  v_mov_b32 v63, 0
  v_mov_b32 v64, 0
  v_mov_b32 v65, 0
  v_mov_b32 v66, 0
  v_mov_b32 v67, 0
  v_mov_b32 v68, 0
  v_mov_b32 v69, 0
  v_mov_b32 v70, 0
  v_mov_b32 v71, 0
  v_mov_b32 v72, 0
  v_mov_b32 v73, 0
  v_mov_b32 v74, 0
  v_mov_b32 v75, 0
  v_mov_b32 v76, 0
  v_mov_b32 v77, 0
  v_mov_b32 v78, 0
  v_mov_b32 v79, 0
  v_mov_b32 v80, 0
  v_mov_b32 v81, 0
  v_mov_b32 v82, 0
  v_mov_b32 v83, 0
  v_mov_b32 v84, 0
  v_mov_b32 v85, 0
  v_mov_b32 v86, 0
  v_mov_b32 v87, 0
  v_mov_b32 v88, 0
  v_mov_b32 v89, 0
  v_mov_b32 v90, 0
  v_mov_b32 v91, 0
  v_mov_b32 v92, 0
  v_mov_b32 v93, 0
  v_mov_b32 v94, 0
  v_mov_b32 v95, 0
  v_mov_b32 v14, 0
  v_mov_b32 v15, 0
  v_mov_b32 v24, 0
  v_mov_b32 v26, 0xff800000
  v_mov_b32 v28, 0xff800000
  v_mov_b32 v144, 0
  v_mov_b32 v145, 0
  v_mov_b32 v146, 0
  v_mov_b32 v147, 0
  v_mov_b32 v148, 0
  v_mov_b32 v149, 0
  v_mov_b32 v150, 0
  v_mov_b32 v151, 0
  v_mov_b32 v152, 0
  v_mov_b32 v153, 0
  v_mov_b32 v154, 0
  v_mov_b32 v155, 0
  v_mov_b32 v156, 0
  v_mov_b32 v157, 0
  v_mov_b32 v158, 0
  v_mov_b32 v159, 0
  v_mov_b32 v22, 0
  v_mov_b32 v23, 0
  v_mov_b32 v25, 0
  v_mov_b32 v27, 0xff800000
  v_mov_b32 v29, 0xff800000
  v_mov_b32 v160, 0
  v_mov_b32 v161, 0
  v_mov_b32 v162, 0
  v_mov_b32 v163, 0
  v_mov_b32 v164, 0
  v_mov_b32 v165, 0
  v_mov_b32 v166, 0
  v_mov_b32 v167, 0
  v_mov_b32 v168, 0
  v_mov_b32 v169, 0
  v_mov_b32 v170, 0
  v_mov_b32 v171, 0
  v_mov_b32 v172, 0
  v_mov_b32 v173, 0
  v_mov_b32 v174, 0
  v_mov_b32 v175, 0
  v_mov_b32 v112, 0xff800000
  v_mov_b32 v113, 0xff800000
  v_mov_b32 v114, 0xff800000
  v_mov_b32 v115, 0xff800000
  v_mov_b32 v116, 0xff800000
  v_mov_b32 v117, 0xff800000
  v_mov_b32 v118, 0xff800000
  v_mov_b32 v119, 0xff800000
  v_mov_b32 v120, 0xff800000
  v_mov_b32 v121, 0xff800000
  v_mov_b32 v122, 0xff800000
  v_mov_b32 v123, 0xff800000
  v_mov_b32 v124, 0xff800000
  v_mov_b32 v125, 0xff800000
  v_mov_b32 v126, 0xff800000
  v_mov_b32 v127, 0xff800000
  s_mov_b32 s84, 0
  s_min_u32 s89, s84, 63
  s_mul_i32 s85, s89, 1536
  s_add_u32 s85, s85, s82
  s_lshl_b32 s86, s89, 11
  s_add_u32 s86, s86, s83
  s_add_u32 s84, s84, 1
  buffer_load_dwordx4 v[32:35], v4, s[36:39], s85 offen
  buffer_load_dwordx2 v[36:37], v5, s[36:39], s85 offen offset:1024
  buffer_load_dwordx4 v[40:43], v4, s[36:39], s86 offen
  buffer_load_dwordx4 v[44:47], v4, s[36:39], s86 offen offset:1024
  s_min_u32 s89, s84, 63
  s_mul_i32 s85, s89, 1536
  s_add_u32 s85, s85, s82
  s_lshl_b32 s86, s89, 11
  s_add_u32 s86, s86, s83
  s_add_u32 s84, s84, 1
  buffer_load_dwordx4 v[48:51], v4, s[36:39], s85 offen
  buffer_load_dwordx2 v[52:53], v5, s[36:39], s85 offen offset:1024
  buffer_load_dwordx4 v[56:59], v4, s[36:39], s86 offen
  buffer_load_dwordx4 v[60:63], v4, s[36:39], s86 offen offset:1024
  s_min_u32 s89, s84, 63
  s_mul_i32 s85, s89, 1536
  s_add_u32 s85, s85, s82
  s_lshl_b32 s86, s89, 11
  s_add_u32 s86, s86, s83
  s_add_u32 s84, s84, 1
  buffer_load_dwordx4 v[64:67], v4, s[36:39], s85 offen
  buffer_load_dwordx2 v[68:69], v5, s[36:39], s85 offen offset:1024
  buffer_load_dwordx4 v[72:75], v4, s[36:39], s86 offen
  buffer_load_dwordx4 v[76:79], v4, s[36:39], s86 offen offset:1024
  s_mov_b32 s87, 16
L_j4_loop:
  s_waitcnt vmcnt(8)
  v_mfma_f32_32x32x16_bf16 v[96:111], v[32:35], v[8:11], 0
  v_mfma_f32_32x32x16_bf16 v[96:111], v[36:39], v[12:15], v[96:111]
  v_max3_f32 v176, v112, v113, v114
  v_max3_f32 v177, v115, v116, v117
  v_max3_f32 v176, v176, v118, v119
  v_max3_f32 v177, v177, v120, v121
  v_max3_f32 v176, v176, v122, v123
  v_max3_f32 v177, v177, v124, v125
  v_max3_f32 v176, v176, v126, v127
  v_max_f32 v176, v176, v177
  v_cmp_gt_f32 vcc, v176, v27
  s_nop 0
  s_cbranch_vccnz rr_19
rb_20:
  v_exp_f32 v112, v112
  v_exp_f32 v113, v113
  v_exp_f32 v114, v114
  v_exp_f32 v115, v115
  v_cvt_pk_bf16_f32 v136, v112, v113
  v_exp_f32 v116, v116
  v_exp_f32 v117, v117
  v_cvt_pk_bf16_f32 v137, v114, v115
  v_exp_f32 v118, v118
  v_exp_f32 v119, v119
  v_cvt_pk_bf16_f32 v138, v116, v117
  v_exp_f32 v120, v120
  v_exp_f32 v121, v121
  v_cvt_pk_bf16_f32 v139, v118, v119
  v_exp_f32 v122, v122
  v_exp_f32 v123, v123
  v_cvt_pk_bf16_f32 v140, v120, v121
  v_exp_f32 v124, v124
  v_exp_f32 v125, v125
  v_cvt_pk_bf16_f32 v141, v122, v123
  v_exp_f32 v126, v126
  v_exp_f32 v127, v127
  v_cvt_pk_bf16_f32 v142, v124, v125
  v_cvt_pk_bf16_f32 v143, v126, v127
  v_mfma_f32_32x32x16_bf16 v[160:175], v[88:91], v[136:139], v[160:175]
  s_nop 0
  v_mfma_f32_32x32x16_bf16 v[160:175], v[92:95], v[140:143], v[160:175]
  v_mfma_f32_32x32x16_bf16 v[112:127], v[32:35], v[16:19], 0
  v_mfma_f32_32x32x16_bf16 v[112:127], v[36:39], v[20:23], v[112:127]
  s_min_u32 s89, s84, 63
  s_mul_i32 s85, s89, 1536
  s_add_u32 s85, s85, s82
  s_lshl_b32 s86, s89, 11
  s_add_u32 s86, s86, s83
  s_add_u32 s84, s84, 1
  buffer_load_dwordx4 v[80:83], v4, s[36:39], s85 offen
  buffer_load_dwordx2 v[84:85], v5, s[36:39], s85 offen offset:1024
  buffer_load_dwordx4 v[88:91], v4, s[36:39], s86 offen
  buffer_load_dwordx4 v[92:95], v4, s[36:39], s86 offen offset:1024
  v_max3_f32 v176, v96, v97, v98
  v_max3_f32 v177, v99, v100, v101
  v_max3_f32 v176, v176, v102, v103
  v_max3_f32 v177, v177, v104, v105
  v_max3_f32 v176, v176, v106, v107
  v_max3_f32 v177, v177, v108, v109
  v_max3_f32 v176, v176, v110, v111
  v_max_f32 v176, v176, v177
  v_cmp_gt_f32 vcc, v176, v26
  s_nop 0
  s_cbranch_vccnz rr_21
rb_22:
  v_exp_f32 v96, v96
  v_exp_f32 v97, v97
  v_exp_f32 v98, v98
  v_exp_f32 v99, v99
  v_cvt_pk_bf16_f32 v128, v96, v97
  v_exp_f32 v100, v100
  v_exp_f32 v101, v101
  v_cvt_pk_bf16_f32 v129, v98, v99
  v_exp_f32 v102, v102
  v_exp_f32 v103, v103
  v_cvt_pk_bf16_f32 v130, v100, v101
  v_exp_f32 v104, v104
  v_exp_f32 v105, v105
  v_cvt_pk_bf16_f32 v131, v102, v103
  v_exp_f32 v106, v106
  v_exp_f32 v107, v107
  v_cvt_pk_bf16_f32 v132, v104, v105
  v_exp_f32 v108, v108
  v_exp_f32 v109, v109
  v_cvt_pk_bf16_f32 v133, v106, v107
  v_exp_f32 v110, v110
  v_exp_f32 v111, v111
  v_cvt_pk_bf16_f32 v134, v108, v109
  v_cvt_pk_bf16_f32 v135, v110, v111
  v_mfma_f32_32x32x16_bf16 v[144:159], v[40:43], v[128:131], v[144:159]
  s_nop 0
  v_mfma_f32_32x32x16_bf16 v[144:159], v[44:47], v[132:135], v[144:159]
  s_waitcnt vmcnt(8)
  v_mfma_f32_32x32x16_bf16 v[96:111], v[48:51], v[8:11], 0
  v_mfma_f32_32x32x16_bf16 v[96:111], v[52:55], v[12:15], v[96:111]
  v_max3_f32 v176, v112, v113, v114
  v_max3_f32 v177, v115, v116, v117
  v_max3_f32 v176, v176, v118, v119
  v_max3_f32 v177, v177, v120, v121
  v_max3_f32 v176, v176, v122, v123
  v_max3_f32 v177, v177, v124, v125
  v_max3_f32 v176, v176, v126, v127
  v_max_f32 v176, v176, v177
  v_cmp_gt_f32 vcc, v176, v27
  s_nop 0
  s_cbranch_vccnz rr_23
rb_24:
  v_exp_f32 v112, v112
  v_exp_f32 v113, v113
  v_exp_f32 v114, v114
  v_exp_f32 v115, v115
  v_cvt_pk_bf16_f32 v136, v112, v113
  v_exp_f32 v116, v116
  v_exp_f32 v117, v117
  v_cvt_pk_bf16_f32 v137, v114, v115
  v_exp_f32 v118, v118
  v_exp_f32 v119, v119
  v_cvt_pk_bf16_f32 v138, v116, v117
  v_exp_f32 v120, v120
  v_exp_f32 v121, v121
  v_cvt_pk_bf16_f32 v139, v118, v119
  v_exp_f32 v122, v122
  v_exp_f32 v123, v123
  v_cvt_pk_bf16_f32 v140, v120, v121
  v_exp_f32 v124, v124
  v_exp_f32 v125, v125
  v_cvt_pk_bf16_f32 v141, v122, v123
  v_exp_f32 v126, v126
  v_exp_f32 v127, v127
  v_cvt_pk_bf16_f32 v142, v124, v125
  v_cvt_pk_bf16_f32 v143, v126, v127
  v_mfma_f32_32x32x16_bf16 v[160:175], v[40:43], v[136:139], v[160:175]
  s_nop 0
  v_mfma_f32_32x32x16_bf16 v[160:175], v[44:47], v[140:143], v[160:175]
  v_mfma_f32_32x32x16_bf16 v[112:127], v[48:51], v[16:19], 0
  v_mfma_f32_32x32x16_bf16 v[112:127], v[52:55], v[20:23], v[112:127]
  s_min_u32 s89, s84, 63
  s_mul_i32 s85, s89, 1536
  s_add_u32 s85, s85, s82
  s_lshl_b32 s86, s89, 11
  s_add_u32 s86, s86, s83
  s_add_u32 s84, s84, 1
  buffer_load_dwordx4 v[32:35], v4, s[36:39], s85 offen
  buffer_load_dwordx2 v[36:37], v5, s[36:39], s85 offen offset:1024
  buffer_load_dwordx4 v[40:43], v4, s[36:39], s86 offen
  buffer_load_dwordx4 v[44:47], v4, s[36:39], s86 offen offset:1024
  v_max3_f32 v176, v96, v97, v98
  v_max3_f32 v177, v99, v100, v101
  v_max3_f32 v176, v176, v102, v103
  v_max3_f32 v177, v177, v104, v105
  v_max3_f32 v176, v176, v106, v107
  v_max3_f32 v177, v177, v108, v109
  v_max3_f32 v176, v176, v110, v111
  v_max_f32 v176, v176, v177
  v_cmp_gt_f32 vcc, v176, v26
  s_nop 0
  s_cbranch_vccnz rr_25
rb_26:
  v_exp_f32 v96, v96
  v_exp_f32 v97, v97
  v_exp_f32 v98, v98
  v_exp_f32 v99, v99
  v_cvt_pk_bf16_f32 v128, v96, v97
  v_exp_f32 v100, v100
  v_exp_f32 v101, v101
  v_cvt_pk_bf16_f32 v129, v98, v99
  v_exp_f32 v102, v102
  v_exp_f32 v103, v103
  v_cvt_pk_bf16_f32 v130, v100, v101
  v_exp_f32 v104, v104
  v_exp_f32 v105, v105
  v_cvt_pk_bf16_f32 v131, v102, v103
  v_exp_f32 v106, v106
  v_exp_f32 v107, v107
  v_cvt_pk_bf16_f32 v132, v104, v105
  v_exp_f32 v108, v108
  v_exp_f32 v109, v109
  v_cvt_pk_bf16_f32 v133, v106, v107
  v_exp_f32 v110, v110
  v_exp_f32 v111, v111
  v_cvt_pk_bf16_f32 v134, v108, v109
  v_cvt_pk_bf16_f32 v135, v110, v111
  v_mfma_f32_32x32x16_bf16 v[144:159], v[56:59], v[128:131], v[144:159]
  s_nop 0
  v_mfma_f32_32x32x16_bf16 v[144:159], v[60:63], v[132:135], v[144:159]
  s_waitcnt vmcnt(8)
  v_mfma_f32_32x32x16_bf16 v[96:111], v[64:67], v[8:11], 0
  v_mfma_f32_32x32x16_bf16 v[96:111], v[68:71], v[12:15], v[96:111]
  v_max3_f32 v176, v112, v113, v114
  v_max3_f32 v177, v115, v116, v117
  v_max3_f32 v176, v176, v118, v119
  v_max3_f32 v177, v177, v120, v121
  v_max3_f32 v176, v176, v122, v123
  v_max3_f32 v177, v177, v124, v125
  v_max3_f32 v176, v176, v126, v127
  v_max_f32 v176, v176, v177
  v_cmp_gt_f32 vcc, v176, v27
  s_nop 0
  s_cbranch_vccnz rr_27
rb_28:
  v_exp_f32 v112, v112
  v_exp_f32 v113, v113
  v_exp_f32 v114, v114
  v_exp_f32 v115, v115
  v_cvt_pk_bf16_f32 v136, v112, v113
  v_exp_f32 v116, v116
  v_exp_f32 v117, v117
  v_cvt_pk_bf16_f32 v137, v114, v115
  v_exp_f32 v118, v118
  v_exp_f32 v119, v119
  v_cvt_pk_bf16_f32 v138, v116, v117
  v_exp_f32 v120, v120
  v_exp_f32 v121, v121
  v_cvt_pk_bf16_f32 v139, v118, v119
  v_exp_f32 v122, v122
  v_exp_f32 v123, v123
  v_cvt_pk_bf16_f32 v140, v120, v121
  v_exp_f32 v124, v124
  v_exp_f32 v125, v125
  v_cvt_pk_bf16_f32 v141, v122, v123
  v_exp_f32 v126, v126
  v_exp_f32 v127, v127
  v_cvt_pk_bf16_f32 v142, v124, v125
  v_cvt_pk_bf16_f32 v143, v126, v127
  v_mfma_f32_32x32x16_bf16 v[160:175], v[56:59], v[136:139], v[160:175]
  s_nop 0
  v_mfma_f32_32x32x16_bf16 v[160:175], v[60:63], v[140:143], v[160:175]
  v_mfma_f32_32x32x16_bf16 v[112:127], v[64:67], v[16:19], 0
  v_mfma_f32_32x32x16_bf16 v[112:127], v[68:71], v[20:23], v[112:127]
  s_min_u32 s89, s84, 63
  s_mul_i32 s85, s89, 1536
  s_add_u32 s85, s85, s82
  s_lshl_b32 s86, s89, 11
  s_add_u32 s86, s86, s83
  s_add_u32 s84, s84, 1
  buffer_load_dwordx4 v[48:51], v4, s[36:39], s85 offen
  buffer_load_dwordx2 v[52:53], v5, s[36:39], s85 offen offset:1024
  buffer_load_dwordx4 v[56:59], v4, s[36:39], s86 offen
  buffer_load_dwordx4 v[60:63], v4, s[36:39], s86 offen offset:1024
  v_max3_f32 v176, v96, v97, v98
  v_max3_f32 v177, v99, v100, v101
  v_max3_f32 v176, v176, v102, v103
  v_max3_f32 v177, v177, v104, v105
  v_max3_f32 v176, v176, v106, v107
  v_max3_f32 v177, v177, v108, v109
  v_max3_f32 v176, v176, v110, v111
  v_max_f32 v176, v176, v177
  v_cmp_gt_f32 vcc, v176, v26
  s_nop 0
  s_cbranch_vccnz rr_29
rb_30:
  v_exp_f32 v96, v96
  v_exp_f32 v97, v97
  v_exp_f32 v98, v98
  v_exp_f32 v99, v99
  v_cvt_pk_bf16_f32 v128, v96, v97
  v_exp_f32 v100, v100
  v_exp_f32 v101, v101
  v_cvt_pk_bf16_f32 v129, v98, v99
  v_exp_f32 v102, v102
  v_exp_f32 v103, v103
  v_cvt_pk_bf16_f32 v130, v100, v101
  v_exp_f32 v104, v104
  v_exp_f32 v105, v105
  v_cvt_pk_bf16_f32 v131, v102, v103
  v_exp_f32 v106, v106
  v_exp_f32 v107, v107
  v_cvt_pk_bf16_f32 v132, v104, v105
  v_exp_f32 v108, v108
  v_exp_f32 v109, v109
  v_cvt_pk_bf16_f32 v133, v106, v107
  v_exp_f32 v110, v110
  v_exp_f32 v111, v111
  v_cvt_pk_bf16_f32 v134, v108, v109
  v_cvt_pk_bf16_f32 v135, v110, v111
  v_mfma_f32_32x32x16_bf16 v[144:159], v[72:75], v[128:131], v[144:159]
  s_nop 0
  v_mfma_f32_32x32x16_bf16 v[144:159], v[76:79], v[132:135], v[144:159]
  s_waitcnt vmcnt(8)
  v_mfma_f32_32x32x16_bf16 v[96:111], v[80:83], v[8:11], 0
  v_mfma_f32_32x32x16_bf16 v[96:111], v[84:87], v[12:15], v[96:111]
  v_max3_f32 v176, v112, v113, v114
  v_max3_f32 v177, v115, v116, v117
  v_max3_f32 v176, v176, v118, v119
  v_max3_f32 v177, v177, v120, v121
  v_max3_f32 v176, v176, v122, v123
  v_max3_f32 v177, v177, v124, v125
  v_max3_f32 v176, v176, v126, v127
  v_max_f32 v176, v176, v177
  v_cmp_gt_f32 vcc, v176, v27
  s_nop 0
  s_cbranch_vccnz rr_31
rb_32:
  v_exp_f32 v112, v112
  v_exp_f32 v113, v113
  v_exp_f32 v114, v114
  v_exp_f32 v115, v115
  v_cvt_pk_bf16_f32 v136, v112, v113
  v_exp_f32 v116, v116
  v_exp_f32 v117, v117
  v_cvt_pk_bf16_f32 v137, v114, v115
  v_exp_f32 v118, v118
  v_exp_f32 v119, v119
  v_cvt_pk_bf16_f32 v138, v116, v117
  v_exp_f32 v120, v120
  v_exp_f32 v121, v121
  v_cvt_pk_bf16_f32 v139, v118, v119
  v_exp_f32 v122, v122
  v_exp_f32 v123, v123
  v_cvt_pk_bf16_f32 v140, v120, v121
  v_exp_f32 v124, v124
  v_exp_f32 v125, v125
  v_cvt_pk_bf16_f32 v141, v122, v123
  v_exp_f32 v126, v126
  v_exp_f32 v127, v127
  v_cvt_pk_bf16_f32 v142, v124, v125
  v_cvt_pk_bf16_f32 v143, v126, v127
  v_mfma_f32_32x32x16_bf16 v[160:175], v[72:75], v[136:139], v[160:175]
  s_nop 0
  v_mfma_f32_32x32x16_bf16 v[160:175], v[76:79], v[140:143], v[160:175]
  v_mfma_f32_32x32x16_bf16 v[112:127], v[80:83], v[16:19], 0
  v_mfma_f32_32x32x16_bf16 v[112:127], v[84:87], v[20:23], v[112:127]
  s_min_u32 s89, s84, 63
  s_mul_i32 s85, s89, 1536
  s_add_u32 s85, s85, s82
  s_lshl_b32 s86, s89, 11
  s_add_u32 s86, s86, s83
  s_add_u32 s84, s84, 1
  buffer_load_dwordx4 v[64:67], v4, s[36:39], s85 offen
  buffer_load_dwordx2 v[68:69], v5, s[36:39], s85 offen offset:1024
  buffer_load_dwordx4 v[72:75], v4, s[36:39], s86 offen
  buffer_load_dwordx4 v[76:79], v4, s[36:39], s86 offen offset:1024
  v_max3_f32 v176, v96, v97, v98
  v_max3_f32 v177, v99, v100, v101
  v_max3_f32 v176, v176, v102, v103
  v_max3_f32 v177, v177, v104, v105
  v_max3_f32 v176, v176, v106, v107
  v_max3_f32 v177, v177, v108, v109
  v_max3_f32 v176, v176, v110, v111
  v_max_f32 v176, v176, v177
  v_cmp_gt_f32 vcc, v176, v26
  s_nop 0
  s_cbranch_vccnz rr_33
rb_34:
  v_exp_f32 v96, v96
  v_exp_f32 v97, v97
  v_exp_f32 v98, v98
  v_exp_f32 v99, v99
  v_cvt_pk_bf16_f32 v128, v96, v97
  v_exp_f32 v100, v100
  v_exp_f32 v101, v101
  v_cvt_pk_bf16_f32 v129, v98, v99
  v_exp_f32 v102, v102
  v_exp_f32 v103, v103
  v_cvt_pk_bf16_f32 v130, v100, v101
  v_exp_f32 v104, v104
  v_exp_f32 v105, v105
  v_cvt_pk_bf16_f32 v131, v102, v103
  v_exp_f32 v106, v106
  v_exp_f32 v107, v107
  v_cvt_pk_bf16_f32 v132, v104, v105
  v_exp_f32 v108, v108
  v_exp_f32 v109, v109
  v_cvt_pk_bf16_f32 v133, v106, v107
  v_exp_f32 v110, v110
  v_exp_f32 v111, v111
  v_cvt_pk_bf16_f32 v134, v108, v109
  v_cvt_pk_bf16_f32 v135, v110, v111
  v_mfma_f32_32x32x16_bf16 v[144:159], v[88:91], v[128:131], v[144:159]
  s_nop 0
  v_mfma_f32_32x32x16_bf16 v[144:159], v[92:95], v[132:135], v[144:159]
  s_sub_u32 s87, s87, 1
  s_cmp_lg_u32 s87, 0
  s_cbranch_scc1 L_j4_loop
  v_max3_f32 v176, v112, v113, v114
  v_max3_f32 v177, v115, v116, v117
  v_max3_f32 v176, v176, v118, v119
  v_max3_f32 v177, v177, v120, v121
  v_max3_f32 v176, v176, v122, v123
  v_max3_f32 v177, v177, v124, v125
  v_max3_f32 v176, v176, v126, v127
  v_max_f32 v176, v176, v177
  v_cmp_gt_f32 vcc, v176, v27
  s_nop 0
  s_cbranch_vccnz rr_35
rb_36:
  v_exp_f32 v112, v112
  v_exp_f32 v113, v113
  v_exp_f32 v114, v114
  v_exp_f32 v115, v115
  v_cvt_pk_bf16_f32 v136, v112, v113
  v_exp_f32 v116, v116
  v_exp_f32 v117, v117
  v_cvt_pk_bf16_f32 v137, v114, v115
  v_exp_f32 v118, v118
  v_exp_f32 v119, v119
  v_cvt_pk_bf16_f32 v138, v116, v117
  v_exp_f32 v120, v120
  v_exp_f32 v121, v121
  v_cvt_pk_bf16_f32 v139, v118, v119
  v_exp_f32 v122, v122
  v_exp_f32 v123, v123
  v_cvt_pk_bf16_f32 v140, v120, v121
  v_exp_f32 v124, v124
  v_exp_f32 v125, v125
  v_cvt_pk_bf16_f32 v141, v122, v123
  v_exp_f32 v126, v126
  v_exp_f32 v127, v127
  v_cvt_pk_bf16_f32 v142, v124, v125
  v_cvt_pk_bf16_f32 v143, v126, v127
  v_mfma_f32_32x32x16_bf16 v[160:175], v[88:91], v[136:139], v[160:175]
  s_nop 0
  v_mfma_f32_32x32x16_bf16 v[160:175], v[92:95], v[140:143], v[160:175]
  s_mul_i32 s89, s88, 40
  s_add_u32 s90, s89, s80
  s_lshl_b32 s90, s90, 10
  s_add_u32 s90, s90, 90177536
  s_lshr_b32 s91, s80, 2
  s_add_u32 s91, s91, s89
  s_add_u32 s91, s91, 32
  s_lshl_b32 s91, s91, 10
  s_add_u32 s91, s91, 90177536
  s_and_b32 s89, s80, 2
  s_lshl_b32 s89, s89, 8
  s_add_u32 s91, s91, s89
  s_and_b32 s89, s80, 1
  s_lshl_b32 s89, s89, 3
  s_add_u32 s91, s91, s89
  v_mov_b32 v176, v152
  v_mov_b32 v177, v152
  s_nop 1
  v_permlane32_swap_b32 v176, v177
  v_rcp_f32 v177, v177
  s_nop 0
  v_mul_f32 v144, v144, v177
  v_mul_f32 v145, v145, v177
  v_mul_f32 v146, v146, v177
  v_mul_f32 v147, v147, v177
  v_mul_f32 v148, v148, v177
  v_mul_f32 v149, v149, v177
  v_mul_f32 v150, v150, v177
  v_mul_f32 v151, v151, v177
  v_mul_f32 v152, v152, v177
  v_mul_f32 v153, v153, v177
  v_mul_f32 v154, v154, v177
  v_mul_f32 v155, v155, v177
  v_cvt_pk_bf16_f32 v128, v144, v145
  v_cvt_pk_bf16_f32 v129, v146, v147
  v_cvt_pk_bf16_f32 v130, v148, v149
  v_cvt_pk_bf16_f32 v131, v150, v151
  v_cvt_pk_bf16_f32 v132, v152, v153
  v_cvt_pk_bf16_f32 v133, v154, v155
  buffer_store_dwordx4 v[128:131], v4, s[36:39], s90 offen sc1
  s_mov_b64 exec, 0xffffffff
  buffer_store_dwordx2 v[132:133], v4, s[36:39], s91 offen sc1
  s_mov_b64 exec, -1
  s_add_u32 s90, s90, 40960
  s_add_u32 s91, s91, 40960
  v_mov_b32 v176, v168
  v_mov_b32 v177, v168
  s_nop 1
  v_permlane32_swap_b32 v176, v177
  v_rcp_f32 v177, v177
  s_nop 0
  v_mul_f32 v160, v160, v177
  v_mul_f32 v161, v161, v177
  v_mul_f32 v162, v162, v177
  v_mul_f32 v163, v163, v177
  v_mul_f32 v164, v164, v177
  v_mul_f32 v165, v165, v177
  v_mul_f32 v166, v166, v177
  v_mul_f32 v167, v167, v177
  v_mul_f32 v168, v168, v177
  v_mul_f32 v169, v169, v177
  v_mul_f32 v170, v170, v177
  v_mul_f32 v171, v171, v177
  v_cvt_pk_bf16_f32 v136, v160, v161
  v_cvt_pk_bf16_f32 v137, v162, v163
  v_cvt_pk_bf16_f32 v138, v164, v165
  v_cvt_pk_bf16_f32 v139, v166, v167
  v_cvt_pk_bf16_f32 v140, v168, v169
  v_cvt_pk_bf16_f32 v141, v170, v171
  buffer_store_dwordx4 v[136:139], v4, s[36:39], s90 offen sc1
  s_mov_b64 exec, 0xffffffff
  buffer_store_dwordx2 v[140:141], v4, s[36:39], s91 offen sc1
  s_mov_b64 exec, -1
  s_add_u32 s90, s90, 40960
  s_add_u32 s91, s91, 40960
  s_lshl_b32 s89, s81, 7
  s_add_u32 s89, s89, 4096
  s_waitcnt vmcnt(0) lgkmcnt(0)
  s_barrier
  s_cmp_lg_u32 s57, 0
  s_cbranch_scc1 sg_37
  s_mov_b64 exec, 1
  v_mov_b32 v2, 1
  v_mov_b32 v3, 0
  buffer_atomic_add v2, v3, s[36:39], s89 offen sc1
  s_mov_b64 exec, -1
sg_37:
  s_branch L_next
rr_19:
  v_mov_b32 v177, v176
  s_nop 1
  v_permlane32_swap_b32 v176, v177
  v_max3_f32 v176, v176, v177, v29
  v_sub_f32 v177, v25, v176
  v_cvt_pk_bf16_f32 v178, v177, v177
  v_lshlrev_b32 v178, 16, v178
  v_sub_f32 v179, v177, v178
  v_cvt_pk_bf16_f32 v179, v177, v179
  v_and_b32 v180, 0xffff0000, v179
  v_add_f32 v178, v178, v180
  v_sub_f32 v180, v178, v25
  v_mov_b32 v25, v178
  v_min_f32 v181, 0, v180
  v_exp_f32 v181, v181
  s_mov_b32 exec_lo, 0
  v_mov_b32 v20, v179
  s_mov_b32 exec_lo, -1
  v_mov_b32 v27, 0x41000000
  v_mov_b32 v29, 0
  v_add_f32 v112, v112, v180
  v_add_f32 v113, v113, v180
  v_add_f32 v114, v114, v180
  v_add_f32 v115, v115, v180
  v_add_f32 v116, v116, v180
  v_add_f32 v117, v117, v180
  v_add_f32 v118, v118, v180
  v_add_f32 v119, v119, v180
  v_add_f32 v120, v120, v180
  v_add_f32 v121, v121, v180
  v_add_f32 v122, v122, v180
  v_add_f32 v123, v123, v180
  v_add_f32 v124, v124, v180
  v_add_f32 v125, v125, v180
  v_add_f32 v126, v126, v180
  v_add_f32 v127, v127, v180
  v_mul_f32 v160, v160, v181
  v_mul_f32 v161, v161, v181
  v_mul_f32 v162, v162, v181
  v_mul_f32 v163, v163, v181
  v_mul_f32 v164, v164, v181
  v_mul_f32 v165, v165, v181
  v_mul_f32 v166, v166, v181
  v_mul_f32 v167, v167, v181
  v_mul_f32 v168, v168, v181
  v_mul_f32 v169, v169, v181
  v_mul_f32 v170, v170, v181
  v_mul_f32 v171, v171, v181
  s_branch rb_20
rr_21:
  v_mov_b32 v177, v176
  s_nop 1
  v_permlane32_swap_b32 v176, v177
  v_max3_f32 v176, v176, v177, v28
  v_sub_f32 v177, v24, v176
  v_cvt_pk_bf16_f32 v178, v177, v177
  v_lshlrev_b32 v178, 16, v178
  v_sub_f32 v179, v177, v178
  v_cvt_pk_bf16_f32 v179, v177, v179
  v_and_b32 v180, 0xffff0000, v179
  v_add_f32 v178, v178, v180
  v_sub_f32 v180, v178, v24
  v_mov_b32 v24, v178
  v_min_f32 v181, 0, v180
  v_exp_f32 v181, v181
  s_mov_b32 exec_lo, 0
  v_mov_b32 v12, v179
  s_mov_b32 exec_lo, -1
  v_mov_b32 v26, 0x41000000
  v_mov_b32 v28, 0
  v_add_f32 v96, v96, v180
  v_add_f32 v97, v97, v180
  v_add_f32 v98, v98, v180
  v_add_f32 v99, v99, v180
  v_add_f32 v100, v100, v180
  v_add_f32 v101, v101, v180
  v_add_f32 v102, v102, v180
  v_add_f32 v103, v103, v180
  v_add_f32 v104, v104, v180
  v_add_f32 v105, v105, v180
  v_add_f32 v106, v106, v180
  v_add_f32 v107, v107, v180
  v_add_f32 v108, v108, v180
  v_add_f32 v109, v109, v180
  v_add_f32 v110, v110, v180
  v_add_f32 v111, v111, v180
  v_mul_f32 v144, v144, v181
  v_mul_f32 v145, v145, v181
  v_mul_f32 v146, v146, v181
  v_mul_f32 v147, v147, v181
  v_mul_f32 v148, v148, v181
  v_mul_f32 v149, v149, v181
  v_mul_f32 v150, v150, v181
  v_mul_f32 v151, v151, v181
  v_mul_f32 v152, v152, v181
  v_mul_f32 v153, v153, v181
  v_mul_f32 v154, v154, v181
  v_mul_f32 v155, v155, v181
  s_branch rb_22
rr_23:
  v_mov_b32 v177, v176
  s_nop 1
  v_permlane32_swap_b32 v176, v177
  v_max3_f32 v176, v176, v177, v29
  v_sub_f32 v177, v25, v176
  v_cvt_pk_bf16_f32 v178, v177, v177
  v_lshlrev_b32 v178, 16, v178
  v_sub_f32 v179, v177, v178
  v_cvt_pk_bf16_f32 v179, v177, v179
  v_and_b32 v180, 0xffff0000, v179
  v_add_f32 v178, v178, v180
  v_sub_f32 v180, v178, v25
  v_mov_b32 v25, v178
  v_min_f32 v181, 0, v180
  v_exp_f32 v181, v181
  s_mov_b32 exec_lo, 0
  v_mov_b32 v20, v179
  s_mov_b32 exec_lo, -1
  v_mov_b32 v27, 0x41000000
  v_mov_b32 v29, 0
  v_add_f32 v112, v112, v180
  v_add_f32 v113, v113, v180
  v_add_f32 v114, v114, v180
  v_add_f32 v115, v115, v180
  v_add_f32 v116, v116, v180
  v_add_f32 v117, v117, v180
  v_add_f32 v118, v118, v180
  v_add_f32 v119, v119, v180
  v_add_f32 v120, v120, v180
  v_add_f32 v121, v121, v180
  v_add_f32 v122, v122, v180
  v_add_f32 v123, v123, v180
  v_add_f32 v124, v124, v180
  v_add_f32 v125, v125, v180
  v_add_f32 v126, v126, v180
  v_add_f32 v127, v127, v180
  v_mul_f32 v160, v160, v181
  v_mul_f32 v161, v161, v181
  v_mul_f32 v162, v162, v181
  v_mul_f32 v163, v163, v181
  v_mul_f32 v164, v164, v181
  v_mul_f32 v165, v165, v181
  v_mul_f32 v166, v166, v181
  v_mul_f32 v167, v167, v181
  v_mul_f32 v168, v168, v181
  v_mul_f32 v169, v169, v181
  v_mul_f32 v170, v170, v181
  v_mul_f32 v171, v171, v181
  s_branch rb_24
rr_25:
  v_mov_b32 v177, v176
  s_nop 1
  v_permlane32_swap_b32 v176, v177
  v_max3_f32 v176, v176, v177, v28
  v_sub_f32 v177, v24, v176
  v_cvt_pk_bf16_f32 v178, v177, v177
  v_lshlrev_b32 v178, 16, v178
  v_sub_f32 v179, v177, v178
  v_cvt_pk_bf16_f32 v179, v177, v179
  v_and_b32 v180, 0xffff0000, v179
  v_add_f32 v178, v178, v180
  v_sub_f32 v180, v178, v24
  v_mov_b32 v24, v178
  v_min_f32 v181, 0, v180
  v_exp_f32 v181, v181
  s_mov_b32 exec_lo, 0
  v_mov_b32 v12, v179
  s_mov_b32 exec_lo, -1
  v_mov_b32 v26, 0x41000000
  v_mov_b32 v28, 0
  v_add_f32 v96, v96, v180
  v_add_f32 v97, v97, v180
  v_add_f32 v98, v98, v180
  v_add_f32 v99, v99, v180
  v_add_f32 v100, v100, v180
  v_add_f32 v101, v101, v180
  v_add_f32 v102, v102, v180
  v_add_f32 v103, v103, v180
  v_add_f32 v104, v104, v180
  v_add_f32 v105, v105, v180
  v_add_f32 v106, v106, v180
  v_add_f32 v107, v107, v180
  v_add_f32 v108, v108, v180
  v_add_f32 v109, v109, v180
  v_add_f32 v110, v110, v180
  v_add_f32 v111, v111, v180
  v_mul_f32 v144, v144, v181
  v_mul_f32 v145, v145, v181
  v_mul_f32 v146, v146, v181
  v_mul_f32 v147, v147, v181
  v_mul_f32 v148, v148, v181
  v_mul_f32 v149, v149, v181
  v_mul_f32 v150, v150, v181
  v_mul_f32 v151, v151, v181
  v_mul_f32 v152, v152, v181
  v_mul_f32 v153, v153, v181
  v_mul_f32 v154, v154, v181
  v_mul_f32 v155, v155, v181
  s_branch rb_26
rr_27:
  v_mov_b32 v177, v176
  s_nop 1
  v_permlane32_swap_b32 v176, v177
  v_max3_f32 v176, v176, v177, v29
  v_sub_f32 v177, v25, v176
  v_cvt_pk_bf16_f32 v178, v177, v177
  v_lshlrev_b32 v178, 16, v178
  v_sub_f32 v179, v177, v178
  v_cvt_pk_bf16_f32 v179, v177, v179
  v_and_b32 v180, 0xffff0000, v179
  v_add_f32 v178, v178, v180
  v_sub_f32 v180, v178, v25
  v_mov_b32 v25, v178
  v_min_f32 v181, 0, v180
  v_exp_f32 v181, v181
  s_mov_b32 exec_lo, 0
  v_mov_b32 v20, v179
  s_mov_b32 exec_lo, -1
  v_mov_b32 v27, 0x41000000
  v_mov_b32 v29, 0
  v_add_f32 v112, v112, v180
  v_add_f32 v113, v113, v180
  v_add_f32 v114, v114, v180
  v_add_f32 v115, v115, v180
  v_add_f32 v116, v116, v180
  v_add_f32 v117, v117, v180
  v_add_f32 v118, v118, v180
  v_add_f32 v119, v119, v180
  v_add_f32 v120, v120, v180
  v_add_f32 v121, v121, v180
  v_add_f32 v122, v122, v180
  v_add_f32 v123, v123, v180
  v_add_f32 v124, v124, v180
  v_add_f32 v125, v125, v180
  v_add_f32 v126, v126, v180
  v_add_f32 v127, v127, v180
  v_mul_f32 v160, v160, v181
  v_mul_f32 v161, v161, v181
  v_mul_f32 v162, v162, v181
  v_mul_f32 v163, v163, v181
  v_mul_f32 v164, v164, v181
  v_mul_f32 v165, v165, v181
  v_mul_f32 v166, v166, v181
  v_mul_f32 v167, v167, v181
  v_mul_f32 v168, v168, v181
  v_mul_f32 v169, v169, v181
  v_mul_f32 v170, v170, v181
  v_mul_f32 v171, v171, v181
  s_branch rb_28
rr_29:
  v_mov_b32 v177, v176
  s_nop 1
  v_permlane32_swap_b32 v176, v177
  v_max3_f32 v176, v176, v177, v28
  v_sub_f32 v177, v24, v176
  v_cvt_pk_bf16_f32 v178, v177, v177
  v_lshlrev_b32 v178, 16, v178
  v_sub_f32 v179, v177, v178
  v_cvt_pk_bf16_f32 v179, v177, v179
  v_and_b32 v180, 0xffff0000, v179
  v_add_f32 v178, v178, v180
  v_sub_f32 v180, v178, v24
  v_mov_b32 v24, v178
  v_min_f32 v181, 0, v180
  v_exp_f32 v181, v181
  s_mov_b32 exec_lo, 0
  v_mov_b32 v12, v179
  s_mov_b32 exec_lo, -1
  v_mov_b32 v26, 0x41000000
  v_mov_b32 v28, 0
  v_add_f32 v96, v96, v180
  v_add_f32 v97, v97, v180
  v_add_f32 v98, v98, v180
  v_add_f32 v99, v99, v180
  v_add_f32 v100, v100, v180
  v_add_f32 v101, v101, v180
  v_add_f32 v102, v102, v180
  v_add_f32 v103, v103, v180
  v_add_f32 v104, v104, v180
  v_add_f32 v105, v105, v180
  v_add_f32 v106, v106, v180
  v_add_f32 v107, v107, v180
  v_add_f32 v108, v108, v180
  v_add_f32 v109, v109, v180
  v_add_f32 v110, v110, v180
  v_add_f32 v111, v111, v180
  v_mul_f32 v144, v144, v181
  v_mul_f32 v145, v145, v181
  v_mul_f32 v146, v146, v181
  v_mul_f32 v147, v147, v181
  v_mul_f32 v148, v148, v181
  v_mul_f32 v149, v149, v181
  v_mul_f32 v150, v150, v181
  v_mul_f32 v151, v151, v181
  v_mul_f32 v152, v152, v181
  v_mul_f32 v153, v153, v181
  v_mul_f32 v154, v154, v181
  v_mul_f32 v155, v155, v181
  s_branch rb_30
rr_31:
  v_mov_b32 v177, v176
  s_nop 1
  v_permlane32_swap_b32 v176, v177
  v_max3_f32 v176, v176, v177, v29
  v_sub_f32 v177, v25, v176
  v_cvt_pk_bf16_f32 v178, v177, v177
  v_lshlrev_b32 v178, 16, v178
  v_sub_f32 v179, v177, v178
  v_cvt_pk_bf16_f32 v179, v177, v179
  v_and_b32 v180, 0xffff0000, v179
  v_add_f32 v178, v178, v180
  v_sub_f32 v180, v178, v25
  v_mov_b32 v25, v178
  v_min_f32 v181, 0, v180
  v_exp_f32 v181, v181
  s_mov_b32 exec_lo, 0
  v_mov_b32 v20, v179
  s_mov_b32 exec_lo, -1
  v_mov_b32 v27, 0x41000000
  v_mov_b32 v29, 0
  v_add_f32 v112, v112, v180
  v_add_f32 v113, v113, v180
  v_add_f32 v114, v114, v180
  v_add_f32 v115, v115, v180
  v_add_f32 v116, v116, v180
  v_add_f32 v117, v117, v180
  v_add_f32 v118, v118, v180
  v_add_f32 v119, v119, v180
  v_add_f32 v120, v120, v180
  v_add_f32 v121, v121, v180
  v_add_f32 v122, v122, v180
  v_add_f32 v123, v123, v180
  v_add_f32 v124, v124, v180
  v_add_f32 v125, v125, v180
  v_add_f32 v126, v126, v180
  v_add_f32 v127, v127, v180
  v_mul_f32 v160, v160, v181
  v_mul_f32 v161, v161, v181
  v_mul_f32 v162, v162, v181
  v_mul_f32 v163, v163, v181
  v_mul_f32 v164, v164, v181
  v_mul_f32 v165, v165, v181
  v_mul_f32 v166, v166, v181
  v_mul_f32 v167, v167, v181
  v_mul_f32 v168, v168, v181
  v_mul_f32 v169, v169, v181
  v_mul_f32 v170, v170, v181
  v_mul_f32 v171, v171, v181
  s_branch rb_32
rr_33:
  v_mov_b32 v177, v176
  s_nop 1
  v_permlane32_swap_b32 v176, v177
  v_max3_f32 v176, v176, v177, v28
  v_sub_f32 v177, v24, v176
  v_cvt_pk_bf16_f32 v178, v177, v177
  v_lshlrev_b32 v178, 16, v178
  v_sub_f32 v179, v177, v178
  v_cvt_pk_bf16_f32 v179, v177, v179
  v_and_b32 v180, 0xffff0000, v179
  v_add_f32 v178, v178, v180
  v_sub_f32 v180, v178, v24
  v_mov_b32 v24, v178
  v_min_f32 v181, 0, v180
  v_exp_f32 v181, v181
  s_mov_b32 exec_lo, 0
  v_mov_b32 v12, v179
  s_mov_b32 exec_lo, -1
  v_mov_b32 v26, 0x41000000
  v_mov_b32 v28, 0
  v_add_f32 v96, v96, v180
  v_add_f32 v97, v97, v180
  v_add_f32 v98, v98, v180
  v_add_f32 v99, v99, v180
  v_add_f32 v100, v100, v180
  v_add_f32 v101, v101, v180
  v_add_f32 v102, v102, v180
  v_add_f32 v103, v103, v180
  v_add_f32 v104, v104, v180
  v_add_f32 v105, v105, v180
  v_add_f32 v106, v106, v180
  v_add_f32 v107, v107, v180
  v_add_f32 v108, v108, v180
  v_add_f32 v109, v109, v180
  v_add_f32 v110, v110, v180
  v_add_f32 v111, v111, v180
  v_mul_f32 v144, v144, v181
  v_mul_f32 v145, v145, v181
  v_mul_f32 v146, v146, v181
  v_mul_f32 v147, v147, v181
  v_mul_f32 v148, v148, v181
  v_mul_f32 v149, v149, v181
  v_mul_f32 v150, v150, v181
  v_mul_f32 v151, v151, v181
  v_mul_f32 v152, v152, v181
  v_mul_f32 v153, v153, v181
  v_mul_f32 v154, v154, v181
  v_mul_f32 v155, v155, v181
  s_branch rb_34
rr_35:
  v_mov_b32 v177, v176
  s_nop 1
  v_permlane32_swap_b32 v176, v177
  v_max3_f32 v176, v176, v177, v29
  v_sub_f32 v177, v25, v176
  v_cvt_pk_bf16_f32 v178, v177, v177
  v_lshlrev_b32 v178, 16, v178
  v_sub_f32 v179, v177, v178
  v_cvt_pk_bf16_f32 v179, v177, v179
  v_and_b32 v180, 0xffff0000, v179
  v_add_f32 v178, v178, v180
  v_sub_f32 v180, v178, v25
  v_mov_b32 v25, v178
  v_min_f32 v181, 0, v180
  v_exp_f32 v181, v181
  s_mov_b32 exec_lo, 0
  v_mov_b32 v20, v179
  s_mov_b32 exec_lo, -1
  v_mov_b32 v27, 0x41000000
  v_mov_b32 v29, 0
  v_add_f32 v112, v112, v180
  v_add_f32 v113, v113, v180
  v_add_f32 v114, v114, v180
  v_add_f32 v115, v115, v180
  v_add_f32 v116, v116, v180
  v_add_f32 v117, v117, v180
  v_add_f32 v118, v118, v180
  v_add_f32 v119, v119, v180
  v_add_f32 v120, v120, v180
  v_add_f32 v121, v121, v180
  v_add_f32 v122, v122, v180
  v_add_f32 v123, v123, v180
  v_add_f32 v124, v124, v180
  v_add_f32 v125, v125, v180
  v_add_f32 v126, v126, v180
  v_add_f32 v127, v127, v180
  v_mul_f32 v160, v160, v181
  v_mul_f32 v161, v161, v181
  v_mul_f32 v162, v162, v181
  v_mul_f32 v163, v163, v181
  v_mul_f32 v164, v164, v181
  v_mul_f32 v165, v165, v181
  v_mul_f32 v166, v166, v181
  v_mul_f32 v167, v167, v181
  v_mul_f32 v168, v168, v181
  v_mul_f32 v169, v169, v181
  v_mul_f32 v170, v170, v181
  v_mul_f32 v171, v171, v181
  s_branch rb_36
L_prep:
  v_lshlrev_b32 v4, 4, v1
  s_mul_i32 s80, s57, 5120
  s_mov_b32 s81, 52429
  s_add_u32 s82, s80, 0
  v_add_u32 v2, s82, v4
  v_lshrrev_b32 v3, 8, v2
  v_mul_lo_u32 v3, v3, s81
  v_lshrrev_b32 v8, 18, v3
  v_mul_u32_u24 v3, 1280, v8
  v_sub_u32 v16, v2, v3
  s_add_u32 s82, s80, 1024
  v_add_u32 v2, s82, v4
  v_lshrrev_b32 v3, 8, v2
  v_mul_lo_u32 v3, v3, s81
  v_lshrrev_b32 v9, 18, v3
  v_mul_u32_u24 v3, 1280, v9
  v_sub_u32 v17, v2, v3
  s_add_u32 s82, s80, 2048
  v_add_u32 v2, s82, v4
  v_lshrrev_b32 v3, 8, v2
  v_mul_lo_u32 v3, v3, s81
  v_lshrrev_b32 v10, 18, v3
  v_mul_u32_u24 v3, 1280, v10
  v_sub_u32 v18, v2, v3
  s_add_u32 s82, s80, 3072
  v_add_u32 v2, s82, v4
  v_lshrrev_b32 v3, 8, v2
  v_mul_lo_u32 v3, v3, s81
  v_lshrrev_b32 v11, 18, v3
  v_mul_u32_u24 v3, 1280, v11
  v_sub_u32 v19, v2, v3
  s_add_u32 s82, s80, 4096
  v_add_u32 v2, s82, v4
  v_lshrrev_b32 v3, 8, v2
  v_mul_lo_u32 v3, v3, s81
  v_lshrrev_b32 v12, 18, v3
  v_mul_u32_u24 v3, 1280, v12
  v_sub_u32 v20, v2, v3
  v_lshrrev_b32 v2, 5, v1
  v_lshlrev_b32 v2, 2, v2
  v_bfe_u32 v3, v1, 2, 2
  v_add_u32 v2, v2, v3
  v_mul_u32_u24 v2, 1280, v2
  v_bfe_u32 v3, v1, 4, 1
  v_lshlrev_b32 v3, 5, v3
  v_add_u32 v2, v2, v3
  v_and_b32 v3, 3, v1
  v_lshlrev_b32 v3, 3, v3
  s_mul_i32 s82, s57, 320
  v_add3_u32 v32, v2, v3, s82
  s_mov_b32 s48, s24
  s_mov_b32 s49, s25
  s_mov_b32 s50, 0x500000
  s_mov_b32 s51, 0x20000
  v_mul_u32_u24 v2, 1280, v8
  v_add_u32 v24, v2, v16
  v_mul_u32_u24 v2, 1280, v9
  v_add_u32 v25, v2, v17
  v_mul_u32_u24 v2, 1280, v10
  v_add_u32 v26, v2, v18
  v_mul_u32_u24 v2, 1280, v11
  v_add_u32 v27, v2, v19
  v_mul_u32_u24 v2, 1280, v12
  v_add_u32 v28, v2, v20
  s_add_u32 s82, s59, 0
  s_mul_i32 s82, s82, 20480
  s_add_u32 m0, s80, 0
  s_nop 0
  buffer_load_dwordx4 v24, s[48:51], s82 offen lds
  s_add_u32 m0, s80, 1024
  s_nop 0
  buffer_load_dwordx4 v25, s[48:51], s82 offen lds
  s_add_u32 m0, s80, 2048
  s_nop 0
  buffer_load_dwordx4 v26, s[48:51], s82 offen lds
  s_add_u32 m0, s80, 3072
  s_nop 0
  buffer_load_dwordx4 v27, s[48:51], s82 offen lds
  s_add_u32 m0, s80, 4096
  s_nop 0
  buffer_load_dwordx4 v28, s[48:51], s82 offen lds
  s_add_u32 s82, s59, 32
  s_mul_i32 s82, s82, 20480
  s_add_u32 m0, s80, 20480
  s_nop 0
  buffer_load_dwordx4 v24, s[48:51], s82 offen lds
  s_add_u32 m0, s80, 21504
  s_nop 0
  buffer_load_dwordx4 v25, s[48:51], s82 offen lds
  s_add_u32 m0, s80, 22528
  s_nop 0
  buffer_load_dwordx4 v26, s[48:51], s82 offen lds
  s_add_u32 m0, s80, 23552
  s_nop 0
  buffer_load_dwordx4 v27, s[48:51], s82 offen lds
  s_add_u32 m0, s80, 24576
  s_nop 0
  buffer_load_dwordx4 v28, s[48:51], s82 offen lds
  s_add_u32 s82, s59, 64
  s_mul_i32 s82, s82, 20480
  s_add_u32 m0, s80, 40960
  s_nop 0
  buffer_load_dwordx4 v24, s[48:51], s82 offen lds
  s_add_u32 m0, s80, 41984
  s_nop 0
  buffer_load_dwordx4 v25, s[48:51], s82 offen lds
  s_add_u32 m0, s80, 43008
  s_nop 0
  buffer_load_dwordx4 v26, s[48:51], s82 offen lds
  s_add_u32 m0, s80, 44032
  s_nop 0
  buffer_load_dwordx4 v27, s[48:51], s82 offen lds
  s_add_u32 m0, s80, 45056
  s_nop 0
  buffer_load_dwordx4 v28, s[48:51], s82 offen lds
  s_add_u32 s82, s59, 96
  s_mul_i32 s82, s82, 20480
  s_add_u32 m0, s80, 61440
  s_nop 0
  buffer_load_dwordx4 v24, s[48:51], s82 offen lds
  s_add_u32 m0, s80, 62464
  s_nop 0
  buffer_load_dwordx4 v25, s[48:51], s82 offen lds
  s_add_u32 m0, s80, 63488
  s_nop 0
  buffer_load_dwordx4 v26, s[48:51], s82 offen lds
  s_add_u32 m0, s80, 64512
  s_nop 0
  buffer_load_dwordx4 v27, s[48:51], s82 offen lds
  s_add_u32 m0, s80, 65536
  s_nop 0
  buffer_load_dwordx4 v28, s[48:51], s82 offen lds
  s_add_u32 s82, s59, 128
  s_mul_i32 s82, s82, 20480
  s_add_u32 m0, s80, 81920
  s_nop 0
  buffer_load_dwordx4 v24, s[48:51], s82 offen lds
  s_add_u32 m0, s80, 82944
  s_nop 0
  buffer_load_dwordx4 v25, s[48:51], s82 offen lds
  s_add_u32 m0, s80, 83968
  s_nop 0
  buffer_load_dwordx4 v26, s[48:51], s82 offen lds
  s_add_u32 m0, s80, 84992
  s_nop 0
  buffer_load_dwordx4 v27, s[48:51], s82 offen lds
  s_add_u32 m0, s80, 86016
  s_nop 0
  buffer_load_dwordx4 v28, s[48:51], s82 offen lds
  s_waitcnt vmcnt(0)
  s_barrier
  ds_read_b64_tr_b16 v[40:41], v32 offset:0
  ds_read_b64_tr_b16 v[42:43], v32 offset:10240
  ds_read_b64_tr_b16 v[44:45], v32 offset:64
  ds_read_b64_tr_b16 v[46:47], v32 offset:10304
  ds_read_b64_tr_b16 v[48:49], v32 offset:128
  ds_read_b64_tr_b16 v[50:51], v32 offset:10368
  ds_read_b64_tr_b16 v[52:53], v32 offset:192
  ds_read_b64_tr_b16 v[54:55], v32 offset:10432
  ds_read_b64_tr_b16 v[56:57], v32 offset:256
  ds_read_b64_tr_b16 v[58:59], v32 offset:10496
  ds_read_b64_tr_b16 v[60:61], v32 offset:20480
  ds_read_b64_tr_b16 v[62:63], v32 offset:30720
  ds_read_b64_tr_b16 v[64:65], v32 offset:20544
  ds_read_b64_tr_b16 v[66:67], v32 offset:30784
  ds_read_b64_tr_b16 v[68:69], v32 offset:20608
  ds_read_b64_tr_b16 v[70:71], v32 offset:30848
  ds_read_b64_tr_b16 v[72:73], v32 offset:20672
  ds_read_b64_tr_b16 v[74:75], v32 offset:30912
  ds_read_b64_tr_b16 v[76:77], v32 offset:20736
  ds_read_b64_tr_b16 v[78:79], v32 offset:30976
  ds_read_b64_tr_b16 v[80:81], v32 offset:40960
  ds_read_b64_tr_b16 v[82:83], v32 offset:51200
  ds_read_b64_tr_b16 v[84:85], v32 offset:41024
  ds_read_b64_tr_b16 v[86:87], v32 offset:51264
  ds_read_b64_tr_b16 v[88:89], v32 offset:41088
  ds_read_b64_tr_b16 v[90:91], v32 offset:51328
  ds_read_b64_tr_b16 v[92:93], v32 offset:41152
  ds_read_b64_tr_b16 v[94:95], v32 offset:51392
  ds_read_b64_tr_b16 v[96:97], v32 offset:41216
  ds_read_b64_tr_b16 v[98:99], v32 offset:51456
  v_add_u32 v33, 61440, v32
  ds_read_b64_tr_b16 v[100:101], v33 offset:0
  ds_read_b64_tr_b16 v[102:103], v33 offset:10240
  ds_read_b64_tr_b16 v[104:105], v33 offset:64
  ds_read_b64_tr_b16 v[106:107], v33 offset:10304
  ds_read_b64_tr_b16 v[108:109], v33 offset:128
  ds_read_b64_tr_b16 v[110:111], v33 offset:10368
  ds_read_b64_tr_b16 v[112:113], v33 offset:192
  ds_read_b64_tr_b16 v[114:115], v33 offset:10432
  ds_read_b64_tr_b16 v[116:117], v33 offset:256
  ds_read_b64_tr_b16 v[118:119], v33 offset:10496
  ds_read_b64_tr_b16 v[120:121], v33 offset:20480
  ds_read_b64_tr_b16 v[122:123], v33 offset:30720
  ds_read_b64_tr_b16 v[124:125], v33 offset:20544
  ds_read_b64_tr_b16 v[126:127], v33 offset:30784
  ds_read_b64_tr_b16 v[128:129], v33 offset:20608
  ds_read_b64_tr_b16 v[130:131], v33 offset:30848
  ds_read_b64_tr_b16 v[132:133], v33 offset:20672
  ds_read_b64_tr_b16 v[134:135], v33 offset:30912
  ds_read_b64_tr_b16 v[136:137], v33 offset:20736
  ds_read_b64_tr_b16 v[138:139], v33 offset:30976
  s_waitcnt lgkmcnt(0)
  s_barrier
  s_mul_i32 s82, s57, 5
  s_add_u32 s82, s82, 0
  s_lshr_b32 s83, s82, 2
  s_mul_i32 s83, s83, 296
  s_add_u32 s83, s83, s59
  s_add_u32 s83, s83, 0
  s_lshl_b32 s83, s83, 2
  s_and_b32 s82, s82, 3
  s_add_u32 s83, s83, s82
  s_lshl_b32 s83, s83, 10
  s_add_u32 s83, s83, 93323264
  buffer_store_dwordx4 v[40:43], v4, s[36:39], s83 offen sc1
  s_mul_i32 s82, s57, 5
  s_add_u32 s82, s82, 1
  s_lshr_b32 s83, s82, 2
  s_mul_i32 s83, s83, 296
  s_add_u32 s83, s83, s59
  s_add_u32 s83, s83, 0
  s_lshl_b32 s83, s83, 2
  s_and_b32 s82, s82, 3
  s_add_u32 s83, s83, s82
  s_lshl_b32 s83, s83, 10
  s_add_u32 s83, s83, 93323264
  buffer_store_dwordx4 v[44:47], v4, s[36:39], s83 offen sc1
  s_mul_i32 s82, s57, 5
  s_add_u32 s82, s82, 2
  s_lshr_b32 s83, s82, 2
  s_mul_i32 s83, s83, 296
  s_add_u32 s83, s83, s59
  s_add_u32 s83, s83, 0
  s_lshl_b32 s83, s83, 2
  s_and_b32 s82, s82, 3
  s_add_u32 s83, s83, s82
  s_lshl_b32 s83, s83, 10
  s_add_u32 s83, s83, 93323264
  buffer_store_dwordx4 v[48:51], v4, s[36:39], s83 offen sc1
  s_mul_i32 s82, s57, 5
  s_add_u32 s82, s82, 3
  s_lshr_b32 s83, s82, 2
  s_mul_i32 s83, s83, 296
  s_add_u32 s83, s83, s59
  s_add_u32 s83, s83, 0
  s_lshl_b32 s83, s83, 2
  s_and_b32 s82, s82, 3
  s_add_u32 s83, s83, s82
  s_lshl_b32 s83, s83, 10
  s_add_u32 s83, s83, 93323264
  buffer_store_dwordx4 v[52:55], v4, s[36:39], s83 offen sc1
  s_mul_i32 s82, s57, 5
  s_add_u32 s82, s82, 4
  s_lshr_b32 s83, s82, 2
  s_mul_i32 s83, s83, 296
  s_add_u32 s83, s83, s59
  s_add_u32 s83, s83, 0
  s_lshl_b32 s83, s83, 2
  s_and_b32 s82, s82, 3
  s_add_u32 s83, s83, s82
  s_lshl_b32 s83, s83, 10
  s_add_u32 s83, s83, 93323264
  buffer_store_dwordx4 v[56:59], v4, s[36:39], s83 offen sc1
  s_mul_i32 s82, s57, 5
  s_add_u32 s82, s82, 0
  s_lshr_b32 s83, s82, 2
  s_mul_i32 s83, s83, 296
  s_add_u32 s83, s83, s59
  s_add_u32 s83, s83, 32
  s_lshl_b32 s83, s83, 2
  s_and_b32 s82, s82, 3
  s_add_u32 s83, s83, s82
  s_lshl_b32 s83, s83, 10
  s_add_u32 s83, s83, 93323264
  buffer_store_dwordx4 v[60:63], v4, s[36:39], s83 offen sc1
  s_mul_i32 s82, s57, 5
  s_add_u32 s82, s82, 1
  s_lshr_b32 s83, s82, 2
  s_mul_i32 s83, s83, 296
  s_add_u32 s83, s83, s59
  s_add_u32 s83, s83, 32
  s_lshl_b32 s83, s83, 2
  s_and_b32 s82, s82, 3
  s_add_u32 s83, s83, s82
  s_lshl_b32 s83, s83, 10
  s_add_u32 s83, s83, 93323264
  buffer_store_dwordx4 v[64:67], v4, s[36:39], s83 offen sc1
  s_mul_i32 s82, s57, 5
  s_add_u32 s82, s82, 2
  s_lshr_b32 s83, s82, 2
  s_mul_i32 s83, s83, 296
  s_add_u32 s83, s83, s59
  s_add_u32 s83, s83, 32
  s_lshl_b32 s83, s83, 2
  s_and_b32 s82, s82, 3
  s_add_u32 s83, s83, s82
  s_lshl_b32 s83, s83, 10
  s_add_u32 s83, s83, 93323264
  buffer_store_dwordx4 v[68:71], v4, s[36:39], s83 offen sc1
  s_mul_i32 s82, s57, 5
  s_add_u32 s82, s82, 3
  s_lshr_b32 s83, s82, 2
  s_mul_i32 s83, s83, 296
  s_add_u32 s83, s83, s59
  s_add_u32 s83, s83, 32
  s_lshl_b32 s83, s83, 2
  s_and_b32 s82, s82, 3
  s_add_u32 s83, s83, s82
  s_lshl_b32 s83, s83, 10
  s_add_u32 s83, s83, 93323264
  buffer_store_dwordx4 v[72:75], v4, s[36:39], s83 offen sc1
  s_mul_i32 s82, s57, 5
  s_add_u32 s82, s82, 4
  s_lshr_b32 s83, s82, 2
  s_mul_i32 s83, s83, 296
  s_add_u32 s83, s83, s59
  s_add_u32 s83, s83, 32
  s_lshl_b32 s83, s83, 2
  s_and_b32 s82, s82, 3
  s_add_u32 s83, s83, s82
  s_lshl_b32 s83, s83, 10
  s_add_u32 s83, s83, 93323264
  buffer_store_dwordx4 v[76:79], v4, s[36:39], s83 offen sc1
  s_mul_i32 s82, s57, 5
  s_add_u32 s82, s82, 0
  s_lshr_b32 s83, s82, 2
  s_mul_i32 s83, s83, 296
  s_add_u32 s83, s83, s59
  s_add_u32 s83, s83, 64
  s_lshl_b32 s83, s83, 2
  s_and_b32 s82, s82, 3
  s_add_u32 s83, s83, s82
  s_lshl_b32 s83, s83, 10
  s_add_u32 s83, s83, 93323264
  buffer_store_dwordx4 v[80:83], v4, s[36:39], s83 offen sc1
  s_mul_i32 s82, s57, 5
  s_add_u32 s82, s82, 1
  s_lshr_b32 s83, s82, 2
  s_mul_i32 s83, s83, 296
  s_add_u32 s83, s83, s59
  s_add_u32 s83, s83, 64
  s_lshl_b32 s83, s83, 2
  s_and_b32 s82, s82, 3
  s_add_u32 s83, s83, s82
  s_lshl_b32 s83, s83, 10
  s_add_u32 s83, s83, 93323264
  buffer_store_dwordx4 v[84:87], v4, s[36:39], s83 offen sc1
  s_mul_i32 s82, s57, 5
  s_add_u32 s82, s82, 2
  s_lshr_b32 s83, s82, 2
  s_mul_i32 s83, s83, 296
  s_add_u32 s83, s83, s59
  s_add_u32 s83, s83, 64
  s_lshl_b32 s83, s83, 2
  s_and_b32 s82, s82, 3
  s_add_u32 s83, s83, s82
  s_lshl_b32 s83, s83, 10
  s_add_u32 s83, s83, 93323264
  buffer_store_dwordx4 v[88:91], v4, s[36:39], s83 offen sc1
  s_mul_i32 s82, s57, 5
  s_add_u32 s82, s82, 3
  s_lshr_b32 s83, s82, 2
  s_mul_i32 s83, s83, 296
  s_add_u32 s83, s83, s59
  s_add_u32 s83, s83, 64
  s_lshl_b32 s83, s83, 2
  s_and_b32 s82, s82, 3
  s_add_u32 s83, s83, s82
  s_lshl_b32 s83, s83, 10
  s_add_u32 s83, s83, 93323264
  buffer_store_dwordx4 v[92:95], v4, s[36:39], s83 offen sc1
  s_mul_i32 s82, s57, 5
  s_add_u32 s82, s82, 4
  s_lshr_b32 s83, s82, 2
  s_mul_i32 s83, s83, 296
  s_add_u32 s83, s83, s59
  s_add_u32 s83, s83, 64
  s_lshl_b32 s83, s83, 2
  s_and_b32 s82, s82, 3
  s_add_u32 s83, s83, s82
  s_lshl_b32 s83, s83, 10
  s_add_u32 s83, s83, 93323264
  buffer_store_dwordx4 v[96:99], v4, s[36:39], s83 offen sc1
  s_mul_i32 s82, s57, 5
  s_add_u32 s82, s82, 0
  s_lshr_b32 s83, s82, 2
  s_mul_i32 s83, s83, 296
  s_add_u32 s83, s83, s59
  s_add_u32 s83, s83, 96
  s_lshl_b32 s83, s83, 2
  s_and_b32 s82, s82, 3
  s_add_u32 s83, s83, s82
  s_lshl_b32 s83, s83, 10
  s_add_u32 s83, s83, 93323264
  buffer_store_dwordx4 v[100:103], v4, s[36:39], s83 offen sc1
  s_mul_i32 s82, s57, 5
  s_add_u32 s82, s82, 1
  s_lshr_b32 s83, s82, 2
  s_mul_i32 s83, s83, 296
  s_add_u32 s83, s83, s59
  s_add_u32 s83, s83, 96
  s_lshl_b32 s83, s83, 2
  s_and_b32 s82, s82, 3
  s_add_u32 s83, s83, s82
  s_lshl_b32 s83, s83, 10
  s_add_u32 s83, s83, 93323264
  buffer_store_dwordx4 v[104:107], v4, s[36:39], s83 offen sc1
  s_mul_i32 s82, s57, 5
  s_add_u32 s82, s82, 2
  s_lshr_b32 s83, s82, 2
  s_mul_i32 s83, s83, 296
  s_add_u32 s83, s83, s59
  s_add_u32 s83, s83, 96
  s_lshl_b32 s83, s83, 2
  s_and_b32 s82, s82, 3
  s_add_u32 s83, s83, s82
  s_lshl_b32 s83, s83, 10
  s_add_u32 s83, s83, 93323264
  buffer_store_dwordx4 v[108:111], v4, s[36:39], s83 offen sc1
  s_mul_i32 s82, s57, 5
  s_add_u32 s82, s82, 3
  s_lshr_b32 s83, s82, 2
  s_mul_i32 s83, s83, 296
  s_add_u32 s83, s83, s59
  s_add_u32 s83, s83, 96
  s_lshl_b32 s83, s83, 2
  s_and_b32 s82, s82, 3
  s_add_u32 s83, s83, s82
  s_lshl_b32 s83, s83, 10
  s_add_u32 s83, s83, 93323264
  buffer_store_dwordx4 v[112:115], v4, s[36:39], s83 offen sc1
  s_mul_i32 s82, s57, 5
  s_add_u32 s82, s82, 4
  s_lshr_b32 s83, s82, 2
  s_mul_i32 s83, s83, 296
  s_add_u32 s83, s83, s59
  s_add_u32 s83, s83, 96
  s_lshl_b32 s83, s83, 2
  s_and_b32 s82, s82, 3
  s_add_u32 s83, s83, s82
  s_lshl_b32 s83, s83, 10
  s_add_u32 s83, s83, 93323264
  buffer_store_dwordx4 v[116:119], v4, s[36:39], s83 offen sc1
  s_mul_i32 s82, s57, 5
  s_add_u32 s82, s82, 0
  s_lshr_b32 s83, s82, 2
  s_mul_i32 s83, s83, 296
  s_add_u32 s83, s83, s59
  s_add_u32 s83, s83, 128
  s_lshl_b32 s83, s83, 2
  s_and_b32 s82, s82, 3
  s_add_u32 s83, s83, s82
  s_lshl_b32 s83, s83, 10
  s_add_u32 s83, s83, 93323264
  buffer_store_dwordx4 v[120:123], v4, s[36:39], s83 offen sc1
  s_mul_i32 s82, s57, 5
  s_add_u32 s82, s82, 1
  s_lshr_b32 s83, s82, 2
  s_mul_i32 s83, s83, 296
  s_add_u32 s83, s83, s59
  s_add_u32 s83, s83, 128
  s_lshl_b32 s83, s83, 2
  s_and_b32 s82, s82, 3
  s_add_u32 s83, s83, s82
  s_lshl_b32 s83, s83, 10
  s_add_u32 s83, s83, 93323264
  buffer_store_dwordx4 v[124:127], v4, s[36:39], s83 offen sc1
  s_mul_i32 s82, s57, 5
  s_add_u32 s82, s82, 2
  s_lshr_b32 s83, s82, 2
  s_mul_i32 s83, s83, 296
  s_add_u32 s83, s83, s59
  s_add_u32 s83, s83, 128
  s_lshl_b32 s83, s83, 2
  s_and_b32 s82, s82, 3
  s_add_u32 s83, s83, s82
  s_lshl_b32 s83, s83, 10
  s_add_u32 s83, s83, 93323264
  buffer_store_dwordx4 v[128:131], v4, s[36:39], s83 offen sc1
  s_mul_i32 s82, s57, 5
  s_add_u32 s82, s82, 3
  s_lshr_b32 s83, s82, 2
  s_mul_i32 s83, s83, 296
  s_add_u32 s83, s83, s59
  s_add_u32 s83, s83, 128
  s_lshl_b32 s83, s83, 2
  s_and_b32 s82, s82, 3
  s_add_u32 s83, s83, s82
  s_lshl_b32 s83, s83, 10
  s_add_u32 s83, s83, 93323264
  buffer_store_dwordx4 v[132:135], v4, s[36:39], s83 offen sc1
  s_mul_i32 s82, s57, 5
  s_add_u32 s82, s82, 4
  s_lshr_b32 s83, s82, 2
  s_mul_i32 s83, s83, 296
  s_add_u32 s83, s83, s59
  s_add_u32 s83, s83, 128
  s_lshl_b32 s83, s83, 2
  s_and_b32 s82, s82, 3
  s_add_u32 s83, s83, s82
  s_lshl_b32 s83, s83, 10
  s_add_u32 s83, s83, 93323264
  buffer_store_dwordx4 v[136:139], v4, s[36:39], s83 offen sc1
  s_add_u32 s82, s59, 160
  s_mul_i32 s82, s82, 20480
  s_add_u32 m0, s80, 0
  s_nop 0
  buffer_load_dwordx4 v24, s[48:51], s82 offen lds
  s_add_u32 m0, s80, 1024
  s_nop 0
  buffer_load_dwordx4 v25, s[48:51], s82 offen lds
  s_add_u32 m0, s80, 2048
  s_nop 0
  buffer_load_dwordx4 v26, s[48:51], s82 offen lds
  s_add_u32 m0, s80, 3072
  s_nop 0
  buffer_load_dwordx4 v27, s[48:51], s82 offen lds
  s_add_u32 m0, s80, 4096
  s_nop 0
  buffer_load_dwordx4 v28, s[48:51], s82 offen lds
  s_add_u32 s82, s59, 192
  s_mul_i32 s82, s82, 20480
  s_add_u32 m0, s80, 20480
  s_nop 0
  buffer_load_dwordx4 v24, s[48:51], s82 offen lds
  s_add_u32 m0, s80, 21504
  s_nop 0
  buffer_load_dwordx4 v25, s[48:51], s82 offen lds
  s_add_u32 m0, s80, 22528
  s_nop 0
  buffer_load_dwordx4 v26, s[48:51], s82 offen lds
  s_add_u32 m0, s80, 23552
  s_nop 0
  buffer_load_dwordx4 v27, s[48:51], s82 offen lds
  s_add_u32 m0, s80, 24576
  s_nop 0
  buffer_load_dwordx4 v28, s[48:51], s82 offen lds
  s_add_u32 s82, s59, 224
  s_mul_i32 s82, s82, 20480
  s_add_u32 m0, s80, 40960
  s_nop 0
  buffer_load_dwordx4 v24, s[48:51], s82 offen lds
  s_add_u32 m0, s80, 41984
  s_nop 0
  buffer_load_dwordx4 v25, s[48:51], s82 offen lds
  s_add_u32 m0, s80, 43008
  s_nop 0
  buffer_load_dwordx4 v26, s[48:51], s82 offen lds
  s_add_u32 m0, s80, 44032
  s_nop 0
  buffer_load_dwordx4 v27, s[48:51], s82 offen lds
  s_add_u32 m0, s80, 45056
  s_nop 0
  buffer_load_dwordx4 v28, s[48:51], s82 offen lds
  s_mov_b32 s48, s12
  s_mov_b32 s49, s13
  s_mov_b32 s50, 0xc8000
  s_mov_b32 s51, 0x20000
  s_mul_i32 s82, s59, 25600
  s_add_u32 m0, s80, 61440
  s_nop 0
  buffer_load_dwordx4 v24, s[48:51], s82 offen lds
  s_add_u32 m0, s80, 62464
  s_nop 0
  buffer_load_dwordx4 v25, s[48:51], s82 offen lds
  s_add_u32 m0, s80, 63488
  s_nop 0
  buffer_load_dwordx4 v26, s[48:51], s82 offen lds
  s_add_u32 m0, s80, 64512
  s_nop 0
  buffer_load_dwordx4 v27, s[48:51], s82 offen lds
  s_add_u32 m0, s80, 65536
  s_nop 0
  buffer_load_dwordx4 v28, s[48:51], s82 offen lds
  v_and_b32 v2, 3, v8
  v_bfe_u32 v3, v8, 2, 1
  v_mad_u32_u24 v2, v3, 40, v2
  v_lshrrev_b32 v3, 3, v8
  v_mad_u32_u24 v2, v3, 20, v2
  v_mul_u32_u24 v2, 1280, v2
  v_add_u32 v24, v2, v16
  v_and_b32 v2, 3, v9
  v_bfe_u32 v3, v9, 2, 1
  v_mad_u32_u24 v2, v3, 40, v2
  v_lshrrev_b32 v3, 3, v9
  v_mad_u32_u24 v2, v3, 20, v2
  v_mul_u32_u24 v2, 1280, v2
  v_add_u32 v25, v2, v17
  v_and_b32 v2, 3, v10
  v_bfe_u32 v3, v10, 2, 1
  v_mad_u32_u24 v2, v3, 40, v2
  v_lshrrev_b32 v3, 3, v10
  v_mad_u32_u24 v2, v3, 20, v2
  v_mul_u32_u24 v2, 1280, v2
  v_add_u32 v26, v2, v18
  v_and_b32 v2, 3, v11
  v_bfe_u32 v3, v11, 2, 1
  v_mad_u32_u24 v2, v3, 40, v2
  v_lshrrev_b32 v3, 3, v11
  v_mad_u32_u24 v2, v3, 20, v2
  v_mul_u32_u24 v2, 1280, v2
  v_add_u32 v27, v2, v19
  v_and_b32 v2, 3, v12
  v_bfe_u32 v3, v12, 2, 1
  v_mad_u32_u24 v2, v3, 40, v2
  v_lshrrev_b32 v3, 3, v12
  v_mad_u32_u24 v2, v3, 20, v2
  v_mul_u32_u24 v2, 1280, v2
  v_add_u32 v28, v2, v20
  s_and_b32 s82, s59, 7
  s_mul_i32 s82, s82, 102400
  s_add_u32 s82, s82, 20480
  s_add_u32 m0, s80, 81920
  s_nop 0
  buffer_load_dwordx4 v24, s[48:51], s82 offen lds
  s_add_u32 m0, s80, 82944
  s_nop 0
  buffer_load_dwordx4 v25, s[48:51], s82 offen lds
  s_add_u32 m0, s80, 83968
  s_nop 0
  buffer_load_dwordx4 v26, s[48:51], s82 offen lds
  s_add_u32 m0, s80, 84992
  s_nop 0
  buffer_load_dwordx4 v27, s[48:51], s82 offen lds
  s_add_u32 m0, s80, 86016
  s_nop 0
  buffer_load_dwordx4 v28, s[48:51], s82 offen lds
  s_waitcnt vmcnt(0)
  s_barrier
  ds_read_b64_tr_b16 v[40:41], v32 offset:0
  ds_read_b64_tr_b16 v[42:43], v32 offset:10240
  ds_read_b64_tr_b16 v[44:45], v32 offset:64
  ds_read_b64_tr_b16 v[46:47], v32 offset:10304
  ds_read_b64_tr_b16 v[48:49], v32 offset:128
  ds_read_b64_tr_b16 v[50:51], v32 offset:10368
  ds_read_b64_tr_b16 v[52:53], v32 offset:192
  ds_read_b64_tr_b16 v[54:55], v32 offset:10432
  ds_read_b64_tr_b16 v[56:57], v32 offset:256
  ds_read_b64_tr_b16 v[58:59], v32 offset:10496
  ds_read_b64_tr_b16 v[60:61], v32 offset:20480
  ds_read_b64_tr_b16 v[62:63], v32 offset:30720
  ds_read_b64_tr_b16 v[64:65], v32 offset:20544
  ds_read_b64_tr_b16 v[66:67], v32 offset:30784
  ds_read_b64_tr_b16 v[68:69], v32 offset:20608
  ds_read_b64_tr_b16 v[70:71], v32 offset:30848
  ds_read_b64_tr_b16 v[72:73], v32 offset:20672
  ds_read_b64_tr_b16 v[74:75], v32 offset:30912
  ds_read_b64_tr_b16 v[76:77], v32 offset:20736
  ds_read_b64_tr_b16 v[78:79], v32 offset:30976
  ds_read_b64_tr_b16 v[80:81], v32 offset:40960
  ds_read_b64_tr_b16 v[82:83], v32 offset:51200
  ds_read_b64_tr_b16 v[84:85], v32 offset:41024
  ds_read_b64_tr_b16 v[86:87], v32 offset:51264
  ds_read_b64_tr_b16 v[88:89], v32 offset:41088
  ds_read_b64_tr_b16 v[90:91], v32 offset:51328
  ds_read_b64_tr_b16 v[92:93], v32 offset:41152
  ds_read_b64_tr_b16 v[94:95], v32 offset:51392
  ds_read_b64_tr_b16 v[96:97], v32 offset:41216
  ds_read_b64_tr_b16 v[98:99], v32 offset:51456
  v_add_u32 v33, 61440, v32
  ds_read_b64_tr_b16 v[100:101], v33 offset:0
  ds_read_b64_tr_b16 v[102:103], v33 offset:10240
  ds_read_b64_tr_b16 v[104:105], v33 offset:64
  ds_read_b64_tr_b16 v[106:107], v33 offset:10304
  ds_read_b64_tr_b16 v[108:109], v33 offset:128
  ds_read_b64_tr_b16 v[110:111], v33 offset:10368
  ds_read_b64_tr_b16 v[112:113], v33 offset:192
  ds_read_b64_tr_b16 v[114:115], v33 offset:10432
  ds_read_b64_tr_b16 v[116:117], v33 offset:256
  ds_read_b64_tr_b16 v[118:119], v33 offset:10496
  ds_read_b64_tr_b16 v[120:121], v33 offset:20480
  ds_read_b64_tr_b16 v[122:123], v33 offset:30720
  ds_read_b64_tr_b16 v[124:125], v33 offset:20544
  ds_read_b64_tr_b16 v[126:127], v33 offset:30784
  ds_read_b64_tr_b16 v[128:129], v33 offset:20608
  ds_read_b64_tr_b16 v[130:131], v33 offset:30848
  ds_read_b64_tr_b16 v[132:133], v33 offset:20672
  ds_read_b64_tr_b16 v[134:135], v33 offset:30912
  ds_read_b64_tr_b16 v[136:137], v33 offset:20736
  ds_read_b64_tr_b16 v[138:139], v33 offset:30976
  s_waitcnt lgkmcnt(0)
  s_barrier
  s_mul_i32 s82, s57, 5
  s_add_u32 s82, s82, 0
  s_lshr_b32 s83, s82, 2
  s_mul_i32 s83, s83, 296
  s_add_u32 s83, s83, s59
  s_add_u32 s83, s83, 160
  s_lshl_b32 s83, s83, 2
  s_and_b32 s82, s82, 3
  s_add_u32 s83, s83, s82
  s_lshl_b32 s83, s83, 10
  s_add_u32 s83, s83, 93323264
  buffer_store_dwordx4 v[40:43], v4, s[36:39], s83 offen sc1
  s_mul_i32 s82, s57, 5
  s_add_u32 s82, s82, 1
  s_lshr_b32 s83, s82, 2
  s_mul_i32 s83, s83, 296
  s_add_u32 s83, s83, s59
  s_add_u32 s83, s83, 160
  s_lshl_b32 s83, s83, 2
  s_and_b32 s82, s82, 3
  s_add_u32 s83, s83, s82
  s_lshl_b32 s83, s83, 10
  s_add_u32 s83, s83, 93323264
  buffer_store_dwordx4 v[44:47], v4, s[36:39], s83 offen sc1
  s_mul_i32 s82, s57, 5
  s_add_u32 s82, s82, 2
  s_lshr_b32 s83, s82, 2
  s_mul_i32 s83, s83, 296
  s_add_u32 s83, s83, s59
  s_add_u32 s83, s83, 160
  s_lshl_b32 s83, s83, 2
  s_and_b32 s82, s82, 3
  s_add_u32 s83, s83, s82
  s_lshl_b32 s83, s83, 10
  s_add_u32 s83, s83, 93323264
  buffer_store_dwordx4 v[48:51], v4, s[36:39], s83 offen sc1
  s_mul_i32 s82, s57, 5
  s_add_u32 s82, s82, 3
  s_lshr_b32 s83, s82, 2
  s_mul_i32 s83, s83, 296
  s_add_u32 s83, s83, s59
  s_add_u32 s83, s83, 160
  s_lshl_b32 s83, s83, 2
  s_and_b32 s82, s82, 3
  s_add_u32 s83, s83, s82
  s_lshl_b32 s83, s83, 10
  s_add_u32 s83, s83, 93323264
  buffer_store_dwordx4 v[52:55], v4, s[36:39], s83 offen sc1
  s_mul_i32 s82, s57, 5
  s_add_u32 s82, s82, 4
  s_lshr_b32 s83, s82, 2
  s_mul_i32 s83, s83, 296
  s_add_u32 s83, s83, s59
  s_add_u32 s83, s83, 160
  s_lshl_b32 s83, s83, 2
  s_and_b32 s82, s82, 3
  s_add_u32 s83, s83, s82
  s_lshl_b32 s83, s83, 10
  s_add_u32 s83, s83, 93323264
  buffer_store_dwordx4 v[56:59], v4, s[36:39], s83 offen sc1
  s_mul_i32 s82, s57, 5
  s_add_u32 s82, s82, 0
  s_lshr_b32 s83, s82, 2
  s_mul_i32 s83, s83, 296
  s_add_u32 s83, s83, s59
  s_add_u32 s83, s83, 192
  s_lshl_b32 s83, s83, 2
  s_and_b32 s82, s82, 3
  s_add_u32 s83, s83, s82
  s_lshl_b32 s83, s83, 10
  s_add_u32 s83, s83, 93323264
  buffer_store_dwordx4 v[60:63], v4, s[36:39], s83 offen sc1
  s_mul_i32 s82, s57, 5
  s_add_u32 s82, s82, 1
  s_lshr_b32 s83, s82, 2
  s_mul_i32 s83, s83, 296
  s_add_u32 s83, s83, s59
  s_add_u32 s83, s83, 192
  s_lshl_b32 s83, s83, 2
  s_and_b32 s82, s82, 3
  s_add_u32 s83, s83, s82
  s_lshl_b32 s83, s83, 10
  s_add_u32 s83, s83, 93323264
  buffer_store_dwordx4 v[64:67], v4, s[36:39], s83 offen sc1
  s_mul_i32 s82, s57, 5
  s_add_u32 s82, s82, 2
  s_lshr_b32 s83, s82, 2
  s_mul_i32 s83, s83, 296
  s_add_u32 s83, s83, s59
  s_add_u32 s83, s83, 192
  s_lshl_b32 s83, s83, 2
  s_and_b32 s82, s82, 3
  s_add_u32 s83, s83, s82
  s_lshl_b32 s83, s83, 10
  s_add_u32 s83, s83, 93323264
  buffer_store_dwordx4 v[68:71], v4, s[36:39], s83 offen sc1
  s_mul_i32 s82, s57, 5
  s_add_u32 s82, s82, 3
  s_lshr_b32 s83, s82, 2
  s_mul_i32 s83, s83, 296
  s_add_u32 s83, s83, s59
  s_add_u32 s83, s83, 192
  s_lshl_b32 s83, s83, 2
  s_and_b32 s82, s82, 3
  s_add_u32 s83, s83, s82
  s_lshl_b32 s83, s83, 10
  s_add_u32 s83, s83, 93323264
  buffer_store_dwordx4 v[72:75], v4, s[36:39], s83 offen sc1
  s_mul_i32 s82, s57, 5
  s_add_u32 s82, s82, 4
  s_lshr_b32 s83, s82, 2
  s_mul_i32 s83, s83, 296
  s_add_u32 s83, s83, s59
  s_add_u32 s83, s83, 192
  s_lshl_b32 s83, s83, 2
  s_and_b32 s82, s82, 3
  s_add_u32 s83, s83, s82
  s_lshl_b32 s83, s83, 10
  s_add_u32 s83, s83, 93323264
  buffer_store_dwordx4 v[76:79], v4, s[36:39], s83 offen sc1
  s_mul_i32 s82, s57, 5
  s_add_u32 s82, s82, 0
  s_lshr_b32 s83, s82, 2
  s_mul_i32 s83, s83, 296
  s_add_u32 s83, s83, s59
  s_add_u32 s83, s83, 224
  s_lshl_b32 s83, s83, 2
  s_and_b32 s82, s82, 3
  s_add_u32 s83, s83, s82
  s_lshl_b32 s83, s83, 10
  s_add_u32 s83, s83, 93323264
  buffer_store_dwordx4 v[80:83], v4, s[36:39], s83 offen sc1
  s_mul_i32 s82, s57, 5
  s_add_u32 s82, s82, 1
  s_lshr_b32 s83, s82, 2
  s_mul_i32 s83, s83, 296
  s_add_u32 s83, s83, s59
  s_add_u32 s83, s83, 224
  s_lshl_b32 s83, s83, 2
  s_and_b32 s82, s82, 3
  s_add_u32 s83, s83, s82
  s_lshl_b32 s83, s83, 10
  s_add_u32 s83, s83, 93323264
  buffer_store_dwordx4 v[84:87], v4, s[36:39], s83 offen sc1
  s_mul_i32 s82, s57, 5
  s_add_u32 s82, s82, 2
  s_lshr_b32 s83, s82, 2
  s_mul_i32 s83, s83, 296
  s_add_u32 s83, s83, s59
  s_add_u32 s83, s83, 224
  s_lshl_b32 s83, s83, 2
  s_and_b32 s82, s82, 3
  s_add_u32 s83, s83, s82
  s_lshl_b32 s83, s83, 10
  s_add_u32 s83, s83, 93323264
  buffer_store_dwordx4 v[88:91], v4, s[36:39], s83 offen sc1
  s_mul_i32 s82, s57, 5
  s_add_u32 s82, s82, 3
  s_lshr_b32 s83, s82, 2
  s_mul_i32 s83, s83, 296
  s_add_u32 s83, s83, s59
  s_add_u32 s83, s83, 224
  s_lshl_b32 s83, s83, 2
  s_and_b32 s82, s82, 3
  s_add_u32 s83, s83, s82
  s_lshl_b32 s83, s83, 10
  s_add_u32 s83, s83, 93323264
  buffer_store_dwordx4 v[92:95], v4, s[36:39], s83 offen sc1
  s_mul_i32 s82, s57, 5
  s_add_u32 s82, s82, 4
  s_lshr_b32 s83, s82, 2
  s_mul_i32 s83, s83, 296
  s_add_u32 s83, s83, s59
  s_add_u32 s83, s83, 224
  s_lshl_b32 s83, s83, 2
  s_and_b32 s82, s82, 3
  s_add_u32 s83, s83, s82
  s_lshl_b32 s83, s83, 10
  s_add_u32 s83, s83, 93323264
  buffer_store_dwordx4 v[96:99], v4, s[36:39], s83 offen sc1
  s_mul_i32 s82, s57, 5
  s_add_u32 s82, s82, 0
  s_lshr_b32 s83, s82, 2
  s_mul_i32 s83, s83, 296
  s_add_u32 s83, s83, s59
  s_add_u32 s83, s83, 256
  s_lshl_b32 s83, s83, 2
  s_and_b32 s82, s82, 3
  s_add_u32 s83, s83, s82
  s_lshl_b32 s83, s83, 10
  s_add_u32 s83, s83, 93323264
  buffer_store_dwordx4 v[100:103], v4, s[36:39], s83 offen sc1
  s_mul_i32 s82, s57, 5
  s_add_u32 s82, s82, 1
  s_lshr_b32 s83, s82, 2
  s_mul_i32 s83, s83, 296
  s_add_u32 s83, s83, s59
  s_add_u32 s83, s83, 256
  s_lshl_b32 s83, s83, 2
  s_and_b32 s82, s82, 3
  s_add_u32 s83, s83, s82
  s_lshl_b32 s83, s83, 10
  s_add_u32 s83, s83, 93323264
  buffer_store_dwordx4 v[104:107], v4, s[36:39], s83 offen sc1
  s_mul_i32 s82, s57, 5
  s_add_u32 s82, s82, 2
  s_lshr_b32 s83, s82, 2
  s_mul_i32 s83, s83, 296
  s_add_u32 s83, s83, s59
  s_add_u32 s83, s83, 256
  s_lshl_b32 s83, s83, 2
  s_and_b32 s82, s82, 3
  s_add_u32 s83, s83, s82
  s_lshl_b32 s83, s83, 10
  s_add_u32 s83, s83, 93323264
  buffer_store_dwordx4 v[108:111], v4, s[36:39], s83 offen sc1
  s_mul_i32 s82, s57, 5
  s_add_u32 s82, s82, 3
  s_lshr_b32 s83, s82, 2
  s_mul_i32 s83, s83, 296
  s_add_u32 s83, s83, s59
  s_add_u32 s83, s83, 256
  s_lshl_b32 s83, s83, 2
  s_and_b32 s82, s82, 3
  s_add_u32 s83, s83, s82
  s_lshl_b32 s83, s83, 10
  s_add_u32 s83, s83, 93323264
  buffer_store_dwordx4 v[112:115], v4, s[36:39], s83 offen sc1
  s_mul_i32 s82, s57, 5
  s_add_u32 s82, s82, 4
  s_lshr_b32 s83, s82, 2
  s_mul_i32 s83, s83, 296
  s_add_u32 s83, s83, s59
  s_add_u32 s83, s83, 256
  s_lshl_b32 s83, s83, 2
  s_and_b32 s82, s82, 3
  s_add_u32 s83, s83, s82
  s_lshl_b32 s83, s83, 10
  s_add_u32 s83, s83, 93323264
  buffer_store_dwordx4 v[116:119], v4, s[36:39], s83 offen sc1
  s_cmp_ge_u32 s59, 8
  s_cbranch_scc1 L_prep_e
  s_mul_i32 s82, s57, 5
  s_add_u32 s82, s82, 0
  s_lshr_b32 s83, s82, 2
  s_mul_i32 s83, s83, 296
  s_add_u32 s83, s83, s59
  s_add_u32 s83, s83, 288
  s_lshl_b32 s83, s83, 2
  s_and_b32 s82, s82, 3
  s_add_u32 s83, s83, s82
  s_lshl_b32 s83, s83, 10
  s_add_u32 s83, s83, 93323264
  buffer_store_dwordx4 v[120:123], v4, s[36:39], s83 offen sc1
  s_mul_i32 s82, s57, 5
  s_add_u32 s82, s82, 1
  s_lshr_b32 s83, s82, 2
  s_mul_i32 s83, s83, 296
  s_add_u32 s83, s83, s59
  s_add_u32 s83, s83, 288
  s_lshl_b32 s83, s83, 2
  s_and_b32 s82, s82, 3
  s_add_u32 s83, s83, s82
  s_lshl_b32 s83, s83, 10
  s_add_u32 s83, s83, 93323264
  buffer_store_dwordx4 v[124:127], v4, s[36:39], s83 offen sc1
  s_mul_i32 s82, s57, 5
  s_add_u32 s82, s82, 2
  s_lshr_b32 s83, s82, 2
  s_mul_i32 s83, s83, 296
  s_add_u32 s83, s83, s59
  s_add_u32 s83, s83, 288
  s_lshl_b32 s83, s83, 2
  s_and_b32 s82, s82, 3
  s_add_u32 s83, s83, s82
  s_lshl_b32 s83, s83, 10
  s_add_u32 s83, s83, 93323264
  buffer_store_dwordx4 v[128:131], v4, s[36:39], s83 offen sc1
  s_mul_i32 s82, s57, 5
  s_add_u32 s82, s82, 3
  s_lshr_b32 s83, s82, 2
  s_mul_i32 s83, s83, 296
  s_add_u32 s83, s83, s59
  s_add_u32 s83, s83, 288
  s_lshl_b32 s83, s83, 2
  s_and_b32 s82, s82, 3
  s_add_u32 s83, s83, s82
  s_lshl_b32 s83, s83, 10
  s_add_u32 s83, s83, 93323264
  buffer_store_dwordx4 v[132:135], v4, s[36:39], s83 offen sc1
  s_mul_i32 s82, s57, 5
  s_add_u32 s82, s82, 4
  s_lshr_b32 s83, s82, 2
  s_mul_i32 s83, s83, 296
  s_add_u32 s83, s83, s59
  s_add_u32 s83, s83, 288
  s_lshl_b32 s83, s83, 2
  s_and_b32 s82, s82, 3
  s_add_u32 s83, s83, s82
  s_lshl_b32 s83, s83, 10
  s_add_u32 s83, s83, 93323264
  buffer_store_dwordx4 v[136:139], v4, s[36:39], s83 offen sc1
L_prep_e:
  s_mov_b32 s82, 5120
  s_waitcnt vmcnt(0) lgkmcnt(0)
  s_barrier
  s_cmp_lg_u32 s57, 0
  s_cbranch_scc1 sg_38
  s_mov_b64 exec, 1
  v_mov_b32 v2, 1
  v_mov_b32 v3, 0
  buffer_atomic_add v2, v3, s[36:39], s82 offen sc1
  s_mov_b64 exec, -1
sg_38:
  s_branch L_next
L_j5:
  s_cmp_eq_u32 s58, 5
  s_cbranch_scc1 L_next
  s_mov_b32 s80, 5120
  s_cmp_lg_u32 s57, 0
  s_cbranch_scc1 wt_39
  s_mov_b64 exec, 0x1
  v_mul_u32_u24 v3, 4, v1
wl_40:
  buffer_load_dword v2, v3, s[36:39], s80 offen sc1
  s_waitcnt vmcnt(0)
  v_cmp_gt_u32 vcc, 32, v2
  s_nop 0
  s_cbranch_vccz wl_40_d
  s_sleep 4
  s_sub_u32 s56, s56, 1
  s_cbranch_scc0 wl_40
  s_mov_b32 s56, 0
wl_40_d:
  s_mov_b64 exec, -1
wt_39:
  s_lshr_b32 s80, s59, 2
  s_lshl_b32 s80, s80, 7
  s_add_u32 s80, s80, 4096
  s_cmp_lg_u32 s57, 0
  s_cbranch_scc1 wt_41
  s_mov_b64 exec, 0x1
  v_mul_u32_u24 v3, 4, v1
wl_42:
  buffer_load_dword v2, v3, s[36:39], s80 offen sc1
  s_waitcnt vmcnt(0)
  v_cmp_gt_u32 vcc, 32, v2
  s_nop 0
  s_cbranch_vccz wl_42_d
  s_sleep 4
  s_sub_u32 s56, s56, 1
  s_cbranch_scc0 wl_42
  s_mov_b32 s56, 0
wl_42_d:
  s_mov_b64 exec, -1
wt_41:
  s_barrier
  s_lshl_b32 s85, s57, 3
  s_add_u32 s85, s85, 8
  s_cmp_eq_u32 s57, 0
  s_cselect_b32 s85, 0, s85
  s_cselect_b32 s83, 2, 1
  s_mul_i32 s80, s59, 80
  s_add_u32 s80, s80, s85
  s_lshl_b32 s80, s80, 10
  s_add_u32 s80, s80, 90177536
  s_add_u32 s81, s80, 40960
  s_mul_i32 s82, s58, 296
  s_add_u32 s82, s82, s85
  s_add_u32 s82, s82, 256
  s_lshl_b32 s82, s82, 12
  s_add_u32 s82, s82, 93323264
  s_lshl_b32 s84, s58, 8
  s_branch L_fg
L_j7:
  s_cmp_eq_u32 s58, 5
  s_cbranch_scc1 L_next
  s_cmp_ge_u32 s59, 27
  s_cbranch_scc1 L_next
  s_lshl_b32 s80, s59, 6
  s_add_u32 s80, s80, 6144
  s_cmp_lg_u32 s57, 0
  s_cbranch_scc1 wt_43
  s_mov_b64 exec, 0x1
  v_mul_u32_u24 v3, 4, v1
wl_44:
  buffer_load_dword v2, v3, s[36:39], s80 offen sc1
  s_waitcnt vmcnt(0)
  v_cmp_gt_u32 vcc, 6, v2
  s_nop 0
  s_cbranch_vccz wl_44_d
  s_sleep 4
  s_sub_u32 s56, s56, 1
  s_cbranch_scc0 wl_44
  s_mov_b32 s56, 0
wl_44_d:
  s_mov_b64 exec, -1
wt_43:
  s_barrier
  s_lshl_b32 s85, s57, 6
  s_mov_b32 s83, 8
  s_lshl_b32 s80, s59, 9
  s_add_u32 s80, s80, s85
  s_lshl_b32 s80, s80, 10
  s_add_u32 s80, s80, 54525952
  s_add_u32 s81, s80, 262144
  s_mul_i32 s82, s58, 296
  s_add_u32 s82, s82, s85
  s_lshl_b32 s82, s82, 12
  s_add_u32 s82, s82, 93323264
  s_lshl_b32 s84, s58, 8
  s_add_u32 s84, s84, 1280
  s_branch L_fg
L_fg:
  v_lshlrev_b32 v4, 4, v1
  buffer_load_dwordx4 v[32:35], v4, s[36:39], s80 offen
  buffer_load_dwordx4 v[36:39], v4, s[36:39], s81 offen
  s_add_u32 s80, s80, 1024
  s_add_u32 s81, s81, 1024
  buffer_load_dwordx4 v[40:43], v4, s[36:39], s82 offen offset:0
  buffer_load_dwordx4 v[44:47], v4, s[36:39], s82 offen offset:1024
  buffer_load_dwordx4 v[48:51], v4, s[36:39], s82 offen offset:2048
  buffer_load_dwordx4 v[52:55], v4, s[36:39], s82 offen offset:3072
  s_add_u32 s82, s82, 4096
  buffer_load_dwordx4 v[56:59], v4, s[36:39], s80 offen
  buffer_load_dwordx4 v[60:63], v4, s[36:39], s81 offen
  s_add_u32 s80, s80, 1024
  s_add_u32 s81, s81, 1024
  buffer_load_dwordx4 v[64:67], v4, s[36:39], s82 offen offset:0
  buffer_load_dwordx4 v[68:71], v4, s[36:39], s82 offen offset:1024
  buffer_load_dwordx4 v[72:75], v4, s[36:39], s82 offen offset:2048
  buffer_load_dwordx4 v[76:79], v4, s[36:39], s82 offen offset:3072
  s_add_u32 s82, s82, 4096
  buffer_load_dwordx4 v[80:83], v4, s[36:39], s80 offen
  buffer_load_dwordx4 v[84:87], v4, s[36:39], s81 offen
  s_add_u32 s80, s80, 1024
  s_add_u32 s81, s81, 1024
  buffer_load_dwordx4 v[88:91], v4, s[36:39], s82 offen offset:0
  buffer_load_dwordx4 v[92:95], v4, s[36:39], s82 offen offset:1024
  buffer_load_dwordx4 v[96:99], v4, s[36:39], s82 offen offset:2048
  buffer_load_dwordx4 v[100:103], v4, s[36:39], s82 offen offset:3072
  s_add_u32 s82, s82, 4096
  buffer_load_dwordx4 v[104:107], v4, s[36:39], s80 offen
  buffer_load_dwordx4 v[108:111], v4, s[36:39], s81 offen
  s_add_u32 s80, s80, 1024
  s_add_u32 s81, s81, 1024
  buffer_load_dwordx4 v[112:115], v4, s[36:39], s82 offen offset:0
  buffer_load_dwordx4 v[116:119], v4, s[36:39], s82 offen offset:1024
  buffer_load_dwordx4 v[120:123], v4, s[36:39], s82 offen offset:2048
  buffer_load_dwordx4 v[124:127], v4, s[36:39], s82 offen offset:3072
  s_add_u32 s82, s82, 4096
  buffer_load_dwordx4 v[128:131], v4, s[36:39], s80 offen
  buffer_load_dwordx4 v[132:135], v4, s[36:39], s81 offen
  s_add_u32 s80, s80, 1024
  s_add_u32 s81, s81, 1024
  buffer_load_dwordx4 v[136:139], v4, s[36:39], s82 offen offset:0
  buffer_load_dwordx4 v[140:143], v4, s[36:39], s82 offen offset:1024
  buffer_load_dwordx4 v[144:147], v4, s[36:39], s82 offen offset:2048
  buffer_load_dwordx4 v[148:151], v4, s[36:39], s82 offen offset:3072
  s_add_u32 s82, s82, 4096
  buffer_load_dwordx4 v[152:155], v4, s[36:39], s80 offen
  buffer_load_dwordx4 v[156:159], v4, s[36:39], s81 offen
  s_add_u32 s80, s80, 1024
  s_add_u32 s81, s81, 1024
  buffer_load_dwordx4 v[160:163], v4, s[36:39], s82 offen offset:0
  buffer_load_dwordx4 v[164:167], v4, s[36:39], s82 offen offset:1024
  buffer_load_dwordx4 v[168:171], v4, s[36:39], s82 offen offset:2048
  buffer_load_dwordx4 v[172:175], v4, s[36:39], s82 offen offset:3072
  s_add_u32 s82, s82, 4096
  buffer_load_dwordx4 v[176:179], v4, s[36:39], s80 offen
  buffer_load_dwordx4 v[180:183], v4, s[36:39], s81 offen
  s_add_u32 s80, s80, 1024
  s_add_u32 s81, s81, 1024
  buffer_load_dwordx4 v[184:187], v4, s[36:39], s82 offen offset:0
  buffer_load_dwordx4 v[188:191], v4, s[36:39], s82 offen offset:1024
  buffer_load_dwordx4 v[192:195], v4, s[36:39], s82 offen offset:2048
  buffer_load_dwordx4 v[196:199], v4, s[36:39], s82 offen offset:3072
  s_add_u32 s82, s82, 4096
  buffer_load_dwordx4 v[200:203], v4, s[36:39], s80 offen
  buffer_load_dwordx4 v[204:207], v4, s[36:39], s81 offen
  s_add_u32 s80, s80, 1024
  s_add_u32 s81, s81, 1024
  buffer_load_dwordx4 v[208:211], v4, s[36:39], s82 offen offset:0
  buffer_load_dwordx4 v[212:215], v4, s[36:39], s82 offen offset:1024
  buffer_load_dwordx4 v[216:219], v4, s[36:39], s82 offen offset:2048
  buffer_load_dwordx4 v[220:223], v4, s[36:39], s82 offen offset:3072
  s_add_u32 s82, s82, 4096
  v_accvgpr_write_b32 a0, 0
  v_accvgpr_write_b32 a1, 0
  v_accvgpr_write_b32 a2, 0
  v_accvgpr_write_b32 a3, 0
  v_accvgpr_write_b32 a4, 0
  v_accvgpr_write_b32 a5, 0
  v_accvgpr_write_b32 a6, 0
  v_accvgpr_write_b32 a7, 0
  v_accvgpr_write_b32 a8, 0
  v_accvgpr_write_b32 a9, 0
  v_accvgpr_write_b32 a10, 0
  v_accvgpr_write_b32 a11, 0
  v_accvgpr_write_b32 a12, 0
  v_accvgpr_write_b32 a13, 0
  v_accvgpr_write_b32 a14, 0
  v_accvgpr_write_b32 a15, 0
  v_accvgpr_write_b32 a16, 0
  v_accvgpr_write_b32 a17, 0
  v_accvgpr_write_b32 a18, 0
  v_accvgpr_write_b32 a19, 0
  v_accvgpr_write_b32 a20, 0
  v_accvgpr_write_b32 a21, 0
  v_accvgpr_write_b32 a22, 0
  v_accvgpr_write_b32 a23, 0
  v_accvgpr_write_b32 a24, 0
  v_accvgpr_write_b32 a25, 0
  v_accvgpr_write_b32 a26, 0
  v_accvgpr_write_b32 a27, 0
  v_accvgpr_write_b32 a28, 0
  v_accvgpr_write_b32 a29, 0
  v_accvgpr_write_b32 a30, 0
  v_accvgpr_write_b32 a31, 0
  v_accvgpr_write_b32 a32, 0
  v_accvgpr_write_b32 a33, 0
  v_accvgpr_write_b32 a34, 0
  v_accvgpr_write_b32 a35, 0
  v_accvgpr_write_b32 a36, 0
  v_accvgpr_write_b32 a37, 0
  v_accvgpr_write_b32 a38, 0
  v_accvgpr_write_b32 a39, 0
  v_accvgpr_write_b32 a40, 0
  v_accvgpr_write_b32 a41, 0
  v_accvgpr_write_b32 a42, 0
  v_accvgpr_write_b32 a43, 0
  v_accvgpr_write_b32 a44, 0
  v_accvgpr_write_b32 a45, 0
  v_accvgpr_write_b32 a46, 0
  v_accvgpr_write_b32 a47, 0
  v_accvgpr_write_b32 a48, 0
  v_accvgpr_write_b32 a49, 0
  v_accvgpr_write_b32 a50, 0
  v_accvgpr_write_b32 a51, 0
  v_accvgpr_write_b32 a52, 0
  v_accvgpr_write_b32 a53, 0
  v_accvgpr_write_b32 a54, 0
  v_accvgpr_write_b32 a55, 0
  v_accvgpr_write_b32 a56, 0
  v_accvgpr_write_b32 a57, 0
  v_accvgpr_write_b32 a58, 0
  v_accvgpr_write_b32 a59, 0
  v_accvgpr_write_b32 a60, 0
  v_accvgpr_write_b32 a61, 0
  v_accvgpr_write_b32 a62, 0
  v_accvgpr_write_b32 a63, 0
  v_accvgpr_write_b32 a64, 0
  v_accvgpr_write_b32 a65, 0
  v_accvgpr_write_b32 a66, 0
  v_accvgpr_write_b32 a67, 0
  v_accvgpr_write_b32 a68, 0
  v_accvgpr_write_b32 a69, 0
  v_accvgpr_write_b32 a70, 0
  v_accvgpr_write_b32 a71, 0
  v_accvgpr_write_b32 a72, 0
  v_accvgpr_write_b32 a73, 0
  v_accvgpr_write_b32 a74, 0
  v_accvgpr_write_b32 a75, 0
  v_accvgpr_write_b32 a76, 0
  v_accvgpr_write_b32 a77, 0
  v_accvgpr_write_b32 a78, 0
  v_accvgpr_write_b32 a79, 0
  v_accvgpr_write_b32 a80, 0
  v_accvgpr_write_b32 a81, 0
  v_accvgpr_write_b32 a82, 0
  v_accvgpr_write_b32 a83, 0
  v_accvgpr_write_b32 a84, 0
  v_accvgpr_write_b32 a85, 0
  v_accvgpr_write_b32 a86, 0
  v_accvgpr_write_b32 a87, 0
  v_accvgpr_write_b32 a88, 0
  v_accvgpr_write_b32 a89, 0
  v_accvgpr_write_b32 a90, 0
  v_accvgpr_write_b32 a91, 0
  v_accvgpr_write_b32 a92, 0
  v_accvgpr_write_b32 a93, 0
  v_accvgpr_write_b32 a94, 0
  v_accvgpr_write_b32 a95, 0
  v_accvgpr_write_b32 a96, 0
  v_accvgpr_write_b32 a97, 0
  v_accvgpr_write_b32 a98, 0
  v_accvgpr_write_b32 a99, 0
  v_accvgpr_write_b32 a100, 0
  v_accvgpr_write_b32 a101, 0
  v_accvgpr_write_b32 a102, 0
  v_accvgpr_write_b32 a103, 0
  v_accvgpr_write_b32 a104, 0
  v_accvgpr_write_b32 a105, 0
  v_accvgpr_write_b32 a106, 0
  v_accvgpr_write_b32 a107, 0
  v_accvgpr_write_b32 a108, 0
  v_accvgpr_write_b32 a109, 0
  v_accvgpr_write_b32 a110, 0
  v_accvgpr_write_b32 a111, 0
  v_accvgpr_write_b32 a112, 0
  v_accvgpr_write_b32 a113, 0
  v_accvgpr_write_b32 a114, 0
  v_accvgpr_write_b32 a115, 0
  v_accvgpr_write_b32 a116, 0
  v_accvgpr_write_b32 a117, 0
  v_accvgpr_write_b32 a118, 0
  v_accvgpr_write_b32 a119, 0
  v_accvgpr_write_b32 a120, 0
  v_accvgpr_write_b32 a121, 0
  v_accvgpr_write_b32 a122, 0
  v_accvgpr_write_b32 a123, 0
  v_accvgpr_write_b32 a124, 0
  v_accvgpr_write_b32 a125, 0
  v_accvgpr_write_b32 a126, 0
  v_accvgpr_write_b32 a127, 0
  s_cmp_eq_u32 s83, 1
  s_cbranch_scc1 L_fg_last
L_fg_loop:
  s_waitcnt vmcnt(42)
  v_mfma_f32_32x32x16_bf16 a[0:15], v[40:43], v[32:35], a[0:15]
  v_mfma_f32_32x32x16_bf16 a[16:31], v[44:47], v[32:35], a[16:31]
  v_mfma_f32_32x32x16_bf16 a[32:47], v[48:51], v[32:35], a[32:47]
  v_mfma_f32_32x32x16_bf16 a[48:63], v[52:55], v[32:35], a[48:63]
  v_mfma_f32_32x32x16_bf16 a[64:79], v[40:43], v[36:39], a[64:79]
  v_mfma_f32_32x32x16_bf16 a[80:95], v[44:47], v[36:39], a[80:95]
  v_mfma_f32_32x32x16_bf16 a[96:111], v[48:51], v[36:39], a[96:111]
  v_mfma_f32_32x32x16_bf16 a[112:127], v[52:55], v[36:39], a[112:127]
  buffer_load_dwordx4 v[32:35], v4, s[36:39], s80 offen
  buffer_load_dwordx4 v[36:39], v4, s[36:39], s81 offen
  s_add_u32 s80, s80, 1024
  s_add_u32 s81, s81, 1024
  buffer_load_dwordx4 v[40:43], v4, s[36:39], s82 offen offset:0
  buffer_load_dwordx4 v[44:47], v4, s[36:39], s82 offen offset:1024
  buffer_load_dwordx4 v[48:51], v4, s[36:39], s82 offen offset:2048
  buffer_load_dwordx4 v[52:55], v4, s[36:39], s82 offen offset:3072
  s_add_u32 s82, s82, 4096
  s_waitcnt vmcnt(42)
  v_mfma_f32_32x32x16_bf16 a[0:15], v[64:67], v[56:59], a[0:15]
  v_mfma_f32_32x32x16_bf16 a[16:31], v[68:71], v[56:59], a[16:31]
  v_mfma_f32_32x32x16_bf16 a[32:47], v[72:75], v[56:59], a[32:47]
  v_mfma_f32_32x32x16_bf16 a[48:63], v[76:79], v[56:59], a[48:63]
  v_mfma_f32_32x32x16_bf16 a[64:79], v[64:67], v[60:63], a[64:79]
  v_mfma_f32_32x32x16_bf16 a[80:95], v[68:71], v[60:63], a[80:95]
  v_mfma_f32_32x32x16_bf16 a[96:111], v[72:75], v[60:63], a[96:111]
  v_mfma_f32_32x32x16_bf16 a[112:127], v[76:79], v[60:63], a[112:127]
  buffer_load_dwordx4 v[56:59], v4, s[36:39], s80 offen
  buffer_load_dwordx4 v[60:63], v4, s[36:39], s81 offen
  s_add_u32 s80, s80, 1024
  s_add_u32 s81, s81, 1024
  buffer_load_dwordx4 v[64:67], v4, s[36:39], s82 offen offset:0
  buffer_load_dwordx4 v[68:71], v4, s[36:39], s82 offen offset:1024
  buffer_load_dwordx4 v[72:75], v4, s[36:39], s82 offen offset:2048
  buffer_load_dwordx4 v[76:79], v4, s[36:39], s82 offen offset:3072
  s_add_u32 s82, s82, 4096
  s_waitcnt vmcnt(42)
  v_mfma_f32_32x32x16_bf16 a[0:15], v[88:91], v[80:83], a[0:15]
  v_mfma_f32_32x32x16_bf16 a[16:31], v[92:95], v[80:83], a[16:31]
  v_mfma_f32_32x32x16_bf16 a[32:47], v[96:99], v[80:83], a[32:47]
  v_mfma_f32_32x32x16_bf16 a[48:63], v[100:103], v[80:83], a[48:63]
  v_mfma_f32_32x32x16_bf16 a[64:79], v[88:91], v[84:87], a[64:79]
  v_mfma_f32_32x32x16_bf16 a[80:95], v[92:95], v[84:87], a[80:95]
  v_mfma_f32_32x32x16_bf16 a[96:111], v[96:99], v[84:87], a[96:111]
  v_mfma_f32_32x32x16_bf16 a[112:127], v[100:103], v[84:87], a[112:127]
  buffer_load_dwordx4 v[80:83], v4, s[36:39], s80 offen
  buffer_load_dwordx4 v[84:87], v4, s[36:39], s81 offen
  s_add_u32 s80, s80, 1024
  s_add_u32 s81, s81, 1024
  buffer_load_dwordx4 v[88:91], v4, s[36:39], s82 offen offset:0
  buffer_load_dwordx4 v[92:95], v4, s[36:39], s82 offen offset:1024
  buffer_load_dwordx4 v[96:99], v4, s[36:39], s82 offen offset:2048
  buffer_load_dwordx4 v[100:103], v4, s[36:39], s82 offen offset:3072
  s_add_u32 s82, s82, 4096
  s_waitcnt vmcnt(42)
  v_mfma_f32_32x32x16_bf16 a[0:15], v[112:115], v[104:107], a[0:15]
  v_mfma_f32_32x32x16_bf16 a[16:31], v[116:119], v[104:107], a[16:31]
  v_mfma_f32_32x32x16_bf16 a[32:47], v[120:123], v[104:107], a[32:47]
  v_mfma_f32_32x32x16_bf16 a[48:63], v[124:127], v[104:107], a[48:63]
  v_mfma_f32_32x32x16_bf16 a[64:79], v[112:115], v[108:111], a[64:79]
  v_mfma_f32_32x32x16_bf16 a[80:95], v[116:119], v[108:111], a[80:95]
  v_mfma_f32_32x32x16_bf16 a[96:111], v[120:123], v[108:111], a[96:111]
  v_mfma_f32_32x32x16_bf16 a[112:127], v[124:127], v[108:111], a[112:127]
  buffer_load_dwordx4 v[104:107], v4, s[36:39], s80 offen
  buffer_load_dwordx4 v[108:111], v4, s[36:39], s81 offen
  s_add_u32 s80, s80, 1024
  s_add_u32 s81, s81, 1024
  buffer_load_dwordx4 v[112:115], v4, s[36:39], s82 offen offset:0
  buffer_load_dwordx4 v[116:119], v4, s[36:39], s82 offen offset:1024
  buffer_load_dwordx4 v[120:123], v4, s[36:39], s82 offen offset:2048
  buffer_load_dwordx4 v[124:127], v4, s[36:39], s82 offen offset:3072
  s_add_u32 s82, s82, 4096
  s_waitcnt vmcnt(42)
  v_mfma_f32_32x32x16_bf16 a[0:15], v[136:139], v[128:131], a[0:15]
  v_mfma_f32_32x32x16_bf16 a[16:31], v[140:143], v[128:131], a[16:31]
  v_mfma_f32_32x32x16_bf16 a[32:47], v[144:147], v[128:131], a[32:47]
  v_mfma_f32_32x32x16_bf16 a[48:63], v[148:151], v[128:131], a[48:63]
  v_mfma_f32_32x32x16_bf16 a[64:79], v[136:139], v[132:135], a[64:79]
  v_mfma_f32_32x32x16_bf16 a[80:95], v[140:143], v[132:135], a[80:95]
  v_mfma_f32_32x32x16_bf16 a[96:111], v[144:147], v[132:135], a[96:111]
  v_mfma_f32_32x32x16_bf16 a[112:127], v[148:151], v[132:135], a[112:127]
  buffer_load_dwordx4 v[128:131], v4, s[36:39], s80 offen
  buffer_load_dwordx4 v[132:135], v4, s[36:39], s81 offen
  s_add_u32 s80, s80, 1024
  s_add_u32 s81, s81, 1024
  buffer_load_dwordx4 v[136:139], v4, s[36:39], s82 offen offset:0
  buffer_load_dwordx4 v[140:143], v4, s[36:39], s82 offen offset:1024
  buffer_load_dwordx4 v[144:147], v4, s[36:39], s82 offen offset:2048
  buffer_load_dwordx4 v[148:151], v4, s[36:39], s82 offen offset:3072
  s_add_u32 s82, s82, 4096
  s_waitcnt vmcnt(42)
  v_mfma_f32_32x32x16_bf16 a[0:15], v[160:163], v[152:155], a[0:15]
  v_mfma_f32_32x32x16_bf16 a[16:31], v[164:167], v[152:155], a[16:31]
  v_mfma_f32_32x32x16_bf16 a[32:47], v[168:171], v[152:155], a[32:47]
  v_mfma_f32_32x32x16_bf16 a[48:63], v[172:175], v[152:155], a[48:63]
  v_mfma_f32_32x32x16_bf16 a[64:79], v[160:163], v[156:159], a[64:79]
  v_mfma_f32_32x32x16_bf16 a[80:95], v[164:167], v[156:159], a[80:95]
  v_mfma_f32_32x32x16_bf16 a[96:111], v[168:171], v[156:159], a[96:111]
  v_mfma_f32_32x32x16_bf16 a[112:127], v[172:175], v[156:159], a[112:127]
  buffer_load_dwordx4 v[152:155], v4, s[36:39], s80 offen
  buffer_load_dwordx4 v[156:159], v4, s[36:39], s81 offen
  s_add_u32 s80, s80, 1024
  s_add_u32 s81, s81, 1024
  buffer_load_dwordx4 v[160:163], v4, s[36:39], s82 offen offset:0
  buffer_load_dwordx4 v[164:167], v4, s[36:39], s82 offen offset:1024
  buffer_load_dwordx4 v[168:171], v4, s[36:39], s82 offen offset:2048
  buffer_load_dwordx4 v[172:175], v4, s[36:39], s82 offen offset:3072
  s_add_u32 s82, s82, 4096
  s_waitcnt vmcnt(42)
  v_mfma_f32_32x32x16_bf16 a[0:15], v[184:187], v[176:179], a[0:15]
  v_mfma_f32_32x32x16_bf16 a[16:31], v[188:191], v[176:179], a[16:31]
  v_mfma_f32_32x32x16_bf16 a[32:47], v[192:195], v[176:179], a[32:47]
  v_mfma_f32_32x32x16_bf16 a[48:63], v[196:199], v[176:179], a[48:63]
  v_mfma_f32_32x32x16_bf16 a[64:79], v[184:187], v[180:183], a[64:79]
  v_mfma_f32_32x32x16_bf16 a[80:95], v[188:191], v[180:183], a[80:95]
  v_mfma_f32_32x32x16_bf16 a[96:111], v[192:195], v[180:183], a[96:111]
  v_mfma_f32_32x32x16_bf16 a[112:127], v[196:199], v[180:183], a[112:127]
  buffer_load_dwordx4 v[176:179], v4, s[36:39], s80 offen
  buffer_load_dwordx4 v[180:183], v4, s[36:39], s81 offen
  s_add_u32 s80, s80, 1024
  s_add_u32 s81, s81, 1024
  buffer_load_dwordx4 v[184:187], v4, s[36:39], s82 offen offset:0
  buffer_load_dwordx4 v[188:191], v4, s[36:39], s82 offen offset:1024
  buffer_load_dwordx4 v[192:195], v4, s[36:39], s82 offen offset:2048
  buffer_load_dwordx4 v[196:199], v4, s[36:39], s82 offen offset:3072
  s_add_u32 s82, s82, 4096
  s_waitcnt vmcnt(42)
  v_mfma_f32_32x32x16_bf16 a[0:15], v[208:211], v[200:203], a[0:15]
  v_mfma_f32_32x32x16_bf16 a[16:31], v[212:215], v[200:203], a[16:31]
  v_mfma_f32_32x32x16_bf16 a[32:47], v[216:219], v[200:203], a[32:47]
  v_mfma_f32_32x32x16_bf16 a[48:63], v[220:223], v[200:203], a[48:63]
  v_mfma_f32_32x32x16_bf16 a[64:79], v[208:211], v[204:207], a[64:79]
  v_mfma_f32_32x32x16_bf16 a[80:95], v[212:215], v[204:207], a[80:95]
  v_mfma_f32_32x32x16_bf16 a[96:111], v[216:219], v[204:207], a[96:111]
  v_mfma_f32_32x32x16_bf16 a[112:127], v[220:223], v[204:207], a[112:127]
  buffer_load_dwordx4 v[200:203], v4, s[36:39], s80 offen
  buffer_load_dwordx4 v[204:207], v4, s[36:39], s81 offen
  s_add_u32 s80, s80, 1024
  s_add_u32 s81, s81, 1024
  buffer_load_dwordx4 v[208:211], v4, s[36:39], s82 offen offset:0
  buffer_load_dwordx4 v[212:215], v4, s[36:39], s82 offen offset:1024
  buffer_load_dwordx4 v[216:219], v4, s[36:39], s82 offen offset:2048
  buffer_load_dwordx4 v[220:223], v4, s[36:39], s82 offen offset:3072
  s_add_u32 s82, s82, 4096
  s_sub_u32 s83, s83, 1
  s_cmp_lg_u32 s83, 1
  s_cbranch_scc1 L_fg_loop
L_fg_last:
  s_waitcnt vmcnt(42)
  v_mfma_f32_32x32x16_bf16 a[0:15], v[40:43], v[32:35], a[0:15]
  v_mfma_f32_32x32x16_bf16 a[16:31], v[44:47], v[32:35], a[16:31]
  v_mfma_f32_32x32x16_bf16 a[32:47], v[48:51], v[32:35], a[32:47]
  v_mfma_f32_32x32x16_bf16 a[48:63], v[52:55], v[32:35], a[48:63]
  v_mfma_f32_32x32x16_bf16 a[64:79], v[40:43], v[36:39], a[64:79]
  v_mfma_f32_32x32x16_bf16 a[80:95], v[44:47], v[36:39], a[80:95]
  v_mfma_f32_32x32x16_bf16 a[96:111], v[48:51], v[36:39], a[96:111]
  v_mfma_f32_32x32x16_bf16 a[112:127], v[52:55], v[36:39], a[112:127]
  s_waitcnt vmcnt(36)
  v_mfma_f32_32x32x16_bf16 a[0:15], v[64:67], v[56:59], a[0:15]
  v_mfma_f32_32x32x16_bf16 a[16:31], v[68:71], v[56:59], a[16:31]
  v_mfma_f32_32x32x16_bf16 a[32:47], v[72:75], v[56:59], a[32:47]
  v_mfma_f32_32x32x16_bf16 a[48:63], v[76:79], v[56:59], a[48:63]
  v_mfma_f32_32x32x16_bf16 a[64:79], v[64:67], v[60:63], a[64:79]
  v_mfma_f32_32x32x16_bf16 a[80:95], v[68:71], v[60:63], a[80:95]
  v_mfma_f32_32x32x16_bf16 a[96:111], v[72:75], v[60:63], a[96:111]
  v_mfma_f32_32x32x16_bf16 a[112:127], v[76:79], v[60:63], a[112:127]
  s_waitcnt vmcnt(30)
  v_mfma_f32_32x32x16_bf16 a[0:15], v[88:91], v[80:83], a[0:15]
  v_mfma_f32_32x32x16_bf16 a[16:31], v[92:95], v[80:83], a[16:31]
  v_mfma_f32_32x32x16_bf16 a[32:47], v[96:99], v[80:83], a[32:47]
  v_mfma_f32_32x32x16_bf16 a[48:63], v[100:103], v[80:83], a[48:63]
  v_mfma_f32_32x32x16_bf16 a[64:79], v[88:91], v[84:87], a[64:79]
  v_mfma_f32_32x32x16_bf16 a[80:95], v[92:95], v[84:87], a[80:95]
  v_mfma_f32_32x32x16_bf16 a[96:111], v[96:99], v[84:87], a[96:111]
  v_mfma_f32_32x32x16_bf16 a[112:127], v[100:103], v[84:87], a[112:127]
  s_waitcnt vmcnt(24)
  v_mfma_f32_32x32x16_bf16 a[0:15], v[112:115], v[104:107], a[0:15]
  v_mfma_f32_32x32x16_bf16 a[16:31], v[116:119], v[104:107], a[16:31]
  v_mfma_f32_32x32x16_bf16 a[32:47], v[120:123], v[104:107], a[32:47]
  v_mfma_f32_32x32x16_bf16 a[48:63], v[124:127], v[104:107], a[48:63]
  v_mfma_f32_32x32x16_bf16 a[64:79], v[112:115], v[108:111], a[64:79]
  v_mfma_f32_32x32x16_bf16 a[80:95], v[116:119], v[108:111], a[80:95]
  v_mfma_f32_32x32x16_bf16 a[96:111], v[120:123], v[108:111], a[96:111]
  v_mfma_f32_32x32x16_bf16 a[112:127], v[124:127], v[108:111], a[112:127]
  s_waitcnt vmcnt(18)
  v_mfma_f32_32x32x16_bf16 a[0:15], v[136:139], v[128:131], a[0:15]
  v_mfma_f32_32x32x16_bf16 a[16:31], v[140:143], v[128:131], a[16:31]
  v_mfma_f32_32x32x16_bf16 a[32:47], v[144:147], v[128:131], a[32:47]
  v_mfma_f32_32x32x16_bf16 a[48:63], v[148:151], v[128:131], a[48:63]
  v_mfma_f32_32x32x16_bf16 a[64:79], v[136:139], v[132:135], a[64:79]
  v_mfma_f32_32x32x16_bf16 a[80:95], v[140:143], v[132:135], a[80:95]
  v_mfma_f32_32x32x16_bf16 a[96:111], v[144:147], v[132:135], a[96:111]
  v_mfma_f32_32x32x16_bf16 a[112:127], v[148:151], v[132:135], a[112:127]
  s_waitcnt vmcnt(12)
  v_mfma_f32_32x32x16_bf16 a[0:15], v[160:163], v[152:155], a[0:15]
  v_mfma_f32_32x32x16_bf16 a[16:31], v[164:167], v[152:155], a[16:31]
  v_mfma_f32_32x32x16_bf16 a[32:47], v[168:171], v[152:155], a[32:47]
  v_mfma_f32_32x32x16_bf16 a[48:63], v[172:175], v[152:155], a[48:63]
  v_mfma_f32_32x32x16_bf16 a[64:79], v[160:163], v[156:159], a[64:79]
  v_mfma_f32_32x32x16_bf16 a[80:95], v[164:167], v[156:159], a[80:95]
  v_mfma_f32_32x32x16_bf16 a[96:111], v[168:171], v[156:159], a[96:111]
  v_mfma_f32_32x32x16_bf16 a[112:127], v[172:175], v[156:159], a[112:127]
  s_waitcnt vmcnt(6)
  v_mfma_f32_32x32x16_bf16 a[0:15], v[184:187], v[176:179], a[0:15]
  v_mfma_f32_32x32x16_bf16 a[16:31], v[188:191], v[176:179], a[16:31]
  v_mfma_f32_32x32x16_bf16 a[32:47], v[192:195], v[176:179], a[32:47]
  v_mfma_f32_32x32x16_bf16 a[48:63], v[196:199], v[176:179], a[48:63]
  v_mfma_f32_32x32x16_bf16 a[64:79], v[184:187], v[180:183], a[64:79]
  v_mfma_f32_32x32x16_bf16 a[80:95], v[188:191], v[180:183], a[80:95]
  v_mfma_f32_32x32x16_bf16 a[96:111], v[192:195], v[180:183], a[96:111]
  v_mfma_f32_32x32x16_bf16 a[112:127], v[196:199], v[180:183], a[112:127]
  s_waitcnt vmcnt(0)
  v_mfma_f32_32x32x16_bf16 a[0:15], v[208:211], v[200:203], a[0:15]
  v_mfma_f32_32x32x16_bf16 a[16:31], v[212:215], v[200:203], a[16:31]
  v_mfma_f32_32x32x16_bf16 a[32:47], v[216:219], v[200:203], a[32:47]
  v_mfma_f32_32x32x16_bf16 a[48:63], v[220:223], v[200:203], a[48:63]
  v_mfma_f32_32x32x16_bf16 a[64:79], v[208:211], v[204:207], a[64:79]
  v_mfma_f32_32x32x16_bf16 a[80:95], v[212:215], v[204:207], a[80:95]
  v_mfma_f32_32x32x16_bf16 a[96:111], v[216:219], v[204:207], a[96:111]
  v_mfma_f32_32x32x16_bf16 a[112:127], v[220:223], v[204:207], a[112:127]
  s_lshl_b32 s85, s57, 15
  v_add_u32 v5, s85, v4
  ds_write_b128 v5, a[0:3] offset:0
  ds_write_b128 v5, a[4:7] offset:1024
  ds_write_b128 v5, a[8:11] offset:2048
  ds_write_b128 v5, a[12:15] offset:3072
  ds_write_b128 v5, a[16:19] offset:4096
  ds_write_b128 v5, a[20:23] offset:5120
  ds_write_b128 v5, a[24:27] offset:6144
  ds_write_b128 v5, a[28:31] offset:7168
  ds_write_b128 v5, a[32:35] offset:8192
  ds_write_b128 v5, a[36:39] offset:9216
  ds_write_b128 v5, a[40:43] offset:10240
  ds_write_b128 v5, a[44:47] offset:11264
  ds_write_b128 v5, a[48:51] offset:12288
  ds_write_b128 v5, a[52:55] offset:13312
  ds_write_b128 v5, a[56:59] offset:14336
  ds_write_b128 v5, a[60:63] offset:15360
  ds_write_b128 v5, a[64:67] offset:16384
  ds_write_b128 v5, a[68:71] offset:17408
  ds_write_b128 v5, a[72:75] offset:18432
  ds_write_b128 v5, a[76:79] offset:19456
  ds_write_b128 v5, a[80:83] offset:20480
  ds_write_b128 v5, a[84:87] offset:21504
  ds_write_b128 v5, a[88:91] offset:22528
  ds_write_b128 v5, a[92:95] offset:23552
  ds_write_b128 v5, a[96:99] offset:24576
  ds_write_b128 v5, a[100:103] offset:25600
  ds_write_b128 v5, a[104:107] offset:26624
  ds_write_b128 v5, a[108:111] offset:27648
  ds_write_b128 v5, a[112:115] offset:28672
  ds_write_b128 v5, a[116:119] offset:29696
  ds_write_b128 v5, a[120:123] offset:30720
  ds_write_b128 v5, a[124:127] offset:31744
  s_waitcnt lgkmcnt(0)
  s_barrier
  s_lshl_b32 s85, s57, 12
  v_add_u32 v5, s85, v4
  v_add_u32 v6, 0x10000, v5
  ds_read_b128 v[32:35], v5 offset:0
  ds_read_b128 v[36:39], v5 offset:1024
  ds_read_b128 v[40:43], v5 offset:2048
  ds_read_b128 v[44:47], v5 offset:3072
  ds_read_b128 v[48:51], v5 offset:32768
  ds_read_b128 v[52:55], v5 offset:33792
  ds_read_b128 v[56:59], v5 offset:34816
  ds_read_b128 v[60:63], v5 offset:35840
  ds_read_b128 v[64:67], v6 offset:0
  ds_read_b128 v[68:71], v6 offset:1024
  ds_read_b128 v[72:75], v6 offset:2048
  ds_read_b128 v[76:79], v6 offset:3072
  ds_read_b128 v[80:83], v6 offset:32768
  ds_read_b128 v[84:87], v6 offset:33792
  ds_read_b128 v[88:91], v6 offset:34816
  ds_read_b128 v[92:95], v6 offset:35840
  ds_read_b128 v[96:99], v5 offset:16384
  ds_read_b128 v[100:103], v5 offset:17408
  ds_read_b128 v[104:107], v5 offset:18432
  ds_read_b128 v[108:111], v5 offset:19456
  ds_read_b128 v[112:115], v5 offset:49152
  ds_read_b128 v[116:119], v5 offset:50176
  ds_read_b128 v[120:123], v5 offset:51200
  ds_read_b128 v[124:127], v5 offset:52224
  ds_read_b128 v[128:131], v6 offset:16384
  ds_read_b128 v[132:135], v6 offset:17408
  ds_read_b128 v[136:139], v6 offset:18432
  ds_read_b128 v[140:143], v6 offset:19456
  ds_read_b128 v[144:147], v6 offset:49152
  ds_read_b128 v[148:151], v6 offset:50176
  ds_read_b128 v[152:155], v6 offset:51200
  ds_read_b128 v[156:159], v6 offset:52224
  v_and_b32 v7, 31, v1
  v_mul_u32_u24 v7, 2560, v7
  v_lshrrev_b32 v8, 5, v1
  v_lshlrev_b32 v8, 4, v8
  v_add_u32 v7, v7, v8
  s_mul_i32 s85, s59, 163840
  s_add_u32 s85, s85, s84
  s_lshl_b32 s86, s57, 6
  s_add_u32 s85, s85, s86
  s_waitcnt lgkmcnt(15)
  s_waitcnt lgkmcnt(0)
  v_add_f32 v32, v32, v48
  v_add_f32 v64, v64, v80
  v_add_f32 v33, v33, v49
  v_add_f32 v65, v65, v81
  v_add_f32 v34, v34, v50
  v_add_f32 v66, v66, v82
  v_add_f32 v35, v35, v51
  v_add_f32 v67, v67, v83
  v_add_f32 v36, v36, v52
  v_add_f32 v68, v68, v84
  v_add_f32 v37, v37, v53
  v_add_f32 v69, v69, v85
  v_add_f32 v38, v38, v54
  v_add_f32 v70, v70, v86
  v_add_f32 v39, v39, v55
  v_add_f32 v71, v71, v87
  v_add_f32 v40, v40, v56
  v_add_f32 v72, v72, v88
  v_add_f32 v41, v41, v57
  v_add_f32 v73, v73, v89
  v_add_f32 v42, v42, v58
  v_add_f32 v74, v74, v90
  v_add_f32 v43, v43, v59
  v_add_f32 v75, v75, v91
  v_add_f32 v44, v44, v60
  v_add_f32 v76, v76, v92
  v_add_f32 v45, v45, v61
  v_add_f32 v77, v77, v93
  v_add_f32 v46, v46, v62
  v_add_f32 v78, v78, v94
  v_add_f32 v47, v47, v63
  v_add_f32 v79, v79, v95
  v_add_f32 v32, v32, v64
  v_add_f32 v33, v33, v65
  v_add_f32 v34, v34, v66
  v_add_f32 v35, v35, v67
  v_add_f32 v36, v36, v68
  v_add_f32 v37, v37, v69
  v_add_f32 v38, v38, v70
  v_add_f32 v39, v39, v71
  v_add_f32 v40, v40, v72
  v_add_f32 v41, v41, v73
  v_add_f32 v42, v42, v74
  v_add_f32 v43, v43, v75
  v_add_f32 v44, v44, v76
  v_add_f32 v45, v45, v77
  v_add_f32 v46, v46, v78
  v_add_f32 v47, v47, v79
  v_cvt_pk_bf16_f32 v48, v32, v33
  v_cvt_pk_bf16_f32 v49, v34, v35
  v_cvt_pk_bf16_f32 v50, v36, v37
  v_cvt_pk_bf16_f32 v51, v38, v39
  v_cvt_pk_bf16_f32 v52, v40, v41
  v_cvt_pk_bf16_f32 v53, v42, v43
  v_cvt_pk_bf16_f32 v54, v44, v45
  v_cvt_pk_bf16_f32 v55, v46, v47
  v_permlane32_swap_b32 v48, v50
  v_permlane32_swap_b32 v49, v51
  v_permlane32_swap_b32 v52, v54
  v_permlane32_swap_b32 v53, v55
  buffer_store_dwordx4 v[48:51], v7, s[40:43], s85 offen offset:0
  buffer_store_dwordx4 v[52:55], v7, s[40:43], s85 offen offset:32
  s_add_u32 s85, s85, 81920
  s_waitcnt lgkmcnt(0)
  v_add_f32 v96, v96, v112
  v_add_f32 v128, v128, v144
  v_add_f32 v97, v97, v113
  v_add_f32 v129, v129, v145
  v_add_f32 v98, v98, v114
  v_add_f32 v130, v130, v146
  v_add_f32 v99, v99, v115
  v_add_f32 v131, v131, v147
  v_add_f32 v100, v100, v116
  v_add_f32 v132, v132, v148
  v_add_f32 v101, v101, v117
  v_add_f32 v133, v133, v149
  v_add_f32 v102, v102, v118
  v_add_f32 v134, v134, v150
  v_add_f32 v103, v103, v119
  v_add_f32 v135, v135, v151
  v_add_f32 v104, v104, v120
  v_add_f32 v136, v136, v152
  v_add_f32 v105, v105, v121
  v_add_f32 v137, v137, v153
  v_add_f32 v106, v106, v122
  v_add_f32 v138, v138, v154
  v_add_f32 v107, v107, v123
  v_add_f32 v139, v139, v155
  v_add_f32 v108, v108, v124
  v_add_f32 v140, v140, v156
  v_add_f32 v109, v109, v125
  v_add_f32 v141, v141, v157
  v_add_f32 v110, v110, v126
  v_add_f32 v142, v142, v158
  v_add_f32 v111, v111, v127
  v_add_f32 v143, v143, v159
  v_add_f32 v96, v96, v128
  v_add_f32 v97, v97, v129
  v_add_f32 v98, v98, v130
  v_add_f32 v99, v99, v131
  v_add_f32 v100, v100, v132
  v_add_f32 v101, v101, v133
  v_add_f32 v102, v102, v134
  v_add_f32 v103, v103, v135
  v_add_f32 v104, v104, v136
  v_add_f32 v105, v105, v137
  v_add_f32 v106, v106, v138
  v_add_f32 v107, v107, v139
  v_add_f32 v108, v108, v140
  v_add_f32 v109, v109, v141
  v_add_f32 v110, v110, v142
  v_add_f32 v111, v111, v143
  v_cvt_pk_bf16_f32 v112, v96, v97
  v_cvt_pk_bf16_f32 v113, v98, v99
  v_cvt_pk_bf16_f32 v114, v100, v101
  v_cvt_pk_bf16_f32 v115, v102, v103
  v_cvt_pk_bf16_f32 v116, v104, v105
  v_cvt_pk_bf16_f32 v117, v106, v107
  v_cvt_pk_bf16_f32 v118, v108, v109
  v_cvt_pk_bf16_f32 v119, v110, v111
  v_permlane32_swap_b32 v112, v114
  v_permlane32_swap_b32 v113, v115
  v_permlane32_swap_b32 v116, v118
  v_permlane32_swap_b32 v117, v119
  buffer_store_dwordx4 v[112:115], v7, s[40:43], s85 offen offset:0
  buffer_store_dwordx4 v[116:119], v7, s[40:43], s85 offen offset:32
  s_add_u32 s85, s85, 81920
  s_waitcnt lgkmcnt(0)
  s_barrier
  s_branch L_next
L_j6:
  s_cmp_ge_u32 s59, 27
  s_cbranch_scc1 L_next
  s_lshl_b32 s80, s58, 2
  s_add_u32 s80, s80, s57
  s_lshl_b32 s87, s59, 1
  s_lshl_b32 s88, s59, 6
  s_mov_b32 s89, 64
L_j6_go:
  v_lshlrev_b32 v4, 4, v1
  v_and_b32 v2, 7, v1
  v_lshrrev_b32 v3, 5, v1
  v_lshlrev_b32 v5, 3, v3
  v_add_u32 v5, v5, v2
  v_lshlrev_b32 v5, 4, v5
  v_and_b32 v2, 31, v1
  v_lshlrev_b32 v6, 4, v2
  v_lshlrev_b32 v7, 3, v3
  v_add_u32 v6, v6, v7
  v_lshlrev_b32 v3, 2, v3
  v_sub_u32 v7, v2, v3
L_j6_loop:
  s_lshr_b32 s81, s80, 5
  s_add_u32 s81, s81, s87
  s_and_b32 s82, s80, 31
  s_lshr_b32 s84, s81, 3
  s_lshl_b32 s85, s84, 7
  s_lshr_b32 s86, s82, 1
  s_lshl_b32 s86, s86, 2
  s_add_u32 s85, s85, s86
  s_add_u32 s85, s85, 0
  s_mov_b64 exec, 0x3
  v_mul_u32_u24 v3, 64, v1
wl_46:
  buffer_load_dword v2, v3, s[36:39], s85 offen sc1
  s_waitcnt vmcnt(0)
  v_cmp_gt_u32 vcc, 2, v2
  s_nop 0
  s_cbranch_vccz wl_46_d
  s_sleep 4
  s_sub_u32 s56, s56, 1
  s_cbranch_scc0 wl_46
  s_mov_b32 s56, 0
wl_46_d:
  s_mov_b64 exec, -1
wt_45:
  s_lshl_b32 s85, s84, 6
  s_add_u32 s85, s85, s86
  s_add_u32 s85, s85, 1024
  s_mov_b64 exec, 0x1
  v_mul_u32_u24 v3, 4, v1
wl_48:
  buffer_load_dword v2, v3, s[36:39], s85 offen sc1
  s_waitcnt vmcnt(0)
  v_cmp_gt_u32 vcc, 1, v2
  s_nop 0
  s_cbranch_vccz wl_48_d
  s_sleep 4
  s_sub_u32 s56, s56, 1
  s_cbranch_scc0 wl_48
  s_mov_b32 s56, 0
wl_48_d:
  s_mov_b64 exec, -1
wt_47:
  s_lshl_b32 s83, s81, 5
  s_add_u32 s83, s83, s82
  s_lshl_b32 s84, s83, 13
  s_add_u32 s85, s84, 37748736
  s_add_u32 s86, s85, 4096
  buffer_load_dwordx4 v[32:35], v4, s[36:39], s85 offen offset:0
  buffer_load_dwordx4 v[36:39], v4, s[36:39], s85 offen offset:1024
  buffer_load_dwordx4 v[40:43], v4, s[36:39], s85 offen offset:2048
  buffer_load_dwordx4 v[44:47], v4, s[36:39], s85 offen offset:3072
  buffer_load_dwordx4 v[48:51], v4, s[36:39], s86 offen offset:0
  buffer_load_dwordx4 v[52:55], v4, s[36:39], s86 offen offset:1024
  buffer_load_dwordx4 v[56:59], v4, s[36:39], s86 offen offset:2048
  buffer_load_dwordx4 v[60:63], v4, s[36:39], s86 offen offset:3072
  s_add_u32 s85, s84, 4194304
  s_add_u32 s86, s85, 4096
  buffer_load_dwordx4 v[64:67], v4, s[36:39], s85 offen offset:0
  buffer_load_dwordx4 v[68:71], v4, s[36:39], s85 offen offset:1024
  buffer_load_dwordx4 v[72:75], v4, s[36:39], s85 offen offset:2048
  buffer_load_dwordx4 v[76:79], v4, s[36:39], s85 offen offset:3072
  buffer_load_dwordx4 v[80:83], v4, s[36:39], s86 offen offset:0
  buffer_load_dwordx4 v[84:87], v4, s[36:39], s86 offen offset:1024
  buffer_load_dwordx4 v[88:91], v4, s[36:39], s86 offen offset:2048
  buffer_load_dwordx4 v[92:95], v4, s[36:39], s86 offen offset:3072
  s_add_u32 s85, s84, 20971520
  s_add_u32 s86, s85, 4096
  buffer_load_dwordx4 v[96:99], v4, s[36:39], s85 offen offset:0
  buffer_load_dwordx4 v[100:103], v4, s[36:39], s85 offen offset:1024
  buffer_load_dwordx4 v[104:107], v4, s[36:39], s85 offen offset:2048
  buffer_load_dwordx4 v[108:111], v4, s[36:39], s85 offen offset:3072
  buffer_load_dwordx4 v[112:115], v4, s[36:39], s86 offen offset:0
  buffer_load_dwordx4 v[116:119], v4, s[36:39], s86 offen offset:1024
  buffer_load_dwordx4 v[120:123], v4, s[36:39], s86 offen offset:2048
  buffer_load_dwordx4 v[124:127], v4, s[36:39], s86 offen offset:3072
  v_mov_b32 v162, 0
  v_mov_b32 v163, 0
  v_mov_b32 v166, 0
  v_mov_b32 v167, 0
  v_mov_b32 v170, 0
  v_mov_b32 v171, 0
  v_mov_b32 v174, 0
  v_mov_b32 v175, 0
  v_mov_b32 v218, 0
  v_mov_b32 v219, 0
  s_waitcnt vmcnt(8)
  v_mfma_f32_32x32x16_bf16 v[176:191], v[64:67], v[32:35], 0
  v_mfma_f32_32x32x16_bf16 v[176:191], v[68:71], v[36:39], v[176:191]
  v_mfma_f32_32x32x16_bf16 v[176:191], v[72:75], v[40:43], v[176:191]
  v_mfma_f32_32x32x16_bf16 v[176:191], v[76:79], v[44:47], v[176:191]
  v_mfma_f32_32x32x16_bf16 v[176:191], v[80:83], v[48:51], v[176:191]
  v_mfma_f32_32x32x16_bf16 v[176:191], v[84:87], v[52:55], v[176:191]
  v_mfma_f32_32x32x16_bf16 v[176:191], v[88:91], v[56:59], v[176:191]
  v_mfma_f32_32x32x16_bf16 v[176:191], v[92:95], v[60:63], v[176:191]
  v_mov_b32 v226, 0xff800000
  v_cmp_le_i32 vcc, 0, v7
  s_nop 9
  v_cndmask_b32 v176, v226, v176, vcc
  v_cmp_le_i32 vcc, 1, v7
  s_nop 1
  v_cndmask_b32 v177, v226, v177, vcc
  v_cmp_le_i32 vcc, 2, v7
  s_nop 1
  v_cndmask_b32 v178, v226, v178, vcc
  v_cmp_le_i32 vcc, 3, v7
  s_nop 1
  v_cndmask_b32 v179, v226, v179, vcc
  v_cmp_le_i32 vcc, 8, v7
  s_nop 1
  v_cndmask_b32 v180, v226, v180, vcc
  v_cmp_le_i32 vcc, 9, v7
  s_nop 1
  v_cndmask_b32 v181, v226, v181, vcc
  v_cmp_le_i32 vcc, 10, v7
  s_nop 1
  v_cndmask_b32 v182, v226, v182, vcc
  v_cmp_le_i32 vcc, 11, v7
  s_nop 1
  v_cndmask_b32 v183, v226, v183, vcc
  v_cmp_le_i32 vcc, 16, v7
  s_nop 1
  v_cndmask_b32 v184, v226, v184, vcc
  v_cmp_le_i32 vcc, 17, v7
  s_nop 1
  v_cndmask_b32 v185, v226, v185, vcc
  v_cmp_le_i32 vcc, 18, v7
  s_nop 1
  v_cndmask_b32 v186, v226, v186, vcc
  v_cmp_le_i32 vcc, 19, v7
  s_nop 1
  v_cndmask_b32 v187, v226, v187, vcc
  v_cmp_le_i32 vcc, 24, v7
  s_nop 1
  v_cndmask_b32 v188, v226, v188, vcc
  v_cmp_le_i32 vcc, 25, v7
  s_nop 1
  v_cndmask_b32 v189, v226, v189, vcc
  v_cmp_le_i32 vcc, 26, v7
  s_nop 1
  v_cndmask_b32 v190, v226, v190, vcc
  v_cmp_le_i32 vcc, 27, v7
  s_nop 1
  v_cndmask_b32 v191, v226, v191, vcc
  v_max3_f32 v224, v176, v177, v178
  v_max3_f32 v224, v224, v179, v180
  v_max3_f32 v224, v224, v181, v182
  v_max3_f32 v224, v224, v183, v184
  v_max3_f32 v224, v224, v185, v186
  v_max3_f32 v224, v224, v187, v188
  v_max3_f32 v224, v224, v189, v190
  s_lshl_b32 s85, s82, 8
  s_add_u32 s85, s85, 16384
  s_add_u32 s86, s81, 1
  s_mov_b64 exec, 0x3
  v_mul_u32_u24 v3, 8192, v1
wl_50:
  buffer_load_dword v2, v3, s[36:39], s85 offen sc1
  s_waitcnt vmcnt(0)
  v_cmp_gt_u32 vcc, s86, v2
  s_nop 0
  s_cbranch_vccz wl_50_d
  s_sleep 1
  s_sub_u32 s56, s56, 1
  s_cbranch_scc0 wl_50
  s_mov_b32 s56, 0
wl_50_d:
  s_mov_b64 exec, -1
wt_49:
  s_lshl_b32 s84, s83, 11
  s_add_u32 s85, s84, 71303168
  s_add_u32 s86, s84, 75497472
  buffer_load_dwordx4 v[128:131], v5, s[36:39], s85 offen offset:0
  buffer_load_dwordx4 v[132:135], v5, s[36:39], s85 offen offset:256
  buffer_load_dwordx4 v[136:139], v5, s[36:39], s85 offen offset:512
  buffer_load_dwordx4 v[140:143], v5, s[36:39], s85 offen offset:768
  buffer_load_dwordx4 v[144:147], v5, s[36:39], s85 offen offset:1024
  buffer_load_dwordx4 v[148:151], v5, s[36:39], s85 offen offset:1280
  buffer_load_dwordx4 v[152:155], v5, s[36:39], s85 offen offset:1536
  buffer_load_dwordx4 v[156:159], v5, s[36:39], s85 offen offset:1792
  buffer_load_dwordx2 v[160:161], v6, s[36:39], s86 offen offset:0
  buffer_load_dwordx2 v[164:165], v6, s[36:39], s86 offen offset:512
  buffer_load_dwordx2 v[168:169], v6, s[36:39], s86 offen offset:1024
  buffer_load_dwordx2 v[172:173], v6, s[36:39], s86 offen offset:1536
  s_waitcnt vmcnt(4)
  v_mfma_f32_32x32x16_bf16 v[192:207], v[128:131], v[32:35], 0
  v_mfma_f32_32x32x16_bf16 v[192:207], v[132:135], v[36:39], v[192:207]
  v_mfma_f32_32x32x16_bf16 v[192:207], v[136:139], v[40:43], v[192:207]
  v_mfma_f32_32x32x16_bf16 v[192:207], v[140:143], v[44:47], v[192:207]
  v_mfma_f32_32x32x16_bf16 v[192:207], v[144:147], v[48:51], v[192:207]
  v_mfma_f32_32x32x16_bf16 v[192:207], v[148:151], v[52:55], v[192:207]
  v_mfma_f32_32x32x16_bf16 v[192:207], v[152:155], v[56:59], v[192:207]
  v_mfma_f32_32x32x16_bf16 v[192:207], v[156:159], v[60:63], v[192:207]
  s_nop 11
  v_max3_f32 v224, v224, v191, v192
  v_max3_f32 v224, v224, v193, v194
  v_max_f32 v224, v224, v195
  v_mov_b32 v225, v224
  s_nop 1
  v_permlane32_swap_b32 v224, v225
  v_max_f32 v224, v224, v225
  s_mov_b32 s84, 0x3e0293ee
  v_mul_f32 v224, s84, v224
  v_fma_f32 v176, v176, s84, -v224
  v_fma_f32 v177, v177, s84, -v224
  v_fma_f32 v178, v178, s84, -v224
  v_fma_f32 v179, v179, s84, -v224
  v_fma_f32 v180, v180, s84, -v224
  v_fma_f32 v181, v181, s84, -v224
  v_fma_f32 v182, v182, s84, -v224
  v_fma_f32 v183, v183, s84, -v224
  v_fma_f32 v184, v184, s84, -v224
  v_fma_f32 v185, v185, s84, -v224
  v_fma_f32 v186, v186, s84, -v224
  v_fma_f32 v187, v187, s84, -v224
  v_fma_f32 v188, v188, s84, -v224
  v_fma_f32 v189, v189, s84, -v224
  v_fma_f32 v190, v190, s84, -v224
  v_fma_f32 v191, v191, s84, -v224
  v_fma_f32 v192, v192, s84, -v224
  v_fma_f32 v193, v193, s84, -v224
  v_fma_f32 v194, v194, s84, -v224
  v_fma_f32 v195, v195, s84, -v224
  v_exp_f32 v176, v176
  v_exp_f32 v177, v177
  v_exp_f32 v178, v178
  v_exp_f32 v179, v179
  v_exp_f32 v180, v180
  v_exp_f32 v181, v181
  v_exp_f32 v182, v182
  v_exp_f32 v183, v183
  v_exp_f32 v184, v184
  v_exp_f32 v185, v185
  v_exp_f32 v186, v186
  v_exp_f32 v187, v187
  v_exp_f32 v188, v188
  v_exp_f32 v189, v189
  v_exp_f32 v190, v190
  v_exp_f32 v191, v191
  v_exp_f32 v192, v192
  v_exp_f32 v193, v193
  v_exp_f32 v194, v194
  v_exp_f32 v195, v195
  v_cvt_pk_bf16_f32 v208, v176, v177
  v_cvt_pk_bf16_f32 v209, v178, v179
  v_cvt_pk_bf16_f32 v210, v180, v181
  v_cvt_pk_bf16_f32 v211, v182, v183
  v_cvt_pk_bf16_f32 v212, v184, v185
  v_cvt_pk_bf16_f32 v213, v186, v187
  v_cvt_pk_bf16_f32 v214, v188, v189
  v_cvt_pk_bf16_f32 v215, v190, v191
  v_cvt_pk_bf16_f32 v216, v192, v193
  v_cvt_pk_bf16_f32 v217, v194, v195
  s_waitcnt vmcnt(0)
  v_mfma_f32_32x32x16_bf16 v[32:47], v[96:99], v[208:211], 0
  v_mfma_f32_32x32x16_bf16 v[32:47], v[100:103], v[212:215], v[32:47]
  v_mfma_f32_32x32x16_bf16 v[32:47], v[160:163], v[216:219], v[32:47]
  v_mfma_f32_32x32x16_bf16 v[48:63], v[104:107], v[208:211], 0
  v_mfma_f32_32x32x16_bf16 v[48:63], v[108:111], v[212:215], v[48:63]
  v_mfma_f32_32x32x16_bf16 v[48:63], v[164:167], v[216:219], v[48:63]
  v_mfma_f32_32x32x16_bf16 v[64:79], v[112:115], v[208:211], 0
  v_mfma_f32_32x32x16_bf16 v[64:79], v[116:119], v[212:215], v[64:79]
  v_mfma_f32_32x32x16_bf16 v[64:79], v[168:171], v[216:219], v[64:79]
  v_mfma_f32_32x32x16_bf16 v[80:95], v[120:123], v[208:211], 0
  v_mfma_f32_32x32x16_bf16 v[80:95], v[124:127], v[212:215], v[80:95]
  v_mfma_f32_32x32x16_bf16 v[80:95], v[172:175], v[216:219], v[80:95]
  v_add_f32 v224, v176, v177
  v_add_f32 v224, v224, v178
  v_add_f32 v224, v224, v179
  v_add_f32 v224, v224, v180
  v_add_f32 v224, v224, v181
  v_add_f32 v224, v224, v182
  v_add_f32 v224, v224, v183
  v_add_f32 v224, v224, v184
  v_add_f32 v224, v224, v185
  v_add_f32 v224, v224, v186
  v_add_f32 v224, v224, v187
  v_add_f32 v224, v224, v188
  v_add_f32 v224, v224, v189
  v_add_f32 v224, v224, v190
  v_add_f32 v224, v224, v191
  v_add_f32 v224, v224, v192
  v_add_f32 v224, v224, v193
  v_add_f32 v224, v224, v194
  v_add_f32 v224, v224, v195
  v_mov_b32 v225, v224
  s_nop 1
  v_permlane32_swap_b32 v224, v225
  v_add_f32 v224, v224, v225
  v_rcp_f32 v224, v224
  s_lshl_b32 s84, s83, 13
  s_add_u32 s85, s84, 54525952
  s_add_u32 s86, s85, 4096
  v_mul_f32 v32, v32, v224
  v_mul_f32 v33, v33, v224
  v_mul_f32 v34, v34, v224
  v_mul_f32 v35, v35, v224
  v_mul_f32 v36, v36, v224
  v_mul_f32 v37, v37, v224
  v_mul_f32 v38, v38, v224
  v_mul_f32 v39, v39, v224
  v_mul_f32 v40, v40, v224
  v_mul_f32 v41, v41, v224
  v_mul_f32 v42, v42, v224
  v_mul_f32 v43, v43, v224
  v_mul_f32 v44, v44, v224
  v_mul_f32 v45, v45, v224
  v_mul_f32 v46, v46, v224
  v_mul_f32 v47, v47, v224
  v_cvt_pk_bf16_f32 v128, v32, v33
  v_cvt_pk_bf16_f32 v129, v34, v35
  v_cvt_pk_bf16_f32 v130, v36, v37
  v_cvt_pk_bf16_f32 v131, v38, v39
  v_cvt_pk_bf16_f32 v132, v40, v41
  v_cvt_pk_bf16_f32 v133, v42, v43
  v_cvt_pk_bf16_f32 v134, v44, v45
  v_cvt_pk_bf16_f32 v135, v46, v47
  buffer_store_dwordx4 v[128:131], v4, s[36:39], s85 offen offset:0 sc1
  buffer_store_dwordx4 v[132:135], v4, s[36:39], s85 offen offset:1024 sc1
  v_mul_f32 v48, v48, v224
  v_mul_f32 v49, v49, v224
  v_mul_f32 v50, v50, v224
  v_mul_f32 v51, v51, v224
  v_mul_f32 v52, v52, v224
  v_mul_f32 v53, v53, v224
  v_mul_f32 v54, v54, v224
  v_mul_f32 v55, v55, v224
  v_mul_f32 v56, v56, v224
  v_mul_f32 v57, v57, v224
  v_mul_f32 v58, v58, v224
  v_mul_f32 v59, v59, v224
  v_mul_f32 v60, v60, v224
  v_mul_f32 v61, v61, v224
  v_mul_f32 v62, v62, v224
  v_mul_f32 v63, v63, v224
  v_cvt_pk_bf16_f32 v136, v48, v49
  v_cvt_pk_bf16_f32 v137, v50, v51
  v_cvt_pk_bf16_f32 v138, v52, v53
  v_cvt_pk_bf16_f32 v139, v54, v55
  v_cvt_pk_bf16_f32 v140, v56, v57
  v_cvt_pk_bf16_f32 v141, v58, v59
  v_cvt_pk_bf16_f32 v142, v60, v61
  v_cvt_pk_bf16_f32 v143, v62, v63
  buffer_store_dwordx4 v[136:139], v4, s[36:39], s85 offen offset:2048 sc1
  buffer_store_dwordx4 v[140:143], v4, s[36:39], s85 offen offset:3072 sc1
  v_mul_f32 v64, v64, v224
  v_mul_f32 v65, v65, v224
  v_mul_f32 v66, v66, v224
  v_mul_f32 v67, v67, v224
  v_mul_f32 v68, v68, v224
  v_mul_f32 v69, v69, v224
  v_mul_f32 v70, v70, v224
  v_mul_f32 v71, v71, v224
  v_mul_f32 v72, v72, v224
  v_mul_f32 v73, v73, v224
  v_mul_f32 v74, v74, v224
  v_mul_f32 v75, v75, v224
  v_mul_f32 v76, v76, v224
  v_mul_f32 v77, v77, v224
  v_mul_f32 v78, v78, v224
  v_mul_f32 v79, v79, v224
  v_cvt_pk_bf16_f32 v144, v64, v65
  v_cvt_pk_bf16_f32 v145, v66, v67
  v_cvt_pk_bf16_f32 v146, v68, v69
  v_cvt_pk_bf16_f32 v147, v70, v71
  v_cvt_pk_bf16_f32 v148, v72, v73
  v_cvt_pk_bf16_f32 v149, v74, v75
  v_cvt_pk_bf16_f32 v150, v76, v77
  v_cvt_pk_bf16_f32 v151, v78, v79
  buffer_store_dwordx4 v[144:147], v4, s[36:39], s86 offen offset:0 sc1
  buffer_store_dwordx4 v[148:151], v4, s[36:39], s86 offen offset:1024 sc1
  v_mul_f32 v80, v80, v224
  v_mul_f32 v81, v81, v224
  v_mul_f32 v82, v82, v224
  v_mul_f32 v83, v83, v224
  v_mul_f32 v84, v84, v224
  v_mul_f32 v85, v85, v224
  v_mul_f32 v86, v86, v224
  v_mul_f32 v87, v87, v224
  v_mul_f32 v88, v88, v224
  v_mul_f32 v89, v89, v224
  v_mul_f32 v90, v90, v224
  v_mul_f32 v91, v91, v224
  v_mul_f32 v92, v92, v224
  v_mul_f32 v93, v93, v224
  v_mul_f32 v94, v94, v224
  v_mul_f32 v95, v95, v224
  v_cvt_pk_bf16_f32 v152, v80, v81
  v_cvt_pk_bf16_f32 v153, v82, v83
  v_cvt_pk_bf16_f32 v154, v84, v85
  v_cvt_pk_bf16_f32 v155, v86, v87
  v_cvt_pk_bf16_f32 v156, v88, v89
  v_cvt_pk_bf16_f32 v157, v90, v91
  v_cvt_pk_bf16_f32 v158, v92, v93
  v_cvt_pk_bf16_f32 v159, v94, v95
  buffer_store_dwordx4 v[152:155], v4, s[36:39], s86 offen offset:2048 sc1
  buffer_store_dwordx4 v[156:159], v4, s[36:39], s86 offen offset:3072 sc1
  s_add_u32 s80, s80, 24
  s_cmp_lt_u32 s80, s89
  s_cbranch_scc1 L_j6_loop
  s_cmp_lg_u32 s89, 0
  s_cbranch_scc1 L_j6_sig
  s_lshl_b32 s80, s82, 2
  s_add_u32 s80, s80, s88
  v_mov_b32 v2, 1
  v_mov_b32 v3, 0
  s_mov_b64 exec, 1
  s_waitcnt vmcnt(0)
  buffer_store_dword v2, v3, s[36:39], s80 offen sc1
  s_mov_b64 exec, -1
  s_branch L_next
L_j6_sig:
  s_add_u32 s80, s88, 6144
  s_waitcnt vmcnt(0) lgkmcnt(0)
  s_barrier
  s_cmp_lg_u32 s57, 0
  s_cbranch_scc1 sg_51
  s_mov_b64 exec, 1
  v_mov_b32 v2, 1
  v_mov_b32 v3, 0
  buffer_atomic_add v2, v3, s[36:39], s80 offen sc1
  s_mov_b64 exec, -1
sg_51:
  s_branch L_next
L_fast2:
  s_add_u32 s87, s58, 4
  s_cmp_lt_u32 s59, 27
  s_cbranch_scc0 L_fa2_hi
  s_cmp_ge_u32 s58, 4
  s_cbranch_scc1 L_f7_go
  s_branch L_exit
L_fa2_hi:
  s_cmp_ge_u32 s58, 2
  s_cbranch_scc1 L_exit
  s_mul_i32 s82, s58, 5
  s_add_u32 s82, s82, s59
  s_add_u32 s82, s82, 43
  s_branch L_fa_6
L_fa_hi:
  s_mul_i32 s82, s58, 5
  s_add_u32 s82, s82, s59
  s_sub_u32 s82, s82, 27
L_fa_6:
  s_lshr_b32 s87, s82, 3
  s_lshl_b32 s88, s87, 7
  s_add_u32 s88, s88, 10496
  s_add_u32 s87, s87, 54
  s_and_b32 s80, s82, 7
  s_lshl_b32 s80, s80, 2
  s_add_u32 s80, s80, s57
  s_mov_b32 s89, 0
  s_branch L_j6_go
L_fast:
  s_cmp_ge_u32 s59, 27
  s_cbranch_scc1 L_fa_hi
  s_cmp_ge_u32 s59, 20
  s_cbranch_scc1 L_exit
  s_mov_b32 s80, 5120
  s_cmp_lg_u32 s57, 0
  s_cbranch_scc1 wt_52
  s_mov_b64 exec, 0x1
  v_mul_u32_u24 v3, 4, v1
wl_53:
  buffer_load_dword v2, v3, s[36:39], s80 offen sc1
  s_waitcnt vmcnt(0)
  v_cmp_gt_u32 vcc, 32, v2
  s_nop 0
  s_cbranch_vccz wl_53_d
  s_sleep 4
  s_sub_u32 s56, s56, 1
  s_cbranch_scc0 wl_53
  s_mov_b32 s56, 0
wl_53_d:
  s_mov_b64 exec, -1
wt_52:
  s_barrier
  v_lshlrev_b32 v4, 4, v1
  s_lshr_b32 s82, s59, 2
  s_mul_i32 s82, s82, 296
  s_lshl_b32 s83, s57, 6
  s_add_u32 s82, s82, s83
  s_lshl_b32 s82, s82, 2
  s_and_b32 s83, s59, 3
  s_add_u32 s82, s82, s83
  s_lshl_b32 s82, s82, 10
  s_add_u32 s82, s82, 93323264
  buffer_load_dwordx4 a[0:3], v4, s[36:39], s82 offen
  s_add_u32 s82, s82, 4096
  buffer_load_dwordx4 a[4:7], v4, s[36:39], s82 offen
  s_add_u32 s82, s82, 4096
  buffer_load_dwordx4 a[8:11], v4, s[36:39], s82 offen
  s_add_u32 s82, s82, 4096
  buffer_load_dwordx4 a[12:15], v4, s[36:39], s82 offen
  s_add_u32 s82, s82, 4096
  buffer_load_dwordx4 a[16:19], v4, s[36:39], s82 offen
  s_add_u32 s82, s82, 4096
  buffer_load_dwordx4 a[20:23], v4, s[36:39], s82 offen
  s_add_u32 s82, s82, 4096
  buffer_load_dwordx4 a[24:27], v4, s[36:39], s82 offen
  s_add_u32 s82, s82, 4096
  buffer_load_dwordx4 a[28:31], v4, s[36:39], s82 offen
  s_add_u32 s82, s82, 4096
  buffer_load_dwordx4 a[32:35], v4, s[36:39], s82 offen
  s_add_u32 s82, s82, 4096
  buffer_load_dwordx4 a[36:39], v4, s[36:39], s82 offen
  s_add_u32 s82, s82, 4096
  buffer_load_dwordx4 a[40:43], v4, s[36:39], s82 offen
  s_add_u32 s82, s82, 4096
  buffer_load_dwordx4 a[44:47], v4, s[36:39], s82 offen
  s_add_u32 s82, s82, 4096
  buffer_load_dwordx4 a[48:51], v4, s[36:39], s82 offen
  s_add_u32 s82, s82, 4096
  buffer_load_dwordx4 a[52:55], v4, s[36:39], s82 offen
  s_add_u32 s82, s82, 4096
  buffer_load_dwordx4 a[56:59], v4, s[36:39], s82 offen
  s_add_u32 s82, s82, 4096
  buffer_load_dwordx4 a[60:63], v4, s[36:39], s82 offen
  s_add_u32 s82, s82, 4096
  buffer_load_dwordx4 a[64:67], v4, s[36:39], s82 offen
  s_add_u32 s82, s82, 4096
  buffer_load_dwordx4 a[68:71], v4, s[36:39], s82 offen
  s_add_u32 s82, s82, 4096
  buffer_load_dwordx4 a[72:75], v4, s[36:39], s82 offen
  s_add_u32 s82, s82, 4096
  buffer_load_dwordx4 a[76:79], v4, s[36:39], s82 offen
  s_add_u32 s82, s82, 4096
  buffer_load_dwordx4 a[80:83], v4, s[36:39], s82 offen
  s_add_u32 s82, s82, 4096
  buffer_load_dwordx4 a[84:87], v4, s[36:39], s82 offen
  s_add_u32 s82, s82, 4096
  buffer_load_dwordx4 a[88:91], v4, s[36:39], s82 offen
  s_add_u32 s82, s82, 4096
  buffer_load_dwordx4 a[92:95], v4, s[36:39], s82 offen
  s_add_u32 s82, s82, 4096
  buffer_load_dwordx4 a[96:99], v4, s[36:39], s82 offen
  s_add_u32 s82, s82, 4096
  buffer_load_dwordx4 a[100:103], v4, s[36:39], s82 offen
  s_add_u32 s82, s82, 4096
  buffer_load_dwordx4 a[104:107], v4, s[36:39], s82 offen
  s_add_u32 s82, s82, 4096
  buffer_load_dwordx4 a[108:111], v4, s[36:39], s82 offen
  s_add_u32 s82, s82, 4096
  buffer_load_dwordx4 a[112:115], v4, s[36:39], s82 offen
  s_add_u32 s82, s82, 4096
  buffer_load_dwordx4 a[116:119], v4, s[36:39], s82 offen
  s_add_u32 s82, s82, 4096
  buffer_load_dwordx4 a[120:123], v4, s[36:39], s82 offen
  s_add_u32 s82, s82, 4096
  buffer_load_dwordx4 a[124:127], v4, s[36:39], s82 offen
  s_add_u32 s82, s82, 4096
  s_waitcnt vmcnt(0)
  buffer_load_dwordx4 a[128:131], v4, s[36:39], s82 offen
  s_add_u32 s82, s82, 4096
  buffer_load_dwordx4 a[132:135], v4, s[36:39], s82 offen
  s_add_u32 s82, s82, 4096
  buffer_load_dwordx4 a[136:139], v4, s[36:39], s82 offen
  s_add_u32 s82, s82, 4096
  buffer_load_dwordx4 a[140:143], v4, s[36:39], s82 offen
  s_add_u32 s82, s82, 4096
  buffer_load_dwordx4 a[144:147], v4, s[36:39], s82 offen
  s_add_u32 s82, s82, 4096
  buffer_load_dwordx4 a[148:151], v4, s[36:39], s82 offen
  s_add_u32 s82, s82, 4096
  buffer_load_dwordx4 a[152:155], v4, s[36:39], s82 offen
  s_add_u32 s82, s82, 4096
  buffer_load_dwordx4 a[156:159], v4, s[36:39], s82 offen
  s_add_u32 s82, s82, 4096
  buffer_load_dwordx4 a[160:163], v4, s[36:39], s82 offen
  s_add_u32 s82, s82, 4096
  buffer_load_dwordx4 a[164:167], v4, s[36:39], s82 offen
  s_add_u32 s82, s82, 4096
  buffer_load_dwordx4 a[168:171], v4, s[36:39], s82 offen
  s_add_u32 s82, s82, 4096
  buffer_load_dwordx4 a[172:175], v4, s[36:39], s82 offen
  s_add_u32 s82, s82, 4096
  buffer_load_dwordx4 a[176:179], v4, s[36:39], s82 offen
  s_add_u32 s82, s82, 4096
  buffer_load_dwordx4 a[180:183], v4, s[36:39], s82 offen
  s_add_u32 s82, s82, 4096
  buffer_load_dwordx4 a[184:187], v4, s[36:39], s82 offen
  s_add_u32 s82, s82, 4096
  buffer_load_dwordx4 a[188:191], v4, s[36:39], s82 offen
  s_add_u32 s82, s82, 4096
  buffer_load_dwordx4 a[192:195], v4, s[36:39], s82 offen
  s_add_u32 s82, s82, 4096
  buffer_load_dwordx4 a[196:199], v4, s[36:39], s82 offen
  s_add_u32 s82, s82, 4096
  buffer_load_dwordx4 a[200:203], v4, s[36:39], s82 offen
  s_add_u32 s82, s82, 4096
  buffer_load_dwordx4 a[204:207], v4, s[36:39], s82 offen
  s_add_u32 s82, s82, 4096
  buffer_load_dwordx4 a[208:211], v4, s[36:39], s82 offen
  s_add_u32 s82, s82, 4096
  buffer_load_dwordx4 a[212:215], v4, s[36:39], s82 offen
  s_add_u32 s82, s82, 4096
  buffer_load_dwordx4 a[216:219], v4, s[36:39], s82 offen
  s_add_u32 s82, s82, 4096
  buffer_load_dwordx4 a[220:223], v4, s[36:39], s82 offen
  s_add_u32 s82, s82, 4096
  buffer_load_dwordx4 a[224:227], v4, s[36:39], s82 offen
  s_add_u32 s82, s82, 4096
  buffer_load_dwordx4 a[228:231], v4, s[36:39], s82 offen
  s_add_u32 s82, s82, 4096
  buffer_load_dwordx4 a[232:235], v4, s[36:39], s82 offen
  s_add_u32 s82, s82, 4096
  buffer_load_dwordx4 a[236:239], v4, s[36:39], s82 offen
  s_add_u32 s82, s82, 4096
  buffer_load_dwordx4 a[240:243], v4, s[36:39], s82 offen
  s_add_u32 s82, s82, 4096
  buffer_load_dwordx4 a[244:247], v4, s[36:39], s82 offen
  s_add_u32 s82, s82, 4096
  buffer_load_dwordx4 a[248:251], v4, s[36:39], s82 offen
  s_add_u32 s82, s82, 4096
  buffer_load_dwordx4 a[252:255], v4, s[36:39], s82 offen
  s_add_u32 s82, s82, 4096
  s_waitcnt vmcnt(0)
  s_cmp_eq_u32 s58, 5
  s_cselect_b32 s82, 30, 50
  s_add_u32 s82, s82, s59
  s_cmp_ge_u32 s58, 4
  s_cbranch_scc1 L_fa_6
  s_mov_b32 s87, s58
L_f7_go:
  v_lshlrev_b32 v4, 4, v1
  v_and_b32 v5, 31, v1
  v_mul_u32_u24 v5, 2560, v5
  v_lshrrev_b32 v6, 5, v1
  v_lshl_add_u32 v5, v6, 3, v5
  s_lshl_b32 s83, s57, 12
  v_add_u32 v6, s83, v4
  s_lshl_b32 s83, s57, 10
  v_add_u32 v7, s83, v4
L_f7_loop:
  s_lshl_b32 s80, s87, 7
  s_add_u32 s80, s80, 10496
  s_add_u32 s81, s87, 54
  s_lshl_b32 s82, s81, 2
  s_add_u32 s82, s82, s57
  s_lshl_b32 s82, s82, 16
  s_add_u32 s82, s82, 54525952
  s_mul_i32 s84, s81, 81920
  s_lshl_b32 s83, s59, 6
  s_add_u32 s84, s84, s83
  s_lshl_b32 s83, s57, 4
  s_add_u32 s84, s84, s83
  s_add_u32 s84, s84, 1280
  s_cmp_ge_u32 s58, 4
  s_cselect_b32 s85, 16, 0
  v_and_b32 v8, 15, v1
  v_add_u32 v8, s85, v8
  v_lshlrev_b32 v8, 4, v8
  v_lshrrev_b32 v9, 5, v1
  v_lshl_add_u32 v8, v9, 9, v8
  v_bfe_u32 v9, v1, 4, 1
  v_lshl_add_u32 v31, v9, 10, v8
  s_cmp_lg_u32 s57, 0
  s_cbranch_scc1 wt_54
  s_mov_b64 exec, 0xffffffff
  v_mul_u32_u24 v3, 4, v1
wl_55:
  buffer_load_dword v2, v3, s[36:39], s80 offen sc1
  s_waitcnt vmcnt(0)
  v_cmp_gt_u32 vcc, 1, v2
  s_nop 0
  s_cbranch_vccz wl_55_d
  s_sleep 1
  s_sub_u32 s56, s56, 1
  s_cbranch_scc0 wl_55
  s_mov_b32 s56, 0
wl_55_d:
  s_mov_b64 exec, -1
wt_54:
  s_barrier
  s_cmp_ge_u32 s87, 8
  s_cbranch_scc1 L_f7h
  buffer_load_dwordx4 v[32:35], v4, s[36:39], s82 offen offset:0
  buffer_load_dwordx4 v[36:39], v4, s[36:39], s82 offen offset:1024
  buffer_load_dwordx4 v[40:43], v4, s[36:39], s82 offen offset:2048
  buffer_load_dwordx4 v[44:47], v4, s[36:39], s82 offen offset:3072
  s_add_u32 s82, s82, 4096
  buffer_load_dwordx4 v[48:51], v4, s[36:39], s82 offen offset:0
  buffer_load_dwordx4 v[52:55], v4, s[36:39], s82 offen offset:1024
  buffer_load_dwordx4 v[56:59], v4, s[36:39], s82 offen offset:2048
  buffer_load_dwordx4 v[60:63], v4, s[36:39], s82 offen offset:3072
  s_add_u32 s82, s82, 4096
  buffer_load_dwordx4 v[64:67], v4, s[36:39], s82 offen offset:0
  buffer_load_dwordx4 v[68:71], v4, s[36:39], s82 offen offset:1024
  buffer_load_dwordx4 v[72:75], v4, s[36:39], s82 offen offset:2048
  buffer_load_dwordx4 v[76:79], v4, s[36:39], s82 offen offset:3072
  s_add_u32 s82, s82, 4096
  buffer_load_dwordx4 v[80:83], v4, s[36:39], s82 offen offset:0
  buffer_load_dwordx4 v[84:87], v4, s[36:39], s82 offen offset:1024
  buffer_load_dwordx4 v[88:91], v4, s[36:39], s82 offen offset:2048
  buffer_load_dwordx4 v[92:95], v4, s[36:39], s82 offen offset:3072
  s_add_u32 s82, s82, 4096
  buffer_load_dwordx4 v[96:99], v4, s[36:39], s82 offen offset:0
  buffer_load_dwordx4 v[100:103], v4, s[36:39], s82 offen offset:1024
  buffer_load_dwordx4 v[104:107], v4, s[36:39], s82 offen offset:2048
  buffer_load_dwordx4 v[108:111], v4, s[36:39], s82 offen offset:3072
  s_add_u32 s82, s82, 4096
  buffer_load_dwordx4 v[112:115], v4, s[36:39], s82 offen offset:0
  buffer_load_dwordx4 v[116:119], v4, s[36:39], s82 offen offset:1024
  buffer_load_dwordx4 v[120:123], v4, s[36:39], s82 offen offset:2048
  buffer_load_dwordx4 v[124:127], v4, s[36:39], s82 offen offset:3072
  s_add_u32 s82, s82, 4096
  buffer_load_dwordx4 v[128:131], v4, s[36:39], s82 offen offset:0
  buffer_load_dwordx4 v[132:135], v4, s[36:39], s82 offen offset:1024
  buffer_load_dwordx4 v[136:139], v4, s[36:39], s82 offen offset:2048
  buffer_load_dwordx4 v[140:143], v4, s[36:39], s82 offen offset:3072
  s_add_u32 s82, s82, 4096
  buffer_load_dwordx4 v[144:147], v4, s[36:39], s82 offen offset:0
  buffer_load_dwordx4 v[148:151], v4, s[36:39], s82 offen offset:1024
  buffer_load_dwordx4 v[152:155], v4, s[36:39], s82 offen offset:2048
  buffer_load_dwordx4 v[156:159], v4, s[36:39], s82 offen offset:3072
  s_add_u32 s82, s82, 4096
  buffer_load_dwordx4 v[160:163], v4, s[36:39], s82 offen offset:0
  buffer_load_dwordx4 v[164:167], v4, s[36:39], s82 offen offset:1024
  buffer_load_dwordx4 v[168:171], v4, s[36:39], s82 offen offset:2048
  buffer_load_dwordx4 v[172:175], v4, s[36:39], s82 offen offset:3072
  s_add_u32 s82, s82, 4096
  buffer_load_dwordx4 v[176:179], v4, s[36:39], s82 offen offset:0
  buffer_load_dwordx4 v[180:183], v4, s[36:39], s82 offen offset:1024
  buffer_load_dwordx4 v[184:187], v4, s[36:39], s82 offen offset:2048
  buffer_load_dwordx4 v[188:191], v4, s[36:39], s82 offen offset:3072
  s_add_u32 s82, s82, 4096
  buffer_load_dwordx4 v[192:195], v4, s[36:39], s82 offen offset:0
  buffer_load_dwordx4 v[196:199], v4, s[36:39], s82 offen offset:1024
  buffer_load_dwordx4 v[200:203], v4, s[36:39], s82 offen offset:2048
  buffer_load_dwordx4 v[204:207], v4, s[36:39], s82 offen offset:3072
  s_add_u32 s82, s82, 4096
  buffer_load_dwordx4 v[208:211], v4, s[36:39], s82 offen offset:0
  buffer_load_dwordx4 v[212:215], v4, s[36:39], s82 offen offset:1024
  buffer_load_dwordx4 v[216:219], v4, s[36:39], s82 offen offset:2048
  buffer_load_dwordx4 v[220:223], v4, s[36:39], s82 offen offset:3072
  s_add_u32 s82, s82, 4096
  buffer_load_dwordx4 v[224:227], v4, s[36:39], s82 offen offset:0
  buffer_load_dwordx4 v[228:231], v4, s[36:39], s82 offen offset:1024
  buffer_load_dwordx4 v[232:235], v4, s[36:39], s82 offen offset:2048
  buffer_load_dwordx4 v[236:239], v4, s[36:39], s82 offen offset:3072
  s_add_u32 s82, s82, 4096
  buffer_load_dwordx4 v[240:243], v4, s[36:39], s82 offen offset:0
  buffer_load_dwordx4 v[244:247], v4, s[36:39], s82 offen offset:1024
  buffer_load_dwordx4 v[248:251], v4, s[36:39], s82 offen offset:2048
  buffer_load_dwordx4 v[252:255], v4, s[36:39], s82 offen offset:3072
  s_add_u32 s82, s82, 4096
  s_waitcnt vmcnt(55)
  v_mfma_f32_32x32x16_bf16 v[8:23], a[0:3], v[32:35], 0
  buffer_load_dwordx4 v[32:35], v4, s[36:39], s82 offen offset:0
  s_waitcnt vmcnt(55)
  v_mfma_f32_32x32x16_bf16 v[8:23], a[4:7], v[36:39], v[8:23]
  buffer_load_dwordx4 v[36:39], v4, s[36:39], s82 offen offset:1024
  s_waitcnt vmcnt(55)
  v_mfma_f32_32x32x16_bf16 v[8:23], a[8:11], v[40:43], v[8:23]
  buffer_load_dwordx4 v[40:43], v4, s[36:39], s82 offen offset:2048
  s_waitcnt vmcnt(55)
  v_mfma_f32_32x32x16_bf16 v[8:23], a[12:15], v[44:47], v[8:23]
  buffer_load_dwordx4 v[44:47], v4, s[36:39], s82 offen offset:3072
  s_add_u32 s82, s82, 4096
  s_waitcnt vmcnt(55)
  v_mfma_f32_32x32x16_bf16 v[8:23], a[16:19], v[48:51], v[8:23]
  buffer_load_dwordx4 v[48:51], v4, s[36:39], s82 offen offset:0
  s_waitcnt vmcnt(55)
  v_mfma_f32_32x32x16_bf16 v[8:23], a[20:23], v[52:55], v[8:23]
  buffer_load_dwordx4 v[52:55], v4, s[36:39], s82 offen offset:1024
  s_waitcnt vmcnt(55)
  v_mfma_f32_32x32x16_bf16 v[8:23], a[24:27], v[56:59], v[8:23]
  buffer_load_dwordx4 v[56:59], v4, s[36:39], s82 offen offset:2048
  s_waitcnt vmcnt(55)
  v_mfma_f32_32x32x16_bf16 v[8:23], a[28:31], v[60:63], v[8:23]
  buffer_load_dwordx4 v[60:63], v4, s[36:39], s82 offen offset:3072
  s_add_u32 s82, s82, 4096
  s_waitcnt vmcnt(55)
  v_mfma_f32_32x32x16_bf16 v[8:23], a[32:35], v[64:67], v[8:23]
  s_waitcnt vmcnt(54)
  v_mfma_f32_32x32x16_bf16 v[8:23], a[36:39], v[68:71], v[8:23]
  s_waitcnt vmcnt(53)
  v_mfma_f32_32x32x16_bf16 v[8:23], a[40:43], v[72:75], v[8:23]
  s_waitcnt vmcnt(52)
  v_mfma_f32_32x32x16_bf16 v[8:23], a[44:47], v[76:79], v[8:23]
  s_waitcnt vmcnt(51)
  v_mfma_f32_32x32x16_bf16 v[8:23], a[48:51], v[80:83], v[8:23]
  s_waitcnt vmcnt(50)
  v_mfma_f32_32x32x16_bf16 v[8:23], a[52:55], v[84:87], v[8:23]
  s_waitcnt vmcnt(49)
  v_mfma_f32_32x32x16_bf16 v[8:23], a[56:59], v[88:91], v[8:23]
  s_waitcnt vmcnt(48)
  v_mfma_f32_32x32x16_bf16 v[8:23], a[60:63], v[92:95], v[8:23]
  s_waitcnt vmcnt(47)
  v_mfma_f32_32x32x16_bf16 v[8:23], a[64:67], v[96:99], v[8:23]
  s_waitcnt vmcnt(46)
  v_mfma_f32_32x32x16_bf16 v[8:23], a[68:71], v[100:103], v[8:23]
  s_waitcnt vmcnt(45)
  v_mfma_f32_32x32x16_bf16 v[8:23], a[72:75], v[104:107], v[8:23]
  s_waitcnt vmcnt(44)
  v_mfma_f32_32x32x16_bf16 v[8:23], a[76:79], v[108:111], v[8:23]
  s_waitcnt vmcnt(43)
  v_mfma_f32_32x32x16_bf16 v[8:23], a[80:83], v[112:115], v[8:23]
  s_waitcnt vmcnt(42)
  v_mfma_f32_32x32x16_bf16 v[8:23], a[84:87], v[116:119], v[8:23]
  s_waitcnt vmcnt(41)
  v_mfma_f32_32x32x16_bf16 v[8:23], a[88:91], v[120:123], v[8:23]
  s_waitcnt vmcnt(40)
  v_mfma_f32_32x32x16_bf16 v[8:23], a[92:95], v[124:127], v[8:23]
  s_waitcnt vmcnt(39)
  v_mfma_f32_32x32x16_bf16 v[8:23], a[96:99], v[128:131], v[8:23]
  s_waitcnt vmcnt(38)
  v_mfma_f32_32x32x16_bf16 v[8:23], a[100:103], v[132:135], v[8:23]
  s_waitcnt vmcnt(37)
  v_mfma_f32_32x32x16_bf16 v[8:23], a[104:107], v[136:139], v[8:23]
  s_waitcnt vmcnt(36)
  v_mfma_f32_32x32x16_bf16 v[8:23], a[108:111], v[140:143], v[8:23]
  s_waitcnt vmcnt(35)
  v_mfma_f32_32x32x16_bf16 v[8:23], a[112:115], v[144:147], v[8:23]
  s_waitcnt vmcnt(34)
  v_mfma_f32_32x32x16_bf16 v[8:23], a[116:119], v[148:151], v[8:23]
  s_waitcnt vmcnt(33)
  v_mfma_f32_32x32x16_bf16 v[8:23], a[120:123], v[152:155], v[8:23]
  s_waitcnt vmcnt(32)
  v_mfma_f32_32x32x16_bf16 v[8:23], a[124:127], v[156:159], v[8:23]
  s_waitcnt vmcnt(31)
  v_mfma_f32_32x32x16_bf16 v[8:23], a[128:131], v[160:163], v[8:23]
  s_waitcnt vmcnt(30)
  v_mfma_f32_32x32x16_bf16 v[8:23], a[132:135], v[164:167], v[8:23]
  s_waitcnt vmcnt(29)
  v_mfma_f32_32x32x16_bf16 v[8:23], a[136:139], v[168:171], v[8:23]
  s_waitcnt vmcnt(28)
  v_mfma_f32_32x32x16_bf16 v[8:23], a[140:143], v[172:175], v[8:23]
  s_waitcnt vmcnt(27)
  v_mfma_f32_32x32x16_bf16 v[8:23], a[144:147], v[176:179], v[8:23]
  s_waitcnt vmcnt(26)
  v_mfma_f32_32x32x16_bf16 v[8:23], a[148:151], v[180:183], v[8:23]
  s_waitcnt vmcnt(25)
  v_mfma_f32_32x32x16_bf16 v[8:23], a[152:155], v[184:187], v[8:23]
  s_waitcnt vmcnt(24)
  v_mfma_f32_32x32x16_bf16 v[8:23], a[156:159], v[188:191], v[8:23]
  s_waitcnt vmcnt(23)
  v_mfma_f32_32x32x16_bf16 v[8:23], a[160:163], v[192:195], v[8:23]
  s_waitcnt vmcnt(22)
  v_mfma_f32_32x32x16_bf16 v[8:23], a[164:167], v[196:199], v[8:23]
  s_waitcnt vmcnt(21)
  v_mfma_f32_32x32x16_bf16 v[8:23], a[168:171], v[200:203], v[8:23]
  s_waitcnt vmcnt(20)
  v_mfma_f32_32x32x16_bf16 v[8:23], a[172:175], v[204:207], v[8:23]
  s_waitcnt vmcnt(19)
  v_mfma_f32_32x32x16_bf16 v[8:23], a[176:179], v[208:211], v[8:23]
  s_waitcnt vmcnt(18)
  v_mfma_f32_32x32x16_bf16 v[8:23], a[180:183], v[212:215], v[8:23]
  s_waitcnt vmcnt(17)
  v_mfma_f32_32x32x16_bf16 v[8:23], a[184:187], v[216:219], v[8:23]
  s_waitcnt vmcnt(16)
  v_mfma_f32_32x32x16_bf16 v[8:23], a[188:191], v[220:223], v[8:23]
  s_waitcnt vmcnt(15)
  v_mfma_f32_32x32x16_bf16 v[8:23], a[192:195], v[224:227], v[8:23]
  s_waitcnt vmcnt(14)
  v_mfma_f32_32x32x16_bf16 v[8:23], a[196:199], v[228:231], v[8:23]
  s_waitcnt vmcnt(13)
  v_mfma_f32_32x32x16_bf16 v[8:23], a[200:203], v[232:235], v[8:23]
  s_waitcnt vmcnt(12)
  v_mfma_f32_32x32x16_bf16 v[8:23], a[204:207], v[236:239], v[8:23]
  s_waitcnt vmcnt(11)
  v_mfma_f32_32x32x16_bf16 v[8:23], a[208:211], v[240:243], v[8:23]
  s_waitcnt vmcnt(10)
  v_mfma_f32_32x32x16_bf16 v[8:23], a[212:215], v[244:247], v[8:23]
  s_waitcnt vmcnt(9)
  v_mfma_f32_32x32x16_bf16 v[8:23], a[216:219], v[248:251], v[8:23]
  s_waitcnt vmcnt(8)
  v_mfma_f32_32x32x16_bf16 v[8:23], a[220:223], v[252:255], v[8:23]
  s_waitcnt vmcnt(7)
  v_mfma_f32_32x32x16_bf16 v[8:23], a[224:227], v[32:35], v[8:23]
  s_waitcnt vmcnt(6)
  v_mfma_f32_32x32x16_bf16 v[8:23], a[228:231], v[36:39], v[8:23]
  s_waitcnt vmcnt(5)
  v_mfma_f32_32x32x16_bf16 v[8:23], a[232:235], v[40:43], v[8:23]
  s_waitcnt vmcnt(4)
  v_mfma_f32_32x32x16_bf16 v[8:23], a[236:239], v[44:47], v[8:23]
  s_waitcnt vmcnt(3)
  v_mfma_f32_32x32x16_bf16 v[8:23], a[240:243], v[48:51], v[8:23]
  s_waitcnt vmcnt(2)
  v_mfma_f32_32x32x16_bf16 v[8:23], a[244:247], v[52:55], v[8:23]
  s_waitcnt vmcnt(1)
  v_mfma_f32_32x32x16_bf16 v[8:23], a[248:251], v[56:59], v[8:23]
  s_waitcnt vmcnt(0)
  v_mfma_f32_32x32x16_bf16 v[8:23], a[252:255], v[60:63], v[8:23]
  s_nop 11
  ds_write_b128 v6, v[8:11] offset:0
  ds_write_b128 v6, v[12:15] offset:1024
  ds_write_b128 v6, v[16:19] offset:2048
  ds_write_b128 v6, v[20:23] offset:3072
  s_waitcnt lgkmcnt(0)
  s_barrier
  ds_read_b128 v[32:35], v7 offset:0
  ds_read_b128 v[36:39], v7 offset:4096
  ds_read_b128 v[40:43], v7 offset:8192
  ds_read_b128 v[44:47], v7 offset:12288
  s_waitcnt lgkmcnt(0)
  v_add_f32 v32, v32, v36
  v_add_f32 v40, v40, v44
  v_add_f32 v33, v33, v37
  v_add_f32 v41, v41, v45
  v_add_f32 v34, v34, v38
  v_add_f32 v42, v42, v46
  v_add_f32 v35, v35, v39
  v_add_f32 v43, v43, v47
  v_add_f32 v32, v32, v40
  v_add_f32 v33, v33, v41
  v_add_f32 v34, v34, v42
  v_add_f32 v35, v35, v43
  v_cvt_pk_bf16_f32 v36, v32, v33
  v_cvt_pk_bf16_f32 v37, v34, v35
  buffer_store_dwordx2 v[36:37], v5, s[40:43], s84 offen
  s_barrier
  s_add_u32 s87, s87, 4
  s_cmp_lt_u32 s87, 10
  s_cbranch_scc1 L_f7_loop
  s_branch L_next
L_f7h:
  buffer_load_dwordx4 v[40:43], v31, s[36:39], s82 offen offset:0
  buffer_load_dwordx4 v[44:47], v31, s[36:39], s82 offen offset:2048
  s_add_u32 s82, s82, 4096
  buffer_load_dwordx4 v[48:51], v31, s[36:39], s82 offen offset:0
  buffer_load_dwordx4 v[52:55], v31, s[36:39], s82 offen offset:2048
  s_add_u32 s82, s82, 4096
  buffer_load_dwordx4 v[56:59], v31, s[36:39], s82 offen offset:0
  buffer_load_dwordx4 v[60:63], v31, s[36:39], s82 offen offset:2048
  s_add_u32 s82, s82, 4096
  buffer_load_dwordx4 v[64:67], v31, s[36:39], s82 offen offset:0
  buffer_load_dwordx4 v[68:71], v31, s[36:39], s82 offen offset:2048
  s_add_u32 s82, s82, 4096
  buffer_load_dwordx4 v[72:75], v31, s[36:39], s82 offen offset:0
  buffer_load_dwordx4 v[76:79], v31, s[36:39], s82 offen offset:2048
  s_add_u32 s82, s82, 4096
  buffer_load_dwordx4 v[80:83], v31, s[36:39], s82 offen offset:0
  buffer_load_dwordx4 v[84:87], v31, s[36:39], s82 offen offset:2048
  s_add_u32 s82, s82, 4096
  buffer_load_dwordx4 v[88:91], v31, s[36:39], s82 offen offset:0
  buffer_load_dwordx4 v[92:95], v31, s[36:39], s82 offen offset:2048
  s_add_u32 s82, s82, 4096
  buffer_load_dwordx4 v[96:99], v31, s[36:39], s82 offen offset:0
  buffer_load_dwordx4 v[100:103], v31, s[36:39], s82 offen offset:2048
  s_add_u32 s82, s82, 4096
  buffer_load_dwordx4 v[104:107], v31, s[36:39], s82 offen offset:0
  buffer_load_dwordx4 v[108:111], v31, s[36:39], s82 offen offset:2048
  s_add_u32 s82, s82, 4096
  buffer_load_dwordx4 v[112:115], v31, s[36:39], s82 offen offset:0
  buffer_load_dwordx4 v[116:119], v31, s[36:39], s82 offen offset:2048
  s_add_u32 s82, s82, 4096
  buffer_load_dwordx4 v[120:123], v31, s[36:39], s82 offen offset:0
  buffer_load_dwordx4 v[124:127], v31, s[36:39], s82 offen offset:2048
  s_add_u32 s82, s82, 4096
  buffer_load_dwordx4 v[128:131], v31, s[36:39], s82 offen offset:0
  buffer_load_dwordx4 v[132:135], v31, s[36:39], s82 offen offset:2048
  s_add_u32 s82, s82, 4096
  buffer_load_dwordx4 v[136:139], v31, s[36:39], s82 offen offset:0
  buffer_load_dwordx4 v[140:143], v31, s[36:39], s82 offen offset:2048
  s_add_u32 s82, s82, 4096
  buffer_load_dwordx4 v[144:147], v31, s[36:39], s82 offen offset:0
  buffer_load_dwordx4 v[148:151], v31, s[36:39], s82 offen offset:2048
  s_add_u32 s82, s82, 4096
  buffer_load_dwordx4 v[152:155], v31, s[36:39], s82 offen offset:0
  buffer_load_dwordx4 v[156:159], v31, s[36:39], s82 offen offset:2048
  s_add_u32 s82, s82, 4096
  buffer_load_dwordx4 v[160:163], v31, s[36:39], s82 offen offset:0
  buffer_load_dwordx4 v[164:167], v31, s[36:39], s82 offen offset:2048
  s_add_u32 s82, s82, 4096
  v_and_b32 v2, 16, v1
  v_cmp_eq_u32 vcc, 0, v2
  s_mul_i32 s85, s85, 2560
  s_add_u32 s84, s84, s85
  s_waitcnt vmcnt(31)
  v_mfma_f32_32x32x16_bf16 v[8:23], a[0:3], v[40:43], 0
  v_mfma_f32_32x32x16_bf16 v[24:39], a[4:7], v[40:43], 0
  s_waitcnt vmcnt(30)
  v_mfma_f32_32x32x16_bf16 v[8:23], a[8:11], v[44:47], v[8:23]
  v_mfma_f32_32x32x16_bf16 v[24:39], a[12:15], v[44:47], v[24:39]
  s_waitcnt vmcnt(29)
  v_mfma_f32_32x32x16_bf16 v[8:23], a[16:19], v[48:51], v[8:23]
  v_mfma_f32_32x32x16_bf16 v[24:39], a[20:23], v[48:51], v[24:39]
  s_waitcnt vmcnt(28)
  v_mfma_f32_32x32x16_bf16 v[8:23], a[24:27], v[52:55], v[8:23]
  v_mfma_f32_32x32x16_bf16 v[24:39], a[28:31], v[52:55], v[24:39]
  s_waitcnt vmcnt(27)
  v_mfma_f32_32x32x16_bf16 v[8:23], a[32:35], v[56:59], v[8:23]
  v_mfma_f32_32x32x16_bf16 v[24:39], a[36:39], v[56:59], v[24:39]
  s_waitcnt vmcnt(26)
  v_mfma_f32_32x32x16_bf16 v[8:23], a[40:43], v[60:63], v[8:23]
  v_mfma_f32_32x32x16_bf16 v[24:39], a[44:47], v[60:63], v[24:39]
  s_waitcnt vmcnt(25)
  v_mfma_f32_32x32x16_bf16 v[8:23], a[48:51], v[64:67], v[8:23]
  v_mfma_f32_32x32x16_bf16 v[24:39], a[52:55], v[64:67], v[24:39]
  s_waitcnt vmcnt(24)
  v_mfma_f32_32x32x16_bf16 v[8:23], a[56:59], v[68:71], v[8:23]
  v_mfma_f32_32x32x16_bf16 v[24:39], a[60:63], v[68:71], v[24:39]
  s_waitcnt vmcnt(23)
  v_mfma_f32_32x32x16_bf16 v[8:23], a[64:67], v[72:75], v[8:23]
  v_mfma_f32_32x32x16_bf16 v[24:39], a[68:71], v[72:75], v[24:39]
  s_waitcnt vmcnt(22)
  v_mfma_f32_32x32x16_bf16 v[8:23], a[72:75], v[76:79], v[8:23]
  v_mfma_f32_32x32x16_bf16 v[24:39], a[76:79], v[76:79], v[24:39]
  s_waitcnt vmcnt(21)
  v_mfma_f32_32x32x16_bf16 v[8:23], a[80:83], v[80:83], v[8:23]
  v_mfma_f32_32x32x16_bf16 v[24:39], a[84:87], v[80:83], v[24:39]
  s_waitcnt vmcnt(20)
  v_mfma_f32_32x32x16_bf16 v[8:23], a[88:91], v[84:87], v[8:23]
  v_mfma_f32_32x32x16_bf16 v[24:39], a[92:95], v[84:87], v[24:39]
  s_waitcnt vmcnt(19)
  v_mfma_f32_32x32x16_bf16 v[8:23], a[96:99], v[88:91], v[8:23]
  v_mfma_f32_32x32x16_bf16 v[24:39], a[100:103], v[88:91], v[24:39]
  s_waitcnt vmcnt(18)
  v_mfma_f32_32x32x16_bf16 v[8:23], a[104:107], v[92:95], v[8:23]
  v_mfma_f32_32x32x16_bf16 v[24:39], a[108:111], v[92:95], v[24:39]
  s_waitcnt vmcnt(17)
  v_mfma_f32_32x32x16_bf16 v[8:23], a[112:115], v[96:99], v[8:23]
  v_mfma_f32_32x32x16_bf16 v[24:39], a[116:119], v[96:99], v[24:39]
  s_waitcnt vmcnt(16)
  v_mfma_f32_32x32x16_bf16 v[8:23], a[120:123], v[100:103], v[8:23]
  v_mfma_f32_32x32x16_bf16 v[24:39], a[124:127], v[100:103], v[24:39]
  s_waitcnt vmcnt(15)
  v_mfma_f32_32x32x16_bf16 v[8:23], a[128:131], v[104:107], v[8:23]
  v_mfma_f32_32x32x16_bf16 v[24:39], a[132:135], v[104:107], v[24:39]
  s_waitcnt vmcnt(14)
  v_mfma_f32_32x32x16_bf16 v[8:23], a[136:139], v[108:111], v[8:23]
  v_mfma_f32_32x32x16_bf16 v[24:39], a[140:143], v[108:111], v[24:39]
  s_waitcnt vmcnt(13)
  v_mfma_f32_32x32x16_bf16 v[8:23], a[144:147], v[112:115], v[8:23]
  v_mfma_f32_32x32x16_bf16 v[24:39], a[148:151], v[112:115], v[24:39]
  s_waitcnt vmcnt(12)
  v_mfma_f32_32x32x16_bf16 v[8:23], a[152:155], v[116:119], v[8:23]
  v_mfma_f32_32x32x16_bf16 v[24:39], a[156:159], v[116:119], v[24:39]
  s_waitcnt vmcnt(11)
  v_mfma_f32_32x32x16_bf16 v[8:23], a[160:163], v[120:123], v[8:23]
  v_mfma_f32_32x32x16_bf16 v[24:39], a[164:167], v[120:123], v[24:39]
  s_waitcnt vmcnt(10)
  v_mfma_f32_32x32x16_bf16 v[8:23], a[168:171], v[124:127], v[8:23]
  v_mfma_f32_32x32x16_bf16 v[24:39], a[172:175], v[124:127], v[24:39]
  s_waitcnt vmcnt(9)
  v_mfma_f32_32x32x16_bf16 v[8:23], a[176:179], v[128:131], v[8:23]
  v_mfma_f32_32x32x16_bf16 v[24:39], a[180:183], v[128:131], v[24:39]
  s_waitcnt vmcnt(8)
  v_mfma_f32_32x32x16_bf16 v[8:23], a[184:187], v[132:135], v[8:23]
  v_mfma_f32_32x32x16_bf16 v[24:39], a[188:191], v[132:135], v[24:39]
  s_waitcnt vmcnt(7)
  v_mfma_f32_32x32x16_bf16 v[8:23], a[192:195], v[136:139], v[8:23]
  v_mfma_f32_32x32x16_bf16 v[24:39], a[196:199], v[136:139], v[24:39]
  s_waitcnt vmcnt(6)
  v_mfma_f32_32x32x16_bf16 v[8:23], a[200:203], v[140:143], v[8:23]
  v_mfma_f32_32x32x16_bf16 v[24:39], a[204:207], v[140:143], v[24:39]
  s_waitcnt vmcnt(5)
  v_mfma_f32_32x32x16_bf16 v[8:23], a[208:211], v[144:147], v[8:23]
  v_mfma_f32_32x32x16_bf16 v[24:39], a[212:215], v[144:147], v[24:39]
  s_waitcnt vmcnt(4)
  v_mfma_f32_32x32x16_bf16 v[8:23], a[216:219], v[148:151], v[8:23]
  v_mfma_f32_32x32x16_bf16 v[24:39], a[220:223], v[148:151], v[24:39]
  s_waitcnt vmcnt(3)
  v_mfma_f32_32x32x16_bf16 v[8:23], a[224:227], v[152:155], v[8:23]
  v_mfma_f32_32x32x16_bf16 v[24:39], a[228:231], v[152:155], v[24:39]
  s_waitcnt vmcnt(2)
  v_mfma_f32_32x32x16_bf16 v[8:23], a[232:235], v[156:159], v[8:23]
  v_mfma_f32_32x32x16_bf16 v[24:39], a[236:239], v[156:159], v[24:39]
  s_waitcnt vmcnt(1)
  v_mfma_f32_32x32x16_bf16 v[8:23], a[240:243], v[160:163], v[8:23]
  v_mfma_f32_32x32x16_bf16 v[24:39], a[244:247], v[160:163], v[24:39]
  s_waitcnt vmcnt(0)
  v_mfma_f32_32x32x16_bf16 v[8:23], a[248:251], v[164:167], v[8:23]
  v_mfma_f32_32x32x16_bf16 v[24:39], a[252:255], v[164:167], v[24:39]
  s_nop 11
  v_cndmask_b32 v8, v24, v8, vcc
  v_cndmask_b32 v9, v25, v9, vcc
  v_cndmask_b32 v10, v26, v10, vcc
  v_cndmask_b32 v11, v27, v11, vcc
  v_cndmask_b32 v12, v28, v12, vcc
  v_cndmask_b32 v13, v29, v13, vcc
  v_cndmask_b32 v14, v30, v14, vcc
  v_cndmask_b32 v15, v31, v15, vcc
  v_cndmask_b32 v16, v32, v16, vcc
  v_cndmask_b32 v17, v33, v17, vcc
  v_cndmask_b32 v18, v34, v18, vcc
  v_cndmask_b32 v19, v35, v19, vcc
  v_cndmask_b32 v20, v36, v20, vcc
  v_cndmask_b32 v21, v37, v21, vcc
  v_cndmask_b32 v22, v38, v22, vcc
  v_cndmask_b32 v23, v39, v23, vcc
  ds_write_b128 v6, v[8:11] offset:0
  ds_write_b128 v6, v[12:15] offset:1024
  ds_write_b128 v6, v[16:19] offset:2048
  ds_write_b128 v6, v[20:23] offset:3072
  s_waitcnt lgkmcnt(0)
  s_barrier
  s_mov_b64 exec, vcc
  ds_read_b128 v[40:43], v7 offset:0
  ds_read_b128 v[44:47], v7 offset:256
  ds_read_b128 v[48:51], v7 offset:4096
  ds_read_b128 v[52:55], v7 offset:4352
  ds_read_b128 v[56:59], v7 offset:8192
  ds_read_b128 v[60:63], v7 offset:8448
  ds_read_b128 v[64:67], v7 offset:12288
  ds_read_b128 v[68:71], v7 offset:12544
  s_waitcnt lgkmcnt(0)
  v_add_f32 v40, v40, v56
  v_add_f32 v41, v41, v57
  v_add_f32 v42, v42, v58
  v_add_f32 v43, v43, v59
  v_add_f32 v44, v44, v60
  v_add_f32 v45, v45, v61
  v_add_f32 v46, v46, v62
  v_add_f32 v47, v47, v63
  v_add_f32 v48, v48, v64
  v_add_f32 v49, v49, v65
  v_add_f32 v50, v50, v66
  v_add_f32 v51, v51, v67
  v_add_f32 v52, v52, v68
  v_add_f32 v53, v53, v69
  v_add_f32 v54, v54, v70
  v_add_f32 v55, v55, v71
  v_add_f32 v40, v40, v48
  v_add_f32 v41, v41, v49
  v_add_f32 v42, v42, v50
  v_add_f32 v43, v43, v51
  v_add_f32 v44, v44, v52
  v_add_f32 v45, v45, v53
  v_add_f32 v46, v46, v54
  v_add_f32 v47, v47, v55
  v_add_f32 v40, v40, v44
  v_add_f32 v41, v41, v45
  v_add_f32 v42, v42, v46
  v_add_f32 v43, v43, v47
  v_cvt_pk_bf16_f32 v44, v40, v41
  v_cvt_pk_bf16_f32 v45, v42, v43
  buffer_store_dwordx2 v[44:45], v5, s[40:43], s84 offen
  s_mov_b64 exec, -1
  s_branch L_next
L_chain:
  s_lshr_b32 s71, s64, 5
  s_and_b32 s72, s64, 31
  s_setprio 2
  v_lshlrev_b32 v2, 4, v1
  v_lshrrev_b32 v58, 4, v1
  v_and_b32 v59, 15, v1
  v_and_b32 v60, 1, v58
  v_lshlrev_b32 v60, 5, v60
  v_lshlrev_b32 v61, 4, v59
  v_xor_b32 v60, v60, v61
  v_xor_b32 v61, 0, v60
  v_add_u32 v62, 0, v58
  v_lshlrev_b32 v63, 13, v62
  v_add_u32 v63, v63, v61
  v_add_u32 v40, 0, v63
  v_mul_u32_u24 v63, 1280, v62
  v_add_u32 v63, v63, v61
  v_add_u32 v44, 0, v63
  v_xor_b32 v61, 64, v60
  v_add_u32 v62, 4, v58
  v_lshlrev_b32 v63, 13, v62
  v_add_u32 v63, v63, v61
  v_add_u32 v41, 4294966272, v63
  v_mul_u32_u24 v63, 1280, v62
  v_add_u32 v63, v63, v61
  v_add_u32 v45, 4294966272, v63
  v_xor_b32 v61, 128, v60
  v_add_u32 v62, 8, v58
  v_lshlrev_b32 v63, 13, v62
  v_add_u32 v63, v63, v61
  v_add_u32 v42, 4294965248, v63
  v_mul_u32_u24 v63, 1280, v62
  v_add_u32 v63, v63, v61
  v_add_u32 v46, 4294965248, v63
  v_xor_b32 v61, 192, v60
  v_add_u32 v62, 12, v58
  v_lshlrev_b32 v63, 13, v62
  v_add_u32 v63, v63, v61
  v_add_u32 v43, 4294964224, v63
  v_mul_u32_u24 v63, 1280, v62
  v_add_u32 v63, v63, v61
  v_add_u32 v47, 4294964224, v63
  v_lshrrev_b32 v62, 3, v1
  v_and_b32 v60, 7, v1
  v_lshlrev_b32 v60, 4, v60
  v_lshrrev_b32 v61, 5, v1
  v_lshlrev_b32 v61, 5, v61
  v_xor_b32 v60, v60, v61
  v_xor_b32 v61, 0, v60
  v_add_u32 v63, 0, v62
  v_mul_u32_u24 v63, 1280, v63
  v_add_u32 v63, v63, v61
  v_add_u32 v48, 0, v63
  v_xor_b32 v61, 64, v60
  v_add_u32 v63, 8, v62
  v_mul_u32_u24 v63, 1280, v63
  v_add_u32 v63, v63, v61
  v_add_u32 v49, 4294966272, v63
  v_xor_b32 v61, 0, v60
  v_add_u32 v63, 16, v62
  v_mul_u32_u24 v63, 1280, v63
  v_add_u32 v63, v63, v61
  v_add_u32 v50, 4294965248, v63
  v_xor_b32 v61, 64, v60
  v_add_u32 v63, 24, v62
  v_mul_u32_u24 v63, 1280, v63
  v_add_u32 v63, v63, v61
  v_add_u32 v51, 4294964224, v63
  v_bfe_u32 v58, v1, 2, 1
  v_bfe_u32 v59, v1, 3, 1
  v_bfe_u32 v60, v1, 4, 1
  v_lshrrev_b32 v61, 5, v1
  v_and_b32 v62, 3, v1
  v_lshlrev_b32 v62, 3, v62
  s_lshl_b32 s95, s57, 1
  v_lshl_add_u32 v63, v61, 4, v58
  v_lshl_add_u32 v63, v60, 2, v63
  v_lshl_add_u32 v63, v59, 3, v63
  v_lshl_add_u32 v64, v60, 1, v58
  v_lshl_add_u32 v64, v59, 2, v64
  v_xor_b32 v64, s95, v64
  v_lshl_add_u32 v64, v64, 5, v62
  v_lshl_add_u32 v52, v63, 8, v64
  v_lshl_add_u32 v63, v60, 4, v58
  v_lshl_add_u32 v63, v61, 3, v63
  v_lshl_add_u32 v63, v59, 2, v63
  v_lshl_add_u32 v64, v59, 1, v58
  v_lshl_add_u32 v64, v61, 2, v64
  v_xor_b32 v64, s95, v64
  v_lshl_add_u32 v64, v64, 5, v62
  v_lshl_add_u32 v54, v63, 8, v64
  v_lshl_add_u32 v64, v61, 1, v59
  v_xor_b32 v64, s57, v64
  v_lshl_add_u32 v64, v64, 5, v62
  v_lshl_add_u32 v56, v63, 7, v64
  s_lshl_b32 s95, s57, 17
  s_lshl_b32 s96, s72, 8
  s_add_u32 s95, s95, s96
  s_mul_i32 s96, s71, 2621440
  s_add_u32 s74, s95, s96
  s_sub_u32 s96, 2621440, s96
  s_add_u32 s75, s95, s96
  s_mul_i32 s95, s72, 163840
  s_mul_i32 s96, s71, 640
  s_add_u32 s95, s95, s96
  s_mul_i32 s96, s57, 20480
  s_add_u32 s76, s95, s96
  s_add_u32 s77, s76, s96
  s_add_u32 s77, s77, 512
  s_lshl_b32 s78, s57, 12
  s_mov_b32 s44, s18
  s_mov_b32 s45, s19
  s_mov_b32 s46, 0x500000
  s_mov_b32 s47, 0x20000
  s_mov_b32 s48, s20
  s_mov_b32 s49, s21
  s_mov_b32 s50, 0x500000
  s_mov_b32 s51, 0x20000
  s_mov_b32 s80, s22
  s_mov_b32 s81, s23
  s_mov_b32 s82, 0x500000
  s_mov_b32 s83, 0x20000
  s_mov_b32 s84, s24
  s_mov_b32 s85, s25
  s_mov_b32 s86, 0x500000
  s_mov_b32 s87, 0x20000
  s_add_u32 m0, s78, 32768
  s_add_u32 s95, s74, 0
  buffer_load_dwordx4 v40, s[44:47], s95 offen offset:0 lds
  buffer_load_dwordx4 v41, s[44:47], s95 offen offset:1024 lds
  buffer_load_dwordx4 v42, s[44:47], s95 offen offset:2048 lds
  buffer_load_dwordx4 v43, s[44:47], s95 offen offset:3072 lds
  s_add_u32 m0, s78, 49152
  s_add_u32 s95, s74, 524288
  buffer_load_dwordx4 v40, s[44:47], s95 offen offset:0 lds
  buffer_load_dwordx4 v41, s[44:47], s95 offen offset:1024 lds
  buffer_load_dwordx4 v42, s[44:47], s95 offen offset:2048 lds
  buffer_load_dwordx4 v43, s[44:47], s95 offen offset:3072 lds
  s_add_u32 m0, s78, 65536
  s_add_u32 s95, s74, 1048576
  buffer_load_dwordx4 v40, s[44:47], s95 offen offset:0 lds
  buffer_load_dwordx4 v41, s[44:47], s95 offen offset:1024 lds
  buffer_load_dwordx4 v42, s[44:47], s95 offen offset:2048 lds
  buffer_load_dwordx4 v43, s[44:47], s95 offen offset:3072 lds
  s_add_u32 m0, s78, 81920
  s_add_u32 s95, s74, 1572864
  buffer_load_dwordx4 v40, s[44:47], s95 offen offset:0 lds
  buffer_load_dwordx4 v41, s[44:47], s95 offen offset:1024 lds
  buffer_load_dwordx4 v42, s[44:47], s95 offen offset:2048 lds
  buffer_load_dwordx4 v43, s[44:47], s95 offen offset:3072 lds
  s_add_u32 m0, s78, 98304
  s_add_u32 s95, s74, 2097152
  buffer_load_dwordx4 v40, s[44:47], s95 offen offset:0 lds
  buffer_load_dwordx4 v41, s[44:47], s95 offen offset:1024 lds
  buffer_load_dwordx4 v42, s[44:47], s95 offen offset:2048 lds
  buffer_load_dwordx4 v43, s[44:47], s95 offen offset:3072 lds
  s_add_u32 m0, s78, 114688
  s_add_u32 s95, s75, 0
  buffer_load_dwordx4 v40, s[44:47], s95 offen offset:0 lds
  buffer_load_dwordx4 v41, s[44:47], s95 offen offset:1024 lds
  buffer_load_dwordx4 v42, s[44:47], s95 offen offset:2048 lds
  buffer_load_dwordx4 v43, s[44:47], s95 offen offset:3072 lds
  s_add_u32 m0, s78, 131072
  s_add_u32 s95, s75, 524288
  buffer_load_dwordx4 v40, s[44:47], s95 offen offset:0 lds
  buffer_load_dwordx4 v41, s[44:47], s95 offen offset:1024 lds
  buffer_load_dwordx4 v42, s[44:47], s95 offen offset:2048 lds
  buffer_load_dwordx4 v43, s[44:47], s95 offen offset:3072 lds
  s_add_u32 m0, s78, 147456
  s_add_u32 s95, s75, 1048576
  buffer_load_dwordx4 v40, s[44:47], s95 offen offset:0 lds
  buffer_load_dwordx4 v41, s[44:47], s95 offen offset:1024 lds
  buffer_load_dwordx4 v42, s[44:47], s95 offen offset:2048 lds
  buffer_load_dwordx4 v43, s[44:47], s95 offen offset:3072 lds
  s_waitcnt vmcnt(28) lgkmcnt(0)
  s_barrier
  s_cmp_lg_u32 s57, 0
  s_cbranch_scc1 rg_56
  s_getreg_b32 s62, hwreg(HW_REG_XCC_ID)
  s_and_b32 s62, s62, 15
  s_lshl_b32 s62, s62, 2
  s_and_b32 s65, s61, 7
  s_mov_b32 s63, 1
  s_cmp_eq_u32 s65, 0
  s_cselect_b32 s63, 0x401, s63
  s_cmp_eq_u32 s65, 1
  s_cselect_b32 s63, 0x100001, s63
  s_mov_b64 exec, 1
  v_mov_b32 v10, s63
  v_mov_b32 v11, 0
  buffer_atomic_add v10, v11, s[52:55], s62 offen sc1
  s_mov_b64 exec, -1
rg_56:
  s_add_u32 m0, s78, 16384
  s_add_u32 s95, s75, 1572864
  buffer_load_dwordx4 v40, s[44:47], s95 offen offset:0 lds
  buffer_load_dwordx4 v41, s[44:47], s95 offen offset:1024 lds
  buffer_load_dwordx4 v42, s[44:47], s95 offen offset:2048 lds
  buffer_load_dwordx4 v43, s[44:47], s95 offen offset:3072 lds
  v_add_u32 v58, 32768, v52
  v_xor_b32 v59, 32, v58
  ds_read_b64_tr_b16 a[0:1], v58 offset:0
  ds_read_b64_tr_b16 a[2:3], v58 offset:512
  ds_read_b64_tr_b16 a[4:5], v58 offset:8192
  ds_read_b64_tr_b16 a[6:7], v58 offset:8704
  ds_read_b64_tr_b16 a[8:9], v59 offset:0
  ds_read_b64_tr_b16 a[10:11], v59 offset:512
  ds_read_b64_tr_b16 a[12:13], v59 offset:8192
  ds_read_b64_tr_b16 a[14:15], v59 offset:8704
  s_waitcnt vmcnt(28) lgkmcnt(0)
  s_barrier
  s_add_u32 m0, s78, 32768
  s_add_u32 s95, s75, 2097152
  buffer_load_dwordx4 v40, s[44:47], s95 offen offset:0 lds
  buffer_load_dwordx4 v41, s[44:47], s95 offen offset:1024 lds
  buffer_load_dwordx4 v42, s[44:47], s95 offen offset:2048 lds
  buffer_load_dwordx4 v43, s[44:47], s95 offen offset:3072 lds
  v_add_u32 v58, 49152, v52
  v_xor_b32 v59, 32, v58
  ds_read_b64_tr_b16 a[16:17], v58 offset:0
  ds_read_b64_tr_b16 a[18:19], v58 offset:512
  ds_read_b64_tr_b16 a[20:21], v58 offset:8192
  ds_read_b64_tr_b16 a[22:23], v58 offset:8704
  ds_read_b64_tr_b16 a[24:25], v59 offset:0
  ds_read_b64_tr_b16 a[26:27], v59 offset:512
  ds_read_b64_tr_b16 a[28:29], v59 offset:8192
  ds_read_b64_tr_b16 a[30:31], v59 offset:8704
  s_waitcnt vmcnt(28) lgkmcnt(0)
  s_barrier
  s_add_u32 m0, s78, 49152
  s_add_u32 s95, s74, 0
  buffer_load_dwordx4 v40, s[48:51], s95 offen offset:0 lds
  buffer_load_dwordx4 v41, s[48:51], s95 offen offset:1024 lds
  buffer_load_dwordx4 v42, s[48:51], s95 offen offset:2048 lds
  buffer_load_dwordx4 v43, s[48:51], s95 offen offset:3072 lds
  v_add_u32 v58, 65536, v52
  v_xor_b32 v59, 32, v58
  ds_read_b64_tr_b16 a[32:33], v58 offset:0
  ds_read_b64_tr_b16 a[34:35], v58 offset:512
  ds_read_b64_tr_b16 a[36:37], v58 offset:8192
  ds_read_b64_tr_b16 a[38:39], v58 offset:8704
  ds_read_b64_tr_b16 a[40:41], v59 offset:0
  ds_read_b64_tr_b16 a[42:43], v59 offset:512
  ds_read_b64_tr_b16 a[44:45], v59 offset:8192
  ds_read_b64_tr_b16 a[46:47], v59 offset:8704
  s_waitcnt vmcnt(28) lgkmcnt(0)
  s_barrier
  s_add_u32 m0, s78, 65536
  s_add_u32 s95, s74, 524288
  buffer_load_dwordx4 v40, s[48:51], s95 offen offset:0 lds
  buffer_load_dwordx4 v41, s[48:51], s95 offen offset:1024 lds
  buffer_load_dwordx4 v42, s[48:51], s95 offen offset:2048 lds
  buffer_load_dwordx4 v43, s[48:51], s95 offen offset:3072 lds
  v_add_u32 v58, 81920, v52
  v_xor_b32 v59, 32, v58
  ds_read_b64_tr_b16 a[48:49], v58 offset:0
  ds_read_b64_tr_b16 a[50:51], v58 offset:512
  ds_read_b64_tr_b16 a[52:53], v58 offset:8192
  ds_read_b64_tr_b16 a[54:55], v58 offset:8704
  ds_read_b64_tr_b16 a[56:57], v59 offset:0
  ds_read_b64_tr_b16 a[58:59], v59 offset:512
  ds_read_b64_tr_b16 a[60:61], v59 offset:8192
  ds_read_b64_tr_b16 a[62:63], v59 offset:8704
  s_waitcnt vmcnt(28) lgkmcnt(0)
  s_barrier
  s_add_u32 m0, s78, 81920
  s_add_u32 s95, s74, 1048576
  buffer_load_dwordx4 v40, s[48:51], s95 offen offset:0 lds
  buffer_load_dwordx4 v41, s[48:51], s95 offen offset:1024 lds
  buffer_load_dwordx4 v42, s[48:51], s95 offen offset:2048 lds
  buffer_load_dwordx4 v43, s[48:51], s95 offen offset:3072 lds
  v_add_u32 v58, 98304, v52
  v_xor_b32 v59, 32, v58
  ds_read_b64_tr_b16 a[64:65], v58 offset:0
  ds_read_b64_tr_b16 a[66:67], v58 offset:512
  ds_read_b64_tr_b16 a[68:69], v58 offset:8192
  ds_read_b64_tr_b16 a[70:71], v58 offset:8704
  ds_read_b64_tr_b16 a[72:73], v59 offset:0
  ds_read_b64_tr_b16 a[74:75], v59 offset:512
  ds_read_b64_tr_b16 a[76:77], v59 offset:8192
  ds_read_b64_tr_b16 a[78:79], v59 offset:8704
  s_waitcnt vmcnt(28) lgkmcnt(0)
  s_barrier
  s_add_u32 m0, s78, 98304
  s_add_u32 s95, s74, 1572864
  buffer_load_dwordx4 v40, s[48:51], s95 offen offset:0 lds
  buffer_load_dwordx4 v41, s[48:51], s95 offen offset:1024 lds
  buffer_load_dwordx4 v42, s[48:51], s95 offen offset:2048 lds
  buffer_load_dwordx4 v43, s[48:51], s95 offen offset:3072 lds
  v_add_u32 v58, 114688, v52
  v_xor_b32 v59, 32, v58
  ds_read_b64_tr_b16 a[80:81], v58 offset:0
  ds_read_b64_tr_b16 a[82:83], v58 offset:512
  ds_read_b64_tr_b16 a[84:85], v58 offset:8192
  ds_read_b64_tr_b16 a[86:87], v58 offset:8704
  ds_read_b64_tr_b16 a[88:89], v59 offset:0
  ds_read_b64_tr_b16 a[90:91], v59 offset:512
  ds_read_b64_tr_b16 a[92:93], v59 offset:8192
  ds_read_b64_tr_b16 a[94:95], v59 offset:8704
  s_waitcnt vmcnt(28) lgkmcnt(0)
  s_barrier
  s_add_u32 m0, s78, 114688
  s_add_u32 s95, s74, 2097152
  buffer_load_dwordx4 v40, s[48:51], s95 offen offset:0 lds
  buffer_load_dwordx4 v41, s[48:51], s95 offen offset:1024 lds
  buffer_load_dwordx4 v42, s[48:51], s95 offen offset:2048 lds
  buffer_load_dwordx4 v43, s[48:51], s95 offen offset:3072 lds
  v_add_u32 v58, 131072, v52
  v_xor_b32 v59, 32, v58
  ds_read_b64_tr_b16 a[96:97], v58 offset:0
  ds_read_b64_tr_b16 a[98:99], v58 offset:512
  ds_read_b64_tr_b16 a[100:101], v58 offset:8192
  ds_read_b64_tr_b16 a[102:103], v58 offset:8704
  ds_read_b64_tr_b16 a[104:105], v59 offset:0
  ds_read_b64_tr_b16 a[106:107], v59 offset:512
  ds_read_b64_tr_b16 a[108:109], v59 offset:8192
  ds_read_b64_tr_b16 a[110:111], v59 offset:8704
  s_waitcnt vmcnt(28) lgkmcnt(0)
  s_barrier
  s_add_u32 m0, s78, 131072
  s_add_u32 s95, s75, 0
  buffer_load_dwordx4 v40, s[48:51], s95 offen offset:0 lds
  buffer_load_dwordx4 v41, s[48:51], s95 offen offset:1024 lds
  buffer_load_dwordx4 v42, s[48:51], s95 offen offset:2048 lds
  buffer_load_dwordx4 v43, s[48:51], s95 offen offset:3072 lds
  v_add_u32 v58, 147456, v52
  v_xor_b32 v59, 32, v58
  ds_read_b64_tr_b16 a[112:113], v58 offset:0
  ds_read_b64_tr_b16 a[114:115], v58 offset:512
  ds_read_b64_tr_b16 a[116:117], v58 offset:8192
  ds_read_b64_tr_b16 a[118:119], v58 offset:8704
  ds_read_b64_tr_b16 a[120:121], v59 offset:0
  ds_read_b64_tr_b16 a[122:123], v59 offset:512
  ds_read_b64_tr_b16 a[124:125], v59 offset:8192
  ds_read_b64_tr_b16 a[126:127], v59 offset:8704
  s_waitcnt vmcnt(28) lgkmcnt(0)
  s_barrier
  s_add_u32 m0, s78, 147456
  s_add_u32 s95, s75, 524288
  buffer_load_dwordx4 v40, s[48:51], s95 offen offset:0 lds
  buffer_load_dwordx4 v41, s[48:51], s95 offen offset:1024 lds
  buffer_load_dwordx4 v42, s[48:51], s95 offen offset:2048 lds
  buffer_load_dwordx4 v43, s[48:51], s95 offen offset:3072 lds
  v_add_u32 v58, 16384, v52
  v_xor_b32 v59, 32, v58
  ds_read_b64_tr_b16 a[128:129], v58 offset:0
  ds_read_b64_tr_b16 a[130:131], v58 offset:512
  ds_read_b64_tr_b16 a[132:133], v58 offset:8192
  ds_read_b64_tr_b16 a[134:135], v58 offset:8704
  ds_read_b64_tr_b16 a[136:137], v59 offset:0
  ds_read_b64_tr_b16 a[138:139], v59 offset:512
  ds_read_b64_tr_b16 a[140:141], v59 offset:8192
  ds_read_b64_tr_b16 a[142:143], v59 offset:8704
  s_waitcnt vmcnt(28) lgkmcnt(0)
  s_barrier
  s_add_u32 m0, s78, 16384
  s_add_u32 s95, s75, 1048576
  buffer_load_dwordx4 v40, s[48:51], s95 offen offset:0 lds
  buffer_load_dwordx4 v41, s[48:51], s95 offen offset:1024 lds
  buffer_load_dwordx4 v42, s[48:51], s95 offen offset:2048 lds
  buffer_load_dwordx4 v43, s[48:51], s95 offen offset:3072 lds
  v_add_u32 v58, 32768, v52
  v_xor_b32 v59, 32, v58
  ds_read_b64_tr_b16 a[144:145], v58 offset:0
  ds_read_b64_tr_b16 a[146:147], v58 offset:512
  ds_read_b64_tr_b16 a[148:149], v58 offset:8192
  ds_read_b64_tr_b16 a[150:151], v58 offset:8704
  ds_read_b64_tr_b16 a[152:153], v59 offset:0
  ds_read_b64_tr_b16 a[154:155], v59 offset:512
  ds_read_b64_tr_b16 a[156:157], v59 offset:8192
  ds_read_b64_tr_b16 a[158:159], v59 offset:8704
  s_waitcnt vmcnt(28) lgkmcnt(0)
  s_barrier
  s_mov_b32 s44, s16
  s_mov_b32 s45, s17
  s_mov_b32 s46, 0x2800
  s_mov_b32 s47, 0x20000
  v_lshlrev_b32 v11, 2, v1
  buffer_load_dword v10, v11, s[52:55], 0 offen sc1
  s_lshl_b32 s62, s57, 5
  s_add_u32 s62, s62, s72
  s_lshl_b32 s96, s62, 4
  s_mul_i32 s97, s71, 640
  s_add_u32 s96, s96, s97
  v_mul_u32_u24 v11, 1280, v1
  s_cmp_ge_u32 s62, 40
  s_cbranch_scc1 C_nold0
  s_mov_b64 exec, 0xff
  buffer_load_dwordx4 v[12:15], v11, s[44:47], s96 offen
  s_mov_b64 exec, -1
C_nold0:
  s_add_u32 m0, s78, 32768
  s_add_u32 s95, s75, 1572864
  buffer_load_dwordx4 v40, s[48:51], s95 offen offset:0 lds
  buffer_load_dwordx4 v41, s[48:51], s95 offen offset:1024 lds
  buffer_load_dwordx4 v42, s[48:51], s95 offen offset:2048 lds
  buffer_load_dwordx4 v43, s[48:51], s95 offen offset:3072 lds
  v_add_u32 v58, 49152, v52
  v_xor_b32 v59, 32, v58
  ds_read_b64_tr_b16 a[160:161], v58 offset:0
  ds_read_b64_tr_b16 a[162:163], v58 offset:512
  ds_read_b64_tr_b16 a[164:165], v58 offset:8192
  ds_read_b64_tr_b16 a[166:167], v58 offset:8704
  ds_read_b64_tr_b16 a[168:169], v59 offset:0
  ds_read_b64_tr_b16 a[170:171], v59 offset:512
  ds_read_b64_tr_b16 a[172:173], v59 offset:8192
  ds_read_b64_tr_b16 a[174:175], v59 offset:8704
  s_waitcnt vmcnt(28) lgkmcnt(0)
  s_barrier
  s_add_u32 m0, s78, 49152
  s_add_u32 s95, s75, 2097152
  buffer_load_dwordx4 v40, s[48:51], s95 offen offset:0 lds
  buffer_load_dwordx4 v41, s[48:51], s95 offen offset:1024 lds
  buffer_load_dwordx4 v42, s[48:51], s95 offen offset:2048 lds
  buffer_load_dwordx4 v43, s[48:51], s95 offen offset:3072 lds
  v_add_u32 v58, 65536, v52
  v_xor_b32 v59, 32, v58
  ds_read_b64_tr_b16 a[176:177], v58 offset:0
  ds_read_b64_tr_b16 a[178:179], v58 offset:512
  ds_read_b64_tr_b16 a[180:181], v58 offset:8192
  ds_read_b64_tr_b16 a[182:183], v58 offset:8704
  ds_read_b64_tr_b16 a[184:185], v59 offset:0
  ds_read_b64_tr_b16 a[186:187], v59 offset:512
  ds_read_b64_tr_b16 a[188:189], v59 offset:8192
  ds_read_b64_tr_b16 a[190:191], v59 offset:8704
  s_waitcnt vmcnt(28) lgkmcnt(0)
  s_barrier
  s_add_u32 m0, s78, 65536
  s_add_u32 s95, s75, 0
  buffer_load_dwordx4 v40, s[80:83], s95 offen offset:0 lds
  buffer_load_dwordx4 v41, s[80:83], s95 offen offset:1024 lds
  buffer_load_dwordx4 v42, s[80:83], s95 offen offset:2048 lds
  buffer_load_dwordx4 v43, s[80:83], s95 offen offset:3072 lds
  v_add_u32 v58, 81920, v52
  v_xor_b32 v59, 32, v58
  ds_read_b64_tr_b16 a[192:193], v58 offset:0
  ds_read_b64_tr_b16 a[194:195], v58 offset:512
  ds_read_b64_tr_b16 a[196:197], v58 offset:8192
  ds_read_b64_tr_b16 a[198:199], v58 offset:8704
  ds_read_b64_tr_b16 a[200:201], v59 offset:0
  ds_read_b64_tr_b16 a[202:203], v59 offset:512
  ds_read_b64_tr_b16 a[204:205], v59 offset:8192
  ds_read_b64_tr_b16 a[206:207], v59 offset:8704
  s_waitcnt vmcnt(28) lgkmcnt(0)
  s_barrier
  s_add_u32 m0, s78, 81920
  s_add_u32 s95, s75, 524288
  buffer_load_dwordx4 v40, s[80:83], s95 offen offset:0 lds
  buffer_load_dwordx4 v41, s[80:83], s95 offen offset:1024 lds
  buffer_load_dwordx4 v42, s[80:83], s95 offen offset:2048 lds
  buffer_load_dwordx4 v43, s[80:83], s95 offen offset:3072 lds
  v_add_u32 v58, 98304, v52
  v_xor_b32 v59, 32, v58
  ds_read_b64_tr_b16 a[208:209], v58 offset:0
  ds_read_b64_tr_b16 a[210:211], v58 offset:512
  ds_read_b64_tr_b16 a[212:213], v58 offset:8192
  ds_read_b64_tr_b16 a[214:215], v58 offset:8704
  ds_read_b64_tr_b16 a[216:217], v59 offset:0
  ds_read_b64_tr_b16 a[218:219], v59 offset:512
  ds_read_b64_tr_b16 a[220:221], v59 offset:8192
  ds_read_b64_tr_b16 a[222:223], v59 offset:8704
  s_waitcnt vmcnt(28) lgkmcnt(0)
  s_barrier
  s_add_u32 m0, s78, 98304
  s_add_u32 s95, s75, 1048576
  buffer_load_dwordx4 v40, s[80:83], s95 offen offset:0 lds
  buffer_load_dwordx4 v41, s[80:83], s95 offen offset:1024 lds
  buffer_load_dwordx4 v42, s[80:83], s95 offen offset:2048 lds
  buffer_load_dwordx4 v43, s[80:83], s95 offen offset:3072 lds
  v_add_u32 v58, 114688, v52
  v_xor_b32 v59, 32, v58
  ds_read_b64_tr_b16 a[224:225], v58 offset:0
  ds_read_b64_tr_b16 a[226:227], v58 offset:512
  ds_read_b64_tr_b16 a[228:229], v58 offset:8192
  ds_read_b64_tr_b16 a[230:231], v58 offset:8704
  ds_read_b64_tr_b16 a[232:233], v59 offset:0
  ds_read_b64_tr_b16 a[234:235], v59 offset:512
  ds_read_b64_tr_b16 a[236:237], v59 offset:8192
  ds_read_b64_tr_b16 a[238:239], v59 offset:8704
  s_waitcnt vmcnt(28) lgkmcnt(0)
  s_barrier
  s_add_u32 m0, s78, 114688
  s_add_u32 s95, s75, 1572864
  buffer_load_dwordx4 v40, s[80:83], s95 offen offset:0 lds
  buffer_load_dwordx4 v41, s[80:83], s95 offen offset:1024 lds
  buffer_load_dwordx4 v42, s[80:83], s95 offen offset:2048 lds
  buffer_load_dwordx4 v43, s[80:83], s95 offen offset:3072 lds
  v_add_u32 v58, 131072, v52
  v_xor_b32 v59, 32, v58
  ds_read_b64_tr_b16 a[240:241], v58 offset:0
  ds_read_b64_tr_b16 a[242:243], v58 offset:512
  ds_read_b64_tr_b16 a[244:245], v58 offset:8192
  ds_read_b64_tr_b16 a[246:247], v58 offset:8704
  ds_read_b64_tr_b16 a[248:249], v59 offset:0
  ds_read_b64_tr_b16 a[250:251], v59 offset:512
  ds_read_b64_tr_b16 a[252:253], v59 offset:8192
  ds_read_b64_tr_b16 a[254:255], v59 offset:8704
  s_waitcnt vmcnt(28) lgkmcnt(0)
  s_barrier
  s_add_u32 m0, s78, 131072
  s_add_u32 s95, s75, 2097152
  buffer_load_dwordx4 v40, s[80:83], s95 offen offset:0 lds
  buffer_load_dwordx4 v41, s[80:83], s95 offen offset:1024 lds
  buffer_load_dwordx4 v42, s[80:83], s95 offen offset:2048 lds
  buffer_load_dwordx4 v43, s[80:83], s95 offen offset:3072 lds
  v_add_u32 v58, 147456, v52
  v_xor_b32 v59, 32, v58
  ds_read_b64_tr_b16 v[80:81], v58 offset:0
  ds_read_b64_tr_b16 v[82:83], v58 offset:512
  ds_read_b64_tr_b16 v[84:85], v58 offset:8192
  ds_read_b64_tr_b16 v[86:87], v58 offset:8704
  ds_read_b64_tr_b16 v[88:89], v59 offset:0
  ds_read_b64_tr_b16 v[90:91], v59 offset:512
  ds_read_b64_tr_b16 v[92:93], v59 offset:8192
  ds_read_b64_tr_b16 v[94:95], v59 offset:8704
  s_waitcnt vmcnt(28) lgkmcnt(0)
  s_barrier
  s_add_u32 m0, s78, 147456
  s_add_u32 s95, s76, 0
  buffer_load_dwordx4 v44, s[84:87], s95 offen offset:0 lds
  buffer_load_dwordx4 v45, s[84:87], s95 offen offset:1024 lds
  buffer_load_dwordx4 v46, s[84:87], s95 offen offset:2048 lds
  buffer_load_dwordx4 v47, s[84:87], s95 offen offset:3072 lds
  v_add_u32 v58, 16384, v52
  v_xor_b32 v59, 32, v58
  ds_read_b64_tr_b16 v[96:97], v58 offset:0
  ds_read_b64_tr_b16 v[98:99], v58 offset:512
  ds_read_b64_tr_b16 v[100:101], v58 offset:8192
  ds_read_b64_tr_b16 v[102:103], v58 offset:8704
  ds_read_b64_tr_b16 v[104:105], v59 offset:0
  ds_read_b64_tr_b16 v[106:107], v59 offset:512
  ds_read_b64_tr_b16 v[108:109], v59 offset:8192
  ds_read_b64_tr_b16 v[110:111], v59 offset:8704
  s_waitcnt vmcnt(28) lgkmcnt(0)
  s_barrier
  s_add_u32 m0, s78, 16384
  s_add_u32 s95, s76, 81920
  buffer_load_dwordx4 v44, s[84:87], s95 offen offset:0 lds
  buffer_load_dwordx4 v45, s[84:87], s95 offen offset:1024 lds
  buffer_load_dwordx4 v46, s[84:87], s95 offen offset:2048 lds
  buffer_load_dwordx4 v47, s[84:87], s95 offen offset:3072 lds
  v_add_u32 v58, 32768, v52
  v_xor_b32 v59, 32, v58
  ds_read_b64_tr_b16 v[112:113], v58 offset:0
  ds_read_b64_tr_b16 v[114:115], v58 offset:512
  ds_read_b64_tr_b16 v[116:117], v58 offset:8192
  ds_read_b64_tr_b16 v[118:119], v58 offset:8704
  ds_read_b64_tr_b16 v[120:121], v59 offset:0
  ds_read_b64_tr_b16 v[122:123], v59 offset:512
  ds_read_b64_tr_b16 v[124:125], v59 offset:8192
  ds_read_b64_tr_b16 v[126:127], v59 offset:8704
  s_waitcnt vmcnt(28) lgkmcnt(0)
  s_barrier
  s_mov_b64 exec, 0xffff
  v_lshlrev_b32 v3, 2, v1
  v_mov_b32 v2, v10
  s_branch cnt_57_c
cnt_57:
  buffer_load_dword v2, v3, s[52:55], 0 offen sc1
  s_waitcnt vmcnt(0)
cnt_57_c:
  s_mov_b32 s68, 0
  s_mov_b32 s66, 1
  s_mov_b32 s67, 1
  v_readlane_b32 s65, v2, 0
  s_and_b32 s70, s65, 1023
  s_add_u32 s68, s68, s70
  s_bfe_u32 s70, s65, 0xa000a
  s_cmp_eq_u32 s70, 32
  s_cselect_b32 s66, 0, s66
  s_lshr_b32 s70, s65, 20
  s_cmp_eq_u32 s70, 32
  s_cselect_b32 s67, 0, s67
  v_readlane_b32 s65, v2, 1
  s_and_b32 s70, s65, 1023
  s_add_u32 s68, s68, s70
  s_bfe_u32 s70, s65, 0xa000a
  s_cmp_eq_u32 s70, 32
  s_cselect_b32 s66, 0, s66
  s_lshr_b32 s70, s65, 20
  s_cmp_eq_u32 s70, 32
  s_cselect_b32 s67, 0, s67
  v_readlane_b32 s65, v2, 2
  s_and_b32 s70, s65, 1023
  s_add_u32 s68, s68, s70
  s_bfe_u32 s70, s65, 0xa000a
  s_cmp_eq_u32 s70, 32
  s_cselect_b32 s66, 0, s66
  s_lshr_b32 s70, s65, 20
  s_cmp_eq_u32 s70, 32
  s_cselect_b32 s67, 0, s67
  v_readlane_b32 s65, v2, 3
  s_and_b32 s70, s65, 1023
  s_add_u32 s68, s68, s70
  s_bfe_u32 s70, s65, 0xa000a
  s_cmp_eq_u32 s70, 32
  s_cselect_b32 s66, 0, s66
  s_lshr_b32 s70, s65, 20
  s_cmp_eq_u32 s70, 32
  s_cselect_b32 s67, 0, s67
  v_readlane_b32 s65, v2, 4
  s_and_b32 s70, s65, 1023
  s_add_u32 s68, s68, s70
  s_bfe_u32 s70, s65, 0xa000a
  s_cmp_eq_u32 s70, 32
  s_cselect_b32 s66, 0, s66
  s_lshr_b32 s70, s65, 20
  s_cmp_eq_u32 s70, 32
  s_cselect_b32 s67, 0, s67
  v_readlane_b32 s65, v2, 5
  s_and_b32 s70, s65, 1023
  s_add_u32 s68, s68, s70
  s_bfe_u32 s70, s65, 0xa000a
  s_cmp_eq_u32 s70, 32
  s_cselect_b32 s66, 0, s66
  s_lshr_b32 s70, s65, 20
  s_cmp_eq_u32 s70, 32
  s_cselect_b32 s67, 0, s67
  v_readlane_b32 s65, v2, 6
  s_and_b32 s70, s65, 1023
  s_add_u32 s68, s68, s70
  s_bfe_u32 s70, s65, 0xa000a
  s_cmp_eq_u32 s70, 32
  s_cselect_b32 s66, 0, s66
  s_lshr_b32 s70, s65, 20
  s_cmp_eq_u32 s70, 32
  s_cselect_b32 s67, 0, s67
  v_readlane_b32 s65, v2, 7
  s_and_b32 s70, s65, 1023
  s_add_u32 s68, s68, s70
  s_bfe_u32 s70, s65, 0xa000a
  s_cmp_eq_u32 s70, 32
  s_cselect_b32 s66, 0, s66
  s_lshr_b32 s70, s65, 20
  s_cmp_eq_u32 s70, 32
  s_cselect_b32 s67, 0, s67
  v_readlane_b32 s65, v2, 8
  s_and_b32 s70, s65, 1023
  s_add_u32 s68, s68, s70
  s_bfe_u32 s70, s65, 0xa000a
  s_cmp_eq_u32 s70, 32
  s_cselect_b32 s66, 0, s66
  s_lshr_b32 s70, s65, 20
  s_cmp_eq_u32 s70, 32
  s_cselect_b32 s67, 0, s67
  v_readlane_b32 s65, v2, 9
  s_and_b32 s70, s65, 1023
  s_add_u32 s68, s68, s70
  s_bfe_u32 s70, s65, 0xa000a
  s_cmp_eq_u32 s70, 32
  s_cselect_b32 s66, 0, s66
  s_lshr_b32 s70, s65, 20
  s_cmp_eq_u32 s70, 32
  s_cselect_b32 s67, 0, s67
  v_readlane_b32 s65, v2, 10
  s_and_b32 s70, s65, 1023
  s_add_u32 s68, s68, s70
  s_bfe_u32 s70, s65, 0xa000a
  s_cmp_eq_u32 s70, 32
  s_cselect_b32 s66, 0, s66
  s_lshr_b32 s70, s65, 20
  s_cmp_eq_u32 s70, 32
  s_cselect_b32 s67, 0, s67
  v_readlane_b32 s65, v2, 11
  s_and_b32 s70, s65, 1023
  s_add_u32 s68, s68, s70
  s_bfe_u32 s70, s65, 0xa000a
  s_cmp_eq_u32 s70, 32
  s_cselect_b32 s66, 0, s66
  s_lshr_b32 s70, s65, 20
  s_cmp_eq_u32 s70, 32
  s_cselect_b32 s67, 0, s67
  v_readlane_b32 s65, v2, 12
  s_and_b32 s70, s65, 1023
  s_add_u32 s68, s68, s70
  s_bfe_u32 s70, s65, 0xa000a
  s_cmp_eq_u32 s70, 32
  s_cselect_b32 s66, 0, s66
  s_lshr_b32 s70, s65, 20
  s_cmp_eq_u32 s70, 32
  s_cselect_b32 s67, 0, s67
  v_readlane_b32 s65, v2, 13
  s_and_b32 s70, s65, 1023
  s_add_u32 s68, s68, s70
  s_bfe_u32 s70, s65, 0xa000a
  s_cmp_eq_u32 s70, 32
  s_cselect_b32 s66, 0, s66
  s_lshr_b32 s70, s65, 20
  s_cmp_eq_u32 s70, 32
  s_cselect_b32 s67, 0, s67
  v_readlane_b32 s65, v2, 14
  s_and_b32 s70, s65, 1023
  s_add_u32 s68, s68, s70
  s_bfe_u32 s70, s65, 0xa000a
  s_cmp_eq_u32 s70, 32
  s_cselect_b32 s66, 0, s66
  s_lshr_b32 s70, s65, 20
  s_cmp_eq_u32 s70, 32
  s_cselect_b32 s67, 0, s67
  v_readlane_b32 s65, v2, 15
  s_and_b32 s70, s65, 1023
  s_add_u32 s68, s68, s70
  s_bfe_u32 s70, s65, 0xa000a
  s_cmp_eq_u32 s70, 32
  s_cselect_b32 s66, 0, s66
  s_lshr_b32 s70, s65, 20
  s_cmp_eq_u32 s70, 32
  s_cselect_b32 s67, 0, s67
  s_cmp_ge_u32 s68, 256
  s_cbranch_scc1 cnt_57_d
  s_sleep 2
  s_sub_u32 s56, s56, 1
  s_cbranch_scc0 cnt_57
  s_mov_b32 s56, 0
cnt_57_d:
  s_mov_b64 exec, -1
  s_or_b32 s63, s66, s67
  v_lshlrev_b32 v2, 4, v1
  s_lshl_b32 s96, s62, 7
  s_mul_i32 s97, s71, 5120
  s_add_u32 s96, s96, s97
  s_add_u32 s96, s96, 720896
  s_add_u32 s97, s96, 655360
  s_cmp_ge_u32 s62, 40
  s_cbranch_scc1 C_nopub0
  s_mov_b64 exec, 0xff
  buffer_store_dwordx4 v[12:15], v2, s[36:39], s96 offen sc1
  buffer_store_dwordx4 v[12:15], v2, s[36:39], s97 offen sc1
  s_mov_b64 exec, -1
C_nopub0:
  s_add_u32 m0, s78, 32768
  s_add_u32 s95, s76, 256
  buffer_load_dwordx4 v44, s[84:87], s95 offen offset:0 lds
  buffer_load_dwordx4 v45, s[84:87], s95 offen offset:1024 lds
  buffer_load_dwordx4 v46, s[84:87], s95 offen offset:2048 lds
  buffer_load_dwordx4 v47, s[84:87], s95 offen offset:3072 lds
  v_add_u32 v58, 49152, v52
  v_xor_b32 v59, 32, v58
  ds_read_b64_tr_b16 v[128:129], v58 offset:0
  ds_read_b64_tr_b16 v[130:131], v58 offset:512
  ds_read_b64_tr_b16 v[132:133], v58 offset:8192
  ds_read_b64_tr_b16 v[134:135], v58 offset:8704
  ds_read_b64_tr_b16 v[136:137], v59 offset:0
  ds_read_b64_tr_b16 v[138:139], v59 offset:512
  ds_read_b64_tr_b16 v[140:141], v59 offset:8192
  ds_read_b64_tr_b16 v[142:143], v59 offset:8704
  s_waitcnt vmcnt(28) lgkmcnt(0)
  s_barrier
  s_add_u32 m0, s78, 49152
  s_add_u32 s95, s76, 82176
  buffer_load_dwordx4 v44, s[84:87], s95 offen offset:0 lds
  buffer_load_dwordx4 v45, s[84:87], s95 offen offset:1024 lds
  buffer_load_dwordx4 v46, s[84:87], s95 offen offset:2048 lds
  buffer_load_dwordx4 v47, s[84:87], s95 offen offset:3072 lds
  v_add_u32 v58, 65536, v52
  v_xor_b32 v59, 32, v58
  ds_read_b64_tr_b16 v[144:145], v58 offset:0
  ds_read_b64_tr_b16 v[146:147], v58 offset:512
  ds_read_b64_tr_b16 v[148:149], v58 offset:8192
  ds_read_b64_tr_b16 v[150:151], v58 offset:8704
  ds_read_b64_tr_b16 v[152:153], v59 offset:0
  ds_read_b64_tr_b16 v[154:155], v59 offset:512
  ds_read_b64_tr_b16 v[156:157], v59 offset:8192
  ds_read_b64_tr_b16 v[158:159], v59 offset:8704
  s_waitcnt vmcnt(28) lgkmcnt(0)
  s_barrier
  s_add_u32 m0, s78, 65536
  s_nop 0
  buffer_load_dwordx4 v48, s[84:87], s77 offen offset:0 lds
  buffer_load_dwordx4 v49, s[84:87], s77 offen offset:1024 lds
  buffer_load_dwordx4 v50, s[84:87], s77 offen offset:2048 lds
  buffer_load_dwordx4 v51, s[84:87], s77 offen offset:3072 lds
  v_add_u32 v58, 81920, v52
  v_xor_b32 v59, 32, v58
  ds_read_b64_tr_b16 v[160:161], v58 offset:0
  ds_read_b64_tr_b16 v[162:163], v58 offset:512
  ds_read_b64_tr_b16 v[164:165], v58 offset:8192
  ds_read_b64_tr_b16 v[166:167], v58 offset:8704
  ds_read_b64_tr_b16 v[168:169], v59 offset:0
  ds_read_b64_tr_b16 v[170:171], v59 offset:512
  ds_read_b64_tr_b16 v[172:173], v59 offset:8192
  ds_read_b64_tr_b16 v[174:175], v59 offset:8704
  s_waitcnt vmcnt(28) lgkmcnt(0)
  s_barrier
  s_add_u32 m0, s78, 81920
  s_add_u32 s95, s74, 524288
  buffer_load_dwordx4 v40, s[80:83], s95 offen offset:0 lds
  buffer_load_dwordx4 v41, s[80:83], s95 offen offset:1024 lds
  buffer_load_dwordx4 v42, s[80:83], s95 offen offset:2048 lds
  buffer_load_dwordx4 v43, s[80:83], s95 offen offset:3072 lds
  v_add_u32 v58, 98304, v52
  v_xor_b32 v59, 32, v58
  ds_read_b64_tr_b16 v[176:177], v58 offset:0
  ds_read_b64_tr_b16 v[178:179], v58 offset:512
  ds_read_b64_tr_b16 v[180:181], v58 offset:8192
  ds_read_b64_tr_b16 v[182:183], v58 offset:8704
  ds_read_b64_tr_b16 v[184:185], v59 offset:0
  ds_read_b64_tr_b16 v[186:187], v59 offset:512
  ds_read_b64_tr_b16 v[188:189], v59 offset:8192
  ds_read_b64_tr_b16 v[190:191], v59 offset:8704
  s_waitcnt vmcnt(28) lgkmcnt(0)
  s_barrier
  s_add_u32 m0, s78, 98304
  s_add_u32 s95, s74, 1048576
  buffer_load_dwordx4 v40, s[80:83], s95 offen offset:0 lds
  buffer_load_dwordx4 v41, s[80:83], s95 offen offset:1024 lds
  buffer_load_dwordx4 v42, s[80:83], s95 offen offset:2048 lds
  buffer_load_dwordx4 v43, s[80:83], s95 offen offset:3072 lds
  v_add_u32 v58, 114688, v52
  v_xor_b32 v59, 32, v58
  ds_read_b64_tr_b16 v[192:193], v58 offset:0
  ds_read_b64_tr_b16 v[194:195], v58 offset:512
  ds_read_b64_tr_b16 v[196:197], v58 offset:8192
  ds_read_b64_tr_b16 v[198:199], v58 offset:8704
  ds_read_b64_tr_b16 v[200:201], v59 offset:0
  ds_read_b64_tr_b16 v[202:203], v59 offset:512
  ds_read_b64_tr_b16 v[204:205], v59 offset:8192
  ds_read_b64_tr_b16 v[206:207], v59 offset:8704
  s_waitcnt vmcnt(28) lgkmcnt(0)
  s_barrier
  s_add_u32 m0, s78, 114688
  s_add_u32 s95, s74, 1572864
  buffer_load_dwordx4 v40, s[80:83], s95 offen offset:0 lds
  buffer_load_dwordx4 v41, s[80:83], s95 offen offset:1024 lds
  buffer_load_dwordx4 v42, s[80:83], s95 offen offset:2048 lds
  buffer_load_dwordx4 v43, s[80:83], s95 offen offset:3072 lds
  v_add_u32 v58, 131072, v52
  v_xor_b32 v59, 32, v58
  ds_read_b64_tr_b16 v[208:209], v58 offset:0
  ds_read_b64_tr_b16 v[210:211], v58 offset:512
  ds_read_b64_tr_b16 v[212:213], v58 offset:8192
  ds_read_b64_tr_b16 v[214:215], v58 offset:8704
  ds_read_b64_tr_b16 v[216:217], v59 offset:0
  ds_read_b64_tr_b16 v[218:219], v59 offset:512
  ds_read_b64_tr_b16 v[220:221], v59 offset:8192
  ds_read_b64_tr_b16 v[222:223], v59 offset:8704
  s_waitcnt vmcnt(28) lgkmcnt(0)
  s_barrier
  s_add_u32 m0, s78, 131072
  s_add_u32 s95, s74, 2097152
  buffer_load_dwordx4 v40, s[80:83], s95 offen offset:0 lds
  buffer_load_dwordx4 v41, s[80:83], s95 offen offset:1024 lds
  buffer_load_dwordx4 v42, s[80:83], s95 offen offset:2048 lds
  buffer_load_dwordx4 v43, s[80:83], s95 offen offset:3072 lds
  v_add_u32 v58, 147456, v54
  v_xor_b32 v59, 32, v58
  ds_read_b64_tr_b16 v[224:225], v58 offset:0
  ds_read_b64_tr_b16 v[226:227], v58 offset:512
  ds_read_b64_tr_b16 v[228:229], v58 offset:8192
  ds_read_b64_tr_b16 v[230:231], v58 offset:8704
  ds_read_b64_tr_b16 v[232:233], v59 offset:0
  ds_read_b64_tr_b16 v[234:235], v59 offset:512
  ds_read_b64_tr_b16 v[236:237], v59 offset:8192
  ds_read_b64_tr_b16 v[238:239], v59 offset:8704
  s_waitcnt vmcnt(28) lgkmcnt(0)
  s_barrier
  s_add_u32 m0, s78, 147456
  s_add_u32 s95, s74, 0
  buffer_load_dwordx4 v40, s[80:83], s95 offen offset:0 lds
  buffer_load_dwordx4 v41, s[80:83], s95 offen offset:1024 lds
  buffer_load_dwordx4 v42, s[80:83], s95 offen offset:2048 lds
  buffer_load_dwordx4 v43, s[80:83], s95 offen offset:3072 lds
  v_add_u32 v58, 16384, v54
  v_xor_b32 v59, 32, v58
  ds_read_b64_tr_b16 v[240:241], v58 offset:0
  ds_read_b64_tr_b16 v[242:243], v58 offset:512
  ds_read_b64_tr_b16 v[244:245], v58 offset:8192
  ds_read_b64_tr_b16 v[246:247], v58 offset:8704
  ds_read_b64_tr_b16 v[248:249], v59 offset:0
  ds_read_b64_tr_b16 v[250:251], v59 offset:512
  ds_read_b64_tr_b16 v[252:253], v59 offset:8192
  ds_read_b64_tr_b16 v[254:255], v59 offset:8704
  v_mov_b32 v76, v52
  v_mov_b32 v77, v54
  v_mov_b32 v78, v56
  s_lshl_b32 s95, s57, 11
  s_add_u32 s95, s95, 32768
  v_add_u32 v79, s95, v2
  s_waitcnt vmcnt(0) lgkmcnt(0)
  s_barrier
  v_add_u32 v8, 32768, v77
  v_xor_b32 v9, 32, v8
  ds_read_b64_tr_b16 v[12:13], v8 offset:0
  ds_read_b64_tr_b16 v[14:15], v8 offset:512
  ds_read_b64_tr_b16 v[16:17], v8 offset:8192
  ds_read_b64_tr_b16 v[18:19], v8 offset:8704
  ds_read_b64_tr_b16 v[20:21], v9 offset:0
  ds_read_b64_tr_b16 v[22:23], v9 offset:512
  ds_read_b64_tr_b16 v[24:25], v9 offset:8192
  ds_read_b64_tr_b16 v[26:27], v9 offset:8704
  s_waitcnt lgkmcnt(0)
  v_add_u32 v8, 49152, v77
  v_xor_b32 v9, 32, v8
  ds_read_b64_tr_b16 v[28:29], v8 offset:0
  ds_read_b64_tr_b16 v[30:31], v8 offset:512
  ds_read_b64_tr_b16 v[32:33], v8 offset:8192
  ds_read_b64_tr_b16 v[34:35], v8 offset:8704
  ds_read_b64_tr_b16 v[36:37], v9 offset:0
  ds_read_b64_tr_b16 v[38:39], v9 offset:512
  ds_read_b64_tr_b16 v[40:41], v9 offset:8192
  ds_read_b64_tr_b16 v[42:43], v9 offset:8704
  s_waitcnt lgkmcnt(0)
  v_add_u32 v8, 65536, v78
  ds_read_b64_tr_b16 v[44:45], v8 offset:0
  ds_read_b64_tr_b16 v[46:47], v8 offset:256
  ds_read_b64_tr_b16 v[48:49], v8 offset:4096
  ds_read_b64_tr_b16 v[50:51], v8 offset:4352
  ds_read_b64_tr_b16 v[52:53], v8 offset:8192
  ds_read_b64_tr_b16 v[54:55], v8 offset:8448
  ds_read_b64_tr_b16 v[56:57], v8 offset:12288
  ds_read_b64_tr_b16 v[58:59], v8 offset:12544
  s_waitcnt lgkmcnt(0)
  v_add_u32 v8, 81920, v76
  v_xor_b32 v9, 32, v8
  ds_read_b64_tr_b16 v[60:61], v8 offset:0
  ds_read_b64_tr_b16 v[62:63], v8 offset:512
  ds_read_b64_tr_b16 v[64:65], v8 offset:8192
  ds_read_b64_tr_b16 v[66:67], v8 offset:8704
  ds_read_b64_tr_b16 v[68:69], v9 offset:0
  ds_read_b64_tr_b16 v[70:71], v9 offset:512
  ds_read_b64_tr_b16 v[72:73], v9 offset:8192
  ds_read_b64_tr_b16 v[74:75], v9 offset:8704
  s_waitcnt lgkmcnt(0)
  s_barrier
  ds_write_b128 v79, v[12:15] offset:0
  ds_write_b128 v79, v[16:19] offset:1024
  ds_write_b128 v79, v[20:23] offset:8192
  ds_write_b128 v79, v[24:27] offset:9216
  ds_write_b128 v79, v[28:31] offset:16384
  ds_write_b128 v79, v[32:35] offset:17408
  ds_write_b128 v79, v[36:39] offset:24576
  ds_write_b128 v79, v[40:43] offset:25600
  s_waitcnt lgkmcnt(0)
  ds_write_b128 v79, v[44:47] offset:32768
  ds_write_b128 v79, v[48:51] offset:33792
  ds_write_b128 v79, v[52:55] offset:40960
  ds_write_b128 v79, v[56:59] offset:41984
  ds_write_b128 v79, v[60:63] offset:49152
  ds_write_b128 v79, v[64:67] offset:50176
  ds_write_b128 v79, v[68:71] offset:57344
  ds_write_b128 v79, v[72:75] offset:58368
  s_waitcnt lgkmcnt(0)
  v_add_u32 v79, 0x10000, v79
  v_add_u32 v8, 98304, v76
  v_xor_b32 v9, 32, v8
  ds_read_b64_tr_b16 v[12:13], v8 offset:0
  ds_read_b64_tr_b16 v[14:15], v8 offset:512
  ds_read_b64_tr_b16 v[16:17], v8 offset:8192
  ds_read_b64_tr_b16 v[18:19], v8 offset:8704
  ds_read_b64_tr_b16 v[20:21], v9 offset:0
  ds_read_b64_tr_b16 v[22:23], v9 offset:512
  ds_read_b64_tr_b16 v[24:25], v9 offset:8192
  ds_read_b64_tr_b16 v[26:27], v9 offset:8704
  s_waitcnt lgkmcnt(0)
  v_add_u32 v8, 114688, v76
  v_xor_b32 v9, 32, v8
  ds_read_b64_tr_b16 v[28:29], v8 offset:0
  ds_read_b64_tr_b16 v[30:31], v8 offset:512
  ds_read_b64_tr_b16 v[32:33], v8 offset:8192
  ds_read_b64_tr_b16 v[34:35], v8 offset:8704
  ds_read_b64_tr_b16 v[36:37], v9 offset:0
  ds_read_b64_tr_b16 v[38:39], v9 offset:512
  ds_read_b64_tr_b16 v[40:41], v9 offset:8192
  ds_read_b64_tr_b16 v[42:43], v9 offset:8704
  s_waitcnt lgkmcnt(0)
  v_add_u32 v8, 131072, v76
  v_xor_b32 v9, 32, v8
  ds_read_b64_tr_b16 v[44:45], v8 offset:0
  ds_read_b64_tr_b16 v[46:47], v8 offset:512
  ds_read_b64_tr_b16 v[48:49], v8 offset:8192
  ds_read_b64_tr_b16 v[50:51], v8 offset:8704
  ds_read_b64_tr_b16 v[52:53], v9 offset:0
  ds_read_b64_tr_b16 v[54:55], v9 offset:512
  ds_read_b64_tr_b16 v[56:57], v9 offset:8192
  ds_read_b64_tr_b16 v[58:59], v9 offset:8704
  s_waitcnt lgkmcnt(0)
  v_add_u32 v8, 147456, v76
  v_xor_b32 v9, 32, v8
  ds_read_b64_tr_b16 v[60:61], v8 offset:0
  ds_read_b64_tr_b16 v[62:63], v8 offset:512
  ds_read_b64_tr_b16 v[64:65], v8 offset:8192
  ds_read_b64_tr_b16 v[66:67], v8 offset:8704
  ds_read_b64_tr_b16 v[68:69], v9 offset:0
  ds_read_b64_tr_b16 v[70:71], v9 offset:512
  ds_read_b64_tr_b16 v[72:73], v9 offset:8192
  ds_read_b64_tr_b16 v[74:75], v9 offset:8704
  s_waitcnt lgkmcnt(0)
  s_barrier
  ds_write_b128 v79, v[12:15] offset:0
  ds_write_b128 v79, v[16:19] offset:1024
  ds_write_b128 v79, v[20:23] offset:8192
  ds_write_b128 v79, v[24:27] offset:9216
  ds_write_b128 v79, v[28:31] offset:16384
  ds_write_b128 v79, v[32:35] offset:17408
  ds_write_b128 v79, v[36:39] offset:24576
  ds_write_b128 v79, v[40:43] offset:25600
  s_waitcnt lgkmcnt(0)
  ds_write_b128 v79, v[44:47] offset:32768
  ds_write_b128 v79, v[48:51] offset:33792
  ds_write_b128 v79, v[52:55] offset:40960
  ds_write_b128 v79, v[56:59] offset:41984
  ds_write_b128 v79, v[60:63] offset:49152
  ds_write_b128 v79, v[64:67] offset:50176
  ds_write_b128 v79, v[68:71] offset:57344
  ds_write_b128 v79, v[72:75] offset:58368
  s_waitcnt lgkmcnt(0)
  s_mov_b32 s85, s63
  v_lshlrev_b32 v2, 4, v1
  v_lshrrev_b32 v58, 4, v1
  v_and_b32 v59, 15, v1
  v_mov_b32 v0, 0x4444
  v_mov_b32 v60, 0xeeee
  v_cmp_lt_u32 vcc, 7, v59
  s_nop 1
  v_cndmask_b32 v0, v0, v60, vcc
  v_lshrrev_b32 v60, 1, v58
  v_and_b32 v61, 1, v58
  v_lshl_add_u32 v62, v60, 4, v59
  v_lshlrev_b32 v62, 4, v62
  v_lshl_add_u32 v62, v61, 3, v62
  s_lshl_b32 s96, s57, 9
  s_cmp_eq_u32 s71, 0
  s_mov_b32 s97, 16384
  s_cselect_b32 s97, 21504, s97
  s_add_u32 s95, s96, s97
  s_add_u32 s68, s96, 28672
  v_add_u32 v3, s95, v62
  v_lshrrev_b32 v62, 2, v59
  v_lshl_add_u32 v62, v60, 4, v62
  v_lshl_add_u32 v62, v61, 2, v62
  v_lshlrev_b32 v62, 4, v62
  v_and_b32 v63, 1, v59
  v_lshl_add_u32 v4, v63, 3, v62
  v_bfe_u32 v63, v59, 1, 1
  v_mul_u32_u24 v63, 2176, v63
  v_add3_u32 v4, v4, v63, s97
  v_and_b32 v62, 8, v59
  v_add_u32 v62, v62, v59
  v_lshlrev_b32 v62, 4, v62
  v_lshl_add_u32 v5, v58, 9, v62
  v_lshrrev_b32 v62, 3, v59
  v_and_b32 v63, 7, v59
  v_lshlrev_b32 v63, 4, v63
  v_lshl_add_u32 v63, v62, 12, v63
  v_lshl_add_u32 v7, v61, 3, v63
  v_lshl_add_u32 v7, v60, 2, v7
  v_lshl_add_u32 v63, v61, 16, v63
  v_lshl_add_u32 v63, v60, 13, v63
  s_lshl_b32 s95, s57, 14
  v_add_u32 v6, s95, v63
  s_and_b32 s96, s57, 1
  s_lshl_b32 s67, s96, 10
  s_mul_i32 s96, s96, 2560
  v_add_u32 v8, s96, v2
  v_lshlrev_b32 v9, 3, v1
  v_add_u32 v9, s96, v9
  s_mov_b32 s73, 0
  s_mul_i32 s95, s71, 5120
  s_add_u32 s74, s95, 720896
  s_sub_u32 s96, 5120, s95
  s_add_u32 s75, s96, 1376256
  s_lshl_b32 s96, s57, 5
  s_add_u32 s96, s96, s72
  s_lshl_b32 s97, s96, 7
  s_add_u32 s76, s74, s97
  s_add_u32 s77, s76, 655360
  s_cmp_lt_u32 s96, 40
  s_cselect_b32 s84, 1, 0
  s_mul_i32 s78, s71, 327680
  s_add_u32 s78, s78, 65536
  s_lshl_b32 s97, s96, 12
  s_add_u32 s80, s78, s97
  s_lshl_b32 s97, s72, 7
  s_add_u32 s78, s78, s97
  s_lshl_b32 s97, s57, 13
  s_add_u32 s79, s78, s97
  s_add_u32 s79, s79, 131072
  s_mov_b32 s70, 163840
  s_lshl_b32 s97, s72, 13
  s_lshr_b32 s92, s72, 1
  s_lshl_b32 s92, s92, 2
  s_bitcmp1_b32 s57, 0
  s_mov_b32 s81, 4194304
  s_cselect_b32 s81, 20971520, s81
  s_cselect_b32 s86, 8192, 0
  s_cselect_b32 s95, 64, 0
  s_add_u32 s92, s92, s95
  s_add_u32 s81, s81, s97
  s_add_u32 s82, s81, 16515072
  s_lshl_b32 s83, s72, 11
  s_add_u32 s83, s83, s67
  s_cmp_eq_u32 s71, 0
  s_mov_b32 s97, 75431936
  s_cselect_b32 s97, 71237504, s97
  s_add_u32 s83, s83, s97
  s_lshl_b32 s69, s64, 8
  s_mov_b32 s66, 0
  s_add_u32 s69, s69, 16384
  s_mov_b32 s87, 4294942720
  s_mov_b32 s88, 0x00ff00ff
  s_mov_b32 s89, 0x00ff00ff
  s_mov_b32 s90, -1
  s_mov_b32 s91, 0
  s_mov_b32 s94, 0x3e0293ee
  s_add_u32 s76, s76, 10240
  s_add_u32 s77, s77, 10240
  s_lshl_b32 s95, s57, 11
  s_add_u32 s95, s95, 32768
  v_add_u32 v1, s95, v2
  s_cmp_lt_u32 s57, 2
  s_cbranch_scc1 C_go
  s_mov_b64 exec, 1
  v_mov_b32 v41, 0
C_fw0:
  buffer_load_dword v40, v41, s[36:39], s92 offen sc1
  s_add_i32 s56, s56, -1
  s_cmp_lt_i32 s56, 0
  s_waitcnt vmcnt(0)
  v_cmp_gt_u32 vcc, 2, v40
  s_cbranch_scc1 C_fw0_d
  s_cbranch_vccnz C_fw0
C_fw0_d:
  s_mov_b64 exec, -1
  s_mov_b32 m0, s86
  s_add_u32 s95, s81, 4096
  buffer_load_dwordx4 v2, s[36:39], s81 offen offset:0 lds
  buffer_load_dwordx4 v2, s[36:39], s81 offen offset:1024 lds
  buffer_load_dwordx4 v2, s[36:39], s81 offen offset:2048 lds
  buffer_load_dwordx4 v2, s[36:39], s81 offen offset:3072 lds
  s_add_u32 m0, s86, 4096
  s_nop 0
  buffer_load_dwordx4 v2, s[36:39], s95 offen offset:0 lds
  buffer_load_dwordx4 v2, s[36:39], s95 offen offset:1024 lds
  buffer_load_dwordx4 v2, s[36:39], s95 offen offset:2048 lds
  buffer_load_dwordx4 v2, s[36:39], s95 offen offset:3072 lds
  s_add_u32 s81, s81, 262144
  s_min_u32 s93, s81, s82
C_go:
  v_add_u32 v11, 0x10000, v1
  ds_read_b128 v[56:59], v11 offset:49152
  ds_read_b128 v[60:63], v11 offset:50176
  ds_read_b128 v[64:67], v11 offset:57344
  ds_read_b128 v[68:71], v11 offset:58368
  v_mov_b64 v[12:13], 0
  v_mov_b64 v[14:15], 0
  v_mov_b64 v[16:17], 0
  v_mov_b64 v[18:19], 0
  v_mov_b64 v[20:21], 0
  v_mov_b64 v[22:23], 0
  v_mov_b64 v[24:25], 0
  v_mov_b64 v[26:27], 0
  v_mov_b64 v[28:29], 0
  v_mov_b64 v[30:31], 0
  v_mov_b64 v[32:33], 0
  v_mov_b64 v[34:35], 0
  s_cmp_ge_u32 s57, 2
  s_cbranch_scc0 CA_top
  s_cmp_eq_u32 s71, 0
  s_cbranch_scc1 CB0_top
  s_branch CB1_top
CA_top:
  s_barrier
  s_sleep 11
  buffer_load_dwordx4 v[72:75], v8, s[36:39], s75 offen sc1
  buffer_load_dwordx4 v[76:79], v8, s[36:39], s75 offen offset:1024 sc1
  buffer_load_dwordx2 v[10:11], v9, s[36:39], s75 offen offset:2048 sc1
  s_waitcnt vmcnt(9) lgkmcnt(0)
  s_barrier
  ds_read_b128 v[36:39], v2 offset:16384
  ds_read_b128 v[40:43], v2 offset:17408
  ds_read_b128 v[44:47], v2 offset:18432
  ds_read_b128 v[48:51], v2 offset:19456
  ds_read_b128 v[52:55], v2 offset:20480
  s_waitcnt lgkmcnt(4)
  v_smfmac_f32_16x16x64_bf16 v[28:31], v[36:39], v[56:63], v0
  ds_read_b128 v[56:59], v1 offset:49152
  ds_read_b128 v[60:63], v1 offset:50176
  v_smfmac_f32_16x16x64_bf16 v[32:35], v[36:39], v[64:71], v0
  ds_read_b128 v[64:67], v1 offset:57344
  ds_read_b128 v[68:71], v1 offset:58368
  v_smfmac_f32_16x16x64_bf16 v[12:15], v[36:39], a[0:7], v0
  v_smfmac_f32_16x16x64_bf16 v[16:19], v[36:39], a[8:15], v0
  v_smfmac_f32_16x16x64_bf16 v[20:23], v[36:39], a[160:167], v0
  v_smfmac_f32_16x16x64_bf16 v[24:27], v[36:39], a[168:175], v0
  s_waitcnt lgkmcnt(7)
  v_smfmac_f32_16x16x64_bf16 v[12:15], v[40:43], a[16:23], v0
  v_add_u32 v36, 0x10000, v1
  v_smfmac_f32_16x16x64_bf16 v[16:19], v[40:43], a[24:31], v0
  v_smfmac_f32_16x16x64_bf16 v[20:23], v[40:43], a[176:183], v0
  v_smfmac_f32_16x16x64_bf16 v[24:27], v[40:43], a[184:191], v0
  s_waitcnt lgkmcnt(2)
  v_smfmac_f32_16x16x64_bf16 v[28:31], v[40:43], v[56:63], v0
  s_waitcnt lgkmcnt(0)
  ds_read_b128 v[56:59], v36 offset:0
  ds_read_b128 v[60:63], v36 offset:1024
  v_smfmac_f32_16x16x64_bf16 v[32:35], v[40:43], v[64:71], v0
  ds_read_b128 v[64:67], v36 offset:8192
  ds_read_b128 v[68:71], v36 offset:9216
  v_smfmac_f32_16x16x64_bf16 v[12:15], v[44:47], a[32:39], v0
  v_smfmac_f32_16x16x64_bf16 v[16:19], v[44:47], a[40:47], v0
  v_smfmac_f32_16x16x64_bf16 v[20:23], v[44:47], a[192:199], v0
  v_smfmac_f32_16x16x64_bf16 v[24:27], v[44:47], a[200:207], v0
  s_waitcnt lgkmcnt(2)
  s_waitcnt vmcnt(2)
  v_max3_u32 v37, v72, v73, v74
  v_smfmac_f32_16x16x64_bf16 v[28:31], v[44:47], v[56:63], v0
  s_waitcnt lgkmcnt(0)
  ds_read_b128 v[56:59], v36 offset:16384
  ds_read_b128 v[60:63], v36 offset:17408
  s_waitcnt vmcnt(1)
  v_max3_u32 v37, v37, v75, v76
  v_smfmac_f32_16x16x64_bf16 v[32:35], v[44:47], v[64:71], v0
  ds_read_b128 v[64:67], v36 offset:24576
  ds_read_b128 v[68:71], v36 offset:25600
  v_max3_u32 v37, v37, v77, v78
  s_waitcnt vmcnt(0)
  v_smfmac_f32_16x16x64_bf16 v[12:15], v[48:51], a[48:55], v0
  v_max3_u32 v37, v37, v79, v10
  v_max_u32 v37, v37, v11
  v_smfmac_f32_16x16x64_bf16 v[16:19], v[48:51], a[56:63], v0
  v_cmp_eq_u32 vcc, -1, v37
  s_nop 0
  s_cbranch_vccnz CA_rr
CA_rd:
  v_smfmac_f32_16x16x64_bf16 v[20:23], v[48:51], a[208:215], v0
  ds_write_b128 v8, v[72:75] offset:25728
  ds_write_b128 v8, v[76:79] offset:26752
  v_smfmac_f32_16x16x64_bf16 v[24:27], v[48:51], a[216:223], v0
  ds_write_b64 v9, v[10:11] offset:27776
  s_waitcnt lgkmcnt(3)
  v_smfmac_f32_16x16x64_bf16 v[28:31], v[48:51], v[56:63], v0
  ds_read_b128 v[56:59], v36 offset:32768
  ds_read_b128 v[60:63], v36 offset:33792
  v_smfmac_f32_16x16x64_bf16 v[32:35], v[48:51], v[64:71], v0
  ds_read_b128 v[64:67], v36 offset:40960
  ds_read_b128 v[68:71], v36 offset:41984
  v_smfmac_f32_16x16x64_bf16 v[12:15], v[52:55], a[64:71], v0
  v_smfmac_f32_16x16x64_bf16 v[16:19], v[52:55], a[72:79], v0
  s_waitcnt lgkmcnt(4)
  s_barrier
  ds_read_b128 v[36:39], v2 offset:25728
  ds_read_b128 v[40:43], v2 offset:26752
  v_smfmac_f32_16x16x64_bf16 v[20:23], v[52:55], a[224:231], v0
  ds_read_b128 v[44:47], v2 offset:27776
  ds_read_b128 v[48:51], v2 offset:28800
  v_smfmac_f32_16x16x64_bf16 v[24:27], v[52:55], a[232:239], v0
  s_waitcnt lgkmcnt(6)
  v_smfmac_f32_16x16x64_bf16 v[28:31], v[52:55], v[56:63], v0
  s_waitcnt lgkmcnt(4)
  v_smfmac_f32_16x16x64_bf16 v[32:35], v[52:55], v[64:71], v0
  ds_read_b128 v[52:55], v2 offset:29824
  s_waitcnt lgkmcnt(4)
  v_smfmac_f32_16x16x64_bf16 v[12:15], v[36:39], a[80:87], v0
  ds_read_b128 v[56:59], v5 offset:0
  ds_read_b128 v[60:63], v5 offset:128
  v_smfmac_f32_16x16x64_bf16 v[16:19], v[36:39], a[88:95], v0
  ds_read_b128 v[64:67], v5 offset:2048
  v_smfmac_f32_16x16x64_bf16 v[20:23], v[36:39], a[240:247], v0
  ds_read_b128 v[68:71], v5 offset:2176
  v_smfmac_f32_16x16x64_bf16 v[24:27], v[36:39], a[248:255], v0
  s_waitcnt lgkmcnt(7)
  v_smfmac_f32_16x16x64_bf16 v[12:15], v[40:43], a[96:103], v0
  v_smfmac_f32_16x16x64_bf16 v[16:19], v[40:43], a[104:111], v0
  v_smfmac_f32_16x16x64_bf16 v[20:23], v[40:43], v[80:87], v0
  v_smfmac_f32_16x16x64_bf16 v[24:27], v[40:43], v[88:95], v0
  s_waitcnt lgkmcnt(6)
  v_smfmac_f32_16x16x64_bf16 v[12:15], v[44:47], a[112:119], v0
  v_smfmac_f32_16x16x64_bf16 v[16:19], v[44:47], a[120:127], v0
  s_waitcnt lgkmcnt(5)
  v_smfmac_f32_16x16x64_bf16 v[12:15], v[48:51], a[128:135], v0
  v_smfmac_f32_16x16x64_bf16 v[16:19], v[48:51], a[136:143], v0
  v_smfmac_f32_16x16x64_bf16 v[20:23], v[44:47], v[96:103], v0
  v_smfmac_f32_16x16x64_bf16 v[24:27], v[44:47], v[104:111], v0
  s_waitcnt lgkmcnt(4)
  v_smfmac_f32_16x16x64_bf16 v[12:15], v[52:55], a[144:151], v0
  v_smfmac_f32_16x16x64_bf16 v[16:19], v[52:55], a[152:159], v0
  v_smfmac_f32_16x16x64_bf16 v[20:23], v[48:51], v[112:119], v0
  v_smfmac_f32_16x16x64_bf16 v[24:27], v[48:51], v[120:127], v0
  v_permlane32_swap_b32 v12, v16
  v_permlane32_swap_b32 v13, v17
  v_permlane32_swap_b32 v14, v18
  v_smfmac_f32_16x16x64_bf16 v[20:23], v[52:55], v[128:135], v0
  v_permlane32_swap_b32 v15, v19
  v_add_f32 v12, v12, v16
  v_add_f32 v13, v13, v17
  v_smfmac_f32_16x16x64_bf16 v[24:27], v[52:55], v[136:143], v0
  v_add_f32 v14, v14, v18
  v_add_f32 v15, v15, v19
  v_cvt_pk_bf16_f32 v16, v12, v13
  v_smfmac_f32_16x16x64_bf16 v[28:31], v[52:55], v[208:215], v0
  v_cvt_pk_bf16_f32 v17, v14, v15
  ds_write_b64 v3, v[16:17] offset:0
  ds_read_b128 v[12:15], v5 offset:6144
  v_smfmac_f32_16x16x64_bf16 v[32:35], v[52:55], v[216:223], v0
  ds_read_b128 v[16:19], v5 offset:6272
  v_permlane32_swap_b32 v20, v24
  v_permlane32_swap_b32 v21, v25
  v_permlane32_swap_b32 v22, v26
  v_smfmac_f32_16x16x64_bf16 v[28:31], v[36:39], v[144:151], v0
  v_permlane32_swap_b32 v23, v27
  v_add_f32 v20, v20, v24
  v_add_f32 v21, v21, v25
  v_smfmac_f32_16x16x64_bf16 v[32:35], v[36:39], v[152:159], v0
  v_add_f32 v22, v22, v26
  v_add_f32 v23, v23, v27
  v_cvt_pk_bf16_f32 v24, v20, v21
  v_smfmac_f32_16x16x64_bf16 v[28:31], v[40:43], v[160:167], v0
  v_cvt_pk_bf16_f32 v25, v22, v23
  ds_write_b64 v3, v[24:25] offset:2176
  v_smfmac_f32_16x16x64_bf16 v[32:35], v[40:43], v[168:175], v0
  v_mov_b32 v53, 0xf149f2ca
  v_cndmask_b32 v52, 0, v53, s[90:91]
  s_waitcnt lgkmcnt(0)
  s_barrier
  ds_read_b64_tr_b16 v[36:37], v4 offset:0
  ds_read_b64_tr_b16 v[38:39], v4 offset:128
  ds_read_b64_tr_b16 v[40:41], v4 offset:512
  ds_read_b64_tr_b16 v[42:43], v4 offset:640
  v_smfmac_f32_16x16x64_bf16 v[28:31], v[44:47], v[176:183], v0
  v_smfmac_f32_16x16x64_bf16 v[32:35], v[44:47], v[184:191], v0
  ds_read_b64_tr_b16 v[44:45], v4 offset:1024
  ds_read_b64_tr_b16 v[46:47], v4 offset:1152
  s_waitcnt vmcnt(0)
  ds_read_b128 v[72:75], v5 offset:4096
  ds_read_b128 v[76:79], v5 offset:4224
  v_smfmac_f32_16x16x64_bf16 v[28:31], v[48:51], v[192:199], v0
  v_mov_b32 v53, v52
  v_mov_b64 v[54:55], v[52:53]
  v_smfmac_f32_16x16x64_bf16 v[32:35], v[48:51], v[200:207], v0
  ds_read_b64_tr_b16 v[48:49], v4 offset:1536
  ds_read_b64_tr_b16 v[50:51], v4 offset:1664
  s_cmp_eq_u32 s73, 63
  s_cbranch_scc1 CA_f63
  s_waitcnt lgkmcnt(8)
  v_mfma_f32_16x16x32_bf16 v[20:23], v[56:59], v[36:39], 0
  v_mfma_f32_16x16x32_bf16 v[24:27], v[60:63], v[36:39], 0
  v_permlane32_swap_b32 v28, v32
  v_permlane32_swap_b32 v29, v33
  v_mfma_f32_16x16x32_bf16 v[52:55], v[36:39], v[36:39], v[52:55]
  v_permlane32_swap_b32 v30, v34
  v_permlane32_swap_b32 v31, v35
  s_waitcnt lgkmcnt(6)
  v_mfma_f32_16x16x32_bf16 v[20:23], v[64:67], v[40:43], v[20:23]
  v_pk_add_f32 v[28:29], v[28:29], v[32:33]
  v_pk_add_f32 v[30:31], v[30:31], v[34:35]
  v_mfma_f32_16x16x32_bf16 v[24:27], v[68:71], v[40:43], v[24:27]
  v_cvt_pk_bf16_f32 v10, v28, v29
  v_cvt_pk_bf16_f32 v11, v30, v31
  ds_write_b64 v3, v[10:11] offset:5120
  v_mfma_f32_16x16x32_bf16 v[52:55], v[40:43], v[40:43], v[52:55]
  v_and_b32 v34, 0x300, v2
  v_mov_b64 v[28:29], v[10:11]
  v_add3_u32 v34, v34, v1, s87
  s_waitcnt lgkmcnt(3)
  v_mfma_f32_16x16x32_bf16 v[20:23], v[72:75], v[44:47], v[20:23]
  ds_read_b128 v[64:67], v34
  ds_read_b128 v[68:71], v34 offset:256
  v_permlane32_swap_b32 v28, v10
  v_mfma_f32_16x16x32_bf16 v[24:27], v[76:79], v[44:47], v[24:27]
  v_permlane32_swap_b32 v29, v11
  v_mov_b32 v30, 0x3f803f80
  v_mov_b32 v31, 0x3f803f80
  v_mfma_f32_16x16x32_bf16 v[52:55], v[44:47], v[44:47], v[52:55]
  s_waitcnt lgkmcnt(3)
  ds_read_b128 v[36:39], v1 offset:0
  ds_read_b128 v[40:43], v1 offset:1024
  v_mov_b64 v[32:33], v[30:31]
  v_mfma_f32_16x16x32_bf16 v[20:23], v[12:15], v[48:51], v[20:23]
  ds_read_b128 v[72:75], v1 offset:24576
  ds_read_b128 v[76:79], v1 offset:25600
  v_lshrrev_b32 v35, 1, v2
  v_mfma_f32_16x16x32_bf16 v[24:27], v[16:19], v[48:51], v[24:27]
  v_and_b32 v35, 0x180, v35
  v_sub_u32 v35, v2, v35
  v_mfma_f32_16x16x32_bf16 v[52:55], v[48:51], v[48:51], v[52:55]
  v_add_u32 v18, s68, v35
  v_max3_f32 v34, v20, v21, v22
  s_nop 1
  v_max3_f32 v35, v24, v25, v26
  v_max3_f32 v34, v34, v23, v27
  s_nop 1
  v_max3_f32 v35, v35, v52, v53
  v_max3_f32 v34, v34, v54, v55
  v_max_f32 v34, v34, v35
  v_mov_b32 v35, v34
  ds_read_b128 v[44:47], v1 offset:8192
  ds_read_b128 v[48:51], v1 offset:9216
  v_permlane32_swap_b32 v34, v35
  v_max_f32 v34, v34, v35
  v_mov_b32 v35, v34
  s_nop 1
  v_permlane16_swap_b32 v34, v35
  v_max_f32 v34, v34, v35
  v_mul_f32 v34, s94, v34
  v_pk_fma_f32 v[52:53], v[52:53], s[94:95], v[34:35] op_sel_hi:[1,0,0] neg_lo:[0,0,1] neg_hi:[0,0,1]
  v_pk_fma_f32 v[54:55], v[54:55], s[94:95], v[34:35] op_sel_hi:[1,0,0] neg_lo:[0,0,1] neg_hi:[0,0,1]
  v_exp_f32 v52, v52
  v_exp_f32 v53, v53
  v_exp_f32 v54, v54
  v_exp_f32 v55, v55
  v_pk_fma_f32 v[20:21], v[20:21], s[94:95], v[34:35] op_sel_hi:[1,0,0] neg_lo:[0,0,1] neg_hi:[0,0,1]
  v_pk_fma_f32 v[22:23], v[22:23], s[94:95], v[34:35] op_sel_hi:[1,0,0] neg_lo:[0,0,1] neg_hi:[0,0,1]
  v_pk_fma_f32 v[24:25], v[24:25], s[94:95], v[34:35] op_sel_hi:[1,0,0] neg_lo:[0,0,1] neg_hi:[0,0,1]
  v_pk_fma_f32 v[26:27], v[26:27], s[94:95], v[34:35] op_sel_hi:[1,0,0] neg_lo:[0,0,1] neg_hi:[0,0,1]
  v_cvt_pk_bf16_f32 v16, v52, v53
  v_cvt_pk_bf16_f32 v17, v54, v55
  v_exp_f32 v20, v20
  v_exp_f32 v21, v21
  v_mfma_f32_16x16x16_bf16 v[60:63], v[30:31], v[16:17], 0
  v_exp_f32 v22, v22
  v_exp_f32 v23, v23
  v_mfma_f32_16x16x16_bf16 v[52:55], v[28:29], v[16:17], 0
  v_exp_f32 v24, v24
  v_exp_f32 v25, v25
  v_mfma_f32_16x16x16_bf16 v[56:59], v[10:11], v[16:17], 0
  v_exp_f32 v26, v26
  v_exp_f32 v27, v27
  v_cvt_pk_bf16_f32 v12, v20, v21
  v_cvt_pk_bf16_f32 v13, v22, v23
  v_cvt_pk_bf16_f32 v14, v24, v25
  v_cvt_pk_bf16_f32 v15, v26, v27
  s_waitcnt lgkmcnt(6)
  s_nop 0
  v_mfma_f32_16x16x32_bf16 v[60:63], v[30:33], v[12:15], v[60:63]
  v_mov_b64 v[20:21], 0
  v_mov_b64 v[22:23], 0
  v_mfma_f32_16x16x32_bf16 v[52:55], v[64:67], v[12:15], v[52:55]
  v_mov_b64 v[24:25], 0
  v_mov_b64 v[26:27], 0
  v_mfma_f32_16x16x32_bf16 v[56:59], v[68:71], v[12:15], v[56:59]
  ds_read_b128 v[64:67], v1 offset:16384
  ds_read_b128 v[68:71], v1 offset:17408
  s_mov_b64 exec, s[88:89]
  v_rcp_f32 v34, v60
  s_nop 0
  v_pk_mul_f32 v[52:53], v[52:53], v[34:35] op_sel_hi:[1,0]
  v_pk_mul_f32 v[54:55], v[54:55], v[34:35] op_sel_hi:[1,0]
  v_cvt_pk_bf16_f32 v12, v52, v53
  v_cvt_pk_bf16_f32 v13, v54, v55
  v_pk_mul_f32 v[56:57], v[56:57], v[34:35] op_sel_hi:[1,0]
  v_pk_mul_f32 v[58:59], v[58:59], v[34:35] op_sel_hi:[1,0]
  v_cvt_pk_bf16_f32 v14, v56, v57
  v_cvt_pk_bf16_f32 v15, v58, v59
  ds_write_b128 v18, v[12:15]
  s_mov_b64 exec, -1
  ds_read_b128 v[52:55], v1 offset:32768
  ds_read_b128 v[56:59], v1 offset:33792
  v_mov_b64 v[60:61], 0
  v_mov_b64 v[62:63], 0
  v_mov_b64 v[28:29], 0
  v_mov_b64 v[30:31], 0
  v_mov_b64 v[32:33], 0
  v_mov_b64 v[34:35], 0
  s_waitcnt lgkmcnt(2)
  s_barrier
  ds_read_b128 v[12:15], v2 offset:28672
  ds_read_b128 v[16:19], v2 offset:29696
  s_cmp_lg_u32 s85, 0
  s_waitcnt lgkmcnt(1)
  v_smfmac_f32_16x16x64_bf16 v[20:23], v[12:15], v[36:43], v0
  ds_read_b128 v[36:39], v1 offset:40960
  ds_read_b128 v[40:43], v1 offset:41984
  v_smfmac_f32_16x16x64_bf16 v[24:27], v[12:15], v[44:51], v0
  s_waitcnt lgkmcnt(2)
  v_smfmac_f32_16x16x64_bf16 v[20:23], v[16:19], v[64:71], v0
  v_smfmac_f32_16x16x64_bf16 v[24:27], v[16:19], v[72:79], v0
  v_smfmac_f32_16x16x64_bf16 v[28:31], v[12:15], v[224:231], v0
  v_smfmac_f32_16x16x64_bf16 v[32:35], v[12:15], v[232:239], v0
  v_permlane32_swap_b32 v20, v24
  v_permlane32_swap_b32 v21, v25
  v_smfmac_f32_16x16x64_bf16 v[28:31], v[16:19], v[240:247], v0
  v_permlane32_swap_b32 v22, v26
  v_permlane32_swap_b32 v23, v27
  v_smfmac_f32_16x16x64_bf16 v[32:35], v[16:19], v[248:255], v0
  v_add_f32 v20, v20, v24
  v_add_f32 v21, v21, v25
  v_smfmac_f32_16x16x64_bf16 v[60:63], v[12:15], v[52:59], v0
  v_add_f32 v22, v22, v26
  v_add_f32 v23, v23, v27
  s_waitcnt lgkmcnt(0)
  v_smfmac_f32_16x16x64_bf16 v[60:63], v[16:19], v[36:43], v0
  v_cvt_pk_bf16_f32 v26, v20, v21
  v_cvt_pk_bf16_f32 v27, v22, v23
  v_permlane32_swap_b32 v28, v32
  v_permlane32_swap_b32 v29, v33
  v_permlane32_swap_b32 v30, v34
  v_permlane32_swap_b32 v31, v35
  v_pk_add_f32 v[28:29], v[28:29], v[32:33]
  v_pk_add_f32 v[30:31], v[30:31], v[34:35]
  v_cvt_pk_bf16_f32 v24, v28, v29
  v_cvt_pk_bf16_f32 v25, v30, v31
  v_permlane32_swap_b32 v60, v62
  v_permlane32_swap_b32 v61, v63
  v_permlane16_swap_b32 v24, v26
  v_permlane16_swap_b32 v25, v27
  v_pk_add_f32 v[60:61], v[60:61], v[62:63]
  s_cbranch_scc1 CA_ps
  buffer_store_dwordx4 v[24:27], v6, s[36:39], s78 offen
  v_cvt_pk_bf16_f32 v60, v60, v61
  buffer_store_dword v60, v7, s[36:39], s79 offen
CA_psd:
  s_cmp_eq_u32 s84, 0
  s_cbranch_scc1 CA_nored
  buffer_load_dwordx4 v[36:39], v2, s[36:39], s80 offen offset:0 sc1
  buffer_load_dwordx4 v[40:43], v2, s[36:39], s80 offen offset:1024 sc1
  buffer_load_dwordx4 v[44:47], v2, s[36:39], s80 offen offset:2048 sc1
  buffer_load_dwordx4 v[48:51], v2, s[36:39], s80 offen offset:3072 sc1
  v_add_u32 v11, 0x10000, v1
  ds_read_b128 v[56:59], v11 offset:49152
  ds_read_b128 v[60:63], v11 offset:50176
  ds_read_b128 v[64:67], v11 offset:57344
  ds_read_b128 v[68:71], v11 offset:58368
  v_mov_b64 v[12:13], 0
  v_mov_b64 v[14:15], 0
  v_mov_b64 v[16:17], 0
  v_mov_b64 v[18:19], 0
  v_mov_b64 v[20:21], 0
  v_mov_b64 v[22:23], 0
  v_mov_b64 v[24:25], 0
  v_mov_b64 v[26:27], 0
  v_mov_b64 v[28:29], 0
  v_mov_b64 v[30:31], 0
  v_mov_b64 v[32:33], 0
  v_mov_b64 v[34:35], 0
  v_bfe_u32 v10, v2, 4, 1
  v_lshlrev_b32 v10, 4, v10
  v_mov_b32 v11, 0x3f80
  v_lshlrev_b32 v10, v10, v11
  v_bfe_u32 v11, v2, 5, 2
  v_cmp_eq_u32 vcc, 0, v11
  s_nop 1
  v_cndmask_b32 v52, 0, v10, vcc
  v_mov_b32 v76, -1
  v_cmp_eq_u32 vcc, 1, v11
  s_nop 1
  v_cndmask_b32 v53, 0, v10, vcc
  v_mov_b32 v77, -1
  v_cmp_eq_u32 vcc, 2, v11
  s_nop 1
  v_cndmask_b32 v54, 0, v10, vcc
  v_mov_b32 v78, -1
  v_cmp_eq_u32 vcc, 3, v11
  s_nop 1
  v_cndmask_b32 v55, 0, v10, vcc
  v_mov_b32 v79, -1
CA_rl:
  buffer_load_dwordx4 v[36:39], v2, s[36:39], s80 offen offset:0 sc1
  buffer_load_dwordx4 v[40:43], v2, s[36:39], s80 offen offset:1024 sc1
  buffer_load_dwordx4 v[44:47], v2, s[36:39], s80 offen offset:2048 sc1
  buffer_load_dwordx4 v[48:51], v2, s[36:39], s80 offen offset:3072 sc1
CA_rc:
  s_add_i32 s56, s56, -1
  s_cmp_lt_i32 s56, 0
  s_waitcnt vmcnt(7)
  v_max3_u32 v10, v36, v37, v38
  v_max_u32 v10, v10, v39
  v_mfma_f32_16x16x32_bf16 v[72:75], v[36:39], v[52:55], 0
  s_waitcnt vmcnt(6)
  v_max3_u32 v10, v10, v40, v41
  v_max3_u32 v10, v10, v42, v43
  v_mfma_f32_16x16x32_bf16 v[72:75], v[40:43], v[52:55], v[72:75]
  s_waitcnt vmcnt(5)
  v_max3_u32 v10, v10, v44, v45
  v_max3_u32 v10, v10, v46, v47
  v_mfma_f32_16x16x32_bf16 v[72:75], v[44:47], v[52:55], v[72:75]
  s_waitcnt vmcnt(4)
  v_max3_u32 v10, v10, v48, v49
  v_max3_u32 v10, v10, v50, v51
  v_mfma_f32_16x16x32_bf16 v[72:75], v[48:51], v[52:55], v[72:75]
  v_cmp_eq_u32 vcc, -1, v10
  s_cbranch_scc1 CA_rdd
  s_cbranch_vccnz CA_rl
CA_rdd:
  s_cmp_lg_u32 s85, 0
  s_nop 4
  v_permlane32_swap_b32 v72, v74
  v_permlane32_swap_b32 v73, v75
  v_pk_add_f32 v[72:73], v[72:73], v[74:75]
  v_cvt_pk_bf16_f32 v74, v72, v73
  v_cvt_pk_bf16_f32 v72, v72, v73
  s_nop 1
  v_permlane16_swap_b32 v72, v74
  s_nop 1
  v_permlane32_swap_b32 v72, v73
  v_permlane32_swap_b32 v74, v75
  s_mov_b64 exec, 0xff
  s_cbranch_scc1 CA_rs
  buffer_store_dwordx4 v[72:75], v2, s[36:39], s77 offen sc1
  buffer_store_dwordx4 v[72:75], v2, s[36:39], s76 offen
  s_mov_b64 exec, -1
  buffer_store_dwordx4 v[76:79], v2, s[36:39], s80 offen offset:0
  buffer_store_dwordx4 v[76:79], v2, s[36:39], s80 offen offset:1024
  buffer_store_dwordx4 v[76:79], v2, s[36:39], s80 offen offset:2048
  buffer_store_dwordx4 v[76:79], v2, s[36:39], s80 offen offset:3072
CA_upd:
  s_add_u32 s78, s78, s70
  s_add_u32 s79, s79, s70
  s_add_u32 s73, s73, 1
  s_add_u32 s80, s80, s70
  s_sub_u32 s70, 0, s70
  s_add_u32 s75, s75, 10240
  s_add_u32 s76, s76, 10240
  s_add_u32 s77, s77, 10240
  s_branch CA_top
CA_fin:
  s_barrier
  s_branch C_end
CB0_top:
  s_barrier
  s_sleep 3
  buffer_load_dwordx4 v[72:75], v8, s[36:39], s74 offen sc1
  buffer_load_dwordx4 v[76:79], v8, s[36:39], s74 offen offset:1024 sc1
  buffer_load_dwordx2 v[10:11], v9, s[36:39], s74 offen offset:2048 sc1
CB0_lp:
  buffer_load_dwordx4 v[72:75], v8, s[36:39], s74 offen sc1
  buffer_load_dwordx4 v[76:79], v8, s[36:39], s74 offen offset:1024 sc1
  buffer_load_dwordx2 v[10:11], v9, s[36:39], s74 offen offset:2048 sc1
  s_add_i32 s56, s56, -1
  s_cmp_lt_i32 s56, 0
  s_waitcnt vmcnt(5)
  v_max3_u32 v36, v72, v73, v74
  s_waitcnt vmcnt(4)
  v_max3_u32 v36, v36, v75, v76
  v_max3_u32 v36, v36, v77, v78
  s_waitcnt vmcnt(3)
  v_max3_u32 v36, v36, v79, v10
  v_max_u32 v36, v36, v11
  v_cmp_eq_u32 vcc, -1, v36
  s_cbranch_scc1 CB0_lpd
  s_cbranch_vccnz CB0_lp
CB0_lpd:
  ds_write_b128 v8, v[72:75] offset:16384
  ds_write_b128 v8, v[76:79] offset:17408
  ds_write_b64 v9, v[10:11] offset:18432
  s_waitcnt lgkmcnt(0)
  s_barrier
  ds_read_b128 v[36:39], v2 offset:16384
  ds_read_b128 v[40:43], v2 offset:17408
  ds_read_b128 v[44:47], v2 offset:18432
  ds_read_b128 v[48:51], v2 offset:19456
  ds_read_b128 v[52:55], v2 offset:20480
  s_waitcnt lgkmcnt(4)
  v_smfmac_f32_16x16x64_bf16 v[28:31], v[36:39], v[56:63], v0
  ds_read_b128 v[56:59], v1 offset:49152
  ds_read_b128 v[60:63], v1 offset:50176
  v_smfmac_f32_16x16x64_bf16 v[32:35], v[36:39], v[64:71], v0
  ds_read_b128 v[64:67], v1 offset:57344
  ds_read_b128 v[68:71], v1 offset:58368
  v_smfmac_f32_16x16x64_bf16 v[12:15], v[36:39], a[0:7], v0
  v_smfmac_f32_16x16x64_bf16 v[16:19], v[36:39], a[8:15], v0
  v_smfmac_f32_16x16x64_bf16 v[20:23], v[36:39], a[160:167], v0
  v_smfmac_f32_16x16x64_bf16 v[24:27], v[36:39], a[168:175], v0
  s_waitcnt lgkmcnt(7)
  v_smfmac_f32_16x16x64_bf16 v[12:15], v[40:43], a[16:23], v0
  v_add_u32 v36, 0x10000, v1
  v_smfmac_f32_16x16x64_bf16 v[16:19], v[40:43], a[24:31], v0
  v_smfmac_f32_16x16x64_bf16 v[20:23], v[40:43], a[176:183], v0
  s_waitcnt vmcnt(0)
  v_smfmac_f32_16x16x64_bf16 v[24:27], v[40:43], a[184:191], v0
  s_waitcnt lgkmcnt(2)
  v_smfmac_f32_16x16x64_bf16 v[28:31], v[40:43], v[56:63], v0
  s_waitcnt lgkmcnt(0)
  ds_read_b128 v[56:59], v36 offset:0
  ds_read_b128 v[60:63], v36 offset:1024
  v_smfmac_f32_16x16x64_bf16 v[32:35], v[40:43], v[64:71], v0
  ds_read_b128 v[64:67], v36 offset:8192
  ds_read_b128 v[68:71], v36 offset:9216
  v_smfmac_f32_16x16x64_bf16 v[12:15], v[44:47], a[32:39], v0
  v_add_u32 v10, s67, v4
  v_lshrrev_b32 v11, 1, v2
  v_smfmac_f32_16x16x64_bf16 v[16:19], v[44:47], a[40:47], v0
  ds_read_b64_tr_b16 v[72:73], v10 offset:0
  ds_read_b64_tr_b16 v[74:75], v10 offset:128
  v_smfmac_f32_16x16x64_bf16 v[20:23], v[44:47], a[192:199], v0
  ds_read_b64_tr_b16 v[76:77], v10 offset:512
  ds_read_b64_tr_b16 v[78:79], v10 offset:640
  v_smfmac_f32_16x16x64_bf16 v[24:27], v[44:47], a[200:207], v0
  v_and_b32 v11, 0x180, v11
  v_sub_u32 v11, v2, v11
  s_waitcnt lgkmcnt(6)
  v_smfmac_f32_16x16x64_bf16 v[28:31], v[44:47], v[56:63], v0
  s_waitcnt lgkmcnt(0)
  ds_read_b128 v[56:59], v36 offset:16384
  ds_read_b128 v[60:63], v36 offset:17408
  v_smfmac_f32_16x16x64_bf16 v[32:35], v[44:47], v[64:71], v0
  ds_read_b128 v[64:67], v36 offset:24576
  ds_read_b128 v[68:71], v36 offset:25600
  v_smfmac_f32_16x16x64_bf16 v[12:15], v[48:51], a[48:55], v0
  v_smfmac_f32_16x16x64_bf16 v[16:19], v[48:51], a[56:63], v0
  v_smfmac_f32_16x16x64_bf16 v[20:23], v[48:51], a[208:215], v0
  v_smfmac_f32_16x16x64_bf16 v[24:27], v[48:51], a[216:223], v0
  s_waitcnt lgkmcnt(0)
  v_smfmac_f32_16x16x64_bf16 v[28:31], v[48:51], v[56:63], v0
  ds_read_b128 v[56:59], v36 offset:32768
  ds_read_b128 v[60:63], v36 offset:33792
  v_smfmac_f32_16x16x64_bf16 v[32:35], v[48:51], v[64:71], v0
  ds_read_b128 v[64:67], v36 offset:40960
  ds_read_b128 v[68:71], v36 offset:41984
  v_smfmac_f32_16x16x64_bf16 v[12:15], v[52:55], a[64:71], v0
  v_smfmac_f32_16x16x64_bf16 v[16:19], v[52:55], a[72:79], v0
  s_barrier
  ds_read_b128 v[36:39], v2 offset:25728
  ds_read_b128 v[40:43], v2 offset:26752
  v_smfmac_f32_16x16x64_bf16 v[20:23], v[52:55], a[224:231], v0
  ds_read_b128 v[44:47], v2 offset:27776
  ds_read_b128 v[48:51], v2 offset:28800
  v_smfmac_f32_16x16x64_bf16 v[24:27], v[52:55], a[232:239], v0
  s_waitcnt lgkmcnt(6)
  v_smfmac_f32_16x16x64_bf16 v[28:31], v[52:55], v[56:63], v0
  s_waitcnt lgkmcnt(4)
  v_smfmac_f32_16x16x64_bf16 v[32:35], v[52:55], v[64:71], v0
  ds_read_b128 v[52:55], v2 offset:29824
  s_waitcnt lgkmcnt(4)
  v_smfmac_f32_16x16x64_bf16 v[12:15], v[36:39], a[80:87], v0
  ds_read_b128 v[56:59], v5 offset:0
  ds_read_b128 v[60:63], v5 offset:128
  v_smfmac_f32_16x16x64_bf16 v[16:19], v[36:39], a[88:95], v0
  ds_read_b128 v[64:67], v5 offset:2048
  v_smfmac_f32_16x16x64_bf16 v[20:23], v[36:39], a[240:247], v0
  ds_read_b128 v[68:71], v5 offset:2176
  v_smfmac_f32_16x16x64_bf16 v[24:27], v[36:39], a[248:255], v0
  s_waitcnt lgkmcnt(7)
  v_lshlrev_b32 v10, 3, v2
  s_lshr_b32 s95, s67, 1
  s_add_u32 m0, s95, 30848
  s_nop 0
  buffer_load_dword v10, s[36:39], s93 offen offset:0 lds
  v_smfmac_f32_16x16x64_bf16 v[12:15], v[40:43], a[96:103], v0
  v_smfmac_f32_16x16x64_bf16 v[16:19], v[40:43], a[104:111], v0
  v_smfmac_f32_16x16x64_bf16 v[20:23], v[40:43], v[80:87], v0
  v_smfmac_f32_16x16x64_bf16 v[24:27], v[40:43], v[88:95], v0
  s_waitcnt lgkmcnt(6)
  v_smfmac_f32_16x16x64_bf16 v[12:15], v[44:47], a[112:119], v0
  v_smfmac_f32_16x16x64_bf16 v[16:19], v[44:47], a[120:127], v0
  s_waitcnt lgkmcnt(5)
  v_smfmac_f32_16x16x64_bf16 v[12:15], v[48:51], a[128:135], v0
  v_smfmac_f32_16x16x64_bf16 v[16:19], v[48:51], a[136:143], v0
  v_smfmac_f32_16x16x64_bf16 v[20:23], v[44:47], v[96:103], v0
  v_smfmac_f32_16x16x64_bf16 v[24:27], v[44:47], v[104:111], v0
  s_waitcnt lgkmcnt(4)
  v_smfmac_f32_16x16x64_bf16 v[12:15], v[52:55], a[144:151], v0
  v_smfmac_f32_16x16x64_bf16 v[16:19], v[52:55], a[152:159], v0
  v_smfmac_f32_16x16x64_bf16 v[20:23], v[48:51], v[112:119], v0
  v_smfmac_f32_16x16x64_bf16 v[24:27], v[48:51], v[120:127], v0
  v_permlane32_swap_b32 v12, v16
  v_permlane32_swap_b32 v13, v17
  v_permlane32_swap_b32 v14, v18
  v_smfmac_f32_16x16x64_bf16 v[20:23], v[52:55], v[128:135], v0
  v_permlane32_swap_b32 v15, v19
  v_add_f32 v12, v12, v16
  v_add_f32 v13, v13, v17
  v_smfmac_f32_16x16x64_bf16 v[24:27], v[52:55], v[136:143], v0
  v_add_f32 v14, v14, v18
  v_add_f32 v15, v15, v19
  v_cvt_pk_bf16_f32 v16, v12, v13
  v_smfmac_f32_16x16x64_bf16 v[28:31], v[52:55], v[208:215], v0
  v_cvt_pk_bf16_f32 v17, v14, v15
  ds_write_b64 v3, v[16:17] offset:0
  ds_read_b128 v[12:15], v5 offset:6144
  v_smfmac_f32_16x16x64_bf16 v[32:35], v[52:55], v[216:223], v0
  ds_read_b128 v[16:19], v5 offset:6272
  v_permlane32_swap_b32 v20, v24
  v_permlane32_swap_b32 v21, v25
  v_permlane32_swap_b32 v22, v26
  v_smfmac_f32_16x16x64_bf16 v[28:31], v[36:39], v[144:151], v0
  v_permlane32_swap_b32 v23, v27
  v_add_f32 v20, v20, v24
  v_add_f32 v21, v21, v25
  v_smfmac_f32_16x16x64_bf16 v[32:35], v[36:39], v[152:159], v0
  v_add_f32 v22, v22, v26
  v_add_f32 v23, v23, v27
  v_cvt_pk_bf16_f32 v24, v20, v21
  v_smfmac_f32_16x16x64_bf16 v[28:31], v[40:43], v[160:167], v0
  v_cvt_pk_bf16_f32 v25, v22, v23
  ds_write_b64 v3, v[24:25] offset:2176
  s_andn2_b64 exec, -1, s[88:89]
  buffer_store_dwordx4 v[72:75], v11, s[36:39], s83 offen sc1
  buffer_store_dwordx4 v[76:79], v11, s[36:39], s83 offen offset:512 sc1
  s_mov_b64 exec, -1
  v_smfmac_f32_16x16x64_bf16 v[32:35], v[40:43], v[168:175], v0
  s_cmp_eq_u32 s57, 2
  s_cselect_b32 s96, 1, 0
  v_mov_b32 v53, 0xf149f2ca
  v_cndmask_b32 v52, 0, v53, s[90:91]
  s_waitcnt lgkmcnt(0)
  s_barrier
  ds_read_b64_tr_b16 v[36:37], v4 offset:0
  ds_read_b64_tr_b16 v[38:39], v4 offset:128
  ds_read_b64_tr_b16 v[40:41], v4 offset:512
  ds_read_b64_tr_b16 v[42:43], v4 offset:640
  v_smfmac_f32_16x16x64_bf16 v[28:31], v[44:47], v[176:183], v0
  s_mov_b32 s97, 0
  v_mov_b32 v10, s66
  v_smfmac_f32_16x16x64_bf16 v[32:35], v[44:47], v[184:191], v0
  v_mov_b32 v11, 0
  s_mov_b64 exec, s[96:97]
  buffer_store_dword v10, v11, s[36:39], s69 offen sc1
  s_mov_b64 exec, -1
  ds_read_b64_tr_b16 v[44:45], v4 offset:1024
  ds_read_b64_tr_b16 v[46:47], v4 offset:1152
  ds_read_b128 v[72:75], v5 offset:4096
  ds_read_b128 v[76:79], v5 offset:4224
  v_smfmac_f32_16x16x64_bf16 v[28:31], v[48:51], v[192:199], v0
  v_mov_b32 v53, v52
  v_mov_b64 v[54:55], v[52:53]
  v_smfmac_f32_16x16x64_bf16 v[32:35], v[48:51], v[200:207], v0
  ds_read_b64_tr_b16 v[48:49], v4 offset:1536
  ds_read_b64_tr_b16 v[50:51], v4 offset:1664
  s_cmp_eq_u32 s73, 63
  s_cbranch_scc1 CB0_f63
  s_waitcnt lgkmcnt(8)
  v_mfma_f32_16x16x32_bf16 v[20:23], v[56:59], v[36:39], 0
  v_mfma_f32_16x16x32_bf16 v[24:27], v[60:63], v[36:39], 0
  v_permlane32_swap_b32 v28, v32
  v_permlane32_swap_b32 v29, v33
  v_mfma_f32_16x16x32_bf16 v[52:55], v[36:39], v[36:39], v[52:55]
  v_permlane32_swap_b32 v30, v34
  v_permlane32_swap_b32 v31, v35
  s_waitcnt lgkmcnt(6)
  v_mfma_f32_16x16x32_bf16 v[20:23], v[64:67], v[40:43], v[20:23]
  v_pk_add_f32 v[28:29], v[28:29], v[32:33]
  v_pk_add_f32 v[30:31], v[30:31], v[34:35]
  v_mfma_f32_16x16x32_bf16 v[24:27], v[68:71], v[40:43], v[24:27]
  v_cvt_pk_bf16_f32 v10, v28, v29
  v_cvt_pk_bf16_f32 v11, v30, v31
  ds_write_b64 v3, v[10:11] offset:5120
  v_mfma_f32_16x16x32_bf16 v[52:55], v[40:43], v[40:43], v[52:55]
  v_and_b32 v34, 0x300, v2
  v_mov_b64 v[28:29], v[10:11]
  v_add3_u32 v34, v34, v1, s87
  s_waitcnt lgkmcnt(3)
  v_mfma_f32_16x16x32_bf16 v[20:23], v[72:75], v[44:47], v[20:23]
  ds_read_b128 v[64:67], v34
  ds_read_b128 v[68:71], v34 offset:256
  v_permlane32_swap_b32 v28, v10
  v_mfma_f32_16x16x32_bf16 v[24:27], v[76:79], v[44:47], v[24:27]
  v_permlane32_swap_b32 v29, v11
  v_mov_b32 v30, 0x3f803f80
  v_mov_b32 v31, 0x3f803f80
  v_mfma_f32_16x16x32_bf16 v[52:55], v[44:47], v[44:47], v[52:55]
  s_waitcnt lgkmcnt(3)
  ds_read_b128 v[36:39], v1 offset:0
  ds_read_b128 v[40:43], v1 offset:1024
  v_mov_b64 v[32:33], v[30:31]
  v_mfma_f32_16x16x32_bf16 v[20:23], v[12:15], v[48:51], v[20:23]
  ds_read_b128 v[72:75], v1 offset:24576
  ds_read_b128 v[76:79], v1 offset:25600
  v_lshrrev_b32 v35, 1, v2
  v_mfma_f32_16x16x32_bf16 v[24:27], v[16:19], v[48:51], v[24:27]
  v_and_b32 v35, 0x180, v35
  v_sub_u32 v35, v2, v35
  v_mfma_f32_16x16x32_bf16 v[52:55], v[48:51], v[48:51], v[52:55]
  v_add_u32 v18, s68, v35
  v_max3_f32 v34, v20, v21, v22
  s_nop 1
  v_max3_f32 v35, v24, v25, v26
  v_max3_f32 v34, v34, v23, v27
  s_nop 1
  v_max3_f32 v35, v35, v52, v53
  v_max3_f32 v34, v34, v54, v55
  v_max_f32 v34, v34, v35
  v_mov_b32 v35, v34
  ds_read_b128 v[44:47], v1 offset:8192
  ds_read_b128 v[48:51], v1 offset:9216
  v_permlane32_swap_b32 v34, v35
  v_max_f32 v34, v34, v35
  v_mov_b32 v35, v34
  s_nop 1
  v_permlane16_swap_b32 v34, v35
  v_max_f32 v34, v34, v35
  v_mul_f32 v34, s94, v34
  v_pk_fma_f32 v[52:53], v[52:53], s[94:95], v[34:35] op_sel_hi:[1,0,0] neg_lo:[0,0,1] neg_hi:[0,0,1]
  v_pk_fma_f32 v[54:55], v[54:55], s[94:95], v[34:35] op_sel_hi:[1,0,0] neg_lo:[0,0,1] neg_hi:[0,0,1]
  v_exp_f32 v52, v52
  v_exp_f32 v53, v53
  v_exp_f32 v54, v54
  v_exp_f32 v55, v55
  v_pk_fma_f32 v[20:21], v[20:21], s[94:95], v[34:35] op_sel_hi:[1,0,0] neg_lo:[0,0,1] neg_hi:[0,0,1]
  v_pk_fma_f32 v[22:23], v[22:23], s[94:95], v[34:35] op_sel_hi:[1,0,0] neg_lo:[0,0,1] neg_hi:[0,0,1]
  v_pk_fma_f32 v[24:25], v[24:25], s[94:95], v[34:35] op_sel_hi:[1,0,0] neg_lo:[0,0,1] neg_hi:[0,0,1]
  v_pk_fma_f32 v[26:27], v[26:27], s[94:95], v[34:35] op_sel_hi:[1,0,0] neg_lo:[0,0,1] neg_hi:[0,0,1]
  v_cvt_pk_bf16_f32 v16, v52, v53
  v_cvt_pk_bf16_f32 v17, v54, v55
  v_exp_f32 v20, v20
  v_exp_f32 v21, v21
  v_mfma_f32_16x16x16_bf16 v[60:63], v[30:31], v[16:17], 0
  v_exp_f32 v22, v22
  v_exp_f32 v23, v23
  v_mfma_f32_16x16x16_bf16 v[52:55], v[28:29], v[16:17], 0
  v_exp_f32 v24, v24
  v_exp_f32 v25, v25
  v_mfma_f32_16x16x16_bf16 v[56:59], v[10:11], v[16:17], 0
  v_exp_f32 v26, v26
  v_exp_f32 v27, v27
  v_cvt_pk_bf16_f32 v12, v20, v21
  v_cvt_pk_bf16_f32 v13, v22, v23
  v_cvt_pk_bf16_f32 v14, v24, v25
  v_cvt_pk_bf16_f32 v15, v26, v27
  s_waitcnt lgkmcnt(6)
  s_nop 0
  v_mfma_f32_16x16x32_bf16 v[60:63], v[30:33], v[12:15], v[60:63]
  v_mov_b64 v[20:21], 0
  v_mov_b64 v[22:23], 0
  v_mfma_f32_16x16x32_bf16 v[52:55], v[64:67], v[12:15], v[52:55]
  v_mov_b64 v[24:25], 0
  v_mov_b64 v[26:27], 0
  v_mfma_f32_16x16x32_bf16 v[56:59], v[68:71], v[12:15], v[56:59]
  ds_read_b128 v[64:67], v1 offset:16384
  ds_read_b128 v[68:71], v1 offset:17408
  s_mov_b64 exec, s[88:89]
  v_rcp_f32 v34, v60
  s_nop 0
  v_pk_mul_f32 v[52:53], v[52:53], v[34:35] op_sel_hi:[1,0]
  v_pk_mul_f32 v[54:55], v[54:55], v[34:35] op_sel_hi:[1,0]
  v_cvt_pk_bf16_f32 v12, v52, v53
  v_cvt_pk_bf16_f32 v13, v54, v55
  v_pk_mul_f32 v[56:57], v[56:57], v[34:35] op_sel_hi:[1,0]
  v_pk_mul_f32 v[58:59], v[58:59], v[34:35] op_sel_hi:[1,0]
  v_cvt_pk_bf16_f32 v14, v56, v57
  v_cvt_pk_bf16_f32 v15, v58, v59
  ds_write_b128 v18, v[12:15]
  s_mov_b64 exec, -1
  ds_read_b128 v[52:55], v1 offset:32768
  ds_read_b128 v[56:59], v1 offset:33792
  v_mov_b64 v[60:61], 0
  v_mov_b64 v[62:63], 0
  v_mov_b64 v[28:29], 0
  v_mov_b64 v[30:31], 0
  v_mov_b64 v[32:33], 0
  v_mov_b64 v[34:35], 0
  s_waitcnt lgkmcnt(2)
  s_barrier
  ds_read_b128 v[12:15], v2 offset:28672
  ds_read_b128 v[16:19], v2 offset:29696
  s_cmp_lg_u32 s85, 0
  s_waitcnt lgkmcnt(1)
  v_smfmac_f32_16x16x64_bf16 v[20:23], v[12:15], v[36:43], v0
  ds_read_b128 v[36:39], v1 offset:40960
  ds_read_b128 v[40:43], v1 offset:41984
  v_smfmac_f32_16x16x64_bf16 v[24:27], v[12:15], v[44:51], v0
  s_waitcnt lgkmcnt(2)
  v_smfmac_f32_16x16x64_bf16 v[20:23], v[16:19], v[64:71], v0
  v_smfmac_f32_16x16x64_bf16 v[24:27], v[16:19], v[72:79], v0
  v_smfmac_f32_16x16x64_bf16 v[28:31], v[12:15], v[224:231], v0
  v_smfmac_f32_16x16x64_bf16 v[32:35], v[12:15], v[232:239], v0
  v_permlane32_swap_b32 v20, v24
  v_permlane32_swap_b32 v21, v25
  v_smfmac_f32_16x16x64_bf16 v[28:31], v[16:19], v[240:247], v0
  v_permlane32_swap_b32 v22, v26
  v_permlane32_swap_b32 v23, v27
  v_smfmac_f32_16x16x64_bf16 v[32:35], v[16:19], v[248:255], v0
  v_add_f32 v20, v20, v24
  v_add_f32 v21, v21, v25
  v_smfmac_f32_16x16x64_bf16 v[60:63], v[12:15], v[52:59], v0
  v_add_f32 v22, v22, v26
  v_add_f32 v23, v23, v27
  s_waitcnt lgkmcnt(0)
  v_smfmac_f32_16x16x64_bf16 v[60:63], v[16:19], v[36:43], v0
  v_cvt_pk_bf16_f32 v26, v20, v21
  v_cvt_pk_bf16_f32 v27, v22, v23
  v_permlane32_swap_b32 v28, v32
  v_permlane32_swap_b32 v29, v33
  v_permlane32_swap_b32 v30, v34
  v_permlane32_swap_b32 v31, v35
  v_pk_add_f32 v[28:29], v[28:29], v[32:33]
  v_pk_add_f32 v[30:31], v[30:31], v[34:35]
  v_cvt_pk_bf16_f32 v24, v28, v29
  v_cvt_pk_bf16_f32 v25, v30, v31
  v_permlane32_swap_b32 v60, v62
  v_permlane32_swap_b32 v61, v63
  v_permlane16_swap_b32 v24, v26
  v_permlane16_swap_b32 v25, v27
  v_pk_add_f32 v[60:61], v[60:61], v[62:63]
  s_cbranch_scc1 CB0_ps
  buffer_store_dwordx4 v[24:27], v6, s[36:39], s78 offen
  v_cvt_pk_bf16_f32 v60, v60, v61
  buffer_store_dword v60, v7, s[36:39], s79 offen
CB0_psd:
  s_mov_b32 m0, s86
  s_add_u32 s95, s81, 4096
  buffer_load_dwordx4 v2, s[36:39], s81 offen offset:0 lds
  buffer_load_dwordx4 v2, s[36:39], s81 offen offset:1024 lds
  buffer_load_dwordx4 v2, s[36:39], s81 offen offset:2048 lds
  buffer_load_dwordx4 v2, s[36:39], s81 offen offset:3072 lds
  s_add_u32 m0, s86, 4096
  s_nop 0
  buffer_load_dwordx4 v2, s[36:39], s95 offen offset:0 lds
  buffer_load_dwordx4 v2, s[36:39], s95 offen offset:1024 lds
  buffer_load_dwordx4 v2, s[36:39], s95 offen offset:2048 lds
  buffer_load_dwordx4 v2, s[36:39], s95 offen offset:3072 lds
  s_add_u32 s81, s81, 262144
  s_min_u32 s93, s81, s82
  v_add_u32 v11, 0x10000, v1
  ds_read_b128 v[56:59], v11 offset:49152
  ds_read_b128 v[60:63], v11 offset:50176
  ds_read_b128 v[64:67], v11 offset:57344
  ds_read_b128 v[68:71], v11 offset:58368
  v_mov_b64 v[12:13], 0
  v_mov_b64 v[14:15], 0
  v_mov_b64 v[16:17], 0
  v_mov_b64 v[18:19], 0
  v_mov_b64 v[20:21], 0
  v_mov_b64 v[22:23], 0
  v_mov_b64 v[24:25], 0
  v_mov_b64 v[26:27], 0
  v_mov_b64 v[28:29], 0
  v_mov_b64 v[30:31], 0
  v_mov_b64 v[32:33], 0
  v_mov_b64 v[34:35], 0
  s_add_u32 s95, s73, 2
  s_and_b32 s96, s95, 7
  s_cmp_lg_u32 s96, 0
  s_cbranch_scc1 CB0_nofw
  s_cmp_ge_u32 s95, 64
  s_cbranch_scc1 CB0_nofw
  s_lshl_b32 s95, s95, 4
  s_add_u32 s95, s95, s92
  s_mov_b64 exec, 1
  v_mov_b32 v41, 0
CB0_fw:
  buffer_load_dword v40, v41, s[36:39], s95 offen sc1
  s_add_i32 s56, s56, -1
  s_cmp_lt_i32 s56, 0
  s_waitcnt vmcnt(0)
  v_cmp_gt_u32 vcc, 2, v40
  s_cbranch_scc1 CB0_fw_d
  s_cbranch_vccnz CB0_fw
CB0_fw_d:
  s_mov_b64 exec, -1
CB0_nofw:
  s_mov_b32 s66, s73
  s_add_u32 s78, s78, s70
  s_add_u32 s79, s79, s70
  s_add_u32 s73, s73, 1
  s_sub_u32 s70, 0, s70
  s_add_u32 s74, s74, 10240
  s_add_u32 s83, s83, 65536
  s_branch CB0_top
CB0_fin:
  s_add_u32 s83, s83, 65536
  v_add_u32 v10, s67, v4
  v_lshrrev_b32 v11, 1, v2
  ds_read_b64_tr_b16 v[72:73], v10 offset:0
  ds_read_b64_tr_b16 v[74:75], v10 offset:128
  ds_read_b64_tr_b16 v[76:77], v10 offset:512
  ds_read_b64_tr_b16 v[78:79], v10 offset:640
  v_and_b32 v11, 0x180, v11
  v_sub_u32 v11, v2, v11
  s_waitcnt lgkmcnt(0)
  s_andn2_b64 exec, -1, s[88:89]
  buffer_store_dwordx4 v[72:75], v11, s[36:39], s83 offen sc1
  buffer_store_dwordx4 v[76:79], v11, s[36:39], s83 offen offset:512 sc1
  s_mov_b64 exec, -1
  s_waitcnt vmcnt(0)
  s_barrier
  s_cmp_eq_u32 s57, 2
  s_cselect_b32 s96, 1, 0
  s_mov_b32 s97, 0
  v_mov_b32 v10, 64
  v_mov_b32 v11, 0
  s_mov_b64 exec, s[96:97]
  buffer_store_dword v10, v11, s[36:39], s69 offen sc1
  s_mov_b64 exec, -1
  s_branch C_end
CB1_top:
  s_barrier
  s_sleep 3
  buffer_load_dwordx4 v[72:75], v8, s[36:39], s74 offen sc1
  buffer_load_dwordx4 v[76:79], v8, s[36:39], s74 offen offset:1024 sc1
  buffer_load_dwordx2 v[10:11], v9, s[36:39], s74 offen offset:2048 sc1
CB1_lp:
  buffer_load_dwordx4 v[72:75], v8, s[36:39], s74 offen sc1
  buffer_load_dwordx4 v[76:79], v8, s[36:39], s74 offen offset:1024 sc1
  buffer_load_dwordx2 v[10:11], v9, s[36:39], s74 offen offset:2048 sc1
  s_add_i32 s56, s56, -1
  s_cmp_lt_i32 s56, 0
  s_waitcnt vmcnt(5)
  v_max3_u32 v36, v72, v73, v74
  s_waitcnt vmcnt(4)
  v_max3_u32 v36, v36, v75, v76
  v_max3_u32 v36, v36, v77, v78
  s_waitcnt vmcnt(3)
  v_max3_u32 v36, v36, v79, v10
  v_max_u32 v36, v36, v11
  v_cmp_eq_u32 vcc, -1, v36
  s_cbranch_scc1 CB1_lpd
  s_cbranch_vccnz CB1_lp
CB1_lpd:
  ds_write_b128 v8, v[72:75] offset:16384
  ds_write_b128 v8, v[76:79] offset:17408
  ds_write_b64 v9, v[10:11] offset:18432
  s_waitcnt lgkmcnt(0)
  s_barrier
  ds_read_b128 v[36:39], v2 offset:16384
  ds_read_b128 v[40:43], v2 offset:17408
  ds_read_b128 v[44:47], v2 offset:18432
  ds_read_b128 v[48:51], v2 offset:19456
  ds_read_b128 v[52:55], v2 offset:20480
  s_waitcnt lgkmcnt(4)
  v_smfmac_f32_16x16x64_bf16 v[28:31], v[36:39], v[56:63], v0
  ds_read_b128 v[56:59], v1 offset:49152
  ds_read_b128 v[60:63], v1 offset:50176
  v_smfmac_f32_16x16x64_bf16 v[32:35], v[36:39], v[64:71], v0
  ds_read_b128 v[64:67], v1 offset:57344
  ds_read_b128 v[68:71], v1 offset:58368
  v_smfmac_f32_16x16x64_bf16 v[12:15], v[36:39], a[0:7], v0
  v_smfmac_f32_16x16x64_bf16 v[16:19], v[36:39], a[8:15], v0
  v_smfmac_f32_16x16x64_bf16 v[20:23], v[36:39], a[160:167], v0
  v_smfmac_f32_16x16x64_bf16 v[24:27], v[36:39], a[168:175], v0
  s_waitcnt lgkmcnt(7)
  v_smfmac_f32_16x16x64_bf16 v[12:15], v[40:43], a[16:23], v0
  v_add_u32 v36, 0x10000, v1
  v_smfmac_f32_16x16x64_bf16 v[16:19], v[40:43], a[24:31], v0
  v_smfmac_f32_16x16x64_bf16 v[20:23], v[40:43], a[176:183], v0
  s_waitcnt vmcnt(0)
  v_smfmac_f32_16x16x64_bf16 v[24:27], v[40:43], a[184:191], v0
  s_waitcnt lgkmcnt(2)
  v_smfmac_f32_16x16x64_bf16 v[28:31], v[40:43], v[56:63], v0
  s_waitcnt lgkmcnt(0)
  ds_read_b128 v[56:59], v36 offset:0
  ds_read_b128 v[60:63], v36 offset:1024
  v_smfmac_f32_16x16x64_bf16 v[32:35], v[40:43], v[64:71], v0
  ds_read_b128 v[64:67], v36 offset:8192
  ds_read_b128 v[68:71], v36 offset:9216
  v_smfmac_f32_16x16x64_bf16 v[12:15], v[44:47], a[32:39], v0
  v_add_u32 v10, s67, v2
  ds_read_b128 v[72:75], v10 offset:21504
  v_smfmac_f32_16x16x64_bf16 v[16:19], v[44:47], a[40:47], v0
  v_smfmac_f32_16x16x64_bf16 v[20:23], v[44:47], a[192:199], v0
  v_smfmac_f32_16x16x64_bf16 v[24:27], v[44:47], a[200:207], v0
  s_waitcnt lgkmcnt(3)
  v_smfmac_f32_16x16x64_bf16 v[28:31], v[44:47], v[56:63], v0
  s_waitcnt lgkmcnt(0)
  ds_read_b128 v[56:59], v36 offset:16384
  ds_read_b128 v[60:63], v36 offset:17408
  v_smfmac_f32_16x16x64_bf16 v[32:35], v[44:47], v[64:71], v0
  ds_read_b128 v[64:67], v36 offset:24576
  ds_read_b128 v[68:71], v36 offset:25600
  v_smfmac_f32_16x16x64_bf16 v[12:15], v[48:51], a[48:55], v0
  v_smfmac_f32_16x16x64_bf16 v[16:19], v[48:51], a[56:63], v0
  v_smfmac_f32_16x16x64_bf16 v[20:23], v[48:51], a[208:215], v0
  v_smfmac_f32_16x16x64_bf16 v[24:27], v[48:51], a[216:223], v0
  s_waitcnt lgkmcnt(0)
  v_smfmac_f32_16x16x64_bf16 v[28:31], v[48:51], v[56:63], v0
  ds_read_b128 v[56:59], v36 offset:32768
  ds_read_b128 v[60:63], v36 offset:33792
  v_smfmac_f32_16x16x64_bf16 v[32:35], v[48:51], v[64:71], v0
  ds_read_b128 v[64:67], v36 offset:40960
  ds_read_b128 v[68:71], v36 offset:41984
  v_smfmac_f32_16x16x64_bf16 v[12:15], v[52:55], a[64:71], v0
  v_smfmac_f32_16x16x64_bf16 v[16:19], v[52:55], a[72:79], v0
  s_barrier
  ds_read_b128 v[36:39], v2 offset:25728
  ds_read_b128 v[40:43], v2 offset:26752
  v_smfmac_f32_16x16x64_bf16 v[20:23], v[52:55], a[224:231], v0
  ds_read_b128 v[44:47], v2 offset:27776
  ds_read_b128 v[48:51], v2 offset:28800
  v_smfmac_f32_16x16x64_bf16 v[24:27], v[52:55], a[232:239], v0
  s_waitcnt lgkmcnt(6)
  v_smfmac_f32_16x16x64_bf16 v[28:31], v[52:55], v[56:63], v0
  s_waitcnt lgkmcnt(4)
  v_smfmac_f32_16x16x64_bf16 v[32:35], v[52:55], v[64:71], v0
  ds_read_b128 v[52:55], v2 offset:29824
  s_waitcnt lgkmcnt(4)
  v_smfmac_f32_16x16x64_bf16 v[12:15], v[36:39], a[80:87], v0
  ds_read_b128 v[56:59], v5 offset:0
  ds_read_b128 v[60:63], v5 offset:128
  v_smfmac_f32_16x16x64_bf16 v[16:19], v[36:39], a[88:95], v0
  ds_read_b128 v[64:67], v5 offset:2048
  v_smfmac_f32_16x16x64_bf16 v[20:23], v[36:39], a[240:247], v0
  ds_read_b128 v[68:71], v5 offset:2176
  v_smfmac_f32_16x16x64_bf16 v[24:27], v[36:39], a[248:255], v0
  s_waitcnt lgkmcnt(7)
  v_lshlrev_b32 v10, 3, v2
  s_lshr_b32 s95, s67, 1
  s_add_u32 m0, s95, 30848
  s_nop 0
  buffer_load_dword v10, s[36:39], s93 offen offset:0 lds
  v_smfmac_f32_16x16x64_bf16 v[12:15], v[40:43], a[96:103], v0
  v_smfmac_f32_16x16x64_bf16 v[16:19], v[40:43], a[104:111], v0
  v_smfmac_f32_16x16x64_bf16 v[20:23], v[40:43], v[80:87], v0
  v_smfmac_f32_16x16x64_bf16 v[24:27], v[40:43], v[88:95], v0
  s_waitcnt lgkmcnt(6)
  v_smfmac_f32_16x16x64_bf16 v[12:15], v[44:47], a[112:119], v0
  v_smfmac_f32_16x16x64_bf16 v[16:19], v[44:47], a[120:127], v0
  s_waitcnt lgkmcnt(5)
  v_smfmac_f32_16x16x64_bf16 v[12:15], v[48:51], a[128:135], v0
  v_smfmac_f32_16x16x64_bf16 v[16:19], v[48:51], a[136:143], v0
  v_smfmac_f32_16x16x64_bf16 v[20:23], v[44:47], v[96:103], v0
  v_smfmac_f32_16x16x64_bf16 v[24:27], v[44:47], v[104:111], v0
  s_waitcnt lgkmcnt(4)
  v_smfmac_f32_16x16x64_bf16 v[12:15], v[52:55], a[144:151], v0
  v_smfmac_f32_16x16x64_bf16 v[16:19], v[52:55], a[152:159], v0
  v_smfmac_f32_16x16x64_bf16 v[20:23], v[48:51], v[112:119], v0
  v_smfmac_f32_16x16x64_bf16 v[24:27], v[48:51], v[120:127], v0
  v_permlane32_swap_b32 v12, v16
  v_permlane32_swap_b32 v13, v17
  v_permlane32_swap_b32 v14, v18
  v_smfmac_f32_16x16x64_bf16 v[20:23], v[52:55], v[128:135], v0
  v_permlane32_swap_b32 v15, v19
  v_add_f32 v12, v12, v16
  v_add_f32 v13, v13, v17
  v_smfmac_f32_16x16x64_bf16 v[24:27], v[52:55], v[136:143], v0
  v_add_f32 v14, v14, v18
  v_add_f32 v15, v15, v19
  v_cvt_pk_bf16_f32 v16, v12, v13
  v_smfmac_f32_16x16x64_bf16 v[28:31], v[52:55], v[208:215], v0
  v_cvt_pk_bf16_f32 v17, v14, v15
  ds_write_b64 v3, v[16:17] offset:0
  ds_read_b128 v[12:15], v5 offset:6144
  v_smfmac_f32_16x16x64_bf16 v[32:35], v[52:55], v[216:223], v0
  ds_read_b128 v[16:19], v5 offset:6272
  v_permlane32_swap_b32 v20, v24
  v_permlane32_swap_b32 v21, v25
  v_permlane32_swap_b32 v22, v26
  v_smfmac_f32_16x16x64_bf16 v[28:31], v[36:39], v[144:151], v0
  v_permlane32_swap_b32 v23, v27
  v_add_f32 v20, v20, v24
  v_add_f32 v21, v21, v25
  v_smfmac_f32_16x16x64_bf16 v[32:35], v[36:39], v[152:159], v0
  v_add_f32 v22, v22, v26
  v_add_f32 v23, v23, v27
  v_cvt_pk_bf16_f32 v24, v20, v21
  v_smfmac_f32_16x16x64_bf16 v[28:31], v[40:43], v[160:167], v0
  v_cvt_pk_bf16_f32 v25, v22, v23
  ds_write_b64 v3, v[24:25] offset:2176
  buffer_store_dwordx4 v[72:75], v2, s[36:39], s83 offen sc1
  v_smfmac_f32_16x16x64_bf16 v[32:35], v[40:43], v[168:175], v0
  s_cmp_eq_u32 s57, 2
  s_cselect_b32 s96, 1, 0
  v_mov_b32 v53, 0xf149f2ca
  v_cndmask_b32 v52, 0, v53, s[90:91]
  s_waitcnt lgkmcnt(0)
  s_barrier
  ds_read_b64_tr_b16 v[36:37], v4 offset:0
  ds_read_b64_tr_b16 v[38:39], v4 offset:128
  ds_read_b64_tr_b16 v[40:41], v4 offset:512
  ds_read_b64_tr_b16 v[42:43], v4 offset:640
  v_smfmac_f32_16x16x64_bf16 v[28:31], v[44:47], v[176:183], v0
  s_mov_b32 s97, 0
  v_mov_b32 v10, s66
  v_smfmac_f32_16x16x64_bf16 v[32:35], v[44:47], v[184:191], v0
  v_mov_b32 v11, 0
  s_mov_b64 exec, s[96:97]
  buffer_store_dword v10, v11, s[36:39], s69 offen sc1
  s_mov_b64 exec, -1
  ds_read_b64_tr_b16 v[44:45], v4 offset:1024
  ds_read_b64_tr_b16 v[46:47], v4 offset:1152
  ds_read_b128 v[72:75], v5 offset:4096
  ds_read_b128 v[76:79], v5 offset:4224
  v_smfmac_f32_16x16x64_bf16 v[28:31], v[48:51], v[192:199], v0
  v_mov_b32 v53, v52
  v_mov_b64 v[54:55], v[52:53]
  v_smfmac_f32_16x16x64_bf16 v[32:35], v[48:51], v[200:207], v0
  ds_read_b64_tr_b16 v[48:49], v4 offset:1536
  ds_read_b64_tr_b16 v[50:51], v4 offset:1664
  s_cmp_eq_u32 s73, 63
  s_cbranch_scc1 CB1_f63
  s_waitcnt lgkmcnt(8)
  v_mfma_f32_16x16x32_bf16 v[20:23], v[56:59], v[36:39], 0
  v_mfma_f32_16x16x32_bf16 v[24:27], v[60:63], v[36:39], 0
  v_permlane32_swap_b32 v28, v32
  v_permlane32_swap_b32 v29, v33
  v_mfma_f32_16x16x32_bf16 v[52:55], v[36:39], v[36:39], v[52:55]
  v_permlane32_swap_b32 v30, v34
  v_permlane32_swap_b32 v31, v35
  s_waitcnt lgkmcnt(6)
  v_mfma_f32_16x16x32_bf16 v[20:23], v[64:67], v[40:43], v[20:23]
  v_pk_add_f32 v[28:29], v[28:29], v[32:33]
  v_pk_add_f32 v[30:31], v[30:31], v[34:35]
  v_mfma_f32_16x16x32_bf16 v[24:27], v[68:71], v[40:43], v[24:27]
  v_cvt_pk_bf16_f32 v10, v28, v29
  v_cvt_pk_bf16_f32 v11, v30, v31
  ds_write_b64 v3, v[10:11] offset:5120
  v_mfma_f32_16x16x32_bf16 v[52:55], v[40:43], v[40:43], v[52:55]
  v_and_b32 v34, 0x300, v2
  v_mov_b64 v[28:29], v[10:11]
  v_add3_u32 v34, v34, v1, s87
  s_waitcnt lgkmcnt(3)
  v_mfma_f32_16x16x32_bf16 v[20:23], v[72:75], v[44:47], v[20:23]
  ds_read_b128 v[64:67], v34
  ds_read_b128 v[68:71], v34 offset:256
  v_permlane32_swap_b32 v28, v10
  v_mfma_f32_16x16x32_bf16 v[24:27], v[76:79], v[44:47], v[24:27]
  v_permlane32_swap_b32 v29, v11
  v_mov_b32 v30, 0x3f803f80
  v_mov_b32 v31, 0x3f803f80
  v_mfma_f32_16x16x32_bf16 v[52:55], v[44:47], v[44:47], v[52:55]
  s_waitcnt lgkmcnt(3)
  ds_read_b128 v[36:39], v1 offset:0
  ds_read_b128 v[40:43], v1 offset:1024
  v_mov_b64 v[32:33], v[30:31]
  v_mfma_f32_16x16x32_bf16 v[20:23], v[12:15], v[48:51], v[20:23]
  ds_read_b128 v[72:75], v1 offset:24576
  ds_read_b128 v[76:79], v1 offset:25600
  v_lshrrev_b32 v35, 1, v2
  v_mfma_f32_16x16x32_bf16 v[24:27], v[16:19], v[48:51], v[24:27]
  v_and_b32 v35, 0x180, v35
  v_sub_u32 v35, v2, v35
  v_mfma_f32_16x16x32_bf16 v[52:55], v[48:51], v[48:51], v[52:55]
  v_add_u32 v18, s68, v35
  v_max3_f32 v34, v20, v21, v22
  s_nop 1
  v_max3_f32 v35, v24, v25, v26
  v_max3_f32 v34, v34, v23, v27
  s_nop 1
  v_max3_f32 v35, v35, v52, v53
  v_max3_f32 v34, v34, v54, v55
  v_max_f32 v34, v34, v35
  v_mov_b32 v35, v34
  ds_read_b128 v[44:47], v1 offset:8192
  ds_read_b128 v[48:51], v1 offset:9216
  v_permlane32_swap_b32 v34, v35
  v_max_f32 v34, v34, v35
  v_mov_b32 v35, v34
  s_nop 1
  v_permlane16_swap_b32 v34, v35
  v_max_f32 v34, v34, v35
  v_mul_f32 v34, s94, v34
  v_pk_fma_f32 v[52:53], v[52:53], s[94:95], v[34:35] op_sel_hi:[1,0,0] neg_lo:[0,0,1] neg_hi:[0,0,1]
  v_pk_fma_f32 v[54:55], v[54:55], s[94:95], v[34:35] op_sel_hi:[1,0,0] neg_lo:[0,0,1] neg_hi:[0,0,1]
  v_exp_f32 v52, v52
  v_exp_f32 v53, v53
  v_exp_f32 v54, v54
  v_exp_f32 v55, v55
  v_pk_fma_f32 v[20:21], v[20:21], s[94:95], v[34:35] op_sel_hi:[1,0,0] neg_lo:[0,0,1] neg_hi:[0,0,1]
  v_pk_fma_f32 v[22:23], v[22:23], s[94:95], v[34:35] op_sel_hi:[1,0,0] neg_lo:[0,0,1] neg_hi:[0,0,1]
  v_pk_fma_f32 v[24:25], v[24:25], s[94:95], v[34:35] op_sel_hi:[1,0,0] neg_lo:[0,0,1] neg_hi:[0,0,1]
  v_pk_fma_f32 v[26:27], v[26:27], s[94:95], v[34:35] op_sel_hi:[1,0,0] neg_lo:[0,0,1] neg_hi:[0,0,1]
  v_cvt_pk_bf16_f32 v16, v52, v53
  v_cvt_pk_bf16_f32 v17, v54, v55
  v_exp_f32 v20, v20
  v_exp_f32 v21, v21
  v_mfma_f32_16x16x16_bf16 v[60:63], v[30:31], v[16:17], 0
  v_exp_f32 v22, v22
  v_exp_f32 v23, v23
  v_mfma_f32_16x16x16_bf16 v[52:55], v[28:29], v[16:17], 0
  v_exp_f32 v24, v24
  v_exp_f32 v25, v25
  v_mfma_f32_16x16x16_bf16 v[56:59], v[10:11], v[16:17], 0
  v_exp_f32 v26, v26
  v_exp_f32 v27, v27
  v_cvt_pk_bf16_f32 v12, v20, v21
  v_cvt_pk_bf16_f32 v13, v22, v23
  v_cvt_pk_bf16_f32 v14, v24, v25
  v_cvt_pk_bf16_f32 v15, v26, v27
  s_waitcnt lgkmcnt(6)
  s_nop 0
  v_mfma_f32_16x16x32_bf16 v[60:63], v[30:33], v[12:15], v[60:63]
  v_mov_b64 v[20:21], 0
  v_mov_b64 v[22:23], 0
  v_mfma_f32_16x16x32_bf16 v[52:55], v[64:67], v[12:15], v[52:55]
  v_mov_b64 v[24:25], 0
  v_mov_b64 v[26:27], 0
  v_mfma_f32_16x16x32_bf16 v[56:59], v[68:71], v[12:15], v[56:59]
  ds_read_b128 v[64:67], v1 offset:16384
  ds_read_b128 v[68:71], v1 offset:17408
  s_mov_b64 exec, s[88:89]
  v_rcp_f32 v34, v60
  s_nop 0
  v_pk_mul_f32 v[52:53], v[52:53], v[34:35] op_sel_hi:[1,0]
  v_pk_mul_f32 v[54:55], v[54:55], v[34:35] op_sel_hi:[1,0]
  v_cvt_pk_bf16_f32 v12, v52, v53
  v_cvt_pk_bf16_f32 v13, v54, v55
  v_pk_mul_f32 v[56:57], v[56:57], v[34:35] op_sel_hi:[1,0]
  v_pk_mul_f32 v[58:59], v[58:59], v[34:35] op_sel_hi:[1,0]
  v_cvt_pk_bf16_f32 v14, v56, v57
  v_cvt_pk_bf16_f32 v15, v58, v59
  ds_write_b128 v18, v[12:15]
  s_mov_b64 exec, -1
  ds_read_b128 v[52:55], v1 offset:32768
  ds_read_b128 v[56:59], v1 offset:33792
  v_mov_b64 v[60:61], 0
  v_mov_b64 v[62:63], 0
  v_mov_b64 v[28:29], 0
  v_mov_b64 v[30:31], 0
  v_mov_b64 v[32:33], 0
  v_mov_b64 v[34:35], 0
  s_waitcnt lgkmcnt(2)
  s_barrier
  ds_read_b128 v[12:15], v2 offset:28672
  ds_read_b128 v[16:19], v2 offset:29696
  s_cmp_lg_u32 s85, 0
  s_waitcnt lgkmcnt(1)
  v_smfmac_f32_16x16x64_bf16 v[20:23], v[12:15], v[36:43], v0
  ds_read_b128 v[36:39], v1 offset:40960
  ds_read_b128 v[40:43], v1 offset:41984
  v_smfmac_f32_16x16x64_bf16 v[24:27], v[12:15], v[44:51], v0
  s_waitcnt lgkmcnt(2)
  v_smfmac_f32_16x16x64_bf16 v[20:23], v[16:19], v[64:71], v0
  v_smfmac_f32_16x16x64_bf16 v[24:27], v[16:19], v[72:79], v0
  v_smfmac_f32_16x16x64_bf16 v[28:31], v[12:15], v[224:231], v0
  v_smfmac_f32_16x16x64_bf16 v[32:35], v[12:15], v[232:239], v0
  v_permlane32_swap_b32 v20, v24
  v_permlane32_swap_b32 v21, v25
  v_smfmac_f32_16x16x64_bf16 v[28:31], v[16:19], v[240:247], v0
  v_permlane32_swap_b32 v22, v26
  v_permlane32_swap_b32 v23, v27
  v_smfmac_f32_16x16x64_bf16 v[32:35], v[16:19], v[248:255], v0
  v_add_f32 v20, v20, v24
  v_add_f32 v21, v21, v25
  v_smfmac_f32_16x16x64_bf16 v[60:63], v[12:15], v[52:59], v0
  v_add_f32 v22, v22, v26
  v_add_f32 v23, v23, v27
  s_waitcnt lgkmcnt(0)
  v_smfmac_f32_16x16x64_bf16 v[60:63], v[16:19], v[36:43], v0
  v_cvt_pk_bf16_f32 v26, v20, v21
  v_cvt_pk_bf16_f32 v27, v22, v23
  v_permlane32_swap_b32 v28, v32
  v_permlane32_swap_b32 v29, v33
  v_permlane32_swap_b32 v30, v34
  v_permlane32_swap_b32 v31, v35
  v_pk_add_f32 v[28:29], v[28:29], v[32:33]
  v_pk_add_f32 v[30:31], v[30:31], v[34:35]
  v_cvt_pk_bf16_f32 v24, v28, v29
  v_cvt_pk_bf16_f32 v25, v30, v31
  v_permlane32_swap_b32 v60, v62
  v_permlane32_swap_b32 v61, v63
  v_permlane16_swap_b32 v24, v26
  v_permlane16_swap_b32 v25, v27
  v_pk_add_f32 v[60:61], v[60:61], v[62:63]
  s_cbranch_scc1 CB1_ps
  buffer_store_dwordx4 v[24:27], v6, s[36:39], s78 offen
  v_cvt_pk_bf16_f32 v60, v60, v61
  buffer_store_dword v60, v7, s[36:39], s79 offen
CB1_psd:
  s_mov_b32 m0, s86
  s_add_u32 s95, s81, 4096
  buffer_load_dwordx4 v2, s[36:39], s81 offen offset:0 lds
  buffer_load_dwordx4 v2, s[36:39], s81 offen offset:1024 lds
  buffer_load_dwordx4 v2, s[36:39], s81 offen offset:2048 lds
  buffer_load_dwordx4 v2, s[36:39], s81 offen offset:3072 lds
  s_add_u32 m0, s86, 4096
  s_nop 0
  buffer_load_dwordx4 v2, s[36:39], s95 offen offset:0 lds
  buffer_load_dwordx4 v2, s[36:39], s95 offen offset:1024 lds
  buffer_load_dwordx4 v2, s[36:39], s95 offen offset:2048 lds
  buffer_load_dwordx4 v2, s[36:39], s95 offen offset:3072 lds
  s_add_u32 s81, s81, 262144
  s_min_u32 s93, s81, s82
  v_add_u32 v11, 0x10000, v1
  ds_read_b128 v[56:59], v11 offset:49152
  ds_read_b128 v[60:63], v11 offset:50176
  ds_read_b128 v[64:67], v11 offset:57344
  ds_read_b128 v[68:71], v11 offset:58368
  v_mov_b64 v[12:13], 0
  v_mov_b64 v[14:15], 0
  v_mov_b64 v[16:17], 0
  v_mov_b64 v[18:19], 0
  v_mov_b64 v[20:21], 0
  v_mov_b64 v[22:23], 0
  v_mov_b64 v[24:25], 0
  v_mov_b64 v[26:27], 0
  v_mov_b64 v[28:29], 0
  v_mov_b64 v[30:31], 0
  v_mov_b64 v[32:33], 0
  v_mov_b64 v[34:35], 0
  s_add_u32 s95, s73, 2
  s_and_b32 s96, s95, 7
  s_cmp_lg_u32 s96, 0
  s_cbranch_scc1 CB1_nofw
  s_cmp_ge_u32 s95, 64
  s_cbranch_scc1 CB1_nofw
  s_lshl_b32 s95, s95, 4
  s_add_u32 s95, s95, s92
  s_mov_b64 exec, 1
  v_mov_b32 v41, 0
CB1_fw:
  buffer_load_dword v40, v41, s[36:39], s95 offen sc1
  s_add_i32 s56, s56, -1
  s_cmp_lt_i32 s56, 0
  s_waitcnt vmcnt(0)
  v_cmp_gt_u32 vcc, 2, v40
  s_cbranch_scc1 CB1_fw_d
  s_cbranch_vccnz CB1_fw
CB1_fw_d:
  s_mov_b64 exec, -1
CB1_nofw:
  s_mov_b32 s66, s73
  s_add_u32 s78, s78, s70
  s_add_u32 s79, s79, s70
  s_add_u32 s73, s73, 1
  s_sub_u32 s70, 0, s70
  s_add_u32 s74, s74, 10240
  s_add_u32 s83, s83, 65536
  s_branch CB1_top
CB1_fin:
  s_add_u32 s83, s83, 65536
  v_add_u32 v10, s67, v2
  ds_read_b128 v[72:75], v10 offset:21504
  s_waitcnt lgkmcnt(0)
  buffer_store_dwordx4 v[72:75], v2, s[36:39], s83 offen sc1
  s_waitcnt vmcnt(0)
  s_barrier
  s_cmp_eq_u32 s57, 2
  s_cselect_b32 s96, 1, 0
  s_mov_b32 s97, 0
  v_mov_b32 v10, 64
  v_mov_b32 v11, 0
  s_mov_b64 exec, s[96:97]
  buffer_store_dword v10, v11, s[36:39], s69 offen sc1
  s_mov_b64 exec, -1
  s_branch C_end
C_end:
  s_branch L_exit
CA_rr:
  buffer_load_dwordx4 v[72:75], v8, s[36:39], s75 offen sc1
  buffer_load_dwordx4 v[76:79], v8, s[36:39], s75 offen offset:1024 sc1
  buffer_load_dwordx2 v[10:11], v9, s[36:39], s75 offen offset:2048 sc1
  s_add_i32 s56, s56, -1
  s_cmp_lt_i32 s56, 0
  s_waitcnt vmcnt(2)
  v_max3_u32 v37, v72, v73, v74
  s_waitcnt vmcnt(1)
  v_max3_u32 v37, v37, v75, v76
  v_max3_u32 v37, v37, v77, v78
  s_waitcnt vmcnt(0)
  v_max3_u32 v37, v37, v79, v10
  v_max_u32 v37, v37, v11
  v_cmp_eq_u32 vcc, -1, v37
  s_cbranch_scc1 CA_rd
  s_cbranch_vccnz CA_rr
  s_branch CA_rd
CA_f63:
  s_nop 15
  v_permlane32_swap_b32 v28, v32
  v_permlane32_swap_b32 v29, v33
  v_permlane32_swap_b32 v30, v34
  v_permlane32_swap_b32 v31, v35
  v_pk_add_f32 v[28:29], v[28:29], v[32:33]
  v_pk_add_f32 v[30:31], v[30:31], v[34:35]
  v_cvt_pk_bf16_f32 v10, v28, v29
  v_cvt_pk_bf16_f32 v11, v30, v31
  ds_write_b64 v3, v[10:11] offset:5120
  s_waitcnt lgkmcnt(0)
  s_barrier
  s_branch CA_fin
CA_ps:
  buffer_store_dwordx4 v[24:27], v6, s[36:39], s78 offen sc1
  v_cvt_pk_bf16_f32 v60, v60, v61
  buffer_store_dword v60, v7, s[36:39], s79 offen sc1
  s_branch CA_psd
CA_rs:
  buffer_store_dwordx4 v[72:75], v2, s[36:39], s77 offen sc1
  buffer_store_dwordx4 v[72:75], v2, s[36:39], s76 offen sc1
  s_mov_b64 exec, -1
  buffer_store_dwordx4 v[76:79], v2, s[36:39], s80 offen offset:0 sc1
  buffer_store_dwordx4 v[76:79], v2, s[36:39], s80 offen offset:1024 sc1
  buffer_store_dwordx4 v[76:79], v2, s[36:39], s80 offen offset:2048 sc1
  buffer_store_dwordx4 v[76:79], v2, s[36:39], s80 offen offset:3072 sc1
  s_branch CA_upd
CA_nored:
  v_add_u32 v11, 0x10000, v1
  ds_read_b128 v[56:59], v11 offset:49152
  ds_read_b128 v[60:63], v11 offset:50176
  ds_read_b128 v[64:67], v11 offset:57344
  ds_read_b128 v[68:71], v11 offset:58368
  v_mov_b64 v[12:13], 0
  v_mov_b64 v[14:15], 0
  v_mov_b64 v[16:17], 0
  v_mov_b64 v[18:19], 0
  v_mov_b64 v[20:21], 0
  v_mov_b64 v[22:23], 0
  v_mov_b64 v[24:25], 0
  v_mov_b64 v[26:27], 0
  v_mov_b64 v[28:29], 0
  v_mov_b64 v[30:31], 0
  v_mov_b64 v[32:33], 0
  v_mov_b64 v[34:35], 0
  s_branch CA_upd
CB0_f63:
  s_nop 15
  v_permlane32_swap_b32 v28, v32
  v_permlane32_swap_b32 v29, v33
  v_permlane32_swap_b32 v30, v34
  v_permlane32_swap_b32 v31, v35
  v_pk_add_f32 v[28:29], v[28:29], v[32:33]
  v_pk_add_f32 v[30:31], v[30:31], v[34:35]
  v_cvt_pk_bf16_f32 v10, v28, v29
  v_cvt_pk_bf16_f32 v11, v30, v31
  ds_write_b64 v3, v[10:11] offset:5120
  s_waitcnt lgkmcnt(0)
  s_barrier
  s_branch CB0_fin
CB0_ps:
  buffer_store_dwordx4 v[24:27], v6, s[36:39], s78 offen sc1
  v_cvt_pk_bf16_f32 v60, v60, v61
  buffer_store_dword v60, v7, s[36:39], s79 offen sc1
  s_branch CB0_psd
CB1_f63:
  s_nop 15
  v_permlane32_swap_b32 v28, v32
  v_permlane32_swap_b32 v29, v33
  v_permlane32_swap_b32 v30, v34
  v_permlane32_swap_b32 v31, v35
  v_pk_add_f32 v[28:29], v[28:29], v[32:33]
  v_pk_add_f32 v[30:31], v[30:31], v[34:35]
  v_cvt_pk_bf16_f32 v10, v28, v29
  v_cvt_pk_bf16_f32 v11, v30, v31
  ds_write_b64 v3, v[10:11] offset:5120
  s_waitcnt lgkmcnt(0)
  s_barrier
  s_branch CB1_fin
CB1_ps:
  buffer_store_dwordx4 v[24:27], v6, s[36:39], s78 offen sc1
  v_cvt_pk_bf16_f32 v60, v60, v61
  buffer_store_dword v60, v7, s[36:39], s79 offen sc1
  s_branch CB1_psd
L_exit:
  s_endpgm
.section .rodata,"a"
.p2align 6
.amdhsa_kernel concat_heads__softmax_full_mha__memory_aug_recurrent_mem_tr__prompt_kernel
  .amdhsa_next_free_vgpr 512
  .amdhsa_next_free_sgpr 102
  .amdhsa_accum_offset 256
  .amdhsa_group_segment_fixed_size 0
  .amdhsa_kernarg_size 104
  .amdhsa_user_sgpr_count 2
  .amdhsa_user_sgpr_kernarg_segment_ptr 1
  .amdhsa_system_sgpr_workgroup_id_x 1
.end_amdhsa_kernel
```
